```python
import torch

def _softmax(x, axis=-1):
    return torch.softmax(x, dim=axis)
def _gelu(x):
    return torch.nn.functional.gelu(x, approximate="tanh")
def _silu(x):
    return torch.nn.functional.silu(x)
def _sigmoid(x):
    return torch.sigmoid(x)
def _layernorm(x, axis=-1, eps=1e-5):
    m = x.mean(dim=axis, keepdim=True)
    v = x.var(dim=axis, keepdim=True, unbiased=False)
    return (x - m) / torch.sqrt(v + eps)
def _scatter_add(tgt, idx, src, axis=0):
    return tgt.clone().index_add_(axis, idx, src)
def _segment_sum(src, seg, n):
    out = torch.zeros((n,) + src.shape[1:], dtype=src.dtype)
    return out.index_add_(0, seg, src)
def _pad(x, pw):
    flat = tuple(v for pair in reversed(pw) for v in pair)
    return torch.nn.functional.pad(x, flat)

kernel_name = 'concat_heads__compressed_kv_cla__sliding_block__prompt'

def setup_inputs():

    _w = (lambda a: (lambda t: t.to(torch.bfloat16) if t.is_floating_point() else t)(torch.as_tensor(a)))
    def _A_setup():
        B, H, Sq, Sk, D, M = 1, 32, 2048, 2048, 128, 512
        Dc = 4 * D
        return {
            "x": _w((lambda *s: torch.randn(*s, dtype=torch.bfloat16) * 0.2)(B, Sq, M)),
            "c_kv": _w((lambda *s: torch.randn(*s, dtype=torch.bfloat16) * 1.6)(B, Sk, Dc)),
            "w_q": _w((lambda *s: torch.randn(*s, dtype=torch.bfloat16) * 3.2)(M, H, D) * (M ** -0.5)),
            "w_uk": _w((lambda *s: torch.randn(*s, dtype=torch.bfloat16) * 3.2)(Dc, H, D) * (Dc ** -0.5)),
            "w_uv": _w((lambda *s: torch.randn(*s, dtype=torch.bfloat16) * 1.6)(Dc, H, D) * (Dc ** -0.5)),
            "w_o": _w((lambda *s: torch.randn(*s, dtype=torch.bfloat16) * 1.6)(H, D, M) * ((H * D) ** -0.5)),
        }
    _A_in = _A_setup()

    def _B_setup():
        B, S, D = 1, 2048, 512
        return {
            "x": _w((lambda *s: torch.randn(*s, dtype=torch.bfloat16) * 0.4)(B, S, D)),
            "wqkv": _w((lambda *s: torch.randn(*s, dtype=torch.bfloat16) * 0.4)(D, 3 * D)),
            "wo": _w((lambda *s: torch.randn(*s, dtype=torch.bfloat16) * 0.05)(D, D)),
        }
    _B_in = _B_setup()

    return {
        "A_x": _A_in["x"],
        "A_c_kv": _A_in["c_kv"],
        "A_w_q": _A_in["w_q"],
        "A_w_uk": _A_in["w_uk"],
        "A_w_uv": _A_in["w_uv"],
        "A_w_o": _A_in["w_o"],
        "B_x": _B_in["x"],
        "B_wqkv": _B_in["wqkv"],
        "B_wo": _B_in["wo"],
    }

def reference(A_x, A_c_kv, A_w_q, A_w_uk, A_w_uv, A_w_o, B_x, B_wqkv, B_wo):
    def _A_ref(x, c_kv, w_q, w_uk, w_uv, w_o):
        B, Sq, M = x.shape[0], x.shape[1], x.shape[2]
        Sk = c_kv.shape[1]
        H, D = w_q.shape[1], w_q.shape[2]
        q = torch.einsum("bqm,mhd->bhqd", x, w_q)
        k = torch.einsum("bkc,chd->bhkd", c_kv, w_uk)
        v = torch.einsum("bkc,chd->bhkd", c_kv, w_uv)
        scores = torch.einsum("bhqd,bhkd->bhqk", q, k) * (D ** -0.5)
        off = Sk - Sq
        qi = torch.arange(Sq)[:, None]
        kj = torch.arange(Sk)[None, :]
        cmask = kj <= (qi + off)
        scores = torch.where(cmask[None, None], scores, -1e9)
        p = _softmax(scores, axis=-1)
        ctx = torch.einsum("bhqk,bhkd->bhqd", p, v)
        return torch.einsum("bhqd,hdm->bqm", ctx, w_o)

    def _B_ref(x, wqkv, wo):
        B, S, D = x.shape
        H = 32; Dh = D // H; W = 256
        qkv = (lambda x, *d: x.permute(*d))((x @ wqkv).reshape(B, S, 3, H, Dh), 2, 0, 3, 1, 4)
        q, k, v = qkv[0], qkv[1], qkv[2]
        scores = torch.einsum("bhqd,bhkd->bhqk", q, k) * (Dh ** -0.5)
        idx = torch.arange(S)
        mask = (idx[:, None] - idx[None, :] >= 0) & (idx[:, None] - idx[None, :] < W)
        scores = torch.where(mask[None, None], scores, -1e9)
        p = _softmax(scores, axis=-1)
        o = torch.einsum("bhqk,bhkd->bhqd", p, v)
        return (lambda x, *d: x.permute(*d))(o, 0, 2, 1, 3).reshape(B, S, D) @ wo

    a = _A_ref(A_x, A_c_kv, A_w_q, A_w_uk, A_w_uv, A_w_o)
    b = _B_ref(B_x, B_wqkv, B_wo)
    return torch.concatenate([a, b], axis=-1)
```

```asm
; @launch grid=(256,1,1) block=(512,1,1) lds=163840
.amdgcn_target "amdgcn-amd-amdhsa--gfx950"
.text
.globl concat_heads__compressed_kv_cla__sliding_block__prompt_kernel
.p2align 8
.type concat_heads__compressed_kv_cla__sliding_block__prompt_kernel,@function
concat_heads__compressed_kv_cla__sliding_block__prompt_kernel:
    s_cmp_ge_u32 s2, 256
    s_cbranch_scc1 m_end
    s_load_dwordx16 s[4:19], s[0:1], 0
    s_load_dwordx8 s[20:27], s[0:1], 64
    s_memrealtime s[64:65]
    v_lshrrev_b32 v1, 6, v0
    v_and_b32 v0, 63, v0
    v_readfirstlane_b32 s48, v1
    s_getpc_b64 s[68:69]
m_pc0:
    s_sub_u32 s68, s68, m_pc0-concat_heads__compressed_kv_cla__sliding_block__prompt_kernel
    s_subb_u32 s69, s69, 0
    s_and_b32 s52, s2, 0xf8
    s_add_u32 s52, s52, s48
    s_lshl_b32 s70, s52, 7
    s_and_b32 s49, s2, 7
    s_lshl_b32 s49, s49, 2
    s_bfe_u32 s52, s2, 0x20003
    s_add_u32 s49, s49, s52
    s_lshr_b32 s50, s2, 5
    s_sub_u32 s55, 15, s50
    s_and_b32 s54, s48, 3
    s_lshl_b32 s51, s54, 10
    s_lshl_b32 s56, s54, 12
    s_bfe_u32 s98, s2, 0x10002
    s_lshl_b32 s98, s98, 3
    s_add_u32 s98, s98, s50
    s_and_b32 s99, s2, 3
    s_lshl_b32 s99, s99, 2
    s_bfe_u32 s52, s2, 0x20003
    s_add_u32 s99, s99, s52
    v_lshlrev_b32 v1, 4, v0
    v_lshrrev_b32 v11, 4, v0
    s_and_b32 s52, s48, 1
    s_lshl_b32 s52, s52, 2
    v_add_u32 v7, s52, v11
    v_and_b32 v8, 7, v0
    v_xor_b32 v7, v7, v8
    v_lshlrev_b32 v7, 4, v7
    v_lshrrev_b32 v8, 3, v0
    v_lshl_add_u32 v7, v8, 10, v7
    s_lshl_b32 s52, s54, 13
    v_add_u32 v2, s52, v7
    v_and_b32 v8, 15, v0
    s_bfe_u32 s52, s48, 0x10001
    s_lshl_b32 s52, s52, 2
    v_or_b32 v7, s52, v11
    v_lshlrev_b32 v7, 1, v7
    v_xor_b32 v7, v7, v8
    v_lshlrev_b32 v7, 4, v7
    s_lshl_b32 s52, s54, 2
    v_add_u32 v9, s52, v11
    v_lshl_add_u32 v7, v9, 13, v7
    s_lshl_b32 s52, s49, 8
    v_add_u32 v3, s52, v7
    s_lshl_b32 s58, s50, 18
    s_lshl_b32 s57, s99, 17
    s_bfe_u32 s3, s2, 0x20003
    s_lshl_b32 s3, s3, 1
    s_add_u32 s3, s3, s50
    s_lshl_b32 s3, s3, 7
    s_waitcnt lgkmcnt(0)
    s_min_u32 s53, s70, m_code_end-concat_heads__compressed_kv_cla__sliding_block__prompt_kernel-4
    s_load_dword s96, s[68:69], s53
    s_add_u32 s70, s70, 32768
    s_min_u32 s53, s70, m_code_end-concat_heads__compressed_kv_cla__sliding_block__prompt_kernel-4
    s_load_dword s96, s[68:69], s53
    s_add_u32 s70, s70, 32768
    s_min_u32 s53, s70, m_code_end-concat_heads__compressed_kv_cla__sliding_block__prompt_kernel-4
    s_load_dword s96, s[68:69], s53
    s_mov_b32 s36, s6
    s_mov_b32 s37, s7
    s_mov_b32 s38, 0x200000
    s_mov_b32 s39, 0x20000
    s_mov_b32 s40, s10
    s_mov_b32 s41, s11
    s_mov_b32 s42, 0x400000
    s_mov_b32 s43, 0x20000
    s_mov_b32 s32, s12
    s_mov_b32 s33, s13
    s_mov_b32 s34, 0x400000
    s_mov_b32 s35, 0x20000
    s_lshr_b32 s52, s48, 2
    s_lshl_b32 s70, s52, 12
    s_add_u32 s70, s70, s51
    s_lshl_b32 s71, s52, 15
    s_add_u32 s71, s71, s58
    s_lshl_b32 s52, s52, 17
    s_add_u32 m0, s70, 98304
    s_add_u32 s53, s52, 0
    buffer_load_dwordx4 v3, s[40:43], s53 offen lds
    s_add_u32 m0, s70, 106496
    s_add_u32 s53, s52, 0
    buffer_load_dwordx4 v3, s[32:35], s53 offen lds
    s_add_u32 m0, s70, 114688
    s_add_u32 s53, s52, 262144
    buffer_load_dwordx4 v3, s[40:43], s53 offen lds
    s_add_u32 m0, s70, 122880
    s_add_u32 s53, s52, 262144
    buffer_load_dwordx4 v3, s[32:35], s53 offen lds
    s_add_u32 m0, s70, 0
    s_add_u32 s53, s71, 0
    buffer_load_dwordx4 v2, s[36:39], s53 offen lds
    s_add_u32 m0, s70, 8192
    s_add_u32 s53, s71, 65536
    buffer_load_dwordx4 v2, s[36:39], s53 offen lds
    s_add_u32 m0, s70, 16384
    s_add_u32 s53, s71, 131072
    buffer_load_dwordx4 v2, s[36:39], s53 offen lds
    s_add_u32 m0, s70, 24576
    s_add_u32 s53, s71, 196608
    buffer_load_dwordx4 v2, s[36:39], s53 offen lds
    s_add_u32 m0, s70, 131072
    s_add_u32 s53, s52, 524288
    buffer_load_dwordx4 v3, s[40:43], s53 offen lds
    s_add_u32 m0, s70, 139264
    s_add_u32 s53, s52, 524288
    buffer_load_dwordx4 v3, s[32:35], s53 offen lds
    s_add_u32 m0, s70, 147456
    s_add_u32 s53, s52, 786432
    buffer_load_dwordx4 v3, s[40:43], s53 offen lds
    s_add_u32 m0, s70, 155648
    s_add_u32 s53, s52, 786432
    buffer_load_dwordx4 v3, s[32:35], s53 offen lds
    s_cmp_lt_u32 s48, 4
    s_cbranch_scc1 m_front_c
    s_setprio 1
    s_lshr_b32 s52, s2, 3
    s_lshl_b32 s52, s52, 3
    s_add_u32 s52, s52, s48
    s_and_b32 s52, s52, 63
    s_min_u32 s53, s52, 34
    s_lshl_b32 s53, s53, 21
    s_add_u32 s68, s26, s53
    s_addc_u32 s69, s27, 0
    s_mov_b32 s53, 0
    s_cmp_eq_u32 s52, 40
    s_cselect_b64 s[68:69], s[4:5], s[68:69]
    s_cmp_eq_u32 s52, 41
    s_cselect_b64 s[68:69], s[4:5], s[68:69]
    s_cselect_b32 s53, 2097088, s53
    s_cmp_eq_u32 s52, 42
    s_cselect_b64 s[68:69], s[6:7], s[68:69]
    s_cmp_eq_u32 s52, 43
    s_cselect_b64 s[68:69], s[6:7], s[68:69]
    s_cselect_b32 s53, 2097088, s53
    s_cmp_eq_u32 s52, 44
    s_cselect_b64 s[68:69], s[8:9], s[68:69]
    s_cmp_eq_u32 s52, 45
    s_cselect_b64 s[68:69], s[8:9], s[68:69]
    s_cselect_b32 s53, 4194240, s53
    s_cmp_eq_u32 s52, 46
    s_cselect_b64 s[68:69], s[10:11], s[68:69]
    s_cmp_eq_u32 s52, 47
    s_cselect_b64 s[68:69], s[10:11], s[68:69]
    s_cselect_b32 s53, 4194240, s53
    s_cmp_eq_u32 s52, 48
    s_cselect_b64 s[68:69], s[12:13], s[68:69]
    s_cmp_eq_u32 s52, 49
    s_cselect_b64 s[68:69], s[12:13], s[68:69]
    s_cselect_b32 s53, 4194240, s53
    s_cmp_eq_u32 s52, 50
    s_cselect_b64 s[68:69], s[14:15], s[68:69]
    s_cmp_eq_u32 s52, 51
    s_cselect_b64 s[68:69], s[14:15], s[68:69]
    s_cselect_b32 s53, 4194240, s53
    s_cmp_eq_u32 s52, 52
    s_cselect_b64 s[68:69], s[16:17], s[68:69]
    s_cmp_eq_u32 s52, 53
    s_cselect_b64 s[68:69], s[16:17], s[68:69]
    s_cselect_b32 s53, 2097088, s53
    s_cmp_eq_u32 s52, 54
    s_cselect_b64 s[68:69], s[18:19], s[68:69]
    s_cmp_eq_u32 s52, 55
    s_cselect_b64 s[68:69], s[18:19], s[68:69]
    s_cselect_b32 s53, 1572800, s53
    s_cmp_eq_u32 s52, 56
    s_cselect_b64 s[68:69], s[20:21], s[68:69]
    s_cmp_eq_u32 s52, 57
    s_cselect_b64 s[68:69], s[20:21], s[68:69]
    s_cselect_b32 s53, 524224, s53
    s_cmp_eq_u32 s52, 58
    s_cselect_b64 s[68:69], s[22:23], s[68:69]
    s_cmp_eq_u32 s52, 59
    s_cselect_b64 s[68:69], s[22:23], s[68:69]
    s_cselect_b32 s53, 4194240, s53
    s_load_dword s97, s[68:69], s53
    s_mov_b32 s44, s26
    s_mov_b32 s45, s27
    s_mov_b32 s46, 0x4600000
    s_mov_b32 s47, 0x20000
    s_mov_b32 s28, s16
    s_mov_b32 s29, s17
    s_mov_b32 s30, 0x200000
    s_mov_b32 s31, 0x20000
    s_mov_b64 s[22:23], s[14:15]
    s_mov_b32 s12, s18
    s_mov_b32 s13, s19
    s_mov_b32 s14, 0x180000
    s_mov_b32 s15, 0x20000
    v_lshrrev_b32 v7, 5, v0
    v_lshlrev_b32 v7, 1, v7
    v_and_b32 v9, 3, v0
    v_xor_b32 v7, v7, v9
    v_lshlrev_b32 v7, 4, v7
    v_lshrrev_b32 v9, 2, v0
    s_lshl_b32 s52, s54, 4
    v_add_u32 v9, s52, v9
    v_mul_u32_u24 v9, 3072, v9
    s_lshl_b32 s52, s98, 6
    v_add3_u32 v4, v7, v9, s52
    v_lshlrev_b32 v9, 2, v11
    v_sub_u32 v5, v8, v9
    v_lshrrev_b32 v9, 1, v8
    v_xor_b32 v9, v9, v11
    v_lshlrev_b32 v9, 4, v9
    v_lshl_add_u32 v26, v8, 7, v9
    v_lshrrev_b32 v7, 2, v8
    v_lshl_add_u32 v10, v11, 3, v7
    s_add_u32 s52, s56, 98304
    v_add_u32 v12, s52, v26
    v_xor_b32 v13, 64, v12
    v_and_b32 v28, 1, v11
    v_xor_b32 v29, 1, v28
    v_lshlrev_b32 v29, 5, v29
    v_and_b32 v30, 3, v0
    v_lshlrev_b32 v30, 3, v30
    v_lshl_add_u32 v29, v10, 6, v29
    v_add_u32 v14, v29, v30
    v_add_u32 v15, 0x10000, v14
    v_lshl_or_b32 v28, v28, 2, v7
    v_lshl_add_u32 v31, v10, 8, v30
    s_lshl_b32 s52, s54, 1
    v_xor_b32 v29, s52, v28
    v_lshl_add_u32 v29, v29, 5, v31
    v_add_u32 v20, 98304, v29
    v_xor_b32 v21, 32, v20
    v_lshl_add_u32 v27, v28, 5, v31
    v_add_u32 v16, 16384, v26
    v_xor_b32 v17, 64, v16
    v_add_u32 v18, 0x10000, v16
    v_add_u32 v19, 0x10000, v17
    s_waitcnt vmcnt(4)
    s_barrier
    ds_read_b64_tr_b16 v[64:65], v20 offset:0
    ds_read_b64_tr_b16 v[66:67], v20 offset:1024
    ds_read_b64_tr_b16 v[68:69], v20 offset:16384
    ds_read_b64_tr_b16 v[70:71], v20 offset:17408
    ds_read_b64_tr_b16 v[72:73], v21 offset:0
    ds_read_b64_tr_b16 v[74:75], v21 offset:1024
    ds_read_b64_tr_b16 v[76:77], v21 offset:16384
    ds_read_b64_tr_b16 v[78:79], v21 offset:17408
    ds_read_b64_tr_b16 v[80:81], v20 offset:8192
    ds_read_b64_tr_b16 v[82:83], v20 offset:9216
    ds_read_b64_tr_b16 v[84:85], v20 offset:24576
    ds_read_b64_tr_b16 v[86:87], v20 offset:25600
    ds_read_b64_tr_b16 v[88:89], v21 offset:8192
    ds_read_b64_tr_b16 v[90:91], v21 offset:9216
    ds_read_b64_tr_b16 v[92:93], v21 offset:24576
    ds_read_b64_tr_b16 v[94:95], v21 offset:25600
    ds_read_b128 v[32:35], v16 offset:0
    ds_read_b128 v[36:39], v17 offset:0
    ds_read_b128 v[40:43], v16 offset:2048
    ds_read_b128 v[44:47], v17 offset:2048
    ds_read_b128 v[48:51], v16 offset:4096
    ds_read_b128 v[52:55], v17 offset:4096
    ds_read_b128 v[56:59], v16 offset:6144
    ds_read_b128 v[60:63], v17 offset:6144
    s_add_u32 m0, s51, 36864
    s_add_u32 s53, s58, 32896
    buffer_load_dwordx4 v2, s[36:39], s53 offen lds
    s_add_u32 m0, s51, 45056
    s_add_u32 s53, s58, 98432
    buffer_load_dwordx4 v2, s[36:39], s53 offen lds
    s_add_u32 m0, s51, 53248
    s_add_u32 s53, s58, 163968
    buffer_load_dwordx4 v2, s[36:39], s53 offen lds
    s_add_u32 m0, s51, 61440
    s_add_u32 s53, s58, 229504
    buffer_load_dwordx4 v2, s[36:39], s53 offen lds
    s_add_u32 m0, s51, 69632
    s_add_u32 s53, s58, 33024
    buffer_load_dwordx4 v2, s[36:39], s53 offen lds
    s_add_u32 m0, s51, 77824
    s_add_u32 s53, s58, 98560
    buffer_load_dwordx4 v2, s[36:39], s53 offen lds
    s_add_u32 m0, s51, 86016
    s_add_u32 s53, s58, 164096
    buffer_load_dwordx4 v2, s[36:39], s53 offen lds
    s_add_u32 m0, s51, 94208
    s_add_u32 s53, s58, 229632
    buffer_load_dwordx4 v2, s[36:39], s53 offen lds
    s_waitcnt lgkmcnt(6)
    v_mfma_f32_16x16x32_bf16 v[128:131], v[64:67], v[32:35], 0
    v_mfma_f32_16x16x32_bf16 v[128:131], v[68:71], v[36:39], v[128:131]
    s_waitcnt vmcnt(8)
    s_barrier
    v_mfma_f32_16x16x32_bf16 v[132:135], v[72:75], v[32:35], 0
    ds_read_b64_tr_b16 v[96:97], v20 offset:32768
    v_mfma_f32_16x16x32_bf16 v[132:135], v[76:79], v[36:39], v[132:135]
    ds_read_b64_tr_b16 v[98:99], v20 offset:33792
    v_mfma_f32_16x16x32_bf16 v[136:139], v[32:35], v[80:83], 0
    ds_read_b64_tr_b16 v[100:101], v20 offset:49152
    v_mfma_f32_16x16x32_bf16 v[136:139], v[36:39], v[84:87], v[136:139]
    ds_read_b64_tr_b16 v[102:103], v20 offset:50176
    v_mfma_f32_16x16x32_bf16 v[140:143], v[32:35], v[88:91], 0
    s_add_u32 m0, s51, 98304
    s_mov_b32 s53, 1048576
    buffer_load_dwordx4 v3, s[40:43], s53 offen lds
    v_mfma_f32_16x16x32_bf16 v[140:143], v[36:39], v[92:95], v[140:143]
    ds_read_b128 v[32:35], v16 offset:8192
    ds_read_b128 v[36:39], v17 offset:8192
    s_waitcnt lgkmcnt(10)
    v_mfma_f32_16x16x32_bf16 v[144:147], v[64:67], v[40:43], 0
    s_add_u32 m0, s51, 102400
    s_mov_b32 s53, 1179648
    buffer_load_dwordx4 v3, s[40:43], s53 offen lds
    v_mfma_f32_16x16x32_bf16 v[144:147], v[68:71], v[44:47], v[144:147]
    s_add_u32 m0, s51, 106496
    s_mov_b32 s53, 1048576
    buffer_load_dwordx4 v3, s[32:35], s53 offen lds
    v_mfma_f32_16x16x32_bf16 v[148:151], v[72:75], v[40:43], 0
    ds_read_b64_tr_b16 v[104:105], v21 offset:32768
    v_mfma_f32_16x16x32_bf16 v[148:151], v[76:79], v[44:47], v[148:151]
    ds_read_b64_tr_b16 v[106:107], v21 offset:33792
    v_mfma_f32_16x16x32_bf16 v[152:155], v[40:43], v[80:83], 0
    ds_read_b64_tr_b16 v[108:109], v21 offset:49152
    v_mfma_f32_16x16x32_bf16 v[152:155], v[44:47], v[84:87], v[152:155]
    ds_read_b64_tr_b16 v[110:111], v21 offset:50176
    v_mfma_f32_16x16x32_bf16 v[156:159], v[40:43], v[88:91], 0
    s_add_u32 m0, s51, 110592
    s_mov_b32 s53, 1179648
    buffer_load_dwordx4 v3, s[32:35], s53 offen lds
    v_mfma_f32_16x16x32_bf16 v[156:159], v[44:47], v[92:95], v[156:159]
    ds_read_b128 v[40:43], v16 offset:10240
    ds_read_b128 v[44:47], v17 offset:10240
    s_waitcnt lgkmcnt(14)
    v_mfma_f32_16x16x32_bf16 v[160:163], v[64:67], v[48:51], 0
    v_mfma_f32_16x16x32_bf16 v[160:163], v[68:71], v[52:55], v[160:163]
    s_add_u32 m0, s51, 114688
    s_mov_b32 s53, 1310720
    buffer_load_dwordx4 v3, s[40:43], s53 offen lds
    v_mfma_f32_16x16x32_bf16 v[164:167], v[72:75], v[48:51], 0
    ds_read_b64_tr_b16 v[112:113], v20 offset:40960
    v_mfma_f32_16x16x32_bf16 v[164:167], v[76:79], v[52:55], v[164:167]
    ds_read_b64_tr_b16 v[114:115], v20 offset:41984
    v_mfma_f32_16x16x32_bf16 v[168:171], v[48:51], v[80:83], 0
    ds_read_b64_tr_b16 v[116:117], v20 offset:57344
    v_mfma_f32_16x16x32_bf16 v[168:171], v[52:55], v[84:87], v[168:171]
    ds_read_b64_tr_b16 v[118:119], v20 offset:58368
    v_mfma_f32_16x16x32_bf16 v[172:175], v[48:51], v[88:91], 0
    s_add_u32 m0, s51, 118784
    s_mov_b32 s53, 1441792
    buffer_load_dwordx4 v3, s[40:43], s53 offen lds
    v_mfma_f32_16x16x32_bf16 v[172:175], v[52:55], v[92:95], v[172:175]
    ds_read_b128 v[48:51], v16 offset:12288
    ds_read_b128 v[52:55], v17 offset:12288
    s_waitcnt lgkmcnt(15)
    v_mfma_f32_16x16x32_bf16 v[176:179], v[64:67], v[56:59], 0
    s_add_u32 m0, s51, 122880
    s_mov_b32 s53, 1310720
    buffer_load_dwordx4 v3, s[32:35], s53 offen lds
    v_mfma_f32_16x16x32_bf16 v[176:179], v[68:71], v[60:63], v[176:179]
    s_add_u32 m0, s51, 126976
    s_mov_b32 s53, 1441792
    buffer_load_dwordx4 v3, s[32:35], s53 offen lds
    v_mfma_f32_16x16x32_bf16 v[180:183], v[72:75], v[56:59], 0
    ds_read_b64_tr_b16 v[120:121], v21 offset:40960
    v_mfma_f32_16x16x32_bf16 v[180:183], v[76:79], v[60:63], v[180:183]
    ds_read_b64_tr_b16 v[122:123], v21 offset:41984
    v_mfma_f32_16x16x32_bf16 v[184:187], v[56:59], v[80:83], 0
    ds_read_b64_tr_b16 v[124:125], v21 offset:57344
    v_mfma_f32_16x16x32_bf16 v[184:187], v[60:63], v[84:87], v[184:187]
    ds_read_b64_tr_b16 v[126:127], v21 offset:58368
    v_mfma_f32_16x16x32_bf16 v[188:191], v[56:59], v[88:91], 0
    v_mfma_f32_16x16x32_bf16 v[188:191], v[60:63], v[92:95], v[188:191]
    ds_read_b128 v[56:59], v16 offset:14336
    ds_read_b128 v[60:63], v17 offset:14336
    s_waitcnt lgkmcnt(15)
    v_mfma_f32_16x16x32_bf16 v[192:195], v[64:67], v[32:35], 0
    v_mfma_f32_16x16x32_bf16 v[192:195], v[68:71], v[36:39], v[192:195]
    v_mfma_f32_16x16x32_bf16 v[196:199], v[72:75], v[32:35], 0
    v_mfma_f32_16x16x32_bf16 v[196:199], v[76:79], v[36:39], v[196:199]
    v_mfma_f32_16x16x32_bf16 v[200:203], v[32:35], v[80:83], 0
    v_mfma_f32_16x16x32_bf16 v[200:203], v[36:39], v[84:87], v[200:203]
    v_mfma_f32_16x16x32_bf16 v[204:207], v[32:35], v[88:91], 0
    s_waitcnt lgkmcnt(0)
    s_waitcnt vmcnt(12)
    s_barrier
    v_mfma_f32_16x16x32_bf16 v[204:207], v[36:39], v[92:95], v[204:207]
    ds_read_b128 v[32:35], v16 offset:32768
    ds_read_b128 v[36:39], v17 offset:32768
    v_mfma_f32_16x16x32_bf16 v[208:211], v[64:67], v[40:43], 0
    s_add_u32 m0, s51, 131072
    s_mov_b32 s53, 1572864
    buffer_load_dwordx4 v3, s[40:43], s53 offen lds
    v_mfma_f32_16x16x32_bf16 v[208:211], v[68:71], v[44:47], v[208:211]
    v_mfma_f32_16x16x32_bf16 v[212:215], v[72:75], v[40:43], 0
    v_mfma_f32_16x16x32_bf16 v[212:215], v[76:79], v[44:47], v[212:215]
    s_add_u32 m0, s51, 135168
    s_mov_b32 s53, 1703936
    buffer_load_dwordx4 v3, s[40:43], s53 offen lds
    v_mfma_f32_16x16x32_bf16 v[216:219], v[40:43], v[80:83], 0
    v_mfma_f32_16x16x32_bf16 v[216:219], v[44:47], v[84:87], v[216:219]
    v_mfma_f32_16x16x32_bf16 v[220:223], v[40:43], v[88:91], 0
    v_mfma_f32_16x16x32_bf16 v[220:223], v[44:47], v[92:95], v[220:223]
    ds_read_b128 v[40:43], v16 offset:34816
    ds_read_b128 v[44:47], v17 offset:34816
    v_mfma_f32_16x16x32_bf16 v[224:227], v[64:67], v[48:51], 0
    s_add_u32 m0, s51, 139264
    s_mov_b32 s53, 1572864
    buffer_load_dwordx4 v3, s[32:35], s53 offen lds
    v_mfma_f32_16x16x32_bf16 v[224:227], v[68:71], v[52:55], v[224:227]
    v_mfma_f32_16x16x32_bf16 v[228:231], v[72:75], v[48:51], 0
    v_mfma_f32_16x16x32_bf16 v[228:231], v[76:79], v[52:55], v[228:231]
    s_add_u32 m0, s51, 143360
    s_mov_b32 s53, 1703936
    buffer_load_dwordx4 v3, s[32:35], s53 offen lds
    v_mfma_f32_16x16x32_bf16 v[232:235], v[48:51], v[80:83], 0
    v_mfma_f32_16x16x32_bf16 v[232:235], v[52:55], v[84:87], v[232:235]
    v_mfma_f32_16x16x32_bf16 v[236:239], v[48:51], v[88:91], 0
    v_mfma_f32_16x16x32_bf16 v[236:239], v[52:55], v[92:95], v[236:239]
    ds_read_b128 v[48:51], v16 offset:36864
    ds_read_b128 v[52:55], v17 offset:36864
    v_mfma_f32_16x16x32_bf16 v[240:243], v[64:67], v[56:59], 0
    s_add_u32 m0, s51, 147456
    s_mov_b32 s53, 1835008
    buffer_load_dwordx4 v3, s[40:43], s53 offen lds
    v_mfma_f32_16x16x32_bf16 v[240:243], v[68:71], v[60:63], v[240:243]
    v_mfma_f32_16x16x32_bf16 v[244:247], v[72:75], v[56:59], 0
    v_mfma_f32_16x16x32_bf16 v[244:247], v[76:79], v[60:63], v[244:247]
    s_add_u32 m0, s51, 151552
    s_mov_b32 s53, 1966080
    buffer_load_dwordx4 v3, s[40:43], s53 offen lds
    v_mfma_f32_16x16x32_bf16 v[248:251], v[56:59], v[80:83], 0
    v_mfma_f32_16x16x32_bf16 v[248:251], v[60:63], v[84:87], v[248:251]
    v_mfma_f32_16x16x32_bf16 v[252:255], v[56:59], v[88:91], 0
    v_mfma_f32_16x16x32_bf16 v[252:255], v[60:63], v[92:95], v[252:255]
    ds_read_b128 v[56:59], v16 offset:38912
    ds_read_b128 v[60:63], v17 offset:38912
    s_waitcnt lgkmcnt(6)
    v_mfma_f32_16x16x32_bf16 v[128:131], v[96:99], v[32:35], v[128:131]
    v_mfma_f32_16x16x32_bf16 v[128:131], v[100:103], v[36:39], v[128:131]
    s_waitcnt vmcnt(6)
    s_barrier
    v_mfma_f32_16x16x32_bf16 v[132:135], v[104:107], v[32:35], v[132:135]
    ds_read_b64_tr_b16 v[64:65], v20 offset:0
    v_mfma_f32_16x16x32_bf16 v[132:135], v[108:111], v[36:39], v[132:135]
    ds_read_b64_tr_b16 v[66:67], v20 offset:1024
    v_mfma_f32_16x16x32_bf16 v[136:139], v[32:35], v[112:115], v[136:139]
    ds_read_b64_tr_b16 v[68:69], v20 offset:16384
    v_mfma_f32_16x16x32_bf16 v[136:139], v[36:39], v[116:119], v[136:139]
    ds_read_b64_tr_b16 v[70:71], v20 offset:17408
    v_mfma_f32_16x16x32_bf16 v[140:143], v[32:35], v[120:123], v[140:143]
    s_add_u32 m0, s51, 155648
    s_mov_b32 s53, 1835008
    buffer_load_dwordx4 v3, s[32:35], s53 offen lds
    v_mfma_f32_16x16x32_bf16 v[140:143], v[36:39], v[124:127], v[140:143]
    ds_read_b128 v[32:35], v16 offset:40960
    ds_read_b128 v[36:39], v17 offset:40960
    s_waitcnt lgkmcnt(10)
    v_mfma_f32_16x16x32_bf16 v[144:147], v[96:99], v[40:43], v[144:147]
    s_add_u32 m0, s51, 159744
    s_mov_b32 s53, 1966080
    buffer_load_dwordx4 v3, s[32:35], s53 offen lds
    v_mfma_f32_16x16x32_bf16 v[144:147], v[100:103], v[44:47], v[144:147]
    s_add_u32 m0, s51, 0
    s_add_u32 s53, s58, 384
    buffer_load_dwordx4 v2, s[36:39], s53 offen lds
    v_mfma_f32_16x16x32_bf16 v[148:151], v[104:107], v[40:43], v[148:151]
    ds_read_b64_tr_b16 v[72:73], v21 offset:0
    v_mfma_f32_16x16x32_bf16 v[148:151], v[108:111], v[44:47], v[148:151]
    ds_read_b64_tr_b16 v[74:75], v21 offset:1024
    v_mfma_f32_16x16x32_bf16 v[152:155], v[40:43], v[112:115], v[152:155]
    ds_read_b64_tr_b16 v[76:77], v21 offset:16384
    v_mfma_f32_16x16x32_bf16 v[152:155], v[44:47], v[116:119], v[152:155]
    ds_read_b64_tr_b16 v[78:79], v21 offset:17408
    v_mfma_f32_16x16x32_bf16 v[156:159], v[40:43], v[120:123], v[156:159]
    s_add_u32 m0, s51, 4096
    s_add_u32 s53, s58, 33152
    buffer_load_dwordx4 v2, s[36:39], s53 offen lds
    v_mfma_f32_16x16x32_bf16 v[156:159], v[44:47], v[124:127], v[156:159]
    ds_read_b128 v[40:43], v16 offset:43008
    ds_read_b128 v[44:47], v17 offset:43008
    s_waitcnt lgkmcnt(14)
    v_mfma_f32_16x16x32_bf16 v[160:163], v[96:99], v[48:51], v[160:163]
    s_add_u32 m0, s51, 8192
    s_add_u32 s53, s58, 65920
    buffer_load_dwordx4 v2, s[36:39], s53 offen lds
    v_mfma_f32_16x16x32_bf16 v[160:163], v[100:103], v[52:55], v[160:163]
    s_add_u32 m0, s51, 12288
    s_add_u32 s53, s58, 98688
    buffer_load_dwordx4 v2, s[36:39], s53 offen lds
    v_mfma_f32_16x16x32_bf16 v[164:167], v[104:107], v[48:51], v[164:167]
    ds_read_b64_tr_b16 v[80:81], v20 offset:8192
    v_mfma_f32_16x16x32_bf16 v[164:167], v[108:111], v[52:55], v[164:167]
    ds_read_b64_tr_b16 v[82:83], v20 offset:9216
    v_mfma_f32_16x16x32_bf16 v[168:171], v[48:51], v[112:115], v[168:171]
    ds_read_b64_tr_b16 v[84:85], v20 offset:24576
    v_mfma_f32_16x16x32_bf16 v[168:171], v[52:55], v[116:119], v[168:171]
    ds_read_b64_tr_b16 v[86:87], v20 offset:25600
    v_mfma_f32_16x16x32_bf16 v[172:175], v[48:51], v[120:123], v[172:175]
    s_add_u32 m0, s51, 16384
    s_add_u32 s53, s58, 131456
    buffer_load_dwordx4 v2, s[36:39], s53 offen lds
    v_mfma_f32_16x16x32_bf16 v[172:175], v[52:55], v[124:127], v[172:175]
    ds_read_b128 v[48:51], v16 offset:45056
    ds_read_b128 v[52:55], v17 offset:45056
    s_waitcnt lgkmcnt(15)
    v_mfma_f32_16x16x32_bf16 v[176:179], v[96:99], v[56:59], v[176:179]
    s_add_u32 m0, s51, 20480
    s_add_u32 s53, s58, 164224
    buffer_load_dwordx4 v2, s[36:39], s53 offen lds
    v_mfma_f32_16x16x32_bf16 v[176:179], v[100:103], v[60:63], v[176:179]
    s_add_u32 m0, s51, 24576
    s_add_u32 s53, s58, 196992
    buffer_load_dwordx4 v2, s[36:39], s53 offen lds
    v_mfma_f32_16x16x32_bf16 v[180:183], v[104:107], v[56:59], v[180:183]
    ds_read_b64_tr_b16 v[88:89], v21 offset:8192
    v_mfma_f32_16x16x32_bf16 v[180:183], v[108:111], v[60:63], v[180:183]
    ds_read_b64_tr_b16 v[90:91], v21 offset:9216
    v_mfma_f32_16x16x32_bf16 v[184:187], v[56:59], v[112:115], v[184:187]
    ds_read_b64_tr_b16 v[92:93], v21 offset:24576
    v_mfma_f32_16x16x32_bf16 v[184:187], v[60:63], v[116:119], v[184:187]
    ds_read_b64_tr_b16 v[94:95], v21 offset:25600
    v_mfma_f32_16x16x32_bf16 v[188:191], v[56:59], v[120:123], v[188:191]
    s_add_u32 m0, s51, 28672
    s_add_u32 s53, s58, 229760
    buffer_load_dwordx4 v2, s[36:39], s53 offen lds
    v_mfma_f32_16x16x32_bf16 v[188:191], v[60:63], v[124:127], v[188:191]
    ds_read_b128 v[56:59], v16 offset:47104
    ds_read_b128 v[60:63], v17 offset:47104
    s_waitcnt lgkmcnt(15)
    v_mfma_f32_16x16x32_bf16 v[192:195], v[96:99], v[32:35], v[192:195]
    v_mfma_f32_16x16x32_bf16 v[192:195], v[100:103], v[36:39], v[192:195]
    v_mfma_f32_16x16x32_bf16 v[196:199], v[104:107], v[32:35], v[196:199]
    v_mfma_f32_16x16x32_bf16 v[196:199], v[108:111], v[36:39], v[196:199]
    v_mfma_f32_16x16x32_bf16 v[200:203], v[32:35], v[112:115], v[200:203]
    v_mfma_f32_16x16x32_bf16 v[200:203], v[36:39], v[116:119], v[200:203]
    v_mfma_f32_16x16x32_bf16 v[204:207], v[32:35], v[120:123], v[204:207]
    s_waitcnt lgkmcnt(0)
    s_barrier
    v_mfma_f32_16x16x32_bf16 v[204:207], v[36:39], v[124:127], v[204:207]
    ds_read_b128 v[32:35], v18 offset:0
    ds_read_b128 v[36:39], v19 offset:0
    v_mfma_f32_16x16x32_bf16 v[208:211], v[96:99], v[40:43], v[208:211]
    s_add_u32 m0, s51, 98304
    s_mov_b32 s53, 2097152
    buffer_load_dwordx4 v3, s[40:43], s53 offen lds
    v_mfma_f32_16x16x32_bf16 v[208:211], v[100:103], v[44:47], v[208:211]
    v_mfma_f32_16x16x32_bf16 v[212:215], v[104:107], v[40:43], v[212:215]
    v_mfma_f32_16x16x32_bf16 v[212:215], v[108:111], v[44:47], v[212:215]
    s_add_u32 m0, s51, 102400
    s_mov_b32 s53, 2228224
    buffer_load_dwordx4 v3, s[40:43], s53 offen lds
    v_mfma_f32_16x16x32_bf16 v[216:219], v[40:43], v[112:115], v[216:219]
    v_mfma_f32_16x16x32_bf16 v[216:219], v[44:47], v[116:119], v[216:219]
    v_mfma_f32_16x16x32_bf16 v[220:223], v[40:43], v[120:123], v[220:223]
    v_mfma_f32_16x16x32_bf16 v[220:223], v[44:47], v[124:127], v[220:223]
    ds_read_b128 v[40:43], v18 offset:2048
    ds_read_b128 v[44:47], v19 offset:2048
    v_mfma_f32_16x16x32_bf16 v[224:227], v[96:99], v[48:51], v[224:227]
    s_add_u32 m0, s51, 106496
    s_mov_b32 s53, 2097152
    buffer_load_dwordx4 v3, s[32:35], s53 offen lds
    v_mfma_f32_16x16x32_bf16 v[224:227], v[100:103], v[52:55], v[224:227]
    v_mfma_f32_16x16x32_bf16 v[228:231], v[104:107], v[48:51], v[228:231]
    v_mfma_f32_16x16x32_bf16 v[228:231], v[108:111], v[52:55], v[228:231]
    s_add_u32 m0, s51, 110592
    s_mov_b32 s53, 2228224
    buffer_load_dwordx4 v3, s[32:35], s53 offen lds
    v_mfma_f32_16x16x32_bf16 v[232:235], v[48:51], v[112:115], v[232:235]
    v_mfma_f32_16x16x32_bf16 v[232:235], v[52:55], v[116:119], v[232:235]
    v_mfma_f32_16x16x32_bf16 v[236:239], v[48:51], v[120:123], v[236:239]
    v_mfma_f32_16x16x32_bf16 v[236:239], v[52:55], v[124:127], v[236:239]
    ds_read_b128 v[48:51], v18 offset:4096
    ds_read_b128 v[52:55], v19 offset:4096
    v_mfma_f32_16x16x32_bf16 v[240:243], v[96:99], v[56:59], v[240:243]
    s_add_u32 m0, s51, 114688
    s_mov_b32 s53, 2359296
    buffer_load_dwordx4 v3, s[40:43], s53 offen lds
    v_mfma_f32_16x16x32_bf16 v[240:243], v[100:103], v[60:63], v[240:243]
    v_mfma_f32_16x16x32_bf16 v[244:247], v[104:107], v[56:59], v[244:247]
    v_mfma_f32_16x16x32_bf16 v[244:247], v[108:111], v[60:63], v[244:247]
    s_add_u32 m0, s51, 118784
    s_mov_b32 s53, 2490368
    buffer_load_dwordx4 v3, s[40:43], s53 offen lds
    v_mfma_f32_16x16x32_bf16 v[248:251], v[56:59], v[112:115], v[248:251]
    v_mfma_f32_16x16x32_bf16 v[248:251], v[60:63], v[116:119], v[248:251]
    v_mfma_f32_16x16x32_bf16 v[252:255], v[56:59], v[120:123], v[252:255]
    v_mfma_f32_16x16x32_bf16 v[252:255], v[60:63], v[124:127], v[252:255]
    ds_read_b128 v[56:59], v18 offset:6144
    ds_read_b128 v[60:63], v19 offset:6144
    s_waitcnt lgkmcnt(6)
    v_mfma_f32_16x16x32_bf16 v[128:131], v[64:67], v[32:35], v[128:131]
    v_mfma_f32_16x16x32_bf16 v[128:131], v[68:71], v[36:39], v[128:131]
    s_waitcnt vmcnt(14)
    s_barrier
    v_mfma_f32_16x16x32_bf16 v[132:135], v[72:75], v[32:35], v[132:135]
    ds_read_b64_tr_b16 v[96:97], v20 offset:32768
    v_mfma_f32_16x16x32_bf16 v[132:135], v[76:79], v[36:39], v[132:135]
    ds_read_b64_tr_b16 v[98:99], v20 offset:33792
    v_mfma_f32_16x16x32_bf16 v[136:139], v[32:35], v[80:83], v[136:139]
    ds_read_b64_tr_b16 v[100:101], v20 offset:49152
    v_mfma_f32_16x16x32_bf16 v[136:139], v[36:39], v[84:87], v[136:139]
    ds_read_b64_tr_b16 v[102:103], v20 offset:50176
    v_mfma_f32_16x16x32_bf16 v[140:143], v[32:35], v[88:91], v[140:143]
    s_add_u32 m0, s51, 122880
    s_mov_b32 s53, 2359296
    buffer_load_dwordx4 v3, s[32:35], s53 offen lds
    v_mfma_f32_16x16x32_bf16 v[140:143], v[36:39], v[92:95], v[140:143]
    ds_read_b128 v[32:35], v18 offset:8192
    ds_read_b128 v[36:39], v19 offset:8192
    s_waitcnt lgkmcnt(10)
    v_mfma_f32_16x16x32_bf16 v[144:147], v[64:67], v[40:43], v[144:147]
    s_add_u32 m0, s51, 126976
    s_mov_b32 s53, 2490368
    buffer_load_dwordx4 v3, s[32:35], s53 offen lds
    v_mfma_f32_16x16x32_bf16 v[144:147], v[68:71], v[44:47], v[144:147]
    s_add_u32 m0, s51, 32768
    s_add_u32 s53, s58, 512
    buffer_load_dwordx4 v2, s[36:39], s53 offen lds
    v_mfma_f32_16x16x32_bf16 v[148:151], v[72:75], v[40:43], v[148:151]
    ds_read_b64_tr_b16 v[104:105], v21 offset:32768
    v_mfma_f32_16x16x32_bf16 v[148:151], v[76:79], v[44:47], v[148:151]
    ds_read_b64_tr_b16 v[106:107], v21 offset:33792
    v_mfma_f32_16x16x32_bf16 v[152:155], v[40:43], v[80:83], v[152:155]
    ds_read_b64_tr_b16 v[108:109], v21 offset:49152
    v_mfma_f32_16x16x32_bf16 v[152:155], v[44:47], v[84:87], v[152:155]
    ds_read_b64_tr_b16 v[110:111], v21 offset:50176
    v_mfma_f32_16x16x32_bf16 v[156:159], v[40:43], v[88:91], v[156:159]
    s_add_u32 m0, s51, 36864
    s_add_u32 s53, s58, 33280
    buffer_load_dwordx4 v2, s[36:39], s53 offen lds
    v_mfma_f32_16x16x32_bf16 v[156:159], v[44:47], v[92:95], v[156:159]
    ds_read_b128 v[40:43], v18 offset:10240
    ds_read_b128 v[44:47], v19 offset:10240
    s_waitcnt lgkmcnt(14)
    v_mfma_f32_16x16x32_bf16 v[160:163], v[64:67], v[48:51], v[160:163]
    s_add_u32 m0, s51, 40960
    s_add_u32 s53, s58, 66048
    buffer_load_dwordx4 v2, s[36:39], s53 offen lds
    v_mfma_f32_16x16x32_bf16 v[160:163], v[68:71], v[52:55], v[160:163]
    s_add_u32 m0, s51, 45056
    s_add_u32 s53, s58, 98816
    buffer_load_dwordx4 v2, s[36:39], s53 offen lds
    v_mfma_f32_16x16x32_bf16 v[164:167], v[72:75], v[48:51], v[164:167]
    ds_read_b64_tr_b16 v[112:113], v20 offset:40960
    v_mfma_f32_16x16x32_bf16 v[164:167], v[76:79], v[52:55], v[164:167]
    ds_read_b64_tr_b16 v[114:115], v20 offset:41984
    v_mfma_f32_16x16x32_bf16 v[168:171], v[48:51], v[80:83], v[168:171]
    ds_read_b64_tr_b16 v[116:117], v20 offset:57344
    v_mfma_f32_16x16x32_bf16 v[168:171], v[52:55], v[84:87], v[168:171]
    ds_read_b64_tr_b16 v[118:119], v20 offset:58368
    v_mfma_f32_16x16x32_bf16 v[172:175], v[48:51], v[88:91], v[172:175]
    s_add_u32 m0, s51, 49152
    s_add_u32 s53, s58, 131584
    buffer_load_dwordx4 v2, s[36:39], s53 offen lds
    v_mfma_f32_16x16x32_bf16 v[172:175], v[52:55], v[92:95], v[172:175]
    ds_read_b128 v[48:51], v18 offset:12288
    ds_read_b128 v[52:55], v19 offset:12288
    s_waitcnt lgkmcnt(15)
    v_mfma_f32_16x16x32_bf16 v[176:179], v[64:67], v[56:59], v[176:179]
    s_add_u32 m0, s51, 53248
    s_add_u32 s53, s58, 164352
    buffer_load_dwordx4 v2, s[36:39], s53 offen lds
    v_mfma_f32_16x16x32_bf16 v[176:179], v[68:71], v[60:63], v[176:179]
    s_add_u32 m0, s51, 57344
    s_add_u32 s53, s58, 197120
    buffer_load_dwordx4 v2, s[36:39], s53 offen lds
    v_mfma_f32_16x16x32_bf16 v[180:183], v[72:75], v[56:59], v[180:183]
    ds_read_b64_tr_b16 v[120:121], v21 offset:40960
    v_mfma_f32_16x16x32_bf16 v[180:183], v[76:79], v[60:63], v[180:183]
    ds_read_b64_tr_b16 v[122:123], v21 offset:41984
    v_mfma_f32_16x16x32_bf16 v[184:187], v[56:59], v[80:83], v[184:187]
    ds_read_b64_tr_b16 v[124:125], v21 offset:57344
    v_mfma_f32_16x16x32_bf16 v[184:187], v[60:63], v[84:87], v[184:187]
    ds_read_b64_tr_b16 v[126:127], v21 offset:58368
    v_mfma_f32_16x16x32_bf16 v[188:191], v[56:59], v[88:91], v[188:191]
    s_add_u32 m0, s51, 61440
    s_add_u32 s53, s58, 229888
    buffer_load_dwordx4 v2, s[36:39], s53 offen lds
    v_mfma_f32_16x16x32_bf16 v[188:191], v[60:63], v[92:95], v[188:191]
    ds_read_b128 v[56:59], v18 offset:14336
    ds_read_b128 v[60:63], v19 offset:14336
    s_waitcnt lgkmcnt(15)
    v_mfma_f32_16x16x32_bf16 v[192:195], v[64:67], v[32:35], v[192:195]
    v_mfma_f32_16x16x32_bf16 v[192:195], v[68:71], v[36:39], v[192:195]
    v_mfma_f32_16x16x32_bf16 v[196:199], v[72:75], v[32:35], v[196:199]
    v_mfma_f32_16x16x32_bf16 v[196:199], v[76:79], v[36:39], v[196:199]
    v_mfma_f32_16x16x32_bf16 v[200:203], v[32:35], v[80:83], v[200:203]
    v_mfma_f32_16x16x32_bf16 v[200:203], v[36:39], v[84:87], v[200:203]
    v_mfma_f32_16x16x32_bf16 v[204:207], v[32:35], v[88:91], v[204:207]
    s_waitcnt lgkmcnt(0)
    s_waitcnt vmcnt(16)
    s_barrier
    v_mfma_f32_16x16x32_bf16 v[204:207], v[36:39], v[92:95], v[204:207]
    ds_read_b128 v[32:35], v16 offset:0
    ds_read_b128 v[36:39], v17 offset:0
    v_mfma_f32_16x16x32_bf16 v[208:211], v[64:67], v[40:43], v[208:211]
    s_add_u32 m0, s51, 131072
    s_mov_b32 s53, 2621440
    buffer_load_dwordx4 v3, s[40:43], s53 offen lds
    v_mfma_f32_16x16x32_bf16 v[208:211], v[68:71], v[44:47], v[208:211]
    v_mfma_f32_16x16x32_bf16 v[212:215], v[72:75], v[40:43], v[212:215]
    v_mfma_f32_16x16x32_bf16 v[212:215], v[76:79], v[44:47], v[212:215]
    s_add_u32 m0, s51, 135168
    s_mov_b32 s53, 2752512
    buffer_load_dwordx4 v3, s[40:43], s53 offen lds
    v_mfma_f32_16x16x32_bf16 v[216:219], v[40:43], v[80:83], v[216:219]
    v_mfma_f32_16x16x32_bf16 v[216:219], v[44:47], v[84:87], v[216:219]
    v_mfma_f32_16x16x32_bf16 v[220:223], v[40:43], v[88:91], v[220:223]
    v_mfma_f32_16x16x32_bf16 v[220:223], v[44:47], v[92:95], v[220:223]
    ds_read_b128 v[40:43], v16 offset:2048
    ds_read_b128 v[44:47], v17 offset:2048
    v_mfma_f32_16x16x32_bf16 v[224:227], v[64:67], v[48:51], v[224:227]
    s_add_u32 m0, s51, 139264
    s_mov_b32 s53, 2621440
    buffer_load_dwordx4 v3, s[32:35], s53 offen lds
    v_mfma_f32_16x16x32_bf16 v[224:227], v[68:71], v[52:55], v[224:227]
    v_mfma_f32_16x16x32_bf16 v[228:231], v[72:75], v[48:51], v[228:231]
    v_mfma_f32_16x16x32_bf16 v[228:231], v[76:79], v[52:55], v[228:231]
    s_add_u32 m0, s51, 143360
    s_mov_b32 s53, 2752512
    buffer_load_dwordx4 v3, s[32:35], s53 offen lds
    v_mfma_f32_16x16x32_bf16 v[232:235], v[48:51], v[80:83], v[232:235]
    v_mfma_f32_16x16x32_bf16 v[232:235], v[52:55], v[84:87], v[232:235]
    v_mfma_f32_16x16x32_bf16 v[236:239], v[48:51], v[88:91], v[236:239]
    v_mfma_f32_16x16x32_bf16 v[236:239], v[52:55], v[92:95], v[236:239]
    ds_read_b128 v[48:51], v16 offset:4096
    ds_read_b128 v[52:55], v17 offset:4096
    v_mfma_f32_16x16x32_bf16 v[240:243], v[64:67], v[56:59], v[240:243]
    s_add_u32 m0, s51, 147456
    s_mov_b32 s53, 2883584
    buffer_load_dwordx4 v3, s[40:43], s53 offen lds
    v_mfma_f32_16x16x32_bf16 v[240:243], v[68:71], v[60:63], v[240:243]
    v_mfma_f32_16x16x32_bf16 v[244:247], v[72:75], v[56:59], v[244:247]
    v_mfma_f32_16x16x32_bf16 v[244:247], v[76:79], v[60:63], v[244:247]
    s_add_u32 m0, s51, 151552
    s_mov_b32 s53, 3014656
    buffer_load_dwordx4 v3, s[40:43], s53 offen lds
    v_mfma_f32_16x16x32_bf16 v[248:251], v[56:59], v[80:83], v[248:251]
    v_mfma_f32_16x16x32_bf16 v[248:251], v[60:63], v[84:87], v[248:251]
    v_mfma_f32_16x16x32_bf16 v[252:255], v[56:59], v[88:91], v[252:255]
    v_mfma_f32_16x16x32_bf16 v[252:255], v[60:63], v[92:95], v[252:255]
    ds_read_b128 v[56:59], v16 offset:6144
    ds_read_b128 v[60:63], v17 offset:6144
    s_waitcnt lgkmcnt(6)
    v_mfma_f32_16x16x32_bf16 v[128:131], v[96:99], v[32:35], v[128:131]
    v_mfma_f32_16x16x32_bf16 v[128:131], v[100:103], v[36:39], v[128:131]
    s_waitcnt vmcnt(14)
    s_barrier
    v_mfma_f32_16x16x32_bf16 v[132:135], v[104:107], v[32:35], v[132:135]
    ds_read_b64_tr_b16 v[64:65], v20 offset:0
    v_mfma_f32_16x16x32_bf16 v[132:135], v[108:111], v[36:39], v[132:135]
    ds_read_b64_tr_b16 v[66:67], v20 offset:1024
    v_mfma_f32_16x16x32_bf16 v[136:139], v[32:35], v[112:115], v[136:139]
    ds_read_b64_tr_b16 v[68:69], v20 offset:16384
    v_mfma_f32_16x16x32_bf16 v[136:139], v[36:39], v[116:119], v[136:139]
    ds_read_b64_tr_b16 v[70:71], v20 offset:17408
    v_mfma_f32_16x16x32_bf16 v[140:143], v[32:35], v[120:123], v[140:143]
    s_add_u32 m0, s51, 155648
    s_mov_b32 s53, 2883584
    buffer_load_dwordx4 v3, s[32:35], s53 offen lds
    v_mfma_f32_16x16x32_bf16 v[140:143], v[36:39], v[124:127], v[140:143]
    ds_read_b128 v[32:35], v16 offset:8192
    ds_read_b128 v[36:39], v17 offset:8192
    s_waitcnt lgkmcnt(10)
    v_mfma_f32_16x16x32_bf16 v[144:147], v[96:99], v[40:43], v[144:147]
    s_add_u32 m0, s51, 159744
    s_mov_b32 s53, 3014656
    buffer_load_dwordx4 v3, s[32:35], s53 offen lds
    v_mfma_f32_16x16x32_bf16 v[144:147], v[100:103], v[44:47], v[144:147]
    s_add_u32 m0, s51, 65536
    s_add_u32 s53, s58, 640
    buffer_load_dwordx4 v2, s[36:39], s53 offen lds
    v_mfma_f32_16x16x32_bf16 v[148:151], v[104:107], v[40:43], v[148:151]
    ds_read_b64_tr_b16 v[72:73], v21 offset:0
    v_mfma_f32_16x16x32_bf16 v[148:151], v[108:111], v[44:47], v[148:151]
    ds_read_b64_tr_b16 v[74:75], v21 offset:1024
    v_mfma_f32_16x16x32_bf16 v[152:155], v[40:43], v[112:115], v[152:155]
    ds_read_b64_tr_b16 v[76:77], v21 offset:16384
    v_mfma_f32_16x16x32_bf16 v[152:155], v[44:47], v[116:119], v[152:155]
    ds_read_b64_tr_b16 v[78:79], v21 offset:17408
    v_mfma_f32_16x16x32_bf16 v[156:159], v[40:43], v[120:123], v[156:159]
    s_add_u32 m0, s51, 69632
    s_add_u32 s53, s58, 33408
    buffer_load_dwordx4 v2, s[36:39], s53 offen lds
    v_mfma_f32_16x16x32_bf16 v[156:159], v[44:47], v[124:127], v[156:159]
    ds_read_b128 v[40:43], v16 offset:10240
    ds_read_b128 v[44:47], v17 offset:10240
    s_waitcnt lgkmcnt(14)
    v_mfma_f32_16x16x32_bf16 v[160:163], v[96:99], v[48:51], v[160:163]
    s_add_u32 m0, s51, 73728
    s_add_u32 s53, s58, 66176
    buffer_load_dwordx4 v2, s[36:39], s53 offen lds
    v_mfma_f32_16x16x32_bf16 v[160:163], v[100:103], v[52:55], v[160:163]
    s_add_u32 m0, s51, 77824
    s_add_u32 s53, s58, 98944
    buffer_load_dwordx4 v2, s[36:39], s53 offen lds
    v_mfma_f32_16x16x32_bf16 v[164:167], v[104:107], v[48:51], v[164:167]
    ds_read_b64_tr_b16 v[80:81], v20 offset:8192
    v_mfma_f32_16x16x32_bf16 v[164:167], v[108:111], v[52:55], v[164:167]
    ds_read_b64_tr_b16 v[82:83], v20 offset:9216
    v_mfma_f32_16x16x32_bf16 v[168:171], v[48:51], v[112:115], v[168:171]
    ds_read_b64_tr_b16 v[84:85], v20 offset:24576
    v_mfma_f32_16x16x32_bf16 v[168:171], v[52:55], v[116:119], v[168:171]
    ds_read_b64_tr_b16 v[86:87], v20 offset:25600
    v_mfma_f32_16x16x32_bf16 v[172:175], v[48:51], v[120:123], v[172:175]
    s_add_u32 m0, s51, 81920
    s_add_u32 s53, s58, 131712
    buffer_load_dwordx4 v2, s[36:39], s53 offen lds
    v_mfma_f32_16x16x32_bf16 v[172:175], v[52:55], v[124:127], v[172:175]
    ds_read_b128 v[48:51], v16 offset:12288
    ds_read_b128 v[52:55], v17 offset:12288
    s_waitcnt lgkmcnt(15)
    v_mfma_f32_16x16x32_bf16 v[176:179], v[96:99], v[56:59], v[176:179]
    s_add_u32 m0, s51, 86016
    s_add_u32 s53, s58, 164480
    buffer_load_dwordx4 v2, s[36:39], s53 offen lds
    v_mfma_f32_16x16x32_bf16 v[176:179], v[100:103], v[60:63], v[176:179]
    s_add_u32 m0, s51, 90112
    s_add_u32 s53, s58, 197248
    buffer_load_dwordx4 v2, s[36:39], s53 offen lds
    v_mfma_f32_16x16x32_bf16 v[180:183], v[104:107], v[56:59], v[180:183]
    ds_read_b64_tr_b16 v[88:89], v21 offset:8192
    v_mfma_f32_16x16x32_bf16 v[180:183], v[108:111], v[60:63], v[180:183]
    ds_read_b64_tr_b16 v[90:91], v21 offset:9216
    v_mfma_f32_16x16x32_bf16 v[184:187], v[56:59], v[112:115], v[184:187]
    ds_read_b64_tr_b16 v[92:93], v21 offset:24576
    v_mfma_f32_16x16x32_bf16 v[184:187], v[60:63], v[116:119], v[184:187]
    ds_read_b64_tr_b16 v[94:95], v21 offset:25600
    v_mfma_f32_16x16x32_bf16 v[188:191], v[56:59], v[120:123], v[188:191]
    s_add_u32 m0, s51, 94208
    s_add_u32 s53, s58, 230016
    buffer_load_dwordx4 v2, s[36:39], s53 offen lds
    v_mfma_f32_16x16x32_bf16 v[188:191], v[60:63], v[124:127], v[188:191]
    ds_read_b128 v[56:59], v16 offset:14336
    ds_read_b128 v[60:63], v17 offset:14336
    s_waitcnt lgkmcnt(15)
    v_mfma_f32_16x16x32_bf16 v[192:195], v[96:99], v[32:35], v[192:195]
    v_mfma_f32_16x16x32_bf16 v[192:195], v[100:103], v[36:39], v[192:195]
    v_mfma_f32_16x16x32_bf16 v[196:199], v[104:107], v[32:35], v[196:199]
    v_mfma_f32_16x16x32_bf16 v[196:199], v[108:111], v[36:39], v[196:199]
    v_mfma_f32_16x16x32_bf16 v[200:203], v[32:35], v[112:115], v[200:203]
    v_mfma_f32_16x16x32_bf16 v[200:203], v[36:39], v[116:119], v[200:203]
    v_mfma_f32_16x16x32_bf16 v[204:207], v[32:35], v[120:123], v[204:207]
    s_waitcnt lgkmcnt(0)
    s_waitcnt vmcnt(16)
    s_barrier
    v_mfma_f32_16x16x32_bf16 v[204:207], v[36:39], v[124:127], v[204:207]
    ds_read_b128 v[32:35], v16 offset:32768
    ds_read_b128 v[36:39], v17 offset:32768
    v_mfma_f32_16x16x32_bf16 v[208:211], v[96:99], v[40:43], v[208:211]
    s_add_u32 m0, s51, 98304
    s_mov_b32 s53, 3145728
    buffer_load_dwordx4 v3, s[40:43], s53 offen lds
    v_mfma_f32_16x16x32_bf16 v[208:211], v[100:103], v[44:47], v[208:211]
    v_mfma_f32_16x16x32_bf16 v[212:215], v[104:107], v[40:43], v[212:215]
    v_mfma_f32_16x16x32_bf16 v[212:215], v[108:111], v[44:47], v[212:215]
    s_add_u32 m0, s51, 102400
    s_mov_b32 s53, 3276800
    buffer_load_dwordx4 v3, s[40:43], s53 offen lds
    v_mfma_f32_16x16x32_bf16 v[216:219], v[40:43], v[112:115], v[216:219]
    v_mfma_f32_16x16x32_bf16 v[216:219], v[44:47], v[116:119], v[216:219]
    v_mfma_f32_16x16x32_bf16 v[220:223], v[40:43], v[120:123], v[220:223]
    v_mfma_f32_16x16x32_bf16 v[220:223], v[44:47], v[124:127], v[220:223]
    ds_read_b128 v[40:43], v16 offset:34816
    ds_read_b128 v[44:47], v17 offset:34816
    v_mfma_f32_16x16x32_bf16 v[224:227], v[96:99], v[48:51], v[224:227]
    s_add_u32 m0, s51, 106496
    s_mov_b32 s53, 3145728
    buffer_load_dwordx4 v3, s[32:35], s53 offen lds
    v_mfma_f32_16x16x32_bf16 v[224:227], v[100:103], v[52:55], v[224:227]
    v_mfma_f32_16x16x32_bf16 v[228:231], v[104:107], v[48:51], v[228:231]
    v_mfma_f32_16x16x32_bf16 v[228:231], v[108:111], v[52:55], v[228:231]
    s_add_u32 m0, s51, 110592
    s_mov_b32 s53, 3276800
    buffer_load_dwordx4 v3, s[32:35], s53 offen lds
    v_mfma_f32_16x16x32_bf16 v[232:235], v[48:51], v[112:115], v[232:235]
    v_mfma_f32_16x16x32_bf16 v[232:235], v[52:55], v[116:119], v[232:235]
    v_mfma_f32_16x16x32_bf16 v[236:239], v[48:51], v[120:123], v[236:239]
    v_mfma_f32_16x16x32_bf16 v[236:239], v[52:55], v[124:127], v[236:239]
    ds_read_b128 v[48:51], v16 offset:36864
    ds_read_b128 v[52:55], v17 offset:36864
    v_mfma_f32_16x16x32_bf16 v[240:243], v[96:99], v[56:59], v[240:243]
    s_add_u32 m0, s51, 114688
    s_mov_b32 s53, 3407872
    buffer_load_dwordx4 v3, s[40:43], s53 offen lds
    v_mfma_f32_16x16x32_bf16 v[240:243], v[100:103], v[60:63], v[240:243]
    v_mfma_f32_16x16x32_bf16 v[244:247], v[104:107], v[56:59], v[244:247]
    v_mfma_f32_16x16x32_bf16 v[244:247], v[108:111], v[60:63], v[244:247]
    s_add_u32 m0, s51, 118784
    s_mov_b32 s53, 3538944
    buffer_load_dwordx4 v3, s[40:43], s53 offen lds
    v_mfma_f32_16x16x32_bf16 v[248:251], v[56:59], v[112:115], v[248:251]
    v_mfma_f32_16x16x32_bf16 v[248:251], v[60:63], v[116:119], v[248:251]
    v_mfma_f32_16x16x32_bf16 v[252:255], v[56:59], v[120:123], v[252:255]
    v_mfma_f32_16x16x32_bf16 v[252:255], v[60:63], v[124:127], v[252:255]
    ds_read_b128 v[56:59], v16 offset:38912
    ds_read_b128 v[60:63], v17 offset:38912
    s_waitcnt lgkmcnt(6)
    v_mfma_f32_16x16x32_bf16 v[128:131], v[64:67], v[32:35], v[128:131]
    v_mfma_f32_16x16x32_bf16 v[128:131], v[68:71], v[36:39], v[128:131]
    s_waitcnt vmcnt(14)
    s_barrier
    v_mfma_f32_16x16x32_bf16 v[132:135], v[72:75], v[32:35], v[132:135]
    ds_read_b64_tr_b16 v[96:97], v20 offset:32768
    v_mfma_f32_16x16x32_bf16 v[132:135], v[76:79], v[36:39], v[132:135]
    ds_read_b64_tr_b16 v[98:99], v20 offset:33792
    v_mfma_f32_16x16x32_bf16 v[136:139], v[32:35], v[80:83], v[136:139]
    ds_read_b64_tr_b16 v[100:101], v20 offset:49152
    v_mfma_f32_16x16x32_bf16 v[136:139], v[36:39], v[84:87], v[136:139]
    ds_read_b64_tr_b16 v[102:103], v20 offset:50176
    v_mfma_f32_16x16x32_bf16 v[140:143], v[32:35], v[88:91], v[140:143]
    s_add_u32 m0, s51, 122880
    s_mov_b32 s53, 3407872
    buffer_load_dwordx4 v3, s[32:35], s53 offen lds
    v_mfma_f32_16x16x32_bf16 v[140:143], v[36:39], v[92:95], v[140:143]
    ds_read_b128 v[32:35], v16 offset:40960
    ds_read_b128 v[36:39], v17 offset:40960
    s_waitcnt lgkmcnt(10)
    v_mfma_f32_16x16x32_bf16 v[144:147], v[64:67], v[40:43], v[144:147]
    s_add_u32 m0, s51, 126976
    s_mov_b32 s53, 3538944
    buffer_load_dwordx4 v3, s[32:35], s53 offen lds
    v_mfma_f32_16x16x32_bf16 v[144:147], v[68:71], v[44:47], v[144:147]
    s_add_u32 m0, s51, 0
    s_add_u32 s53, s58, 768
    buffer_load_dwordx4 v2, s[36:39], s53 offen lds
    v_mfma_f32_16x16x32_bf16 v[148:151], v[72:75], v[40:43], v[148:151]
    ds_read_b64_tr_b16 v[104:105], v21 offset:32768
    v_mfma_f32_16x16x32_bf16 v[148:151], v[76:79], v[44:47], v[148:151]
    ds_read_b64_tr_b16 v[106:107], v21 offset:33792
    v_mfma_f32_16x16x32_bf16 v[152:155], v[40:43], v[80:83], v[152:155]
    ds_read_b64_tr_b16 v[108:109], v21 offset:49152
    v_mfma_f32_16x16x32_bf16 v[152:155], v[44:47], v[84:87], v[152:155]
    ds_read_b64_tr_b16 v[110:111], v21 offset:50176
    v_mfma_f32_16x16x32_bf16 v[156:159], v[40:43], v[88:91], v[156:159]
    s_add_u32 m0, s51, 4096
    s_add_u32 s53, s58, 33536
    buffer_load_dwordx4 v2, s[36:39], s53 offen lds
    v_mfma_f32_16x16x32_bf16 v[156:159], v[44:47], v[92:95], v[156:159]
    ds_read_b128 v[40:43], v16 offset:43008
    ds_read_b128 v[44:47], v17 offset:43008
    s_waitcnt lgkmcnt(14)
    v_mfma_f32_16x16x32_bf16 v[160:163], v[64:67], v[48:51], v[160:163]
    s_add_u32 m0, s51, 8192
    s_add_u32 s53, s58, 66304
    buffer_load_dwordx4 v2, s[36:39], s53 offen lds
    v_mfma_f32_16x16x32_bf16 v[160:163], v[68:71], v[52:55], v[160:163]
    s_add_u32 m0, s51, 12288
    s_add_u32 s53, s58, 99072
    buffer_load_dwordx4 v2, s[36:39], s53 offen lds
    v_mfma_f32_16x16x32_bf16 v[164:167], v[72:75], v[48:51], v[164:167]
    ds_read_b64_tr_b16 v[112:113], v20 offset:40960
    v_mfma_f32_16x16x32_bf16 v[164:167], v[76:79], v[52:55], v[164:167]
    ds_read_b64_tr_b16 v[114:115], v20 offset:41984
    v_mfma_f32_16x16x32_bf16 v[168:171], v[48:51], v[80:83], v[168:171]
    ds_read_b64_tr_b16 v[116:117], v20 offset:57344
    v_mfma_f32_16x16x32_bf16 v[168:171], v[52:55], v[84:87], v[168:171]
    ds_read_b64_tr_b16 v[118:119], v20 offset:58368
    v_mfma_f32_16x16x32_bf16 v[172:175], v[48:51], v[88:91], v[172:175]
    s_add_u32 m0, s51, 16384
    s_add_u32 s53, s58, 131840
    buffer_load_dwordx4 v2, s[36:39], s53 offen lds
    v_mfma_f32_16x16x32_bf16 v[172:175], v[52:55], v[92:95], v[172:175]
    ds_read_b128 v[48:51], v16 offset:45056
    ds_read_b128 v[52:55], v17 offset:45056
    s_waitcnt lgkmcnt(15)
    v_mfma_f32_16x16x32_bf16 v[176:179], v[64:67], v[56:59], v[176:179]
    s_add_u32 m0, s51, 20480
    s_add_u32 s53, s58, 164608
    buffer_load_dwordx4 v2, s[36:39], s53 offen lds
    v_mfma_f32_16x16x32_bf16 v[176:179], v[68:71], v[60:63], v[176:179]
    s_add_u32 m0, s51, 24576
    s_add_u32 s53, s58, 197376
    buffer_load_dwordx4 v2, s[36:39], s53 offen lds
    v_mfma_f32_16x16x32_bf16 v[180:183], v[72:75], v[56:59], v[180:183]
    ds_read_b64_tr_b16 v[120:121], v21 offset:40960
    v_mfma_f32_16x16x32_bf16 v[180:183], v[76:79], v[60:63], v[180:183]
    ds_read_b64_tr_b16 v[122:123], v21 offset:41984
    v_mfma_f32_16x16x32_bf16 v[184:187], v[56:59], v[80:83], v[184:187]
    ds_read_b64_tr_b16 v[124:125], v21 offset:57344
    v_mfma_f32_16x16x32_bf16 v[184:187], v[60:63], v[84:87], v[184:187]
    ds_read_b64_tr_b16 v[126:127], v21 offset:58368
    v_mfma_f32_16x16x32_bf16 v[188:191], v[56:59], v[88:91], v[188:191]
    s_add_u32 m0, s51, 28672
    s_add_u32 s53, s58, 230144
    buffer_load_dwordx4 v2, s[36:39], s53 offen lds
    v_mfma_f32_16x16x32_bf16 v[188:191], v[60:63], v[92:95], v[188:191]
    ds_read_b128 v[56:59], v16 offset:47104
    ds_read_b128 v[60:63], v17 offset:47104
    s_waitcnt lgkmcnt(15)
    v_mfma_f32_16x16x32_bf16 v[192:195], v[64:67], v[32:35], v[192:195]
    v_mfma_f32_16x16x32_bf16 v[192:195], v[68:71], v[36:39], v[192:195]
    v_mfma_f32_16x16x32_bf16 v[196:199], v[72:75], v[32:35], v[196:199]
    v_mfma_f32_16x16x32_bf16 v[196:199], v[76:79], v[36:39], v[196:199]
    v_mfma_f32_16x16x32_bf16 v[200:203], v[32:35], v[80:83], v[200:203]
    v_mfma_f32_16x16x32_bf16 v[200:203], v[36:39], v[84:87], v[200:203]
    v_mfma_f32_16x16x32_bf16 v[204:207], v[32:35], v[88:91], v[204:207]
    s_waitcnt lgkmcnt(0)
    s_waitcnt vmcnt(16)
    s_barrier
    v_mfma_f32_16x16x32_bf16 v[204:207], v[36:39], v[92:95], v[204:207]
    ds_read_b128 v[32:35], v18 offset:0
    ds_read_b128 v[36:39], v19 offset:0
    v_mfma_f32_16x16x32_bf16 v[208:211], v[64:67], v[40:43], v[208:211]
    s_add_u32 m0, s51, 131072
    s_mov_b32 s53, 3670016
    buffer_load_dwordx4 v3, s[40:43], s53 offen lds
    v_mfma_f32_16x16x32_bf16 v[208:211], v[68:71], v[44:47], v[208:211]
    v_mfma_f32_16x16x32_bf16 v[212:215], v[72:75], v[40:43], v[212:215]
    v_mfma_f32_16x16x32_bf16 v[212:215], v[76:79], v[44:47], v[212:215]
    s_add_u32 m0, s51, 135168
    s_mov_b32 s53, 3801088
    buffer_load_dwordx4 v3, s[40:43], s53 offen lds
    v_mfma_f32_16x16x32_bf16 v[216:219], v[40:43], v[80:83], v[216:219]
    v_mfma_f32_16x16x32_bf16 v[216:219], v[44:47], v[84:87], v[216:219]
    v_mfma_f32_16x16x32_bf16 v[220:223], v[40:43], v[88:91], v[220:223]
    v_mfma_f32_16x16x32_bf16 v[220:223], v[44:47], v[92:95], v[220:223]
    ds_read_b128 v[40:43], v18 offset:2048
    ds_read_b128 v[44:47], v19 offset:2048
    v_mfma_f32_16x16x32_bf16 v[224:227], v[64:67], v[48:51], v[224:227]
    s_add_u32 m0, s51, 139264
    s_mov_b32 s53, 3670016
    buffer_load_dwordx4 v3, s[32:35], s53 offen lds
    v_mfma_f32_16x16x32_bf16 v[224:227], v[68:71], v[52:55], v[224:227]
    v_mfma_f32_16x16x32_bf16 v[228:231], v[72:75], v[48:51], v[228:231]
    v_mfma_f32_16x16x32_bf16 v[228:231], v[76:79], v[52:55], v[228:231]
    s_add_u32 m0, s51, 143360
    s_mov_b32 s53, 3801088
    buffer_load_dwordx4 v3, s[32:35], s53 offen lds
    v_mfma_f32_16x16x32_bf16 v[232:235], v[48:51], v[80:83], v[232:235]
    v_mfma_f32_16x16x32_bf16 v[232:235], v[52:55], v[84:87], v[232:235]
    v_mfma_f32_16x16x32_bf16 v[236:239], v[48:51], v[88:91], v[236:239]
    v_mfma_f32_16x16x32_bf16 v[236:239], v[52:55], v[92:95], v[236:239]
    ds_read_b128 v[48:51], v18 offset:4096
    ds_read_b128 v[52:55], v19 offset:4096
    v_mfma_f32_16x16x32_bf16 v[240:243], v[64:67], v[56:59], v[240:243]
    s_add_u32 m0, s51, 147456
    s_mov_b32 s53, 3932160
    buffer_load_dwordx4 v3, s[40:43], s53 offen lds
    v_mfma_f32_16x16x32_bf16 v[240:243], v[68:71], v[60:63], v[240:243]
    v_mfma_f32_16x16x32_bf16 v[244:247], v[72:75], v[56:59], v[244:247]
    v_mfma_f32_16x16x32_bf16 v[244:247], v[76:79], v[60:63], v[244:247]
    s_add_u32 m0, s51, 151552
    s_mov_b32 s53, 4063232
    buffer_load_dwordx4 v3, s[40:43], s53 offen lds
    v_mfma_f32_16x16x32_bf16 v[248:251], v[56:59], v[80:83], v[248:251]
    v_mfma_f32_16x16x32_bf16 v[248:251], v[60:63], v[84:87], v[248:251]
    v_mfma_f32_16x16x32_bf16 v[252:255], v[56:59], v[88:91], v[252:255]
    v_mfma_f32_16x16x32_bf16 v[252:255], v[60:63], v[92:95], v[252:255]
    ds_read_b128 v[56:59], v18 offset:6144
    ds_read_b128 v[60:63], v19 offset:6144
    s_waitcnt lgkmcnt(6)
    v_mfma_f32_16x16x32_bf16 v[128:131], v[96:99], v[32:35], v[128:131]
    v_mfma_f32_16x16x32_bf16 v[128:131], v[100:103], v[36:39], v[128:131]
    s_waitcnt vmcnt(14)
    s_barrier
    v_mfma_f32_16x16x32_bf16 v[132:135], v[104:107], v[32:35], v[132:135]
    ds_read_b64_tr_b16 v[64:65], v20 offset:0
    v_mfma_f32_16x16x32_bf16 v[132:135], v[108:111], v[36:39], v[132:135]
    ds_read_b64_tr_b16 v[66:67], v20 offset:1024
    v_mfma_f32_16x16x32_bf16 v[136:139], v[32:35], v[112:115], v[136:139]
    ds_read_b64_tr_b16 v[68:69], v20 offset:16384
    v_mfma_f32_16x16x32_bf16 v[136:139], v[36:39], v[116:119], v[136:139]
    ds_read_b64_tr_b16 v[70:71], v20 offset:17408
    v_mfma_f32_16x16x32_bf16 v[140:143], v[32:35], v[120:123], v[140:143]
    s_add_u32 m0, s51, 155648
    s_mov_b32 s53, 3932160
    buffer_load_dwordx4 v3, s[32:35], s53 offen lds
    v_mfma_f32_16x16x32_bf16 v[140:143], v[36:39], v[124:127], v[140:143]
    ds_read_b128 v[32:35], v18 offset:8192
    ds_read_b128 v[36:39], v19 offset:8192
    s_waitcnt lgkmcnt(10)
    v_mfma_f32_16x16x32_bf16 v[144:147], v[96:99], v[40:43], v[144:147]
    s_add_u32 m0, s51, 159744
    s_mov_b32 s53, 4063232
    buffer_load_dwordx4 v3, s[32:35], s53 offen lds
    v_mfma_f32_16x16x32_bf16 v[144:147], v[100:103], v[44:47], v[144:147]
    s_add_u32 m0, s51, 32768
    s_add_u32 s53, s58, 896
    buffer_load_dwordx4 v2, s[36:39], s53 offen lds
    v_mfma_f32_16x16x32_bf16 v[148:151], v[104:107], v[40:43], v[148:151]
    ds_read_b64_tr_b16 v[72:73], v21 offset:0
    v_mfma_f32_16x16x32_bf16 v[148:151], v[108:111], v[44:47], v[148:151]
    ds_read_b64_tr_b16 v[74:75], v21 offset:1024
    v_mfma_f32_16x16x32_bf16 v[152:155], v[40:43], v[112:115], v[152:155]
    ds_read_b64_tr_b16 v[76:77], v21 offset:16384
    v_mfma_f32_16x16x32_bf16 v[152:155], v[44:47], v[116:119], v[152:155]
    ds_read_b64_tr_b16 v[78:79], v21 offset:17408
    v_mfma_f32_16x16x32_bf16 v[156:159], v[40:43], v[120:123], v[156:159]
    s_add_u32 m0, s51, 36864
    s_add_u32 s53, s58, 33664
    buffer_load_dwordx4 v2, s[36:39], s53 offen lds
    v_mfma_f32_16x16x32_bf16 v[156:159], v[44:47], v[124:127], v[156:159]
    ds_read_b128 v[40:43], v18 offset:10240
    ds_read_b128 v[44:47], v19 offset:10240
    s_waitcnt lgkmcnt(14)
    v_mfma_f32_16x16x32_bf16 v[160:163], v[96:99], v[48:51], v[160:163]
    s_add_u32 m0, s51, 40960
    s_add_u32 s53, s58, 66432
    buffer_load_dwordx4 v2, s[36:39], s53 offen lds
    v_mfma_f32_16x16x32_bf16 v[160:163], v[100:103], v[52:55], v[160:163]
    s_add_u32 m0, s51, 45056
    s_add_u32 s53, s58, 99200
    buffer_load_dwordx4 v2, s[36:39], s53 offen lds
    v_mfma_f32_16x16x32_bf16 v[164:167], v[104:107], v[48:51], v[164:167]
    ds_read_b64_tr_b16 v[80:81], v20 offset:8192
    v_mfma_f32_16x16x32_bf16 v[164:167], v[108:111], v[52:55], v[164:167]
    ds_read_b64_tr_b16 v[82:83], v20 offset:9216
    v_mfma_f32_16x16x32_bf16 v[168:171], v[48:51], v[112:115], v[168:171]
    ds_read_b64_tr_b16 v[84:85], v20 offset:24576
    v_mfma_f32_16x16x32_bf16 v[168:171], v[52:55], v[116:119], v[168:171]
    ds_read_b64_tr_b16 v[86:87], v20 offset:25600
    v_mfma_f32_16x16x32_bf16 v[172:175], v[48:51], v[120:123], v[172:175]
    s_add_u32 m0, s51, 49152
    s_add_u32 s53, s58, 131968
    buffer_load_dwordx4 v2, s[36:39], s53 offen lds
    v_mfma_f32_16x16x32_bf16 v[172:175], v[52:55], v[124:127], v[172:175]
    ds_read_b128 v[48:51], v18 offset:12288
    ds_read_b128 v[52:55], v19 offset:12288
    s_waitcnt lgkmcnt(15)
    v_mfma_f32_16x16x32_bf16 v[176:179], v[96:99], v[56:59], v[176:179]
    s_add_u32 m0, s51, 53248
    s_add_u32 s53, s58, 164736
    buffer_load_dwordx4 v2, s[36:39], s53 offen lds
    v_mfma_f32_16x16x32_bf16 v[176:179], v[100:103], v[60:63], v[176:179]
    s_add_u32 m0, s51, 57344
    s_add_u32 s53, s58, 197504
    buffer_load_dwordx4 v2, s[36:39], s53 offen lds
    v_mfma_f32_16x16x32_bf16 v[180:183], v[104:107], v[56:59], v[180:183]
    ds_read_b64_tr_b16 v[88:89], v21 offset:8192
    v_mfma_f32_16x16x32_bf16 v[180:183], v[108:111], v[60:63], v[180:183]
    ds_read_b64_tr_b16 v[90:91], v21 offset:9216
    v_mfma_f32_16x16x32_bf16 v[184:187], v[56:59], v[112:115], v[184:187]
    ds_read_b64_tr_b16 v[92:93], v21 offset:24576
    v_mfma_f32_16x16x32_bf16 v[184:187], v[60:63], v[116:119], v[184:187]
    ds_read_b64_tr_b16 v[94:95], v21 offset:25600
    v_mfma_f32_16x16x32_bf16 v[188:191], v[56:59], v[120:123], v[188:191]
    s_add_u32 m0, s51, 61440
    s_add_u32 s53, s58, 230272
    buffer_load_dwordx4 v2, s[36:39], s53 offen lds
    v_mfma_f32_16x16x32_bf16 v[188:191], v[60:63], v[124:127], v[188:191]
    ds_read_b128 v[56:59], v18 offset:14336
    ds_read_b128 v[60:63], v19 offset:14336
    s_waitcnt lgkmcnt(15)
    v_mfma_f32_16x16x32_bf16 v[192:195], v[96:99], v[32:35], v[192:195]
    v_mfma_f32_16x16x32_bf16 v[192:195], v[100:103], v[36:39], v[192:195]
    v_mfma_f32_16x16x32_bf16 v[196:199], v[104:107], v[32:35], v[196:199]
    v_mfma_f32_16x16x32_bf16 v[196:199], v[108:111], v[36:39], v[196:199]
    v_mfma_f32_16x16x32_bf16 v[200:203], v[32:35], v[112:115], v[200:203]
    v_mfma_f32_16x16x32_bf16 v[200:203], v[36:39], v[116:119], v[200:203]
    v_mfma_f32_16x16x32_bf16 v[204:207], v[32:35], v[120:123], v[204:207]
    s_waitcnt lgkmcnt(0)
    s_waitcnt vmcnt(16)
    s_barrier
    v_mfma_f32_16x16x32_bf16 v[204:207], v[36:39], v[124:127], v[204:207]
    ds_read_b128 v[32:35], v16 offset:0
    ds_read_b128 v[36:39], v17 offset:0
    v_mfma_f32_16x16x32_bf16 v[208:211], v[96:99], v[40:43], v[208:211]
    s_add_u32 m0, s51, 98304
    s_add_u32 s53, s57, 0
    buffer_load_dwordx4 v2, s[28:31], s53 offen lds
    v_mfma_f32_16x16x32_bf16 v[208:211], v[100:103], v[44:47], v[208:211]
    v_mfma_f32_16x16x32_bf16 v[212:215], v[104:107], v[40:43], v[212:215]
    v_mfma_f32_16x16x32_bf16 v[212:215], v[108:111], v[44:47], v[212:215]
    s_add_u32 m0, s51, 102400
    s_add_u32 s53, s57, 32768
    buffer_load_dwordx4 v2, s[28:31], s53 offen lds
    v_mfma_f32_16x16x32_bf16 v[216:219], v[40:43], v[112:115], v[216:219]
    v_mfma_f32_16x16x32_bf16 v[216:219], v[44:47], v[116:119], v[216:219]
    v_mfma_f32_16x16x32_bf16 v[220:223], v[40:43], v[120:123], v[220:223]
    v_mfma_f32_16x16x32_bf16 v[220:223], v[44:47], v[124:127], v[220:223]
    ds_read_b128 v[40:43], v16 offset:2048
    ds_read_b128 v[44:47], v17 offset:2048
    v_mfma_f32_16x16x32_bf16 v[224:227], v[96:99], v[48:51], v[224:227]
    s_add_u32 m0, s51, 106496
    s_add_u32 s53, s57, 65536
    buffer_load_dwordx4 v2, s[28:31], s53 offen lds
    v_mfma_f32_16x16x32_bf16 v[224:227], v[100:103], v[52:55], v[224:227]
    v_mfma_f32_16x16x32_bf16 v[228:231], v[104:107], v[48:51], v[228:231]
    v_mfma_f32_16x16x32_bf16 v[228:231], v[108:111], v[52:55], v[228:231]
    s_add_u32 m0, s51, 110592
    s_add_u32 s53, s57, 98304
    buffer_load_dwordx4 v2, s[28:31], s53 offen lds
    v_mfma_f32_16x16x32_bf16 v[232:235], v[48:51], v[112:115], v[232:235]
    v_mfma_f32_16x16x32_bf16 v[232:235], v[52:55], v[116:119], v[232:235]
    v_mfma_f32_16x16x32_bf16 v[236:239], v[48:51], v[120:123], v[236:239]
    v_mfma_f32_16x16x32_bf16 v[236:239], v[52:55], v[124:127], v[236:239]
    ds_read_b128 v[48:51], v16 offset:4096
    ds_read_b128 v[52:55], v17 offset:4096
    v_mfma_f32_16x16x32_bf16 v[240:243], v[96:99], v[56:59], v[240:243]
    s_add_u32 m0, s51, 114688
    s_add_u32 s53, s57, 128
    buffer_load_dwordx4 v2, s[28:31], s53 offen lds
    v_mfma_f32_16x16x32_bf16 v[240:243], v[100:103], v[60:63], v[240:243]
    v_mfma_f32_16x16x32_bf16 v[244:247], v[104:107], v[56:59], v[244:247]
    v_mfma_f32_16x16x32_bf16 v[244:247], v[108:111], v[60:63], v[244:247]
    s_add_u32 m0, s51, 118784
    s_add_u32 s53, s57, 32896
    buffer_load_dwordx4 v2, s[28:31], s53 offen lds
    v_mfma_f32_16x16x32_bf16 v[248:251], v[56:59], v[112:115], v[248:251]
    v_mfma_f32_16x16x32_bf16 v[248:251], v[60:63], v[116:119], v[248:251]
    v_mfma_f32_16x16x32_bf16 v[252:255], v[56:59], v[120:123], v[252:255]
    v_mfma_f32_16x16x32_bf16 v[252:255], v[60:63], v[124:127], v[252:255]
    ds_read_b128 v[56:59], v16 offset:6144
    ds_read_b128 v[60:63], v17 offset:6144
    s_waitcnt lgkmcnt(6)
    v_mfma_f32_16x16x32_bf16 v[128:131], v[64:67], v[32:35], v[128:131]
    v_mfma_f32_16x16x32_bf16 v[128:131], v[68:71], v[36:39], v[128:131]
    s_waitcnt vmcnt(14)
    s_barrier
    v_mfma_f32_16x16x32_bf16 v[132:135], v[72:75], v[32:35], v[132:135]
    ds_read_b64_tr_b16 v[96:97], v20 offset:32768
    v_mfma_f32_16x16x32_bf16 v[132:135], v[76:79], v[36:39], v[132:135]
    ds_read_b64_tr_b16 v[98:99], v20 offset:33792
    v_mfma_f32_16x16x32_bf16 v[136:139], v[32:35], v[80:83], v[136:139]
    ds_read_b64_tr_b16 v[100:101], v20 offset:49152
    v_mfma_f32_16x16x32_bf16 v[136:139], v[36:39], v[84:87], v[136:139]
    ds_read_b64_tr_b16 v[102:103], v20 offset:50176
    v_mfma_f32_16x16x32_bf16 v[140:143], v[32:35], v[88:91], v[140:143]
    s_add_u32 m0, s51, 122880
    s_add_u32 s53, s57, 65664
    buffer_load_dwordx4 v2, s[28:31], s53 offen lds
    v_mfma_f32_16x16x32_bf16 v[140:143], v[36:39], v[92:95], v[140:143]
    ds_read_b128 v[32:35], v16 offset:8192
    ds_read_b128 v[36:39], v17 offset:8192
    s_waitcnt lgkmcnt(10)
    v_mfma_f32_16x16x32_bf16 v[144:147], v[64:67], v[40:43], v[144:147]
    s_add_u32 m0, s51, 126976
    s_add_u32 s53, s57, 98432
    buffer_load_dwordx4 v2, s[28:31], s53 offen lds
    v_mfma_f32_16x16x32_bf16 v[144:147], v[68:71], v[44:47], v[144:147]
    s_add_u32 m0, s51, 65536
    s_mov_b32 s53, 0
    buffer_load_dwordx4 v4, s[12:15], s53 offen lds
    v_mfma_f32_16x16x32_bf16 v[148:151], v[72:75], v[40:43], v[148:151]
    ds_read_b64_tr_b16 v[104:105], v21 offset:32768
    v_mfma_f32_16x16x32_bf16 v[148:151], v[76:79], v[44:47], v[148:151]
    ds_read_b64_tr_b16 v[106:107], v21 offset:33792
    v_mfma_f32_16x16x32_bf16 v[152:155], v[40:43], v[80:83], v[152:155]
    ds_read_b64_tr_b16 v[108:109], v21 offset:49152
    v_mfma_f32_16x16x32_bf16 v[152:155], v[44:47], v[84:87], v[152:155]
    ds_read_b64_tr_b16 v[110:111], v21 offset:50176
    v_mfma_f32_16x16x32_bf16 v[156:159], v[40:43], v[88:91], v[156:159]
    s_add_u32 m0, s51, 69632
    s_mov_b32 s53, 196608
    buffer_load_dwordx4 v4, s[12:15], s53 offen lds
    v_mfma_f32_16x16x32_bf16 v[156:159], v[44:47], v[92:95], v[156:159]
    ds_read_b128 v[40:43], v16 offset:10240
    ds_read_b128 v[44:47], v17 offset:10240
    s_waitcnt lgkmcnt(14)
    v_mfma_f32_16x16x32_bf16 v[160:163], v[64:67], v[48:51], v[160:163]
    s_add_u32 m0, s51, 73728
    s_mov_b32 s53, 1024
    buffer_load_dwordx4 v4, s[12:15], s53 offen lds
    v_mfma_f32_16x16x32_bf16 v[160:163], v[68:71], v[52:55], v[160:163]
    s_add_u32 m0, s51, 77824
    s_mov_b32 s53, 197632
    buffer_load_dwordx4 v4, s[12:15], s53 offen lds
    v_mfma_f32_16x16x32_bf16 v[164:167], v[72:75], v[48:51], v[164:167]
    ds_read_b64_tr_b16 v[112:113], v20 offset:40960
    v_mfma_f32_16x16x32_bf16 v[164:167], v[76:79], v[52:55], v[164:167]
    ds_read_b64_tr_b16 v[114:115], v20 offset:41984
    v_mfma_f32_16x16x32_bf16 v[168:171], v[48:51], v[80:83], v[168:171]
    ds_read_b64_tr_b16 v[116:117], v20 offset:57344
    v_mfma_f32_16x16x32_bf16 v[168:171], v[52:55], v[84:87], v[168:171]
    ds_read_b64_tr_b16 v[118:119], v20 offset:58368
    v_mfma_f32_16x16x32_bf16 v[172:175], v[48:51], v[88:91], v[172:175]
    s_add_u32 m0, s51, 81920
    s_mov_b32 s53, 2048
    buffer_load_dwordx4 v4, s[12:15], s53 offen lds
    v_mfma_f32_16x16x32_bf16 v[172:175], v[52:55], v[92:95], v[172:175]
    ds_read_b128 v[48:51], v16 offset:12288
    ds_read_b128 v[52:55], v17 offset:12288
    s_waitcnt lgkmcnt(15)
    v_mfma_f32_16x16x32_bf16 v[176:179], v[64:67], v[56:59], v[176:179]
    s_add_u32 m0, s51, 86016
    s_mov_b32 s53, 198656
    buffer_load_dwordx4 v4, s[12:15], s53 offen lds
    v_mfma_f32_16x16x32_bf16 v[176:179], v[68:71], v[60:63], v[176:179]
    s_add_u32 m0, s51, 90112
    s_mov_b32 s53, 393216
    buffer_load_dwordx4 v4, s[12:15], s53 offen lds
    v_mfma_f32_16x16x32_bf16 v[180:183], v[72:75], v[56:59], v[180:183]
    ds_read_b64_tr_b16 v[120:121], v21 offset:40960
    v_mfma_f32_16x16x32_bf16 v[180:183], v[76:79], v[60:63], v[180:183]
    ds_read_b64_tr_b16 v[122:123], v21 offset:41984
    v_mfma_f32_16x16x32_bf16 v[184:187], v[56:59], v[80:83], v[184:187]
    ds_read_b64_tr_b16 v[124:125], v21 offset:57344
    v_mfma_f32_16x16x32_bf16 v[184:187], v[60:63], v[84:87], v[184:187]
    ds_read_b64_tr_b16 v[126:127], v21 offset:58368
    v_mfma_f32_16x16x32_bf16 v[188:191], v[56:59], v[88:91], v[188:191]
    s_add_u32 m0, s51, 94208
    s_mov_b32 s53, 589824
    buffer_load_dwordx4 v4, s[12:15], s53 offen lds
    v_mfma_f32_16x16x32_bf16 v[188:191], v[60:63], v[92:95], v[188:191]
    ds_read_b128 v[56:59], v16 offset:14336
    ds_read_b128 v[60:63], v17 offset:14336
    s_waitcnt lgkmcnt(15)
    v_mfma_f32_16x16x32_bf16 v[192:195], v[64:67], v[32:35], v[192:195]
    v_mfma_f32_16x16x32_bf16 v[192:195], v[68:71], v[36:39], v[192:195]
    v_mfma_f32_16x16x32_bf16 v[196:199], v[72:75], v[32:35], v[196:199]
    v_mfma_f32_16x16x32_bf16 v[196:199], v[76:79], v[36:39], v[196:199]
    v_mfma_f32_16x16x32_bf16 v[200:203], v[32:35], v[80:83], v[200:203]
    v_mfma_f32_16x16x32_bf16 v[200:203], v[36:39], v[84:87], v[200:203]
    v_mfma_f32_16x16x32_bf16 v[204:207], v[32:35], v[88:91], v[204:207]
    s_waitcnt lgkmcnt(0)
    s_waitcnt vmcnt(16)
    s_barrier
    v_mfma_f32_16x16x32_bf16 v[204:207], v[36:39], v[92:95], v[204:207]
    ds_read_b128 v[32:35], v16 offset:32768
    ds_read_b128 v[36:39], v17 offset:32768
    v_mfma_f32_16x16x32_bf16 v[208:211], v[64:67], v[40:43], v[208:211]
    s_add_u32 m0, s51, 131072
    s_add_u32 s53, s57, 256
    buffer_load_dwordx4 v2, s[28:31], s53 offen lds
    v_mfma_f32_16x16x32_bf16 v[208:211], v[68:71], v[44:47], v[208:211]
    v_mfma_f32_16x16x32_bf16 v[212:215], v[72:75], v[40:43], v[212:215]
    v_mfma_f32_16x16x32_bf16 v[212:215], v[76:79], v[44:47], v[212:215]
    s_add_u32 m0, s51, 135168
    s_add_u32 s53, s57, 33024
    buffer_load_dwordx4 v2, s[28:31], s53 offen lds
    v_mfma_f32_16x16x32_bf16 v[216:219], v[40:43], v[80:83], v[216:219]
    v_mfma_f32_16x16x32_bf16 v[216:219], v[44:47], v[84:87], v[216:219]
    v_mfma_f32_16x16x32_bf16 v[220:223], v[40:43], v[88:91], v[220:223]
    v_mfma_f32_16x16x32_bf16 v[220:223], v[44:47], v[92:95], v[220:223]
    ds_read_b128 v[40:43], v16 offset:34816
    ds_read_b128 v[44:47], v17 offset:34816
    v_mfma_f32_16x16x32_bf16 v[224:227], v[64:67], v[48:51], v[224:227]
    s_add_u32 m0, s51, 139264
    s_add_u32 s53, s57, 65792
    buffer_load_dwordx4 v2, s[28:31], s53 offen lds
    v_mfma_f32_16x16x32_bf16 v[224:227], v[68:71], v[52:55], v[224:227]
    v_mfma_f32_16x16x32_bf16 v[228:231], v[72:75], v[48:51], v[228:231]
    v_mfma_f32_16x16x32_bf16 v[228:231], v[76:79], v[52:55], v[228:231]
    s_add_u32 m0, s51, 143360
    s_add_u32 s53, s57, 98560
    buffer_load_dwordx4 v2, s[28:31], s53 offen lds
    v_mfma_f32_16x16x32_bf16 v[232:235], v[48:51], v[80:83], v[232:235]
    v_mfma_f32_16x16x32_bf16 v[232:235], v[52:55], v[84:87], v[232:235]
    v_mfma_f32_16x16x32_bf16 v[236:239], v[48:51], v[88:91], v[236:239]
    v_mfma_f32_16x16x32_bf16 v[236:239], v[52:55], v[92:95], v[236:239]
    ds_read_b128 v[48:51], v16 offset:36864
    ds_read_b128 v[52:55], v17 offset:36864
    v_mfma_f32_16x16x32_bf16 v[240:243], v[64:67], v[56:59], v[240:243]
    s_add_u32 m0, s51, 147456
    s_add_u32 s53, s57, 384
    buffer_load_dwordx4 v2, s[28:31], s53 offen lds
    v_mfma_f32_16x16x32_bf16 v[240:243], v[68:71], v[60:63], v[240:243]
    v_mfma_f32_16x16x32_bf16 v[244:247], v[72:75], v[56:59], v[244:247]
    v_mfma_f32_16x16x32_bf16 v[244:247], v[76:79], v[60:63], v[244:247]
    s_add_u32 m0, s51, 151552
    s_add_u32 s53, s57, 33152
    buffer_load_dwordx4 v2, s[28:31], s53 offen lds
    v_mfma_f32_16x16x32_bf16 v[248:251], v[56:59], v[80:83], v[248:251]
    v_mfma_f32_16x16x32_bf16 v[248:251], v[60:63], v[84:87], v[248:251]
    v_mfma_f32_16x16x32_bf16 v[252:255], v[56:59], v[88:91], v[252:255]
    v_mfma_f32_16x16x32_bf16 v[252:255], v[60:63], v[92:95], v[252:255]
    ds_read_b128 v[56:59], v16 offset:38912
    ds_read_b128 v[60:63], v17 offset:38912
    s_waitcnt lgkmcnt(6)
    v_mfma_f32_16x16x32_bf16 v[128:131], v[96:99], v[32:35], v[128:131]
    v_mfma_f32_16x16x32_bf16 v[128:131], v[100:103], v[36:39], v[128:131]
    v_mfma_f32_16x16x32_bf16 v[132:135], v[104:107], v[32:35], v[132:135]
    s_add_u32 m0, s51, 155648
    s_add_u32 s53, s57, 65920
    buffer_load_dwordx4 v2, s[28:31], s53 offen lds
    v_mfma_f32_16x16x32_bf16 v[132:135], v[108:111], v[36:39], v[132:135]
    v_mfma_f32_16x16x32_bf16 v[136:139], v[32:35], v[112:115], v[136:139]
    s_add_u32 m0, s51, 159744
    s_add_u32 s53, s57, 98688
    buffer_load_dwordx4 v2, s[28:31], s53 offen lds
    v_mfma_f32_16x16x32_bf16 v[136:139], v[36:39], v[116:119], v[136:139]
    v_mfma_f32_16x16x32_bf16 v[140:143], v[32:35], v[120:123], v[140:143]
    v_mfma_f32_16x16x32_bf16 v[140:143], v[36:39], v[124:127], v[140:143]
    ds_read_b128 v[32:35], v16 offset:40960
    ds_read_b128 v[36:39], v17 offset:40960
    s_waitcnt lgkmcnt(6)
    v_mfma_f32_16x16x32_bf16 v[144:147], v[96:99], v[40:43], v[144:147]
    s_add_u32 m0, s51, 0
    s_mov_b32 s53, 394240
    buffer_load_dwordx4 v4, s[12:15], s53 offen lds
    v_mfma_f32_16x16x32_bf16 v[144:147], v[100:103], v[44:47], v[144:147]
    v_mfma_f32_16x16x32_bf16 v[148:151], v[104:107], v[40:43], v[148:151]
    s_add_u32 m0, s51, 4096
    s_mov_b32 s53, 590848
    buffer_load_dwordx4 v4, s[12:15], s53 offen lds
    v_mfma_f32_16x16x32_bf16 v[148:151], v[108:111], v[44:47], v[148:151]
    v_mfma_f32_16x16x32_bf16 v[152:155], v[40:43], v[112:115], v[152:155]
    v_mfma_f32_16x16x32_bf16 v[152:155], v[44:47], v[116:119], v[152:155]
    s_add_u32 m0, s51, 8192
    s_mov_b32 s53, 395264
    buffer_load_dwordx4 v4, s[12:15], s53 offen lds
    v_mfma_f32_16x16x32_bf16 v[156:159], v[40:43], v[120:123], v[156:159]
    v_mfma_f32_16x16x32_bf16 v[156:159], v[44:47], v[124:127], v[156:159]
    ds_read_b128 v[40:43], v16 offset:43008
    ds_read_b128 v[44:47], v17 offset:43008
    s_waitcnt lgkmcnt(6)
    v_mfma_f32_16x16x32_bf16 v[160:163], v[96:99], v[48:51], v[160:163]
    v_mfma_f32_16x16x32_bf16 v[160:163], v[100:103], v[52:55], v[160:163]
    s_add_u32 m0, s51, 12288
    s_mov_b32 s53, 591872
    buffer_load_dwordx4 v4, s[12:15], s53 offen lds
    v_mfma_f32_16x16x32_bf16 v[164:167], v[104:107], v[48:51], v[164:167]
    v_mfma_f32_16x16x32_bf16 v[164:167], v[108:111], v[52:55], v[164:167]
    s_add_u32 m0, s51, 16384
    s_mov_b32 s53, 786432
    buffer_load_dwordx4 v4, s[12:15], s53 offen lds
    v_mfma_f32_16x16x32_bf16 v[168:171], v[48:51], v[112:115], v[168:171]
    v_mfma_f32_16x16x32_bf16 v[168:171], v[52:55], v[116:119], v[168:171]
    v_mfma_f32_16x16x32_bf16 v[172:175], v[48:51], v[120:123], v[172:175]
    s_add_u32 m0, s51, 20480
    s_mov_b32 s53, 983040
    buffer_load_dwordx4 v4, s[12:15], s53 offen lds
    v_mfma_f32_16x16x32_bf16 v[172:175], v[52:55], v[124:127], v[172:175]
    ds_read_b128 v[48:51], v16 offset:45056
    ds_read_b128 v[52:55], v17 offset:45056
    s_waitcnt lgkmcnt(6)
    v_mfma_f32_16x16x32_bf16 v[176:179], v[96:99], v[56:59], v[176:179]
    v_mfma_f32_16x16x32_bf16 v[176:179], v[100:103], v[60:63], v[176:179]
    s_add_u32 m0, s51, 24576
    s_mov_b32 s53, 787456
    buffer_load_dwordx4 v4, s[12:15], s53 offen lds
    v_mfma_f32_16x16x32_bf16 v[180:183], v[104:107], v[56:59], v[180:183]
    v_mfma_f32_16x16x32_bf16 v[180:183], v[108:111], v[60:63], v[180:183]
    v_mfma_f32_16x16x32_bf16 v[184:187], v[56:59], v[112:115], v[184:187]
    s_add_u32 m0, s51, 28672
    s_mov_b32 s53, 984064
    buffer_load_dwordx4 v4, s[12:15], s53 offen lds
    v_mfma_f32_16x16x32_bf16 v[184:187], v[60:63], v[116:119], v[184:187]
    v_mfma_f32_16x16x32_bf16 v[188:191], v[56:59], v[120:123], v[188:191]
    v_mfma_f32_16x16x32_bf16 v[188:191], v[60:63], v[124:127], v[188:191]
    ds_read_b128 v[56:59], v16 offset:47104
    ds_read_b128 v[60:63], v17 offset:47104
    s_waitcnt lgkmcnt(6)
    v_mfma_f32_16x16x32_bf16 v[192:195], v[96:99], v[32:35], v[192:195]
    v_mfma_f32_16x16x32_bf16 v[192:195], v[100:103], v[36:39], v[192:195]
    v_mfma_f32_16x16x32_bf16 v[196:199], v[104:107], v[32:35], v[196:199]
    v_mfma_f32_16x16x32_bf16 v[196:199], v[108:111], v[36:39], v[196:199]
    v_mfma_f32_16x16x32_bf16 v[200:203], v[32:35], v[112:115], v[200:203]
    v_mfma_f32_16x16x32_bf16 v[200:203], v[36:39], v[116:119], v[200:203]
    v_mfma_f32_16x16x32_bf16 v[204:207], v[32:35], v[120:123], v[204:207]
    s_waitcnt lgkmcnt(0)
    s_barrier
    v_mfma_f32_16x16x32_bf16 v[204:207], v[36:39], v[124:127], v[204:207]
    v_mfma_f32_16x16x32_bf16 v[208:211], v[96:99], v[40:43], v[208:211]
    s_add_u32 m0, s51, 32768
    s_mov_b32 s53, 788480
    buffer_load_dwordx4 v4, s[12:15], s53 offen lds
    v_mfma_f32_16x16x32_bf16 v[208:211], v[100:103], v[44:47], v[208:211]
    v_mfma_f32_16x16x32_bf16 v[212:215], v[104:107], v[40:43], v[212:215]
    s_add_u32 m0, s51, 36864
    s_mov_b32 s53, 985088
    buffer_load_dwordx4 v4, s[12:15], s53 offen lds
    v_mfma_f32_16x16x32_bf16 v[212:215], v[108:111], v[44:47], v[212:215]
    v_mfma_f32_16x16x32_bf16 v[216:219], v[40:43], v[112:115], v[216:219]
    v_mfma_f32_16x16x32_bf16 v[216:219], v[44:47], v[116:119], v[216:219]
    s_add_u32 m0, s51, 40960
    s_mov_b32 s53, 1179648
    buffer_load_dwordx4 v4, s[12:15], s53 offen lds
    v_mfma_f32_16x16x32_bf16 v[220:223], v[40:43], v[120:123], v[220:223]
    v_mfma_f32_16x16x32_bf16 v[220:223], v[44:47], v[124:127], v[220:223]
    v_mfma_f32_16x16x32_bf16 v[224:227], v[96:99], v[48:51], v[224:227]
    s_add_u32 m0, s51, 45056
    s_mov_b32 s53, 1376256
    buffer_load_dwordx4 v4, s[12:15], s53 offen lds
    v_mfma_f32_16x16x32_bf16 v[224:227], v[100:103], v[52:55], v[224:227]
    v_mfma_f32_16x16x32_bf16 v[228:231], v[104:107], v[48:51], v[228:231]
    v_mfma_f32_16x16x32_bf16 v[228:231], v[108:111], v[52:55], v[228:231]
    s_add_u32 m0, s51, 49152
    s_mov_b32 s53, 1180672
    buffer_load_dwordx4 v4, s[12:15], s53 offen lds
    v_mfma_f32_16x16x32_bf16 v[232:235], v[48:51], v[112:115], v[232:235]
    v_mfma_f32_16x16x32_bf16 v[232:235], v[52:55], v[116:119], v[232:235]
    v_mfma_f32_16x16x32_bf16 v[236:239], v[48:51], v[120:123], v[236:239]
    s_add_u32 m0, s51, 53248
    s_mov_b32 s53, 1377280
    buffer_load_dwordx4 v4, s[12:15], s53 offen lds
    v_mfma_f32_16x16x32_bf16 v[236:239], v[52:55], v[124:127], v[236:239]
    v_mfma_f32_16x16x32_bf16 v[240:243], v[96:99], v[56:59], v[240:243]
    v_mfma_f32_16x16x32_bf16 v[240:243], v[100:103], v[60:63], v[240:243]
    s_add_u32 m0, s51, 57344
    s_mov_b32 s53, 1181696
    buffer_load_dwordx4 v4, s[12:15], s53 offen lds
    v_mfma_f32_16x16x32_bf16 v[244:247], v[104:107], v[56:59], v[244:247]
    v_mfma_f32_16x16x32_bf16 v[244:247], v[108:111], v[60:63], v[244:247]
    v_mfma_f32_16x16x32_bf16 v[248:251], v[56:59], v[112:115], v[248:251]
    s_add_u32 m0, s51, 61440
    s_mov_b32 s53, 1378304
    buffer_load_dwordx4 v4, s[12:15], s53 offen lds
    v_mfma_f32_16x16x32_bf16 v[248:251], v[60:63], v[116:119], v[248:251]
    v_mfma_f32_16x16x32_bf16 v[252:255], v[56:59], v[120:123], v[252:255]
    v_mfma_f32_16x16x32_bf16 v[252:255], v[60:63], v[124:127], v[252:255]
    s_waitcnt vmcnt(26)
    s_barrier
    ds_read_b128 v[32:35], v12 offset:0
    ds_read_b128 v[36:39], v12 offset:2048
    ds_read_b64_tr_b16 v[40:41], v15 offset:0
    ds_read_b64_tr_b16 v[42:43], v15 offset:256
    ds_read_b64_tr_b16 v[44:45], v15 offset:8192
    ds_read_b64_tr_b16 v[46:47], v15 offset:8448
    ds_read_b64_tr_b16 v[48:49], v15 offset:16384
    ds_read_b64_tr_b16 v[50:51], v15 offset:16640
    ds_read_b128 v[52:55], v13 offset:0
    ds_read_b128 v[56:59], v13 offset:2048
    ds_read_b64_tr_b16 v[60:61], v15 offset:2048
    ds_read_b64_tr_b16 v[62:63], v15 offset:2304
    ds_read_b64_tr_b16 v[64:65], v15 offset:10240
    ds_read_b64_tr_b16 v[66:67], v15 offset:10496
    ds_read_b64_tr_b16 v[68:69], v15 offset:18432
    ds_read_b64_tr_b16 v[70:71], v15 offset:18688
    s_mov_b32 s36, s4
    s_mov_b32 s37, s5
    s_mov_b32 s38, 0x200000
    s_mov_b32 s39, 0x20000
    s_mov_b32 s40, s8
    s_mov_b32 s41, s9
    s_mov_b32 s42, 0x400000
    s_mov_b32 s43, 0x20000
    s_lshl_b32 s52, s49, 6
    s_lshl_b32 s53, s50, 3
    s_add_u32 s52, s52, s53
    s_add_u32 s52, s52, 4
    s_lshl_b32 s52, s52, 13
    s_add_u32 s64, s51, s52
    s_add_u32 s65, s64, s51
    s_add_u32 s65, s65, 16777216
    v_cvt_pk_bf16_f32 v72, v128, v129
    v_cvt_pk_bf16_f32 v73, v130, v131
    v_cvt_pk_bf16_f32 v74, v132, v133
    v_cvt_pk_bf16_f32 v75, v134, v135
    v_cvt_pk_bf16_f32 v76, v144, v145
    v_cvt_pk_bf16_f32 v77, v146, v147
    v_cvt_pk_bf16_f32 v78, v148, v149
    v_cvt_pk_bf16_f32 v79, v150, v151
    v_cvt_pk_bf16_f32 v80, v136, v137
    v_cvt_pk_bf16_f32 v81, v138, v139
    v_cvt_pk_bf16_f32 v82, v152, v153
    v_cvt_pk_bf16_f32 v83, v154, v155
    v_cvt_pk_bf16_f32 v84, v140, v141
    v_cvt_pk_bf16_f32 v85, v142, v143
    v_cvt_pk_bf16_f32 v86, v156, v157
    v_cvt_pk_bf16_f32 v87, v158, v159
    s_lshl_b32 s60, s55, 17
    s_lshl_b32 s61, s50, 17
    s_waitcnt lgkmcnt(8)
    s_barrier
    v_mfma_f32_16x16x32_bf16 v[88:91], v[40:43], v[32:35], 0
    ds_read_b128 v[112:115], v12 offset:16384
    v_cvt_pk_bf16_f32 v136, v160, v161
    s_add_u32 s54, s64, 0
    buffer_store_dwordx4 v[72:75], v1, s[44:47], s54 offen sc1
    v_mfma_f32_16x16x32_bf16 v[92:95], v[40:43], v[36:39], 0
    ds_read_b128 v[116:119], v12 offset:18432
    v_cvt_pk_bf16_f32 v137, v162, v163
    v_mfma_f32_16x16x32_bf16 v[96:99], v[44:47], v[32:35], 0
    ds_read_b64_tr_b16 v[120:121], v15 offset:4096
    v_cvt_pk_bf16_f32 v138, v164, v165
    v_mfma_f32_16x16x32_bf16 v[100:103], v[44:47], v[36:39], 0
    ds_read_b64_tr_b16 v[122:123], v15 offset:4352
    v_cvt_pk_bf16_f32 v139, v166, v167
    v_mfma_f32_16x16x32_bf16 v[104:107], v[32:35], v[48:51], 0
    ds_read_b64_tr_b16 v[124:125], v15 offset:12288
    ds_read_b64_tr_b16 v[126:127], v15 offset:12544
    v_cvt_pk_bf16_f32 v140, v176, v177
    v_mfma_f32_16x16x32_bf16 v[108:111], v[36:39], v[48:51], 0
    ds_read_b64_tr_b16 v[128:129], v15 offset:20480
    ds_read_b64_tr_b16 v[130:131], v15 offset:20736
    v_cvt_pk_bf16_f32 v141, v178, v179
    s_waitcnt lgkmcnt(8)
    v_mfma_f32_16x16x32_bf16 v[88:91], v[60:63], v[52:55], v[88:91]
    ds_read_b128 v[32:35], v13 offset:16384
    v_cvt_pk_bf16_f32 v142, v180, v181
    v_mfma_f32_16x16x32_bf16 v[92:95], v[60:63], v[56:59], v[92:95]
    ds_read_b128 v[36:39], v13 offset:18432
    v_cvt_pk_bf16_f32 v143, v182, v183
    v_mfma_f32_16x16x32_bf16 v[96:99], v[64:67], v[52:55], v[96:99]
    ds_read_b64_tr_b16 v[40:41], v15 offset:6144
    v_cvt_pk_bf16_f32 v144, v168, v169
    v_mfma_f32_16x16x32_bf16 v[100:103], v[64:67], v[56:59], v[100:103]
    ds_read_b64_tr_b16 v[42:43], v15 offset:6400
    v_cvt_pk_bf16_f32 v145, v170, v171
    v_mfma_f32_16x16x32_bf16 v[104:107], v[52:55], v[68:71], v[104:107]
    ds_read_b64_tr_b16 v[44:45], v15 offset:14336
    ds_read_b64_tr_b16 v[46:47], v15 offset:14592
    v_cvt_pk_bf16_f32 v146, v184, v185
    v_mfma_f32_16x16x32_bf16 v[108:111], v[56:59], v[68:71], v[108:111]
    ds_read_b64_tr_b16 v[48:49], v15 offset:22528
    ds_read_b64_tr_b16 v[50:51], v15 offset:22784
    v_cvt_pk_bf16_f32 v147, v186, v187
    s_waitcnt lgkmcnt(8)
    s_waitcnt vmcnt(13)
    s_barrier
    v_mfma_f32_16x16x32_bf16 v[88:91], v[120:123], v[112:115], v[88:91]
    ds_read_b128 v[52:55], v12 offset:32768
    v_cvt_pk_bf16_f32 v148, v172, v173
    s_add_u32 m0, s51, 98304
    s_add_u32 s53, s57, 512
    buffer_load_dwordx4 v2, s[28:31], s53 offen lds
    v_mfma_f32_16x16x32_bf16 v[92:95], v[120:123], v[116:119], v[92:95]
    ds_read_b128 v[56:59], v12 offset:34816
    v_cvt_pk_bf16_f32 v149, v174, v175
    v_mfma_f32_16x16x32_bf16 v[96:99], v[124:127], v[112:115], v[96:99]
    ds_read_b64_tr_b16 v[60:61], v15 offset:24576
    v_cvt_pk_bf16_f32 v150, v188, v189
    s_add_u32 m0, s51, 102400
    s_add_u32 s53, s57, 33280
    buffer_load_dwordx4 v2, s[28:31], s53 offen lds
    v_mfma_f32_16x16x32_bf16 v[100:103], v[124:127], v[116:119], v[100:103]
    ds_read_b64_tr_b16 v[62:63], v15 offset:24832
    v_cvt_pk_bf16_f32 v151, v190, v191
    v_mfma_f32_16x16x32_bf16 v[104:107], v[112:115], v[128:131], v[104:107]
    ds_read_b64_tr_b16 v[64:65], v14 offset:0
    ds_read_b64_tr_b16 v[66:67], v14 offset:256
    v_cvt_pk_bf16_f32 v152, v192, v193
    s_cmp_lt_u32 s50, 2
    s_cbranch_scc0 m_l_g1
    s_add_u32 s54, s64, 4096
    buffer_store_dwordx4 v[76:79], v1, s[44:47], s54 offen sc1
m_l_g1:
    v_mfma_f32_16x16x32_bf16 v[108:111], v[116:119], v[128:131], v[108:111]
    ds_read_b64_tr_b16 v[68:69], v14 offset:8192
    ds_read_b64_tr_b16 v[70:71], v14 offset:8448
    v_cvt_pk_bf16_f32 v153, v194, v195
    s_waitcnt lgkmcnt(8)
    v_mfma_f32_16x16x32_bf16 v[88:91], v[40:43], v[32:35], v[88:91]
    ds_read_b128 v[112:115], v13 offset:32768
    v_cvt_pk_bf16_f32 v154, v196, v197
    s_add_u32 m0, s51, 106496
    s_add_u32 s53, s57, 66048
    buffer_load_dwordx4 v2, s[28:31], s53 offen lds
    v_mfma_f32_16x16x32_bf16 v[92:95], v[40:43], v[36:39], v[92:95]
    ds_read_b128 v[116:119], v13 offset:34816
    v_cvt_pk_bf16_f32 v155, v198, v199
    v_mfma_f32_16x16x32_bf16 v[96:99], v[44:47], v[32:35], v[96:99]
    ds_read_b64_tr_b16 v[120:121], v15 offset:26624
    v_cvt_pk_bf16_f32 v156, v208, v209
    v_mfma_f32_16x16x32_bf16 v[100:103], v[44:47], v[36:39], v[100:103]
    ds_read_b64_tr_b16 v[122:123], v15 offset:26880
    v_cvt_pk_bf16_f32 v157, v210, v211
    s_add_u32 m0, s51, 110592
    s_add_u32 s53, s57, 98816
    buffer_load_dwordx4 v2, s[28:31], s53 offen lds
    v_mfma_f32_16x16x32_bf16 v[104:107], v[32:35], v[48:51], v[104:107]
    ds_read_b64_tr_b16 v[124:125], v14 offset:2048
    ds_read_b64_tr_b16 v[126:127], v14 offset:2304
    v_cvt_pk_bf16_f32 v158, v212, v213
    v_mfma_f32_16x16x32_bf16 v[108:111], v[36:39], v[48:51], v[108:111]
    ds_read_b64_tr_b16 v[128:129], v14 offset:10240
    ds_read_b64_tr_b16 v[130:131], v14 offset:10496
    v_cvt_pk_bf16_f32 v159, v214, v215
    s_waitcnt lgkmcnt(8)
    s_barrier
    v_mfma_f32_16x16x32_bf16 v[88:91], v[60:63], v[52:55], v[88:91]
    ds_read_b128 v[32:35], v12 offset:49152
    v_cvt_pk_bf16_f32 v160, v200, v201
    s_add_u32 m0, s51, 114688
    s_add_u32 s53, s57, 640
    buffer_load_dwordx4 v2, s[28:31], s53 offen lds
    v_mfma_f32_16x16x32_bf16 v[92:95], v[60:63], v[56:59], v[92:95]
    ds_read_b128 v[36:39], v12 offset:51200
    v_cvt_pk_bf16_f32 v161, v202, v203
    v_mfma_f32_16x16x32_bf16 v[96:99], v[64:67], v[52:55], v[96:99]
    ds_read_b64_tr_b16 v[40:41], v15 offset:28672
    v_cvt_pk_bf16_f32 v162, v216, v217
    s_cmp_lt_u32 s50, 2
    s_cbranch_scc1 m_l_g2
    s_add_u32 s54, s64, 4096
    buffer_store_dwordx4 v[76:79], v1, s[44:47], s54 offen sc1
m_l_g2:
    v_mfma_f32_16x16x32_bf16 v[100:103], v[64:67], v[56:59], v[100:103]
    ds_read_b64_tr_b16 v[42:43], v15 offset:28928
    v_cvt_pk_bf16_f32 v163, v218, v219
    v_mfma_f32_16x16x32_bf16 v[104:107], v[52:55], v[68:71], v[104:107]
    ds_read_b64_tr_b16 v[44:45], v14 offset:4096
    ds_read_b64_tr_b16 v[46:47], v14 offset:4352
    v_cvt_pk_bf16_f32 v164, v204, v205
    s_add_u32 m0, s51, 118784
    s_add_u32 s53, s57, 33408
    buffer_load_dwordx4 v2, s[28:31], s53 offen lds
    v_mfma_f32_16x16x32_bf16 v[108:111], v[56:59], v[68:71], v[108:111]
    ds_read_b64_tr_b16 v[48:49], v14 offset:12288
    ds_read_b64_tr_b16 v[50:51], v14 offset:12544
    v_cvt_pk_bf16_f32 v165, v206, v207
    s_waitcnt lgkmcnt(8)
    v_mfma_f32_16x16x32_bf16 v[88:91], v[120:123], v[112:115], v[88:91]
    ds_read_b128 v[52:55], v13 offset:49152
    v_cvt_pk_bf16_f32 v166, v220, v221
    s_add_u32 m0, s51, 122880
    s_add_u32 s53, s57, 66176
    buffer_load_dwordx4 v2, s[28:31], s53 offen lds
    v_mfma_f32_16x16x32_bf16 v[92:95], v[120:123], v[116:119], v[92:95]
    ds_read_b128 v[56:59], v13 offset:51200
    v_cvt_pk_bf16_f32 v167, v222, v223
    v_mfma_f32_16x16x32_bf16 v[96:99], v[124:127], v[112:115], v[96:99]
    ds_read_b64_tr_b16 v[60:61], v15 offset:30720
    v_cvt_pk_bf16_f32 v172, v224, v225
    s_cmp_lt_u32 s50, 2
    s_cbranch_scc0 m_l_g3
    s_add_u32 s54, s65, 0
    buffer_store_dwordx4 v[80:83], v1, s[44:47], s54 offen sc1
m_l_g3:
    v_mfma_f32_16x16x32_bf16 v[100:103], v[124:127], v[116:119], v[100:103]
    ds_read_b64_tr_b16 v[62:63], v15 offset:30976
    v_cvt_pk_bf16_f32 v173, v226, v227
    v_mfma_f32_16x16x32_bf16 v[104:107], v[112:115], v[128:131], v[104:107]
    ds_read_b64_tr_b16 v[64:65], v14 offset:6144
    ds_read_b64_tr_b16 v[66:67], v14 offset:6400
    v_cvt_pk_bf16_f32 v174, v228, v229
    s_add_u32 m0, s51, 126976
    s_add_u32 s53, s57, 98944
    buffer_load_dwordx4 v2, s[28:31], s53 offen lds
    v_mfma_f32_16x16x32_bf16 v[108:111], v[116:119], v[128:131], v[108:111]
    ds_read_b64_tr_b16 v[68:69], v14 offset:14336
    ds_read_b64_tr_b16 v[70:71], v14 offset:14592
    v_cvt_pk_bf16_f32 v175, v230, v231
    s_waitcnt lgkmcnt(8)
    s_waitcnt vmcnt(4)
    s_barrier
    v_mfma_f32_16x16x32_bf16 v[88:91], v[40:43], v[32:35], v[88:91]
    ds_read_b128 v[112:115], v12 offset:0
    v_cvt_pk_bf16_f32 v176, v240, v241
    s_add_u32 m0, s51, 131072
    s_add_u32 s53, s57, 768
    buffer_load_dwordx4 v2, s[28:31], s53 offen lds
    v_mfma_f32_16x16x32_bf16 v[92:95], v[40:43], v[36:39], v[92:95]
    ds_read_b128 v[116:119], v12 offset:2048
    v_cvt_pk_bf16_f32 v177, v242, v243
    v_mfma_f32_16x16x32_bf16 v[96:99], v[44:47], v[32:35], v[96:99]
    ds_read_b64_tr_b16 v[120:121], v14 offset:16384
    v_cvt_pk_bf16_f32 v178, v244, v245
    s_add_u32 m0, s51, 135168
    s_add_u32 s53, s57, 33536
    buffer_load_dwordx4 v2, s[28:31], s53 offen lds
    v_mfma_f32_16x16x32_bf16 v[100:103], v[44:47], v[36:39], v[100:103]
    ds_read_b64_tr_b16 v[122:123], v14 offset:16640
    v_cvt_pk_bf16_f32 v179, v246, v247
    v_mfma_f32_16x16x32_bf16 v[104:107], v[32:35], v[48:51], v[104:107]
    ds_read_b64_tr_b16 v[124:125], v14 offset:24576
    ds_read_b64_tr_b16 v[126:127], v14 offset:24832
    v_cvt_pk_bf16_f32 v180, v232, v233
    s_cmp_lt_u32 s50, 2
    s_cbranch_scc0 m_l_g4
    s_add_u32 s54, s65, 1024
    buffer_store_dwordx4 v[84:87], v1, s[44:47], s54 offen sc1
m_l_g4:
    v_mfma_f32_16x16x32_bf16 v[108:111], v[36:39], v[48:51], v[108:111]
    ds_read_b64_tr_b16 v[128:129], v14 offset:32768
    ds_read_b64_tr_b16 v[130:131], v14 offset:33024
    v_cvt_pk_bf16_f32 v181, v234, v235
    s_waitcnt lgkmcnt(8)
    v_mfma_f32_16x16x32_bf16 v[88:91], v[60:63], v[52:55], v[88:91]
    ds_read_b128 v[32:35], v13 offset:0
    v_cvt_pk_bf16_f32 v182, v248, v249
    s_add_u32 m0, s51, 139264
    s_add_u32 s53, s57, 66304
    buffer_load_dwordx4 v2, s[28:31], s53 offen lds
    v_mfma_f32_16x16x32_bf16 v[92:95], v[60:63], v[56:59], v[92:95]
    ds_read_b128 v[36:39], v13 offset:2048
    v_cvt_pk_bf16_f32 v183, v250, v251
    v_mfma_f32_16x16x32_bf16 v[96:99], v[64:67], v[52:55], v[96:99]
    ds_read_b64_tr_b16 v[40:41], v14 offset:18432
    v_cvt_pk_bf16_f32 v248, v236, v237
    v_mfma_f32_16x16x32_bf16 v[100:103], v[64:67], v[56:59], v[100:103]
    ds_read_b64_tr_b16 v[42:43], v14 offset:18688
    v_cvt_pk_bf16_f32 v249, v238, v239
    s_add_u32 m0, s51, 143360
    s_add_u32 s53, s57, 99072
    buffer_load_dwordx4 v2, s[28:31], s53 offen lds
    v_mfma_f32_16x16x32_bf16 v[104:107], v[52:55], v[68:71], v[104:107]
    ds_read_b64_tr_b16 v[44:45], v14 offset:26624
    ds_read_b64_tr_b16 v[46:47], v14 offset:26880
    v_cvt_pk_bf16_f32 v250, v252, v253
    v_mfma_f32_16x16x32_bf16 v[108:111], v[56:59], v[68:71], v[108:111]
    ds_read_b64_tr_b16 v[48:49], v14 offset:34816
    ds_read_b64_tr_b16 v[50:51], v14 offset:35072
    v_cvt_pk_bf16_f32 v251, v254, v255
    s_waitcnt lgkmcnt(8)
    s_waitcnt vmcnt(4)
    s_barrier
    v_mfma_f32_16x16x32_bf16 v[88:91], v[120:123], v[112:115], v[88:91]
    ds_read_b128 v[52:55], v12 offset:16384
    s_add_u32 m0, s51, 147456
    s_add_u32 s53, s57, 896
    buffer_load_dwordx4 v2, s[28:31], s53 offen lds
    s_add_u32 m0, s51, 151552
    s_add_u32 s53, s57, 33664
    buffer_load_dwordx4 v2, s[28:31], s53 offen lds
    v_mfma_f32_16x16x32_bf16 v[92:95], v[120:123], v[116:119], v[92:95]
    ds_read_b128 v[56:59], v12 offset:18432
    s_add_u32 m0, s51, 155648
    s_add_u32 s53, s57, 66432
    buffer_load_dwordx4 v2, s[28:31], s53 offen lds
    v_mfma_f32_16x16x32_bf16 v[96:99], v[124:127], v[112:115], v[96:99]
    ds_read_b64_tr_b16 v[60:61], v14 offset:20480
    s_add_u32 m0, s51, 159744
    s_add_u32 s53, s57, 99200
    buffer_load_dwordx4 v2, s[28:31], s53 offen lds
    s_cmp_lt_u32 s50, 2
    s_cbranch_scc1 m_l_g5
    s_add_u32 s54, s65, 0
    buffer_store_dwordx4 v[80:83], v1, s[44:47], s54 offen sc1
m_l_g5:
    v_mfma_f32_16x16x32_bf16 v[100:103], v[124:127], v[116:119], v[100:103]
    ds_read_b64_tr_b16 v[62:63], v14 offset:20736
    s_add_u32 m0, s51, 0
    s_mov_b32 s53, 0
    buffer_load_dwordx4 v3, s[40:43], s53 offen lds
    v_mfma_f32_16x16x32_bf16 v[104:107], v[112:115], v[128:131], v[104:107]
    ds_read_b64_tr_b16 v[64:65], v14 offset:28672
    ds_read_b64_tr_b16 v[66:67], v14 offset:28928
    s_add_u32 m0, s51, 4096
    s_mov_b32 s53, 131072
    buffer_load_dwordx4 v3, s[40:43], s53 offen lds
    s_add_u32 m0, s51, 8192
    s_mov_b32 s53, 262144
    buffer_load_dwordx4 v3, s[40:43], s53 offen lds
    v_mfma_f32_16x16x32_bf16 v[108:111], v[116:119], v[128:131], v[108:111]
    ds_read_b64_tr_b16 v[68:69], v14 offset:36864
    ds_read_b64_tr_b16 v[70:71], v14 offset:37120
    s_add_u32 m0, s51, 12288
    s_mov_b32 s53, 393216
    buffer_load_dwordx4 v3, s[40:43], s53 offen lds
    s_waitcnt lgkmcnt(8)
    v_mfma_f32_16x16x32_bf16 v[88:91], v[40:43], v[32:35], v[88:91]
    ds_read_b128 v[112:115], v13 offset:16384
    s_add_u32 m0, s51, 65536
    s_add_u32 s53, s60, 0
    buffer_load_dwordx4 v2, s[36:39], s53 offen lds
    s_add_u32 m0, s51, 69632
    s_add_u32 s53, s60, 32768
    buffer_load_dwordx4 v2, s[36:39], s53 offen lds
    v_mfma_f32_16x16x32_bf16 v[92:95], v[40:43], v[36:39], v[92:95]
    ds_read_b128 v[116:119], v13 offset:18432
    s_add_u32 m0, s51, 73728
    s_add_u32 s53, s60, 65536
    buffer_load_dwordx4 v2, s[36:39], s53 offen lds
    v_mfma_f32_16x16x32_bf16 v[96:99], v[44:47], v[32:35], v[96:99]
    ds_read_b64_tr_b16 v[120:121], v14 offset:22528
    s_add_u32 m0, s51, 77824
    s_add_u32 s53, s60, 98304
    buffer_load_dwordx4 v2, s[36:39], s53 offen lds
    s_cmp_lt_u32 s50, 2
    s_cbranch_scc0 m_l_g6
    s_add_u32 s54, s64, 8192
    buffer_store_dwordx4 v[136:139], v1, s[44:47], s54 offen sc1
m_l_g6:
    v_mfma_f32_16x16x32_bf16 v[100:103], v[44:47], v[36:39], v[100:103]
    ds_read_b64_tr_b16 v[122:123], v14 offset:22784
    s_add_u32 m0, s51, 81920
    s_add_u32 s53, s61, 0
    buffer_load_dwordx4 v2, s[36:39], s53 offen lds
    v_mfma_f32_16x16x32_bf16 v[104:107], v[32:35], v[48:51], v[104:107]
    ds_read_b64_tr_b16 v[124:125], v14 offset:30720
    ds_read_b64_tr_b16 v[126:127], v14 offset:30976
    s_add_u32 m0, s51, 86016
    s_add_u32 s53, s61, 32768
    buffer_load_dwordx4 v2, s[36:39], s53 offen lds
    s_add_u32 m0, s51, 90112
    s_add_u32 s53, s61, 65536
    buffer_load_dwordx4 v2, s[36:39], s53 offen lds
    v_mfma_f32_16x16x32_bf16 v[108:111], v[36:39], v[48:51], v[108:111]
    ds_read_b64_tr_b16 v[128:129], v14 offset:38912
    ds_read_b64_tr_b16 v[130:131], v14 offset:39168
    s_add_u32 m0, s51, 94208
    s_add_u32 s53, s61, 98304
    buffer_load_dwordx4 v2, s[36:39], s53 offen lds
    s_waitcnt lgkmcnt(8)
    s_waitcnt vmcnt(16)
    s_barrier
    v_mfma_f32_16x16x32_bf16 v[88:91], v[60:63], v[52:55], v[88:91]
    ds_read_b128 v[32:35], v12 offset:32768
    s_cmp_lt_u32 s50, 2
    s_cbranch_scc0 m_l_g7
    s_add_u32 s54, s64, 12288
    buffer_store_dwordx4 v[140:143], v1, s[44:47], s54 offen sc1
m_l_g7:
    v_mfma_f32_16x16x32_bf16 v[92:95], v[60:63], v[56:59], v[92:95]
    ds_read_b128 v[36:39], v12 offset:34816
    v_mfma_f32_16x16x32_bf16 v[96:99], v[64:67], v[52:55], v[96:99]
    ds_read_b64_tr_b16 v[40:41], v14 offset:40960
    v_mfma_f32_16x16x32_bf16 v[100:103], v[64:67], v[56:59], v[100:103]
    ds_read_b64_tr_b16 v[42:43], v14 offset:41216
    v_mfma_f32_16x16x32_bf16 v[104:107], v[52:55], v[68:71], v[104:107]
    ds_read_b64_tr_b16 v[44:45], v14 offset:49152
    ds_read_b64_tr_b16 v[46:47], v14 offset:49408
    v_mfma_f32_16x16x32_bf16 v[108:111], v[56:59], v[68:71], v[108:111]
    ds_read_b64_tr_b16 v[48:49], v14 offset:57344
    ds_read_b64_tr_b16 v[50:51], v14 offset:57600
    s_waitcnt lgkmcnt(8)
    v_mfma_f32_16x16x32_bf16 v[88:91], v[120:123], v[112:115], v[88:91]
    ds_read_b128 v[52:55], v13 offset:32768
    v_mfma_f32_16x16x32_bf16 v[92:95], v[120:123], v[116:119], v[92:95]
    ds_read_b128 v[56:59], v13 offset:34816
    v_mfma_f32_16x16x32_bf16 v[96:99], v[124:127], v[112:115], v[96:99]
    ds_read_b64_tr_b16 v[60:61], v14 offset:43008
    v_mfma_f32_16x16x32_bf16 v[100:103], v[124:127], v[116:119], v[100:103]
    ds_read_b64_tr_b16 v[62:63], v14 offset:43264
    v_mfma_f32_16x16x32_bf16 v[104:107], v[112:115], v[128:131], v[104:107]
    ds_read_b64_tr_b16 v[64:65], v14 offset:51200
    ds_read_b64_tr_b16 v[66:67], v14 offset:51456
    v_mfma_f32_16x16x32_bf16 v[108:111], v[116:119], v[128:131], v[108:111]
    ds_read_b64_tr_b16 v[68:69], v14 offset:59392
    ds_read_b64_tr_b16 v[70:71], v14 offset:59648
    s_waitcnt lgkmcnt(8)
    s_waitcnt vmcnt(12)
    s_barrier
    v_mfma_f32_16x16x32_bf16 v[88:91], v[40:43], v[32:35], v[88:91]
    ds_read_b128 v[112:115], v12 offset:49152
    s_add_u32 m0, s51, 16384
    s_mov_b32 s53, 524288
    buffer_load_dwordx4 v3, s[40:43], s53 offen lds
    s_add_u32 m0, s51, 20480
    s_mov_b32 s53, 655360
    buffer_load_dwordx4 v3, s[40:43], s53 offen lds
    v_mfma_f32_16x16x32_bf16 v[92:95], v[40:43], v[36:39], v[92:95]
    ds_read_b128 v[116:119], v12 offset:51200
    s_add_u32 m0, s51, 24576
    s_mov_b32 s53, 786432
    buffer_load_dwordx4 v3, s[40:43], s53 offen lds
    v_mfma_f32_16x16x32_bf16 v[96:99], v[44:47], v[32:35], v[96:99]
    ds_read_b64_tr_b16 v[120:121], v14 offset:45056
    s_cmp_lt_u32 s50, 2
    s_cbranch_scc1 m_l_g8
    s_add_u32 s54, s65, 1024
    buffer_store_dwordx4 v[84:87], v1, s[44:47], s54 offen sc1
m_l_g8:
    v_mfma_f32_16x16x32_bf16 v[100:103], v[44:47], v[36:39], v[100:103]
    ds_read_b64_tr_b16 v[122:123], v14 offset:45312
    s_add_u32 m0, s51, 28672
    s_mov_b32 s53, 917504
    buffer_load_dwordx4 v3, s[40:43], s53 offen lds
    v_mfma_f32_16x16x32_bf16 v[104:107], v[32:35], v[48:51], v[104:107]
    ds_read_b64_tr_b16 v[124:125], v14 offset:53248
    ds_read_b64_tr_b16 v[126:127], v14 offset:53504
    s_add_u32 m0, s51, 98304
    s_add_u32 s53, s60, 128
    buffer_load_dwordx4 v2, s[36:39], s53 offen lds
    v_mfma_f32_16x16x32_bf16 v[108:111], v[36:39], v[48:51], v[108:111]
    ds_read_b64_tr_b16 v[128:129], v14 offset:61440
    ds_read_b64_tr_b16 v[130:131], v14 offset:61696
    s_add_u32 m0, s51, 102400
    s_add_u32 s53, s60, 32896
    buffer_load_dwordx4 v2, s[36:39], s53 offen lds
    s_waitcnt lgkmcnt(8)
    v_mfma_f32_16x16x32_bf16 v[88:91], v[60:63], v[52:55], v[88:91]
    ds_read_b128 v[32:35], v13 offset:49152
    s_add_u32 m0, s51, 106496
    s_add_u32 s53, s60, 65664
    buffer_load_dwordx4 v2, s[36:39], s53 offen lds
    s_add_u32 m0, s51, 110592
    s_add_u32 s53, s60, 98432
    buffer_load_dwordx4 v2, s[36:39], s53 offen lds
    v_mfma_f32_16x16x32_bf16 v[92:95], v[60:63], v[56:59], v[92:95]
    ds_read_b128 v[36:39], v13 offset:51200
    s_add_u32 m0, s51, 114688
    s_add_u32 s53, s61, 128
    buffer_load_dwordx4 v2, s[36:39], s53 offen lds
    v_mfma_f32_16x16x32_bf16 v[96:99], v[64:67], v[52:55], v[96:99]
    ds_read_b64_tr_b16 v[40:41], v14 offset:47104
    s_cmp_lt_u32 s50, 2
    s_cbranch_scc0 m_l_g9
    s_add_u32 s54, s65, 8192
    buffer_store_dwordx4 v[144:147], v1, s[44:47], s54 offen sc1
m_l_g9:
    v_mfma_f32_16x16x32_bf16 v[100:103], v[64:67], v[56:59], v[100:103]
    ds_read_b64_tr_b16 v[42:43], v14 offset:47360
    s_add_u32 m0, s51, 118784
    s_add_u32 s53, s61, 32896
    buffer_load_dwordx4 v2, s[36:39], s53 offen lds
    v_mfma_f32_16x16x32_bf16 v[104:107], v[52:55], v[68:71], v[104:107]
    ds_read_b64_tr_b16 v[44:45], v14 offset:55296
    ds_read_b64_tr_b16 v[46:47], v14 offset:55552
    s_add_u32 m0, s51, 122880
    s_add_u32 s53, s61, 65664
    buffer_load_dwordx4 v2, s[36:39], s53 offen lds
    v_mfma_f32_16x16x32_bf16 v[108:111], v[56:59], v[68:71], v[108:111]
    ds_read_b64_tr_b16 v[48:49], v14 offset:63488
    ds_read_b64_tr_b16 v[50:51], v14 offset:63744
    s_add_u32 m0, s51, 126976
    s_add_u32 s53, s61, 98432
    buffer_load_dwordx4 v2, s[36:39], s53 offen lds
    s_waitcnt lgkmcnt(0)
    s_barrier
    v_mfma_f32_16x16x32_bf16 v[88:91], v[120:123], v[112:115], v[88:91]
    s_add_u32 m0, s51, 32768
    s_mov_b32 s53, 1048576
    buffer_load_dwordx4 v3, s[40:43], s53 offen lds
    v_mfma_f32_16x16x32_bf16 v[92:95], v[120:123], v[116:119], v[92:95]
    s_add_u32 m0, s51, 36864
    s_mov_b32 s53, 1179648
    buffer_load_dwordx4 v3, s[40:43], s53 offen lds
    v_mfma_f32_16x16x32_bf16 v[96:99], v[124:127], v[112:115], v[96:99]
    s_add_u32 m0, s51, 40960
    s_mov_b32 s53, 1310720
    buffer_load_dwordx4 v3, s[40:43], s53 offen lds
    v_mfma_f32_16x16x32_bf16 v[100:103], v[124:127], v[116:119], v[100:103]
    s_add_u32 m0, s51, 45056
    s_mov_b32 s53, 1441792
    buffer_load_dwordx4 v3, s[40:43], s53 offen lds
    v_mfma_f32_16x16x32_bf16 v[104:107], v[112:115], v[128:131], v[104:107]
    s_add_u32 m0, s51, 131072
    s_add_u32 s53, s60, 256
    buffer_load_dwordx4 v2, s[36:39], s53 offen lds
    v_mfma_f32_16x16x32_bf16 v[108:111], v[116:119], v[128:131], v[108:111]
    s_add_u32 m0, s51, 135168
    s_add_u32 s53, s60, 33024
    buffer_load_dwordx4 v2, s[36:39], s53 offen lds
    s_waitcnt lgkmcnt(0)
    v_mfma_f32_16x16x32_bf16 v[88:91], v[40:43], v[32:35], v[88:91]
    s_add_u32 m0, s51, 139264
    s_add_u32 s53, s60, 65792
    buffer_load_dwordx4 v2, s[36:39], s53 offen lds
    v_mfma_f32_16x16x32_bf16 v[92:95], v[40:43], v[36:39], v[92:95]
    s_add_u32 m0, s51, 143360
    s_add_u32 s53, s60, 98560
    buffer_load_dwordx4 v2, s[36:39], s53 offen lds
    v_mfma_f32_16x16x32_bf16 v[96:99], v[44:47], v[32:35], v[96:99]
    s_add_u32 m0, s51, 147456
    s_add_u32 s53, s61, 256
    buffer_load_dwordx4 v2, s[36:39], s53 offen lds
    v_mfma_f32_16x16x32_bf16 v[100:103], v[44:47], v[36:39], v[100:103]
    s_add_u32 m0, s51, 151552
    s_add_u32 s53, s61, 33024
    buffer_load_dwordx4 v2, s[36:39], s53 offen lds
    v_mfma_f32_16x16x32_bf16 v[104:107], v[32:35], v[48:51], v[104:107]
    s_add_u32 m0, s51, 155648
    s_add_u32 s53, s61, 65792
    buffer_load_dwordx4 v2, s[36:39], s53 offen lds
    v_mfma_f32_16x16x32_bf16 v[108:111], v[36:39], v[48:51], v[108:111]
    s_add_u32 m0, s51, 159744
    s_add_u32 s53, s61, 98560
    buffer_load_dwordx4 v2, s[36:39], s53 offen lds
    s_sub_u32 s52, 7, s48
    s_lshl_b32 s59, s50, 2
    s_add_u32 s59, s59, s52
    s_lshl_b32 s52, s52, 12
    s_add_u32 s52, s52, 81920
    v_add_u32 v16, s52, v26
    v_xor_b32 v17, 64, v16
    v_add_u32 v18, 65536, v16
    v_add_u32 v19, 65536, v17
    v_mov_b32 v20, v27
    v_xor_b32 v21, 32, v20
    v_xor_b32 v22, 64, v20
    v_xor_b32 v23, 96, v20
    v_xor_b32 v24, 128, v20
    v_xor_b32 v25, 160, v20
    v_xor_b32 v26, 192, v20
    v_xor_b32 v27, 224, v20
    s_lshl_b32 s52, s98, 1
    s_add_u32 s52, s52, 1
    s_lshl_b32 s52, s52, 4
    s_add_u32 s52, s52, s99
    s_lshl_b32 s52, s52, 12
    s_add_u32 s52, s52, s51
    s_mov_b32 s54, 0x3eb8aa3b
    v_mul_f32 v88, s54, v88
    v_mul_f32 v89, s54, v89
    v_mul_f32 v90, s54, v90
    v_mul_f32 v91, s54, v91
    v_mul_f32 v92, s54, v92
    v_mul_f32 v93, s54, v93
    v_mul_f32 v94, s54, v94
    v_mul_f32 v95, s54, v95
    v_cvt_pk_bf16_f32 v32, v88, v89
    v_cvt_pk_bf16_f32 v33, v90, v91
    v_cvt_pk_bf16_f32 v34, v92, v93
    v_cvt_pk_bf16_f32 v35, v94, v95
    v_cvt_pk_bf16_f32 v36, v96, v97
    v_cvt_pk_bf16_f32 v37, v98, v99
    v_cvt_pk_bf16_f32 v38, v100, v101
    v_cvt_pk_bf16_f32 v39, v102, v103
    v_cvt_pk_bf16_f32 v40, v104, v105
    v_cvt_pk_bf16_f32 v41, v106, v107
    v_cvt_pk_bf16_f32 v42, v108, v109
    v_cvt_pk_bf16_f32 v43, v110, v111
    s_waitcnt vmcnt(24)
    s_barrier
    ds_read_b128 v[120:123], v16 offset:0
    ds_read_b128 v[124:127], v17 offset:0
    ds_read_b128 v[128:131], v16 offset:2048
    ds_read_b128 v[132:135], v17 offset:2048
    ds_read_b64_tr_b16 v[88:89], v20 offset:0
    ds_read_b64_tr_b16 v[90:91], v20 offset:1024
    ds_read_b64_tr_b16 v[92:93], v20 offset:8192
    ds_read_b64_tr_b16 v[94:95], v20 offset:9216
    ds_read_b64_tr_b16 v[96:97], v21 offset:0
    ds_read_b64_tr_b16 v[98:99], v21 offset:1024
    ds_read_b64_tr_b16 v[100:101], v21 offset:8192
    ds_read_b64_tr_b16 v[102:103], v21 offset:9216
    ds_read_b64_tr_b16 v[104:105], v22 offset:0
    ds_read_b64_tr_b16 v[106:107], v22 offset:1024
    ds_read_b64_tr_b16 v[108:109], v22 offset:8192
    ds_read_b64_tr_b16 v[110:111], v22 offset:9216
    ds_read_b64_tr_b16 v[112:113], v23 offset:0
    ds_read_b64_tr_b16 v[114:115], v23 offset:1024
    ds_read_b64_tr_b16 v[116:117], v23 offset:8192
    ds_read_b64_tr_b16 v[118:119], v23 offset:9216
    s_mov_b32 s100, s52
    v_add_u32 v4, 98304, v1
    s_lshl_b32 s52, s49, 19
    s_add_u32 s28, s26, s52
    s_addc_u32 s29, s27, 0
    s_add_u32 s52, s55, 1
    s_lshl_b32 s30, s52, 15
    s_mov_b32 s31, 0x20000
    s_add_u32 s8, s28, 16777216
    s_addc_u32 s9, s29, 0
    s_mov_b32 s10, s30
    s_mov_b32 s11, 0x20000
    s_waitcnt lgkmcnt(12)
    v_mfma_f32_16x16x32_bf16 v[184:187], v[88:91], v[120:123], 0
    s_add_u32 s54, s100, 57671680
    buffer_store_dwordx4 v[32:35], v1, s[44:47], s54 offen sc1
    v_mfma_f32_16x16x32_bf16 v[184:187], v[92:95], v[124:127], v[184:187]
    v_mfma_f32_16x16x32_bf16 v[216:219], v[88:91], v[128:131], 0
    v_mfma_f32_16x16x32_bf16 v[216:219], v[92:95], v[132:135], v[216:219]
    ds_read_b64_tr_b16 v[88:89], v24 offset:0
    s_waitcnt lgkmcnt(9)
    v_mfma_f32_16x16x32_bf16 v[188:191], v[96:99], v[120:123], 0
    ds_read_b64_tr_b16 v[90:91], v24 offset:1024
    s_cmp_lt_u32 s50, 2
    s_cbranch_scc0 m_l_g10
    s_add_u32 s54, s65, 9216
    buffer_store_dwordx4 v[148:151], v1, s[44:47], s54 offen sc1
m_l_g10:
    v_mfma_f32_16x16x32_bf16 v[188:191], v[100:103], v[124:127], v[188:191]
    ds_read_b64_tr_b16 v[92:93], v24 offset:8192
    v_mfma_f32_16x16x32_bf16 v[220:223], v[96:99], v[128:131], 0
    ds_read_b64_tr_b16 v[94:95], v24 offset:9216
    v_mfma_f32_16x16x32_bf16 v[220:223], v[100:103], v[132:135], v[220:223]
    ds_read_b64_tr_b16 v[96:97], v25 offset:0
    s_waitcnt lgkmcnt(9)
    v_mfma_f32_16x16x32_bf16 v[192:195], v[104:107], v[120:123], 0
    ds_read_b64_tr_b16 v[98:99], v25 offset:1024
    s_add_u32 s54, s100, 59768832
    buffer_store_dwordx4 v[36:39], v1, s[44:47], s54 offen sc1
    v_mfma_f32_16x16x32_bf16 v[192:195], v[108:111], v[124:127], v[192:195]
    ds_read_b64_tr_b16 v[100:101], v25 offset:8192
    v_mfma_f32_16x16x32_bf16 v[224:227], v[104:107], v[128:131], 0
    ds_read_b64_tr_b16 v[102:103], v25 offset:9216
    v_mfma_f32_16x16x32_bf16 v[224:227], v[108:111], v[132:135], v[224:227]
    ds_read_b64_tr_b16 v[104:105], v26 offset:0
    s_waitcnt lgkmcnt(9)
    v_mfma_f32_16x16x32_bf16 v[196:199], v[112:115], v[120:123], 0
    ds_read_b64_tr_b16 v[106:107], v26 offset:1024
    s_add_u32 s54, s100, 61865984
    buffer_store_dwordx4 v[40:43], v1, s[44:47], s54 offen sc1
    v_mfma_f32_16x16x32_bf16 v[196:199], v[116:119], v[124:127], v[196:199]
    ds_read_b64_tr_b16 v[108:109], v26 offset:8192
    v_mfma_f32_16x16x32_bf16 v[228:231], v[112:115], v[128:131], 0
    ds_read_b64_tr_b16 v[110:111], v26 offset:9216
    v_mfma_f32_16x16x32_bf16 v[228:231], v[116:119], v[132:135], v[228:231]
    ds_read_b64_tr_b16 v[112:113], v27 offset:0
    ds_read_b64_tr_b16 v[114:115], v27 offset:1024
    ds_read_b64_tr_b16 v[116:117], v27 offset:8192
    ds_read_b64_tr_b16 v[118:119], v27 offset:9216
    s_waitcnt lgkmcnt(12)
    v_mfma_f32_16x16x32_bf16 v[200:203], v[88:91], v[120:123], 0
    v_mfma_f32_16x16x32_bf16 v[200:203], v[92:95], v[124:127], v[200:203]
    v_mfma_f32_16x16x32_bf16 v[232:235], v[88:91], v[128:131], 0
    v_mfma_f32_16x16x32_bf16 v[232:235], v[92:95], v[132:135], v[232:235]
    s_waitcnt lgkmcnt(0)
    s_waitcnt vmcnt(15)
    s_barrier
    ds_read_b64_tr_b16 v[88:89], v20 offset:16384
    v_mfma_f32_16x16x32_bf16 v[204:207], v[96:99], v[120:123], 0
    ds_read_b64_tr_b16 v[90:91], v20 offset:17408
    s_add_u32 m0, s51, 0
    s_mov_b32 s53, 1572864
    buffer_load_dwordx4 v3, s[40:43], s53 offen lds
    v_mfma_f32_16x16x32_bf16 v[204:207], v[100:103], v[124:127], v[204:207]
    ds_read_b64_tr_b16 v[92:93], v20 offset:24576
    v_mfma_f32_16x16x32_bf16 v[236:239], v[96:99], v[128:131], 0
    ds_read_b64_tr_b16 v[94:95], v20 offset:25600
    ds_read_b128 v[44:47], v16 offset:32768
    s_cmp_lt_u32 s50, 2
    s_cbranch_scc1 m_l_g11
    s_add_u32 s54, s64, 8192
    buffer_store_dwordx4 v[136:139], v1, s[44:47], s54 offen sc1
m_l_g11:
    v_mfma_f32_16x16x32_bf16 v[236:239], v[100:103], v[132:135], v[236:239]
    ds_read_b64_tr_b16 v[96:97], v21 offset:16384
    v_mfma_f32_16x16x32_bf16 v[208:211], v[104:107], v[120:123], 0
    ds_read_b64_tr_b16 v[98:99], v21 offset:17408
    ds_read_b128 v[48:51], v17 offset:32768
    s_add_u32 m0, s51, 4096
    s_mov_b32 s53, 1703936
    buffer_load_dwordx4 v3, s[40:43], s53 offen lds
    v_mfma_f32_16x16x32_bf16 v[208:211], v[108:111], v[124:127], v[208:211]
    ds_read_b64_tr_b16 v[100:101], v21 offset:24576
    v_mfma_f32_16x16x32_bf16 v[240:243], v[104:107], v[128:131], 0
    ds_read_b64_tr_b16 v[102:103], v21 offset:25600
    ds_read_b128 v[52:55], v16 offset:34816
    s_add_u32 m0, s51, 8192
    s_mov_b32 s53, 1835008
    buffer_load_dwordx4 v3, s[40:43], s53 offen lds
    v_mfma_f32_16x16x32_bf16 v[240:243], v[108:111], v[132:135], v[240:243]
    ds_read_b64_tr_b16 v[104:105], v22 offset:16384
    v_mfma_f32_16x16x32_bf16 v[212:215], v[112:115], v[120:123], 0
    ds_read_b64_tr_b16 v[106:107], v22 offset:17408
    ds_read_b128 v[56:59], v17 offset:34816
    s_cmp_lt_u32 s50, 2
    s_cbranch_scc0 m_l_g12
    s_add_u32 s54, s64, 16384
    buffer_store_dwordx4 v[152:155], v1, s[44:47], s54 offen sc1
m_l_g12:
    v_mfma_f32_16x16x32_bf16 v[212:215], v[116:119], v[124:127], v[212:215]
    ds_read_b64_tr_b16 v[108:109], v22 offset:24576
    v_mfma_f32_16x16x32_bf16 v[244:247], v[112:115], v[128:131], 0
    ds_read_b64_tr_b16 v[110:111], v22 offset:25600
    s_add_u32 m0, s51, 12288
    s_mov_b32 s53, 1966080
    buffer_load_dwordx4 v3, s[40:43], s53 offen lds
    v_mfma_f32_16x16x32_bf16 v[244:247], v[116:119], v[132:135], v[244:247]
    ds_read_b64_tr_b16 v[112:113], v23 offset:16384
    s_waitcnt lgkmcnt(3)
    v_mfma_f32_16x16x32_bf16 v[184:187], v[88:91], v[44:47], v[184:187]
    ds_read_b64_tr_b16 v[114:115], v23 offset:17408
    s_add_u32 m0, s51, 65536
    s_add_u32 s53, s60, 384
    buffer_load_dwordx4 v2, s[36:39], s53 offen lds
    v_mfma_f32_16x16x32_bf16 v[184:187], v[92:95], v[48:51], v[184:187]
    ds_read_b64_tr_b16 v[116:117], v23 offset:24576
    s_add_u32 m0, s51, 69632
    s_add_u32 s53, s60, 33152
    buffer_load_dwordx4 v2, s[36:39], s53 offen lds
    v_mfma_f32_16x16x32_bf16 v[216:219], v[88:91], v[52:55], v[216:219]
    ds_read_b64_tr_b16 v[118:119], v23 offset:25600
    v_mfma_f32_16x16x32_bf16 v[216:219], v[92:95], v[56:59], v[216:219]
    ds_read_b64_tr_b16 v[88:89], v24 offset:16384
    s_cmp_lt_u32 s50, 2
    s_cbranch_scc1 m_l_g13
    s_add_u32 s54, s64, 12288
    buffer_store_dwordx4 v[140:143], v1, s[44:47], s54 offen sc1
m_l_g13:
    v_mfma_f32_16x16x32_bf16 v[188:191], v[96:99], v[44:47], v[188:191]
    ds_read_b64_tr_b16 v[90:91], v24 offset:17408
    s_add_u32 m0, s51, 73728
    s_add_u32 s53, s60, 65920
    buffer_load_dwordx4 v2, s[36:39], s53 offen lds
    v_mfma_f32_16x16x32_bf16 v[188:191], v[100:103], v[48:51], v[188:191]
    ds_read_b64_tr_b16 v[92:93], v24 offset:24576
    v_mfma_f32_16x16x32_bf16 v[220:223], v[96:99], v[52:55], v[220:223]
    ds_read_b64_tr_b16 v[94:95], v24 offset:25600
    s_add_u32 m0, s51, 77824
    s_add_u32 s53, s60, 98688
    buffer_load_dwordx4 v2, s[36:39], s53 offen lds
    v_mfma_f32_16x16x32_bf16 v[220:223], v[100:103], v[56:59], v[220:223]
    ds_read_b64_tr_b16 v[96:97], v25 offset:16384
    s_waitcnt lgkmcnt(9)
    v_mfma_f32_16x16x32_bf16 v[192:195], v[104:107], v[44:47], v[192:195]
    ds_read_b64_tr_b16 v[98:99], v25 offset:17408
    s_add_u32 m0, s51, 81920
    s_add_u32 s53, s61, 384
    buffer_load_dwordx4 v2, s[36:39], s53 offen lds
    v_mfma_f32_16x16x32_bf16 v[192:195], v[108:111], v[48:51], v[192:195]
    ds_read_b64_tr_b16 v[100:101], v25 offset:24576
    s_add_u32 m0, s51, 86016
    s_add_u32 s53, s61, 33152
    buffer_load_dwordx4 v2, s[36:39], s53 offen lds
    v_mfma_f32_16x16x32_bf16 v[224:227], v[104:107], v[52:55], v[224:227]
    ds_read_b64_tr_b16 v[102:103], v25 offset:25600
    v_mfma_f32_16x16x32_bf16 v[224:227], v[108:111], v[56:59], v[224:227]
    ds_read_b64_tr_b16 v[104:105], v26 offset:16384
    s_cmp_lt_u32 s50, 2
    s_cbranch_scc0 m_l_g14
    s_add_u32 s54, s64, 20480
    buffer_store_dwordx4 v[156:159], v1, s[44:47], s54 offen sc1
m_l_g14:
    s_waitcnt lgkmcnt(9)
    v_mfma_f32_16x16x32_bf16 v[196:199], v[112:115], v[44:47], v[196:199]
    ds_read_b64_tr_b16 v[106:107], v26 offset:17408
    s_add_u32 m0, s51, 90112
    s_add_u32 s53, s61, 65920
    buffer_load_dwordx4 v2, s[36:39], s53 offen lds
    v_mfma_f32_16x16x32_bf16 v[196:199], v[116:119], v[48:51], v[196:199]
    ds_read_b64_tr_b16 v[108:109], v26 offset:24576
    v_mfma_f32_16x16x32_bf16 v[228:231], v[112:115], v[52:55], v[228:231]
    ds_read_b64_tr_b16 v[110:111], v26 offset:25600
    s_add_u32 m0, s51, 94208
    s_add_u32 s53, s61, 98688
    buffer_load_dwordx4 v2, s[36:39], s53 offen lds
    v_mfma_f32_16x16x32_bf16 v[228:231], v[116:119], v[56:59], v[228:231]
    ds_read_b64_tr_b16 v[112:113], v27 offset:16384
    ds_read_b64_tr_b16 v[114:115], v27 offset:17408
    ds_read_b64_tr_b16 v[116:117], v27 offset:24576
    ds_read_b64_tr_b16 v[118:119], v27 offset:25600
    s_waitcnt lgkmcnt(12)
    v_mfma_f32_16x16x32_bf16 v[200:203], v[88:91], v[44:47], v[200:203]
    v_mfma_f32_16x16x32_bf16 v[200:203], v[92:95], v[48:51], v[200:203]
    v_mfma_f32_16x16x32_bf16 v[232:235], v[88:91], v[52:55], v[232:235]
    v_mfma_f32_16x16x32_bf16 v[232:235], v[92:95], v[56:59], v[232:235]
    s_waitcnt lgkmcnt(0)
    s_waitcnt vmcnt(15)
    s_barrier
    ds_read_b64_tr_b16 v[88:89], v20 offset:32768
    v_mfma_f32_16x16x32_bf16 v[204:207], v[96:99], v[44:47], v[204:207]
    ds_read_b64_tr_b16 v[90:91], v20 offset:33792
    s_add_u32 m0, s51, 16384
    s_mov_b32 s53, 2097152
    buffer_load_dwordx4 v3, s[40:43], s53 offen lds
    v_mfma_f32_16x16x32_bf16 v[204:207], v[100:103], v[48:51], v[204:207]
    ds_read_b64_tr_b16 v[92:93], v20 offset:40960
    v_mfma_f32_16x16x32_bf16 v[236:239], v[96:99], v[52:55], v[236:239]
    ds_read_b64_tr_b16 v[94:95], v20 offset:41984
    ds_read_b128 v[120:123], v18 offset:0
    s_cmp_lt_u32 s50, 2
    s_cbranch_scc1 m_l_g15
    s_add_u32 s54, s65, 8192
    buffer_store_dwordx4 v[144:147], v1, s[44:47], s54 offen sc1
m_l_g15:
    v_mfma_f32_16x16x32_bf16 v[236:239], v[100:103], v[56:59], v[236:239]
    ds_read_b64_tr_b16 v[96:97], v21 offset:32768
    v_mfma_f32_16x16x32_bf16 v[208:211], v[104:107], v[44:47], v[208:211]
    ds_read_b64_tr_b16 v[98:99], v21 offset:33792
    ds_read_b128 v[124:127], v19 offset:0
    s_add_u32 m0, s51, 20480
    s_mov_b32 s53, 2228224
    buffer_load_dwordx4 v3, s[40:43], s53 offen lds
    v_mfma_f32_16x16x32_bf16 v[208:211], v[108:111], v[48:51], v[208:211]
    ds_read_b64_tr_b16 v[100:101], v21 offset:40960
    v_mfma_f32_16x16x32_bf16 v[240:243], v[104:107], v[52:55], v[240:243]
    ds_read_b64_tr_b16 v[102:103], v21 offset:41984
    ds_read_b128 v[128:131], v18 offset:2048
    s_add_u32 m0, s51, 24576
    s_mov_b32 s53, 2359296
    buffer_load_dwordx4 v3, s[40:43], s53 offen lds
    v_mfma_f32_16x16x32_bf16 v[240:243], v[108:111], v[56:59], v[240:243]
    ds_read_b64_tr_b16 v[104:105], v22 offset:32768
    v_mfma_f32_16x16x32_bf16 v[212:215], v[112:115], v[44:47], v[212:215]
    ds_read_b64_tr_b16 v[106:107], v22 offset:33792
    ds_read_b128 v[132:135], v19 offset:2048
    s_cmp_lt_u32 s50, 2
    s_cbranch_scc0 m_l_g16
    s_add_u32 s54, s65, 16384
    buffer_store_dwordx4 v[160:163], v1, s[44:47], s54 offen sc1
m_l_g16:
    v_mfma_f32_16x16x32_bf16 v[212:215], v[116:119], v[48:51], v[212:215]
    ds_read_b64_tr_b16 v[108:109], v22 offset:40960
    v_mfma_f32_16x16x32_bf16 v[244:247], v[112:115], v[52:55], v[244:247]
    ds_read_b64_tr_b16 v[110:111], v22 offset:41984
    s_add_u32 m0, s51, 28672
    s_mov_b32 s53, 2490368
    buffer_load_dwordx4 v3, s[40:43], s53 offen lds
    v_mfma_f32_16x16x32_bf16 v[244:247], v[116:119], v[56:59], v[244:247]
    ds_read_b64_tr_b16 v[112:113], v23 offset:32768
    s_waitcnt lgkmcnt(3)
    v_mfma_f32_16x16x32_bf16 v[184:187], v[88:91], v[120:123], v[184:187]
    ds_read_b64_tr_b16 v[114:115], v23 offset:33792
    s_add_u32 m0, s51, 98304
    s_add_u32 s53, s60, 512
    buffer_load_dwordx4 v2, s[36:39], s53 offen lds
    v_mfma_f32_16x16x32_bf16 v[184:187], v[92:95], v[124:127], v[184:187]
    ds_read_b64_tr_b16 v[116:117], v23 offset:40960
    s_add_u32 m0, s51, 102400
    s_add_u32 s53, s60, 33280
    buffer_load_dwordx4 v2, s[36:39], s53 offen lds
    v_mfma_f32_16x16x32_bf16 v[216:219], v[88:91], v[128:131], v[216:219]
    ds_read_b64_tr_b16 v[118:119], v23 offset:41984
    v_mfma_f32_16x16x32_bf16 v[216:219], v[92:95], v[132:135], v[216:219]
    ds_read_b64_tr_b16 v[88:89], v24 offset:32768
    s_cmp_lt_u32 s50, 2
    s_cbranch_scc1 m_l_g17
    s_add_u32 s54, s65, 9216
    buffer_store_dwordx4 v[148:151], v1, s[44:47], s54 offen sc1
m_l_g17:
    v_mfma_f32_16x16x32_bf16 v[188:191], v[96:99], v[120:123], v[188:191]
    ds_read_b64_tr_b16 v[90:91], v24 offset:33792
    s_add_u32 m0, s51, 106496
    s_add_u32 s53, s60, 66048
    buffer_load_dwordx4 v2, s[36:39], s53 offen lds
    v_mfma_f32_16x16x32_bf16 v[188:191], v[100:103], v[124:127], v[188:191]
    ds_read_b64_tr_b16 v[92:93], v24 offset:40960
    v_mfma_f32_16x16x32_bf16 v[220:223], v[96:99], v[128:131], v[220:223]
    ds_read_b64_tr_b16 v[94:95], v24 offset:41984
    s_add_u32 m0, s51, 110592
    s_add_u32 s53, s60, 98816
    buffer_load_dwordx4 v2, s[36:39], s53 offen lds
    v_mfma_f32_16x16x32_bf16 v[220:223], v[100:103], v[132:135], v[220:223]
    ds_read_b64_tr_b16 v[96:97], v25 offset:32768
    s_waitcnt lgkmcnt(9)
    v_mfma_f32_16x16x32_bf16 v[192:195], v[104:107], v[120:123], v[192:195]
    ds_read_b64_tr_b16 v[98:99], v25 offset:33792
    s_add_u32 m0, s51, 114688
    s_add_u32 s53, s61, 512
    buffer_load_dwordx4 v2, s[36:39], s53 offen lds
    v_mfma_f32_16x16x32_bf16 v[192:195], v[108:111], v[124:127], v[192:195]
    ds_read_b64_tr_b16 v[100:101], v25 offset:40960
    s_add_u32 m0, s51, 118784
    s_add_u32 s53, s61, 33280
    buffer_load_dwordx4 v2, s[36:39], s53 offen lds
    v_mfma_f32_16x16x32_bf16 v[224:227], v[104:107], v[128:131], v[224:227]
    ds_read_b64_tr_b16 v[102:103], v25 offset:41984
    v_mfma_f32_16x16x32_bf16 v[224:227], v[108:111], v[132:135], v[224:227]
    ds_read_b64_tr_b16 v[104:105], v26 offset:32768
    s_cmp_lt_u32 s50, 2
    s_cbranch_scc0 m_l_g18
    s_add_u32 s54, s65, 17408
    buffer_store_dwordx4 v[164:167], v1, s[44:47], s54 offen sc1
m_l_g18:
    s_waitcnt lgkmcnt(9)
    v_mfma_f32_16x16x32_bf16 v[196:199], v[112:115], v[120:123], v[196:199]
    ds_read_b64_tr_b16 v[106:107], v26 offset:33792
    s_add_u32 m0, s51, 122880
    s_add_u32 s53, s61, 66048
    buffer_load_dwordx4 v2, s[36:39], s53 offen lds
    v_mfma_f32_16x16x32_bf16 v[196:199], v[116:119], v[124:127], v[196:199]
    ds_read_b64_tr_b16 v[108:109], v26 offset:40960
    v_mfma_f32_16x16x32_bf16 v[228:231], v[112:115], v[128:131], v[228:231]
    ds_read_b64_tr_b16 v[110:111], v26 offset:41984
    s_add_u32 m0, s51, 126976
    s_add_u32 s53, s61, 98816
    buffer_load_dwordx4 v2, s[36:39], s53 offen lds
    v_mfma_f32_16x16x32_bf16 v[228:231], v[116:119], v[132:135], v[228:231]
    ds_read_b64_tr_b16 v[112:113], v27 offset:32768
    ds_read_b64_tr_b16 v[114:115], v27 offset:33792
    ds_read_b64_tr_b16 v[116:117], v27 offset:40960
    ds_read_b64_tr_b16 v[118:119], v27 offset:41984
    s_waitcnt lgkmcnt(12)
    v_mfma_f32_16x16x32_bf16 v[200:203], v[88:91], v[120:123], v[200:203]
    v_mfma_f32_16x16x32_bf16 v[200:203], v[92:95], v[124:127], v[200:203]
    v_mfma_f32_16x16x32_bf16 v[232:235], v[88:91], v[128:131], v[232:235]
    v_mfma_f32_16x16x32_bf16 v[232:235], v[92:95], v[132:135], v[232:235]
    s_waitcnt lgkmcnt(0)
    s_waitcnt vmcnt(12)
    s_barrier
    ds_read_b64_tr_b16 v[88:89], v20 offset:0
    v_mfma_f32_16x16x32_bf16 v[204:207], v[96:99], v[120:123], v[204:207]
    ds_read_b64_tr_b16 v[90:91], v20 offset:1024
    s_cmp_lt_u32 s50, 2
    s_cbranch_scc1 m_l_g19
    s_add_u32 s54, s64, 16384
    buffer_store_dwordx4 v[152:155], v1, s[44:47], s54 offen sc1
m_l_g19:
    v_mfma_f32_16x16x32_bf16 v[204:207], v[100:103], v[124:127], v[204:207]
    ds_read_b64_tr_b16 v[92:93], v20 offset:8192
    v_mfma_f32_16x16x32_bf16 v[236:239], v[96:99], v[128:131], v[236:239]
    ds_read_b64_tr_b16 v[94:95], v20 offset:9216
    ds_read_b128 v[44:47], v16 offset:0
    s_add_u32 m0, s51, 32768
    s_mov_b32 s53, 2621440
    buffer_load_dwordx4 v3, s[40:43], s53 offen lds
    v_mfma_f32_16x16x32_bf16 v[236:239], v[100:103], v[132:135], v[236:239]
    ds_read_b64_tr_b16 v[96:97], v21 offset:0
    v_mfma_f32_16x16x32_bf16 v[208:211], v[104:107], v[120:123], v[208:211]
    ds_read_b64_tr_b16 v[98:99], v21 offset:1024
    ds_read_b128 v[48:51], v17 offset:0
    s_add_u32 m0, s51, 36864
    s_mov_b32 s53, 2752512
    buffer_load_dwordx4 v3, s[40:43], s53 offen lds
    v_mfma_f32_16x16x32_bf16 v[208:211], v[108:111], v[124:127], v[208:211]
    ds_read_b64_tr_b16 v[100:101], v21 offset:8192
    v_mfma_f32_16x16x32_bf16 v[240:243], v[104:107], v[128:131], v[240:243]
    ds_read_b64_tr_b16 v[102:103], v21 offset:9216
    ds_read_b128 v[52:55], v16 offset:2048
    s_cmp_lt_u32 s50, 2
    s_cbranch_scc0 m_l_g20
    s_add_u32 s54, s64, 24576
    buffer_store_dwordx4 v[172:175], v1, s[44:47], s54 offen sc1
m_l_g20:
    v_mfma_f32_16x16x32_bf16 v[240:243], v[108:111], v[132:135], v[240:243]
    ds_read_b64_tr_b16 v[104:105], v22 offset:0
    v_mfma_f32_16x16x32_bf16 v[212:215], v[112:115], v[120:123], v[212:215]
    ds_read_b64_tr_b16 v[106:107], v22 offset:1024
    ds_read_b128 v[56:59], v17 offset:2048
    s_add_u32 m0, s51, 40960
    s_mov_b32 s53, 2883584
    buffer_load_dwordx4 v3, s[40:43], s53 offen lds
    v_mfma_f32_16x16x32_bf16 v[212:215], v[116:119], v[124:127], v[212:215]
    ds_read_b64_tr_b16 v[108:109], v22 offset:8192
    v_mfma_f32_16x16x32_bf16 v[244:247], v[112:115], v[128:131], v[244:247]
    ds_read_b64_tr_b16 v[110:111], v22 offset:9216
    s_add_u32 m0, s51, 45056
    s_mov_b32 s53, 3014656
    buffer_load_dwordx4 v3, s[40:43], s53 offen lds
    v_mfma_f32_16x16x32_bf16 v[244:247], v[116:119], v[132:135], v[244:247]
    ds_read_b64_tr_b16 v[112:113], v23 offset:0
    s_waitcnt lgkmcnt(3)
    v_mfma_f32_16x16x32_bf16 v[184:187], v[88:91], v[44:47], v[184:187]
    ds_read_b64_tr_b16 v[114:115], v23 offset:1024
    s_add_u32 m0, s51, 131072
    s_add_u32 s53, s60, 640
    buffer_load_dwordx4 v2, s[36:39], s53 offen lds
    v_mfma_f32_16x16x32_bf16 v[184:187], v[92:95], v[48:51], v[184:187]
    ds_read_b64_tr_b16 v[116:117], v23 offset:8192
    s_add_u32 m0, s51, 135168
    s_add_u32 s53, s60, 33408
    buffer_load_dwordx4 v2, s[36:39], s53 offen lds
    v_mfma_f32_16x16x32_bf16 v[216:219], v[88:91], v[52:55], v[216:219]
    ds_read_b64_tr_b16 v[118:119], v23 offset:9216
    v_mfma_f32_16x16x32_bf16 v[216:219], v[92:95], v[56:59], v[216:219]
    ds_read_b64_tr_b16 v[88:89], v24 offset:0
    s_cmp_lt_u32 s50, 2
    s_cbranch_scc1 m_l_g21
    s_add_u32 s54, s64, 20480
    buffer_store_dwordx4 v[156:159], v1, s[44:47], s54 offen sc1
m_l_g21:
    v_mfma_f32_16x16x32_bf16 v[188:191], v[96:99], v[44:47], v[188:191]
    ds_read_b64_tr_b16 v[90:91], v24 offset:1024
    s_add_u32 m0, s51, 139264
    s_add_u32 s53, s60, 66176
    buffer_load_dwordx4 v2, s[36:39], s53 offen lds
    v_mfma_f32_16x16x32_bf16 v[188:191], v[100:103], v[48:51], v[188:191]
    ds_read_b64_tr_b16 v[92:93], v24 offset:8192
    v_mfma_f32_16x16x32_bf16 v[220:223], v[96:99], v[52:55], v[220:223]
    ds_read_b64_tr_b16 v[94:95], v24 offset:9216
    s_add_u32 m0, s51, 143360
    s_add_u32 s53, s60, 98944
    buffer_load_dwordx4 v2, s[36:39], s53 offen lds
    v_mfma_f32_16x16x32_bf16 v[220:223], v[100:103], v[56:59], v[220:223]
    ds_read_b64_tr_b16 v[96:97], v25 offset:0
    s_waitcnt lgkmcnt(9)
    v_mfma_f32_16x16x32_bf16 v[192:195], v[104:107], v[44:47], v[192:195]
    ds_read_b64_tr_b16 v[98:99], v25 offset:1024
    s_add_u32 m0, s51, 147456
    s_add_u32 s53, s61, 640
    buffer_load_dwordx4 v2, s[36:39], s53 offen lds
    v_mfma_f32_16x16x32_bf16 v[192:195], v[108:111], v[48:51], v[192:195]
    ds_read_b64_tr_b16 v[100:101], v25 offset:8192
    s_add_u32 m0, s51, 151552
    s_add_u32 s53, s61, 33408
    buffer_load_dwordx4 v2, s[36:39], s53 offen lds
    v_mfma_f32_16x16x32_bf16 v[224:227], v[104:107], v[52:55], v[224:227]
    ds_read_b64_tr_b16 v[102:103], v25 offset:9216
    v_mfma_f32_16x16x32_bf16 v[224:227], v[108:111], v[56:59], v[224:227]
    ds_read_b64_tr_b16 v[104:105], v26 offset:0
    s_cmp_lt_u32 s50, 2
    s_cbranch_scc0 m_l_g22
    s_add_u32 s54, s64, 28672
    buffer_store_dwordx4 v[176:179], v1, s[44:47], s54 offen sc1
m_l_g22:
    s_waitcnt lgkmcnt(9)
    v_mfma_f32_16x16x32_bf16 v[196:199], v[112:115], v[44:47], v[196:199]
    ds_read_b64_tr_b16 v[106:107], v26 offset:1024
    s_add_u32 m0, s51, 155648
    s_add_u32 s53, s61, 66176
    buffer_load_dwordx4 v2, s[36:39], s53 offen lds
    v_mfma_f32_16x16x32_bf16 v[196:199], v[116:119], v[48:51], v[196:199]
    ds_read_b64_tr_b16 v[108:109], v26 offset:8192
    v_mfma_f32_16x16x32_bf16 v[228:231], v[112:115], v[52:55], v[228:231]
    ds_read_b64_tr_b16 v[110:111], v26 offset:9216
    s_add_u32 m0, s51, 159744
    s_add_u32 s53, s61, 98944
    buffer_load_dwordx4 v2, s[36:39], s53 offen lds
    v_mfma_f32_16x16x32_bf16 v[228:231], v[116:119], v[56:59], v[228:231]
    ds_read_b64_tr_b16 v[112:113], v27 offset:0
    ds_read_b64_tr_b16 v[114:115], v27 offset:1024
    ds_read_b64_tr_b16 v[116:117], v27 offset:8192
    ds_read_b64_tr_b16 v[118:119], v27 offset:9216
    s_waitcnt lgkmcnt(12)
    v_mfma_f32_16x16x32_bf16 v[200:203], v[88:91], v[44:47], v[200:203]
    v_mfma_f32_16x16x32_bf16 v[200:203], v[92:95], v[48:51], v[200:203]
    v_mfma_f32_16x16x32_bf16 v[232:235], v[88:91], v[52:55], v[232:235]
    v_mfma_f32_16x16x32_bf16 v[232:235], v[92:95], v[56:59], v[232:235]
    s_waitcnt lgkmcnt(0)
    s_waitcnt vmcnt(12)
    s_barrier
    ds_read_b64_tr_b16 v[88:89], v20 offset:16384
    v_mfma_f32_16x16x32_bf16 v[204:207], v[96:99], v[44:47], v[204:207]
    ds_read_b64_tr_b16 v[90:91], v20 offset:17408
    s_add_u32 m0, s51, 0
    s_mov_b32 s53, 3145728
    buffer_load_dwordx4 v3, s[40:43], s53 offen lds
    v_mfma_f32_16x16x32_bf16 v[204:207], v[100:103], v[48:51], v[204:207]
    ds_read_b64_tr_b16 v[92:93], v20 offset:24576
    v_mfma_f32_16x16x32_bf16 v[236:239], v[96:99], v[52:55], v[236:239]
    ds_read_b64_tr_b16 v[94:95], v20 offset:25600
    ds_read_b128 v[120:123], v16 offset:32768
    s_cmp_lt_u32 s50, 2
    s_cbranch_scc1 m_l_g23
    s_add_u32 s54, s65, 16384
    buffer_store_dwordx4 v[160:163], v1, s[44:47], s54 offen sc1
m_l_g23:
    v_mfma_f32_16x16x32_bf16 v[236:239], v[100:103], v[56:59], v[236:239]
    ds_read_b64_tr_b16 v[96:97], v21 offset:16384
    v_mfma_f32_16x16x32_bf16 v[208:211], v[104:107], v[44:47], v[208:211]
    ds_read_b64_tr_b16 v[98:99], v21 offset:17408
    ds_read_b128 v[124:127], v17 offset:32768
    s_add_u32 m0, s51, 4096
    s_mov_b32 s53, 3276800
    buffer_load_dwordx4 v3, s[40:43], s53 offen lds
    v_mfma_f32_16x16x32_bf16 v[208:211], v[108:111], v[48:51], v[208:211]
    ds_read_b64_tr_b16 v[100:101], v21 offset:24576
    v_mfma_f32_16x16x32_bf16 v[240:243], v[104:107], v[52:55], v[240:243]
    ds_read_b64_tr_b16 v[102:103], v21 offset:25600
    ds_read_b128 v[128:131], v16 offset:34816
    s_add_u32 m0, s51, 8192
    s_mov_b32 s53, 3407872
    buffer_load_dwordx4 v3, s[40:43], s53 offen lds
    v_mfma_f32_16x16x32_bf16 v[240:243], v[108:111], v[56:59], v[240:243]
    ds_read_b64_tr_b16 v[104:105], v22 offset:16384
    v_mfma_f32_16x16x32_bf16 v[212:215], v[112:115], v[44:47], v[212:215]
    ds_read_b64_tr_b16 v[106:107], v22 offset:17408
    ds_read_b128 v[132:135], v17 offset:34816
    s_cmp_lt_u32 s50, 2
    s_cbranch_scc0 m_l_g24
    s_add_u32 s54, s65, 24576
    buffer_store_dwordx4 v[180:183], v1, s[44:47], s54 offen sc1
m_l_g24:
    v_mfma_f32_16x16x32_bf16 v[212:215], v[116:119], v[48:51], v[212:215]
    ds_read_b64_tr_b16 v[108:109], v22 offset:24576
    v_mfma_f32_16x16x32_bf16 v[244:247], v[112:115], v[52:55], v[244:247]
    ds_read_b64_tr_b16 v[110:111], v22 offset:25600
    s_add_u32 m0, s51, 12288
    s_mov_b32 s53, 3538944
    buffer_load_dwordx4 v3, s[40:43], s53 offen lds
    v_mfma_f32_16x16x32_bf16 v[244:247], v[116:119], v[56:59], v[244:247]
    ds_read_b64_tr_b16 v[112:113], v23 offset:16384
    s_waitcnt lgkmcnt(3)
    v_mfma_f32_16x16x32_bf16 v[184:187], v[88:91], v[120:123], v[184:187]
    ds_read_b64_tr_b16 v[114:115], v23 offset:17408
    s_add_u32 m0, s51, 65536
    s_add_u32 s53, s60, 768
    buffer_load_dwordx4 v2, s[36:39], s53 offen lds
    v_mfma_f32_16x16x32_bf16 v[184:187], v[92:95], v[124:127], v[184:187]
    ds_read_b64_tr_b16 v[116:117], v23 offset:24576
    s_add_u32 m0, s51, 69632
    s_add_u32 s53, s60, 33536
    buffer_load_dwordx4 v2, s[36:39], s53 offen lds
    v_mfma_f32_16x16x32_bf16 v[216:219], v[88:91], v[128:131], v[216:219]
    ds_read_b64_tr_b16 v[118:119], v23 offset:25600
    v_mfma_f32_16x16x32_bf16 v[216:219], v[92:95], v[132:135], v[216:219]
    ds_read_b64_tr_b16 v[88:89], v24 offset:16384
    s_cmp_lt_u32 s50, 2
    s_cbranch_scc1 m_l_g25
    s_add_u32 s54, s65, 17408
    buffer_store_dwordx4 v[164:167], v1, s[44:47], s54 offen sc1
m_l_g25:
    v_mfma_f32_16x16x32_bf16 v[188:191], v[96:99], v[120:123], v[188:191]
    ds_read_b64_tr_b16 v[90:91], v24 offset:17408
    s_add_u32 m0, s51, 73728
    s_add_u32 s53, s60, 66304
    buffer_load_dwordx4 v2, s[36:39], s53 offen lds
    v_mfma_f32_16x16x32_bf16 v[188:191], v[100:103], v[124:127], v[188:191]
    ds_read_b64_tr_b16 v[92:93], v24 offset:24576
    v_mfma_f32_16x16x32_bf16 v[220:223], v[96:99], v[128:131], v[220:223]
    ds_read_b64_tr_b16 v[94:95], v24 offset:25600
    s_add_u32 m0, s51, 77824
    s_add_u32 s53, s60, 99072
    buffer_load_dwordx4 v2, s[36:39], s53 offen lds
    v_mfma_f32_16x16x32_bf16 v[220:223], v[100:103], v[132:135], v[220:223]
    ds_read_b64_tr_b16 v[96:97], v25 offset:16384
    s_waitcnt lgkmcnt(9)
    v_mfma_f32_16x16x32_bf16 v[192:195], v[104:107], v[120:123], v[192:195]
    ds_read_b64_tr_b16 v[98:99], v25 offset:17408
    s_add_u32 m0, s51, 81920
    s_add_u32 s53, s61, 768
    buffer_load_dwordx4 v2, s[36:39], s53 offen lds
    v_mfma_f32_16x16x32_bf16 v[192:195], v[108:111], v[124:127], v[192:195]
    ds_read_b64_tr_b16 v[100:101], v25 offset:24576
    s_add_u32 m0, s51, 86016
    s_add_u32 s53, s61, 33536
    buffer_load_dwordx4 v2, s[36:39], s53 offen lds
    v_mfma_f32_16x16x32_bf16 v[224:227], v[104:107], v[128:131], v[224:227]
    ds_read_b64_tr_b16 v[102:103], v25 offset:25600
    v_mfma_f32_16x16x32_bf16 v[224:227], v[108:111], v[132:135], v[224:227]
    ds_read_b64_tr_b16 v[104:105], v26 offset:16384
    s_cmp_lt_u32 s50, 2
    s_cbranch_scc0 m_l_g26
    s_add_u32 s54, s65, 25600
    buffer_store_dwordx4 v[248:251], v1, s[44:47], s54 offen sc1
m_l_g26:
    s_waitcnt lgkmcnt(9)
    v_mfma_f32_16x16x32_bf16 v[196:199], v[112:115], v[120:123], v[196:199]
    ds_read_b64_tr_b16 v[106:107], v26 offset:17408
    s_add_u32 m0, s51, 90112
    s_add_u32 s53, s61, 66304
    buffer_load_dwordx4 v2, s[36:39], s53 offen lds
    v_mfma_f32_16x16x32_bf16 v[196:199], v[116:119], v[124:127], v[196:199]
    ds_read_b64_tr_b16 v[108:109], v26 offset:24576
    v_mfma_f32_16x16x32_bf16 v[228:231], v[112:115], v[128:131], v[228:231]
    ds_read_b64_tr_b16 v[110:111], v26 offset:25600
    s_add_u32 m0, s51, 94208
    s_add_u32 s53, s61, 99072
    buffer_load_dwordx4 v2, s[36:39], s53 offen lds
    v_mfma_f32_16x16x32_bf16 v[228:231], v[116:119], v[132:135], v[228:231]
    ds_read_b64_tr_b16 v[112:113], v27 offset:16384
    ds_read_b64_tr_b16 v[114:115], v27 offset:17408
    ds_read_b64_tr_b16 v[116:117], v27 offset:24576
    ds_read_b64_tr_b16 v[118:119], v27 offset:25600
    s_waitcnt lgkmcnt(12)
    v_mfma_f32_16x16x32_bf16 v[200:203], v[88:91], v[120:123], v[200:203]
    v_mfma_f32_16x16x32_bf16 v[200:203], v[92:95], v[124:127], v[200:203]
    v_mfma_f32_16x16x32_bf16 v[232:235], v[88:91], v[128:131], v[232:235]
    v_mfma_f32_16x16x32_bf16 v[232:235], v[92:95], v[132:135], v[232:235]
    s_waitcnt lgkmcnt(0)
    s_waitcnt vmcnt(12)
    s_barrier
    ds_read_b64_tr_b16 v[88:89], v20 offset:32768
    v_mfma_f32_16x16x32_bf16 v[204:207], v[96:99], v[120:123], v[204:207]
    ds_read_b64_tr_b16 v[90:91], v20 offset:33792
    s_add_u32 m0, s51, 16384
    s_mov_b32 s53, 3670016
    buffer_load_dwordx4 v3, s[40:43], s53 offen lds
    v_mfma_f32_16x16x32_bf16 v[204:207], v[100:103], v[124:127], v[204:207]
    ds_read_b64_tr_b16 v[92:93], v20 offset:40960
    v_mfma_f32_16x16x32_bf16 v[236:239], v[96:99], v[128:131], v[236:239]
    ds_read_b64_tr_b16 v[94:95], v20 offset:41984
    ds_read_b128 v[44:47], v18 offset:0
    s_add_u32 m0, s51, 20480
    s_mov_b32 s53, 3801088
    buffer_load_dwordx4 v3, s[40:43], s53 offen lds
    v_mfma_f32_16x16x32_bf16 v[236:239], v[100:103], v[132:135], v[236:239]
    ds_read_b64_tr_b16 v[96:97], v21 offset:32768
    v_mfma_f32_16x16x32_bf16 v[208:211], v[104:107], v[120:123], v[208:211]
    ds_read_b64_tr_b16 v[98:99], v21 offset:33792
    ds_read_b128 v[48:51], v19 offset:0
    s_cmp_lt_u32 s50, 2
    s_cbranch_scc1 m_l_g27
    s_add_u32 s54, s64, 24576
    buffer_store_dwordx4 v[172:175], v1, s[44:47], s54 offen sc1
m_l_g27:
    v_mfma_f32_16x16x32_bf16 v[208:211], v[108:111], v[124:127], v[208:211]
    ds_read_b64_tr_b16 v[100:101], v21 offset:40960
    v_mfma_f32_16x16x32_bf16 v[240:243], v[104:107], v[128:131], v[240:243]
    ds_read_b64_tr_b16 v[102:103], v21 offset:41984
    ds_read_b128 v[52:55], v18 offset:2048
    v_mfma_f32_16x16x32_bf16 v[240:243], v[108:111], v[132:135], v[240:243]
    ds_read_b64_tr_b16 v[104:105], v22 offset:32768
    s_add_u32 m0, s51, 24576
    s_mov_b32 s53, 3932160
    buffer_load_dwordx4 v3, s[40:43], s53 offen lds
    v_mfma_f32_16x16x32_bf16 v[212:215], v[112:115], v[120:123], v[212:215]
    ds_read_b64_tr_b16 v[106:107], v22 offset:33792
    ds_read_b128 v[56:59], v19 offset:2048
    v_mfma_f32_16x16x32_bf16 v[212:215], v[116:119], v[124:127], v[212:215]
    ds_read_b64_tr_b16 v[108:109], v22 offset:40960
    s_add_u32 m0, s51, 28672
    s_mov_b32 s53, 4063232
    buffer_load_dwordx4 v3, s[40:43], s53 offen lds
    v_mfma_f32_16x16x32_bf16 v[244:247], v[112:115], v[128:131], v[244:247]
    ds_read_b64_tr_b16 v[110:111], v22 offset:41984
    v_mfma_f32_16x16x32_bf16 v[244:247], v[116:119], v[132:135], v[244:247]
    ds_read_b64_tr_b16 v[112:113], v23 offset:32768
    s_waitcnt lgkmcnt(3)
    v_mfma_f32_16x16x32_bf16 v[184:187], v[88:91], v[44:47], v[184:187]
    ds_read_b64_tr_b16 v[114:115], v23 offset:33792
    s_add_u32 m0, s51, 98304
    s_add_u32 s53, s60, 896
    buffer_load_dwordx4 v2, s[36:39], s53 offen lds
    v_mfma_f32_16x16x32_bf16 v[184:187], v[92:95], v[48:51], v[184:187]
    ds_read_b64_tr_b16 v[116:117], v23 offset:40960
    s_add_u32 m0, s51, 102400
    s_add_u32 s53, s60, 33664
    buffer_load_dwordx4 v2, s[36:39], s53 offen lds
    v_mfma_f32_16x16x32_bf16 v[216:219], v[88:91], v[52:55], v[216:219]
    ds_read_b64_tr_b16 v[118:119], v23 offset:41984
    v_mfma_f32_16x16x32_bf16 v[216:219], v[92:95], v[56:59], v[216:219]
    ds_read_b64_tr_b16 v[88:89], v24 offset:32768
    s_add_u32 m0, s51, 106496
    s_add_u32 s53, s60, 66432
    buffer_load_dwordx4 v2, s[36:39], s53 offen lds
    v_mfma_f32_16x16x32_bf16 v[188:191], v[96:99], v[44:47], v[188:191]
    ds_read_b64_tr_b16 v[90:91], v24 offset:33792
    v_mfma_f32_16x16x32_bf16 v[188:191], v[100:103], v[48:51], v[188:191]
    ds_read_b64_tr_b16 v[92:93], v24 offset:40960
    s_add_u32 m0, s51, 110592
    s_add_u32 s53, s60, 99200
    buffer_load_dwordx4 v2, s[36:39], s53 offen lds
    v_mfma_f32_16x16x32_bf16 v[220:223], v[96:99], v[52:55], v[220:223]
    ds_read_b64_tr_b16 v[94:95], v24 offset:41984
    v_mfma_f32_16x16x32_bf16 v[220:223], v[100:103], v[56:59], v[220:223]
    ds_read_b64_tr_b16 v[96:97], v25 offset:32768
    s_cmp_lt_u32 s50, 2
    s_cbranch_scc1 m_l_g28
    s_add_u32 s54, s64, 28672
    buffer_store_dwordx4 v[176:179], v1, s[44:47], s54 offen sc1
m_l_g28:
    s_waitcnt lgkmcnt(9)
    v_mfma_f32_16x16x32_bf16 v[192:195], v[104:107], v[44:47], v[192:195]
    ds_read_b64_tr_b16 v[98:99], v25 offset:33792
    s_add_u32 m0, s51, 114688
    s_add_u32 s53, s61, 896
    buffer_load_dwordx4 v2, s[36:39], s53 offen lds
    v_mfma_f32_16x16x32_bf16 v[192:195], v[108:111], v[48:51], v[192:195]
    ds_read_b64_tr_b16 v[100:101], v25 offset:40960
    v_mfma_f32_16x16x32_bf16 v[224:227], v[104:107], v[52:55], v[224:227]
    ds_read_b64_tr_b16 v[102:103], v25 offset:41984
    s_add_u32 m0, s51, 118784
    s_add_u32 s53, s61, 33664
    buffer_load_dwordx4 v2, s[36:39], s53 offen lds
    v_mfma_f32_16x16x32_bf16 v[224:227], v[108:111], v[56:59], v[224:227]
    ds_read_b64_tr_b16 v[104:105], v26 offset:32768
    s_waitcnt lgkmcnt(9)
    v_mfma_f32_16x16x32_bf16 v[196:199], v[112:115], v[44:47], v[196:199]
    ds_read_b64_tr_b16 v[106:107], v26 offset:33792
    s_add_u32 m0, s51, 122880
    s_add_u32 s53, s61, 66432
    buffer_load_dwordx4 v2, s[36:39], s53 offen lds
    v_mfma_f32_16x16x32_bf16 v[196:199], v[116:119], v[48:51], v[196:199]
    ds_read_b64_tr_b16 v[108:109], v26 offset:40960
    v_mfma_f32_16x16x32_bf16 v[228:231], v[112:115], v[52:55], v[228:231]
    ds_read_b64_tr_b16 v[110:111], v26 offset:41984
    s_add_u32 m0, s51, 126976
    s_add_u32 s53, s61, 99200
    buffer_load_dwordx4 v2, s[36:39], s53 offen lds
    v_mfma_f32_16x16x32_bf16 v[228:231], v[116:119], v[56:59], v[228:231]
    ds_read_b64_tr_b16 v[112:113], v27 offset:32768
    ds_read_b64_tr_b16 v[114:115], v27 offset:33792
    ds_read_b64_tr_b16 v[116:117], v27 offset:40960
    ds_read_b64_tr_b16 v[118:119], v27 offset:41984
    s_waitcnt lgkmcnt(12)
    v_mfma_f32_16x16x32_bf16 v[200:203], v[88:91], v[44:47], v[200:203]
    v_mfma_f32_16x16x32_bf16 v[200:203], v[92:95], v[48:51], v[200:203]
    v_mfma_f32_16x16x32_bf16 v[232:235], v[88:91], v[52:55], v[232:235]
    v_mfma_f32_16x16x32_bf16 v[232:235], v[92:95], v[56:59], v[232:235]
    s_waitcnt lgkmcnt(0)
    s_waitcnt vmcnt(4)
    s_barrier
    ds_read_b64_tr_b16 v[88:89], v20 offset:0
    v_mfma_f32_16x16x32_bf16 v[204:207], v[96:99], v[44:47], v[204:207]
    ds_read_b64_tr_b16 v[90:91], v20 offset:1024
    s_cmp_lt_u32 s50, 2
    s_cbranch_scc1 m_l_g29
    s_add_u32 s54, s65, 24576
    buffer_store_dwordx4 v[180:183], v1, s[44:47], s54 offen sc1
m_l_g29:
    v_mfma_f32_16x16x32_bf16 v[204:207], v[100:103], v[48:51], v[204:207]
    ds_read_b64_tr_b16 v[92:93], v20 offset:8192
    v_mfma_f32_16x16x32_bf16 v[236:239], v[96:99], v[52:55], v[236:239]
    ds_read_b64_tr_b16 v[94:95], v20 offset:9216
    ds_read_b128 v[120:123], v16 offset:0
    v_mfma_f32_16x16x32_bf16 v[236:239], v[100:103], v[56:59], v[236:239]
    ds_read_b64_tr_b16 v[96:97], v21 offset:0
    v_mfma_f32_16x16x32_bf16 v[208:211], v[104:107], v[44:47], v[208:211]
    ds_read_b64_tr_b16 v[98:99], v21 offset:1024
    ds_read_b128 v[124:127], v17 offset:0
    v_mfma_f32_16x16x32_bf16 v[208:211], v[108:111], v[48:51], v[208:211]
    ds_read_b64_tr_b16 v[100:101], v21 offset:8192
    v_mfma_f32_16x16x32_bf16 v[240:243], v[104:107], v[52:55], v[240:243]
    ds_read_b64_tr_b16 v[102:103], v21 offset:9216
    ds_read_b128 v[128:131], v16 offset:2048
    v_mfma_f32_16x16x32_bf16 v[240:243], v[108:111], v[56:59], v[240:243]
    ds_read_b64_tr_b16 v[104:105], v22 offset:0
    v_mfma_f32_16x16x32_bf16 v[212:215], v[112:115], v[44:47], v[212:215]
    ds_read_b64_tr_b16 v[106:107], v22 offset:1024
    ds_read_b128 v[132:135], v17 offset:2048
    v_mfma_f32_16x16x32_bf16 v[212:215], v[116:119], v[48:51], v[212:215]
    ds_read_b64_tr_b16 v[108:109], v22 offset:8192
    v_mfma_f32_16x16x32_bf16 v[244:247], v[112:115], v[52:55], v[244:247]
    ds_read_b64_tr_b16 v[110:111], v22 offset:9216
    v_mfma_f32_16x16x32_bf16 v[244:247], v[116:119], v[56:59], v[244:247]
    ds_read_b64_tr_b16 v[112:113], v23 offset:0
    s_waitcnt lgkmcnt(3)
    v_mfma_f32_16x16x32_bf16 v[184:187], v[88:91], v[120:123], v[184:187]
    ds_read_b64_tr_b16 v[114:115], v23 offset:1024
    s_cmp_lt_u32 s50, 2
    s_cbranch_scc1 m_l_g30
    s_add_u32 s54, s65, 25600
    buffer_store_dwordx4 v[248:251], v1, s[44:47], s54 offen sc1
m_l_g30:
    v_mfma_f32_16x16x32_bf16 v[184:187], v[92:95], v[124:127], v[184:187]
    ds_read_b64_tr_b16 v[116:117], v23 offset:8192
    v_mfma_f32_16x16x32_bf16 v[216:219], v[88:91], v[128:131], v[216:219]
    ds_read_b64_tr_b16 v[118:119], v23 offset:9216
    v_mfma_f32_16x16x32_bf16 v[216:219], v[92:95], v[132:135], v[216:219]
    ds_read_b64_tr_b16 v[88:89], v24 offset:0
    v_mfma_f32_16x16x32_bf16 v[188:191], v[96:99], v[120:123], v[188:191]
    ds_read_b64_tr_b16 v[90:91], v24 offset:1024
    v_mfma_f32_16x16x32_bf16 v[188:191], v[100:103], v[124:127], v[188:191]
    ds_read_b64_tr_b16 v[92:93], v24 offset:8192
    v_mfma_f32_16x16x32_bf16 v[220:223], v[96:99], v[128:131], v[220:223]
    ds_read_b64_tr_b16 v[94:95], v24 offset:9216
    v_mfma_f32_16x16x32_bf16 v[220:223], v[100:103], v[132:135], v[220:223]
    ds_read_b64_tr_b16 v[96:97], v25 offset:0
    s_waitcnt lgkmcnt(9)
    v_mfma_f32_16x16x32_bf16 v[192:195], v[104:107], v[120:123], v[192:195]
    ds_read_b64_tr_b16 v[98:99], v25 offset:1024
    v_mfma_f32_16x16x32_bf16 v[192:195], v[108:111], v[124:127], v[192:195]
    ds_read_b64_tr_b16 v[100:101], v25 offset:8192
    v_mfma_f32_16x16x32_bf16 v[224:227], v[104:107], v[128:131], v[224:227]
    ds_read_b64_tr_b16 v[102:103], v25 offset:9216
    v_mfma_f32_16x16x32_bf16 v[224:227], v[108:111], v[132:135], v[224:227]
    ds_read_b64_tr_b16 v[104:105], v26 offset:0
    s_waitcnt lgkmcnt(9)
    v_mfma_f32_16x16x32_bf16 v[196:199], v[112:115], v[120:123], v[196:199]
    ds_read_b64_tr_b16 v[106:107], v26 offset:1024
    v_mfma_f32_16x16x32_bf16 v[196:199], v[116:119], v[124:127], v[196:199]
    ds_read_b64_tr_b16 v[108:109], v26 offset:8192
    v_mfma_f32_16x16x32_bf16 v[228:231], v[112:115], v[128:131], v[228:231]
    ds_read_b64_tr_b16 v[110:111], v26 offset:9216
    v_mfma_f32_16x16x32_bf16 v[228:231], v[116:119], v[132:135], v[228:231]
    ds_read_b64_tr_b16 v[112:113], v27 offset:0
    ds_read_b64_tr_b16 v[114:115], v27 offset:1024
    ds_read_b64_tr_b16 v[116:117], v27 offset:8192
    ds_read_b64_tr_b16 v[118:119], v27 offset:9216
    s_waitcnt lgkmcnt(12)
    v_mfma_f32_16x16x32_bf16 v[200:203], v[88:91], v[120:123], v[200:203]
    v_mfma_f32_16x16x32_bf16 v[200:203], v[92:95], v[124:127], v[200:203]
    v_mfma_f32_16x16x32_bf16 v[232:235], v[88:91], v[128:131], v[232:235]
    v_mfma_f32_16x16x32_bf16 v[232:235], v[92:95], v[132:135], v[232:235]
    s_waitcnt lgkmcnt(0)
    s_waitcnt vmcnt(0)
    s_barrier
    ds_read_b64_tr_b16 v[88:89], v20 offset:16384
    v_mfma_f32_16x16x32_bf16 v[204:207], v[96:99], v[120:123], v[204:207]
    ds_read_b64_tr_b16 v[90:91], v20 offset:17408
    s_add_u32 m0, s56, 131072
    s_add_u32 s53, s56, 0
    buffer_load_dwordx4 v1, s[28:31], s53 offen offset:0 sc1 lds
    v_mfma_f32_16x16x32_bf16 v[204:207], v[100:103], v[124:127], v[204:207]
    ds_read_b64_tr_b16 v[92:93], v20 offset:24576
    v_mfma_f32_16x16x32_bf16 v[236:239], v[96:99], v[128:131], v[236:239]
    ds_read_b64_tr_b16 v[94:95], v20 offset:25600
    ds_read_b128 v[44:47], v16 offset:32768
    buffer_load_dwordx4 v1, s[28:31], s53 offen offset:1024 sc1 lds
    v_mfma_f32_16x16x32_bf16 v[236:239], v[100:103], v[132:135], v[236:239]
    ds_read_b64_tr_b16 v[96:97], v21 offset:16384
    v_mfma_f32_16x16x32_bf16 v[208:211], v[104:107], v[120:123], v[208:211]
    ds_read_b64_tr_b16 v[98:99], v21 offset:17408
    ds_read_b128 v[48:51], v17 offset:32768
    buffer_load_dwordx4 v1, s[28:31], s53 offen offset:2048 sc1 lds
    v_mfma_f32_16x16x32_bf16 v[208:211], v[108:111], v[124:127], v[208:211]
    ds_read_b64_tr_b16 v[100:101], v21 offset:24576
    v_mfma_f32_16x16x32_bf16 v[240:243], v[104:107], v[128:131], v[240:243]
    ds_read_b64_tr_b16 v[102:103], v21 offset:25600
    ds_read_b128 v[52:55], v16 offset:34816
    buffer_load_dwordx4 v1, s[28:31], s53 offen offset:3072 sc1 lds
    v_mfma_f32_16x16x32_bf16 v[240:243], v[108:111], v[132:135], v[240:243]
    ds_read_b64_tr_b16 v[104:105], v22 offset:16384
    v_mfma_f32_16x16x32_bf16 v[212:215], v[112:115], v[120:123], v[212:215]
    ds_read_b64_tr_b16 v[106:107], v22 offset:17408
    ds_read_b128 v[56:59], v17 offset:34816
    s_add_u32 m0, s56, 147456
    s_add_u32 s53, s56, 16384
    buffer_load_dwordx4 v1, s[28:31], s53 offen offset:0 sc1 lds
    v_mfma_f32_16x16x32_bf16 v[212:215], v[116:119], v[124:127], v[212:215]
    ds_read_b64_tr_b16 v[108:109], v22 offset:24576
    v_mfma_f32_16x16x32_bf16 v[244:247], v[112:115], v[128:131], v[244:247]
    ds_read_b64_tr_b16 v[110:111], v22 offset:25600
    buffer_load_dwordx4 v1, s[28:31], s53 offen offset:1024 sc1 lds
    v_mfma_f32_16x16x32_bf16 v[244:247], v[116:119], v[132:135], v[244:247]
    ds_read_b64_tr_b16 v[112:113], v23 offset:16384
    s_waitcnt lgkmcnt(3)
    v_mfma_f32_16x16x32_bf16 v[184:187], v[88:91], v[44:47], v[184:187]
    ds_read_b64_tr_b16 v[114:115], v23 offset:17408
    buffer_load_dwordx4 v1, s[28:31], s53 offen offset:2048 sc1 lds
    v_mfma_f32_16x16x32_bf16 v[184:187], v[92:95], v[48:51], v[184:187]
    ds_read_b64_tr_b16 v[116:117], v23 offset:24576
    buffer_load_dwordx4 v1, s[28:31], s53 offen offset:3072 sc1 lds
    v_mfma_f32_16x16x32_bf16 v[216:219], v[88:91], v[52:55], v[216:219]
    ds_read_b64_tr_b16 v[118:119], v23 offset:25600
    v_mfma_f32_16x16x32_bf16 v[216:219], v[92:95], v[56:59], v[216:219]
    ds_read_b64_tr_b16 v[88:89], v24 offset:16384
    s_add_u32 m0, s56, 32768
    s_add_u32 s53, s56, 0
    buffer_load_dwordx4 v1, s[8:11], s53 offen offset:0 sc1 lds
    v_mfma_f32_16x16x32_bf16 v[188:191], v[96:99], v[44:47], v[188:191]
    ds_read_b64_tr_b16 v[90:91], v24 offset:17408
    buffer_load_dwordx4 v1, s[8:11], s53 offen offset:1024 sc1 lds
    v_mfma_f32_16x16x32_bf16 v[188:191], v[100:103], v[48:51], v[188:191]
    ds_read_b64_tr_b16 v[92:93], v24 offset:24576
    v_mfma_f32_16x16x32_bf16 v[220:223], v[96:99], v[52:55], v[220:223]
    ds_read_b64_tr_b16 v[94:95], v24 offset:25600
    buffer_load_dwordx4 v1, s[8:11], s53 offen offset:2048 sc1 lds
    v_mfma_f32_16x16x32_bf16 v[220:223], v[100:103], v[56:59], v[220:223]
    ds_read_b64_tr_b16 v[96:97], v25 offset:16384
    s_waitcnt lgkmcnt(9)
    v_mfma_f32_16x16x32_bf16 v[192:195], v[104:107], v[44:47], v[192:195]
    ds_read_b64_tr_b16 v[98:99], v25 offset:17408
    buffer_load_dwordx4 v1, s[8:11], s53 offen offset:3072 sc1 lds
    v_mfma_f32_16x16x32_bf16 v[192:195], v[108:111], v[48:51], v[192:195]
    ds_read_b64_tr_b16 v[100:101], v25 offset:24576
    s_add_u32 m0, s56, 49152
    s_add_u32 s53, s56, 16384
    buffer_load_dwordx4 v1, s[8:11], s53 offen offset:0 sc1 lds
    v_mfma_f32_16x16x32_bf16 v[224:227], v[104:107], v[52:55], v[224:227]
    ds_read_b64_tr_b16 v[102:103], v25 offset:25600
    v_mfma_f32_16x16x32_bf16 v[224:227], v[108:111], v[56:59], v[224:227]
    ds_read_b64_tr_b16 v[104:105], v26 offset:16384
    buffer_load_dwordx4 v1, s[8:11], s53 offen offset:1024 sc1 lds
    s_waitcnt lgkmcnt(9)
    v_mfma_f32_16x16x32_bf16 v[196:199], v[112:115], v[44:47], v[196:199]
    ds_read_b64_tr_b16 v[106:107], v26 offset:17408
    buffer_load_dwordx4 v1, s[8:11], s53 offen offset:2048 sc1 lds
    v_mfma_f32_16x16x32_bf16 v[196:199], v[116:119], v[48:51], v[196:199]
    ds_read_b64_tr_b16 v[108:109], v26 offset:24576
    v_mfma_f32_16x16x32_bf16 v[228:231], v[112:115], v[52:55], v[228:231]
    ds_read_b64_tr_b16 v[110:111], v26 offset:25600
    buffer_load_dwordx4 v1, s[8:11], s53 offen offset:3072 sc1 lds
    v_mfma_f32_16x16x32_bf16 v[228:231], v[116:119], v[56:59], v[228:231]
    ds_read_b64_tr_b16 v[112:113], v27 offset:16384
    ds_read_b64_tr_b16 v[114:115], v27 offset:17408
    ds_read_b64_tr_b16 v[116:117], v27 offset:24576
    ds_read_b64_tr_b16 v[118:119], v27 offset:25600
    s_waitcnt lgkmcnt(12)
    v_mfma_f32_16x16x32_bf16 v[200:203], v[88:91], v[44:47], v[200:203]
    v_mfma_f32_16x16x32_bf16 v[200:203], v[92:95], v[48:51], v[200:203]
    v_mfma_f32_16x16x32_bf16 v[232:235], v[88:91], v[52:55], v[232:235]
    v_mfma_f32_16x16x32_bf16 v[232:235], v[92:95], v[56:59], v[232:235]
    s_waitcnt lgkmcnt(8)
    v_mfma_f32_16x16x32_bf16 v[204:207], v[96:99], v[44:47], v[204:207]
    v_mfma_f32_16x16x32_bf16 v[204:207], v[100:103], v[48:51], v[204:207]
    v_mfma_f32_16x16x32_bf16 v[236:239], v[96:99], v[52:55], v[236:239]
    v_mfma_f32_16x16x32_bf16 v[236:239], v[100:103], v[56:59], v[236:239]
    s_waitcnt lgkmcnt(4)
    v_mfma_f32_16x16x32_bf16 v[208:211], v[104:107], v[44:47], v[208:211]
    v_mfma_f32_16x16x32_bf16 v[208:211], v[108:111], v[48:51], v[208:211]
    v_mfma_f32_16x16x32_bf16 v[240:243], v[104:107], v[52:55], v[240:243]
    v_mfma_f32_16x16x32_bf16 v[240:243], v[108:111], v[56:59], v[240:243]
    s_waitcnt lgkmcnt(0)
    v_mfma_f32_16x16x32_bf16 v[212:215], v[112:115], v[44:47], v[212:215]
    v_mfma_f32_16x16x32_bf16 v[212:215], v[116:119], v[48:51], v[212:215]
    v_mfma_f32_16x16x32_bf16 v[244:247], v[112:115], v[52:55], v[244:247]
    v_mfma_f32_16x16x32_bf16 v[244:247], v[116:119], v[56:59], v[244:247]
    s_lshl_b32 s60, s55, 1
    s_add_u32 s60, s60, 2
    v_mov_b32 v6, 0x3e0293ee
    v_mov_b32 v7, 0x3e0293ee
    s_nop 2
    v_pk_mul_f32 v[184:185], v[184:185], v[6:7]
    v_pk_mul_f32 v[186:187], v[186:187], v[6:7]
    v_cvt_pk_bf16_f32 v152, v184, v185
    v_cvt_pk_bf16_f32 v153, v186, v187
    v_pk_mul_f32 v[188:189], v[188:189], v[6:7]
    v_pk_mul_f32 v[190:191], v[190:191], v[6:7]
    v_cvt_pk_bf16_f32 v154, v188, v189
    v_cvt_pk_bf16_f32 v155, v190, v191
    v_pk_mul_f32 v[192:193], v[192:193], v[6:7]
    v_pk_mul_f32 v[194:195], v[194:195], v[6:7]
    v_cvt_pk_bf16_f32 v156, v192, v193
    v_cvt_pk_bf16_f32 v157, v194, v195
    v_pk_mul_f32 v[196:197], v[196:197], v[6:7]
    v_pk_mul_f32 v[198:199], v[198:199], v[6:7]
    v_cvt_pk_bf16_f32 v158, v196, v197
    v_cvt_pk_bf16_f32 v159, v198, v199
    v_pk_mul_f32 v[200:201], v[200:201], v[6:7]
    v_pk_mul_f32 v[202:203], v[202:203], v[6:7]
    v_cvt_pk_bf16_f32 v160, v200, v201
    v_cvt_pk_bf16_f32 v161, v202, v203
    v_pk_mul_f32 v[204:205], v[204:205], v[6:7]
    v_pk_mul_f32 v[206:207], v[206:207], v[6:7]
    v_cvt_pk_bf16_f32 v162, v204, v205
    v_cvt_pk_bf16_f32 v163, v206, v207
    v_pk_mul_f32 v[208:209], v[208:209], v[6:7]
    v_pk_mul_f32 v[210:211], v[210:211], v[6:7]
    v_cvt_pk_bf16_f32 v164, v208, v209
    v_cvt_pk_bf16_f32 v165, v210, v211
    v_pk_mul_f32 v[212:213], v[212:213], v[6:7]
    v_pk_mul_f32 v[214:215], v[214:215], v[6:7]
    v_cvt_pk_bf16_f32 v166, v212, v213
    v_cvt_pk_bf16_f32 v167, v214, v215
    v_pk_mul_f32 v[216:217], v[216:217], v[6:7]
    v_pk_mul_f32 v[218:219], v[218:219], v[6:7]
    v_cvt_pk_bf16_f32 v168, v216, v217
    v_cvt_pk_bf16_f32 v169, v218, v219
    v_pk_mul_f32 v[220:221], v[220:221], v[6:7]
    v_pk_mul_f32 v[222:223], v[222:223], v[6:7]
    v_cvt_pk_bf16_f32 v170, v220, v221
    v_cvt_pk_bf16_f32 v171, v222, v223
    v_pk_mul_f32 v[224:225], v[224:225], v[6:7]
    v_pk_mul_f32 v[226:227], v[226:227], v[6:7]
    v_cvt_pk_bf16_f32 v172, v224, v225
    v_cvt_pk_bf16_f32 v173, v226, v227
    v_pk_mul_f32 v[228:229], v[228:229], v[6:7]
    v_pk_mul_f32 v[230:231], v[230:231], v[6:7]
    v_cvt_pk_bf16_f32 v174, v228, v229
    v_cvt_pk_bf16_f32 v175, v230, v231
    v_pk_mul_f32 v[232:233], v[232:233], v[6:7]
    v_pk_mul_f32 v[234:235], v[234:235], v[6:7]
    v_cvt_pk_bf16_f32 v176, v232, v233
    v_cvt_pk_bf16_f32 v177, v234, v235
    v_pk_mul_f32 v[236:237], v[236:237], v[6:7]
    v_pk_mul_f32 v[238:239], v[238:239], v[6:7]
    v_cvt_pk_bf16_f32 v178, v236, v237
    v_cvt_pk_bf16_f32 v179, v238, v239
    v_pk_mul_f32 v[240:241], v[240:241], v[6:7]
    v_pk_mul_f32 v[242:243], v[242:243], v[6:7]
    v_cvt_pk_bf16_f32 v180, v240, v241
    v_cvt_pk_bf16_f32 v181, v242, v243
    v_pk_mul_f32 v[244:245], v[244:245], v[6:7]
    v_pk_mul_f32 v[246:247], v[246:247], v[6:7]
    v_cvt_pk_bf16_f32 v182, v244, v245
    v_cvt_pk_bf16_f32 v183, v246, v247
    s_mov_b32 s61, 1
    s_mov_b32 s62, 0xc000
    s_mov_b32 s63, 0x8000
    s_mov_b32 s66, s56
    s_add_u32 s64, s66, 49152
    s_add_u32 s65, s66, 32768
    s_mov_b32 s67, s59
    v_add_u32 v2, 0xc000, v4
    v_add_u32 v3, 0x8000, v1
    s_mov_b32 s98, 0xc000
    s_mov_b32 s99, 0
    s_lshl_b32 s71, s49, 7
    s_add_u32 s71, s71, 63963136
    v_and_b32 v254, 7, v0
    v_lshlrev_b32 v254, 3, v254
    v_mov_b32 v6, 0xf149f2ca
    v_mov_b32 v7, 0x10000
    v_mov_b32 v12, 0x3f803f80
    v_mov_b32 v13, 0x3f803f80
    v_mov_b32 v14, 0x3f803f80
    v_mov_b32 v15, 0x3f803f80
    v_mov_b64 v[24:25], 0
    v_mov_b64 v[26:27], 0
    v_mov_b64 v[28:29], 0
    v_mov_b64 v[30:31], 0
    v_mov_b64 v[32:33], 0
    v_mov_b64 v[34:35], 0
    v_mov_b64 v[36:37], 0
    v_mov_b64 v[38:39], 0
    s_waitcnt vmcnt(0)
    s_branch m_join
m_front_c:
    s_lshr_b32 s52, s2, 3
    s_lshl_b32 s52, s52, 3
    s_add_u32 s52, s52, s48
    s_and_b32 s52, s52, 63
    s_min_u32 s53, s52, 34
    s_lshl_b32 s53, s53, 21
    s_add_u32 s68, s26, s53
    s_addc_u32 s69, s27, 0
    s_mov_b32 s53, 0
    s_cmp_eq_u32 s52, 40
    s_cselect_b64 s[68:69], s[4:5], s[68:69]
    s_cmp_eq_u32 s52, 41
    s_cselect_b64 s[68:69], s[4:5], s[68:69]
    s_cselect_b32 s53, 2097088, s53
    s_cmp_eq_u32 s52, 42
    s_cselect_b64 s[68:69], s[6:7], s[68:69]
    s_cmp_eq_u32 s52, 43
    s_cselect_b64 s[68:69], s[6:7], s[68:69]
    s_cselect_b32 s53, 2097088, s53
    s_cmp_eq_u32 s52, 44
    s_cselect_b64 s[68:69], s[8:9], s[68:69]
    s_cmp_eq_u32 s52, 45
    s_cselect_b64 s[68:69], s[8:9], s[68:69]
    s_cselect_b32 s53, 4194240, s53
    s_cmp_eq_u32 s52, 46
    s_cselect_b64 s[68:69], s[10:11], s[68:69]
    s_cmp_eq_u32 s52, 47
    s_cselect_b64 s[68:69], s[10:11], s[68:69]
    s_cselect_b32 s53, 4194240, s53
    s_cmp_eq_u32 s52, 48
    s_cselect_b64 s[68:69], s[12:13], s[68:69]
    s_cmp_eq_u32 s52, 49
    s_cselect_b64 s[68:69], s[12:13], s[68:69]
    s_cselect_b32 s53, 4194240, s53
    s_cmp_eq_u32 s52, 50
    s_cselect_b64 s[68:69], s[14:15], s[68:69]
    s_cmp_eq_u32 s52, 51
    s_cselect_b64 s[68:69], s[14:15], s[68:69]
    s_cselect_b32 s53, 4194240, s53
    s_cmp_eq_u32 s52, 52
    s_cselect_b64 s[68:69], s[16:17], s[68:69]
    s_cmp_eq_u32 s52, 53
    s_cselect_b64 s[68:69], s[16:17], s[68:69]
    s_cselect_b32 s53, 2097088, s53
    s_cmp_eq_u32 s52, 54
    s_cselect_b64 s[68:69], s[18:19], s[68:69]
    s_cmp_eq_u32 s52, 55
    s_cselect_b64 s[68:69], s[18:19], s[68:69]
    s_cselect_b32 s53, 1572800, s53
    s_cmp_eq_u32 s52, 56
    s_cselect_b64 s[68:69], s[20:21], s[68:69]
    s_cmp_eq_u32 s52, 57
    s_cselect_b64 s[68:69], s[20:21], s[68:69]
    s_cselect_b32 s53, 524224, s53
    s_cmp_eq_u32 s52, 58
    s_cselect_b64 s[68:69], s[22:23], s[68:69]
    s_cmp_eq_u32 s52, 59
    s_cselect_b64 s[68:69], s[22:23], s[68:69]
    s_cselect_b32 s53, 4194240, s53
    s_load_dword s97, s[68:69], s53
    s_mov_b32 s44, s26
    s_mov_b32 s45, s27
    s_mov_b32 s46, 0x4600000
    s_mov_b32 s47, 0x20000
    s_mov_b32 s28, s16
    s_mov_b32 s29, s17
    s_mov_b32 s30, 0x200000
    s_mov_b32 s31, 0x20000
    s_mov_b64 s[22:23], s[14:15]
    s_mov_b32 s12, s18
    s_mov_b32 s13, s19
    s_mov_b32 s14, 0x180000
    s_mov_b32 s15, 0x20000
    v_lshlrev_b32 v9, 2, v11
    v_sub_u32 v5, v8, v9
    v_lshrrev_b32 v9, 1, v8
    v_xor_b32 v9, v9, v11
    v_lshlrev_b32 v9, 4, v9
    v_lshl_add_u32 v26, v8, 7, v9
    v_lshrrev_b32 v7, 2, v8
    v_lshl_add_u32 v10, v11, 3, v7
    s_add_u32 s52, s56, 98304
    v_add_u32 v12, s52, v26
    v_xor_b32 v13, 64, v12
    v_and_b32 v28, 1, v11
    v_xor_b32 v29, 0, v28
    v_lshlrev_b32 v29, 5, v29
    v_and_b32 v30, 3, v0
    v_lshlrev_b32 v30, 3, v30
    v_lshl_add_u32 v29, v10, 6, v29
    v_add_u32 v14, v29, v30
    v_add_u32 v15, 0x10000, v14
    v_lshl_or_b32 v28, v28, 2, v7
    v_lshl_add_u32 v31, v10, 8, v30
    s_lshl_b32 s52, s54, 1
    v_xor_b32 v29, s52, v28
    v_lshl_add_u32 v29, v29, 5, v31
    v_add_u32 v20, 98304, v29
    v_xor_b32 v21, 32, v20
    v_lshl_add_u32 v27, v28, 5, v31
    v_add_u32 v16, 0, v26
    v_xor_b32 v17, 64, v16
    v_add_u32 v18, 0x10000, v16
    v_add_u32 v19, 0x10000, v17
    s_bfe_u32 s59, s2, 0x30003
    s_cmp_eq_u32 s48, 0
    s_cselect_b32 s59, s59, 99
    s_mov_b32 s68, s24
    s_mov_b32 s69, s25
    s_mov_b32 s70, 0x100
    s_mov_b32 s71, 0x20000
    s_or_b32 s64, s64, 1
    v_mov_b32 v22, s64
    v_mov_b32 v23, s65
    v_mov_b32 v24, 0
    v_mov_b32 v25, 0
    s_lshr_b32 s52, s2, 3
    s_and_b32 s67, s2, 3
    s_lshl_b32 s67, s67, 19
    s_lshl_b32 s53, s52, 14
    s_add_u32 s67, s67, s53
    v_and_b32 v10, 15, v0
    v_lshlrev_b32 v10, 10, v10
    v_lshl_add_u32 v10, v11, 7, v10
    s_lshl_b32 s62, s2, 13
    s_lshl_b32 s52, s51, 1
    s_add_u32 s62, s62, s52
    s_lshl_b32 s63, s62, 1
    s_waitcnt vmcnt(4)
    s_barrier
    ds_read_b64_tr_b16 v[64:65], v20 offset:0
    ds_read_b64_tr_b16 v[66:67], v20 offset:1024
    ds_read_b64_tr_b16 v[68:69], v20 offset:16384
    ds_read_b64_tr_b16 v[70:71], v20 offset:17408
    ds_read_b64_tr_b16 v[72:73], v21 offset:0
    ds_read_b64_tr_b16 v[74:75], v21 offset:1024
    ds_read_b64_tr_b16 v[76:77], v21 offset:16384
    ds_read_b64_tr_b16 v[78:79], v21 offset:17408
    ds_read_b64_tr_b16 v[80:81], v20 offset:8192
    ds_read_b64_tr_b16 v[82:83], v20 offset:9216
    ds_read_b64_tr_b16 v[84:85], v20 offset:24576
    ds_read_b64_tr_b16 v[86:87], v20 offset:25600
    ds_read_b64_tr_b16 v[88:89], v21 offset:8192
    ds_read_b64_tr_b16 v[90:91], v21 offset:9216
    ds_read_b64_tr_b16 v[92:93], v21 offset:24576
    ds_read_b64_tr_b16 v[94:95], v21 offset:25600
    ds_read_b128 v[32:35], v16 offset:0
    ds_read_b128 v[36:39], v17 offset:0
    ds_read_b128 v[40:43], v16 offset:2048
    ds_read_b128 v[44:47], v17 offset:2048
    ds_read_b128 v[48:51], v16 offset:4096
    ds_read_b128 v[52:55], v17 offset:4096
    ds_read_b128 v[56:59], v16 offset:6144
    ds_read_b128 v[60:63], v17 offset:6144
    s_add_u32 m0, s51, 32768
    s_add_u32 s53, s58, 128
    buffer_load_dwordx4 v2, s[36:39], s53 offen lds
    s_add_u32 m0, s51, 40960
    s_add_u32 s53, s58, 65664
    buffer_load_dwordx4 v2, s[36:39], s53 offen lds
    s_add_u32 m0, s51, 49152
    s_add_u32 s53, s58, 131200
    buffer_load_dwordx4 v2, s[36:39], s53 offen lds
    s_add_u32 m0, s51, 57344
    s_add_u32 s53, s58, 196736
    buffer_load_dwordx4 v2, s[36:39], s53 offen lds
    s_add_u32 m0, s51, 65536
    s_add_u32 s53, s58, 256
    buffer_load_dwordx4 v2, s[36:39], s53 offen lds
    s_add_u32 m0, s51, 73728
    s_add_u32 s53, s58, 65792
    buffer_load_dwordx4 v2, s[36:39], s53 offen lds
    s_add_u32 m0, s51, 81920
    s_add_u32 s53, s58, 131328
    buffer_load_dwordx4 v2, s[36:39], s53 offen lds
    s_add_u32 m0, s51, 90112
    s_add_u32 s53, s58, 196864
    buffer_load_dwordx4 v2, s[36:39], s53 offen lds
    s_waitcnt lgkmcnt(6)
    v_mfma_f32_16x16x32_bf16 v[128:131], v[64:67], v[32:35], 0
    v_mfma_f32_16x16x32_bf16 v[128:131], v[68:71], v[36:39], v[128:131]
    s_waitcnt vmcnt(8)
    s_barrier
    v_mfma_f32_16x16x32_bf16 v[132:135], v[72:75], v[32:35], 0
    ds_read_b64_tr_b16 v[96:97], v20 offset:32768
    v_mfma_f32_16x16x32_bf16 v[132:135], v[76:79], v[36:39], v[132:135]
    ds_read_b64_tr_b16 v[98:99], v20 offset:33792
    v_mfma_f32_16x16x32_bf16 v[136:139], v[32:35], v[80:83], 0
    ds_read_b64_tr_b16 v[100:101], v20 offset:49152
    v_mfma_f32_16x16x32_bf16 v[136:139], v[36:39], v[84:87], v[136:139]
    ds_read_b64_tr_b16 v[102:103], v20 offset:50176
    v_mfma_f32_16x16x32_bf16 v[140:143], v[32:35], v[88:91], 0
    s_cmp_lg_u32 s59, 0
    s_cbranch_scc1 m_c_notok0
    s_mov_b64 exec, 1
    buffer_atomic_cmpswap_x2 v[22:25], off, s[68:71], 0 sc0 sc1
    s_mov_b64 exec, -1
m_c_notok0:
    v_mfma_f32_16x16x32_bf16 v[140:143], v[36:39], v[92:95], v[140:143]
    ds_read_b128 v[32:35], v16 offset:8192
    ds_read_b128 v[36:39], v17 offset:8192
    s_waitcnt lgkmcnt(10)
    v_mfma_f32_16x16x32_bf16 v[144:147], v[64:67], v[40:43], 0
    v_mfma_f32_16x16x32_bf16 v[144:147], v[68:71], v[44:47], v[144:147]
    v_mfma_f32_16x16x32_bf16 v[148:151], v[72:75], v[40:43], 0
    ds_read_b64_tr_b16 v[104:105], v21 offset:32768
    v_mfma_f32_16x16x32_bf16 v[148:151], v[76:79], v[44:47], v[148:151]
    ds_read_b64_tr_b16 v[106:107], v21 offset:33792
    v_mfma_f32_16x16x32_bf16 v[152:155], v[40:43], v[80:83], 0
    ds_read_b64_tr_b16 v[108:109], v21 offset:49152
    v_mfma_f32_16x16x32_bf16 v[152:155], v[44:47], v[84:87], v[152:155]
    ds_read_b64_tr_b16 v[110:111], v21 offset:50176
    v_mfma_f32_16x16x32_bf16 v[156:159], v[40:43], v[88:91], 0
    v_mfma_f32_16x16x32_bf16 v[156:159], v[44:47], v[92:95], v[156:159]
    ds_read_b128 v[40:43], v16 offset:10240
    ds_read_b128 v[44:47], v17 offset:10240
    s_waitcnt lgkmcnt(14)
    v_mfma_f32_16x16x32_bf16 v[160:163], v[64:67], v[48:51], 0
    v_mfma_f32_16x16x32_bf16 v[160:163], v[68:71], v[52:55], v[160:163]
    v_mfma_f32_16x16x32_bf16 v[164:167], v[72:75], v[48:51], 0
    ds_read_b64_tr_b16 v[112:113], v20 offset:40960
    v_mfma_f32_16x16x32_bf16 v[164:167], v[76:79], v[52:55], v[164:167]
    ds_read_b64_tr_b16 v[114:115], v20 offset:41984
    v_mfma_f32_16x16x32_bf16 v[168:171], v[48:51], v[80:83], 0
    ds_read_b64_tr_b16 v[116:117], v20 offset:57344
    v_mfma_f32_16x16x32_bf16 v[168:171], v[52:55], v[84:87], v[168:171]
    ds_read_b64_tr_b16 v[118:119], v20 offset:58368
    v_mfma_f32_16x16x32_bf16 v[172:175], v[48:51], v[88:91], 0
    v_mfma_f32_16x16x32_bf16 v[172:175], v[52:55], v[92:95], v[172:175]
    ds_read_b128 v[48:51], v16 offset:12288
    ds_read_b128 v[52:55], v17 offset:12288
    s_waitcnt lgkmcnt(15)
    v_mfma_f32_16x16x32_bf16 v[176:179], v[64:67], v[56:59], 0
    v_mfma_f32_16x16x32_bf16 v[176:179], v[68:71], v[60:63], v[176:179]
    v_mfma_f32_16x16x32_bf16 v[180:183], v[72:75], v[56:59], 0
    ds_read_b64_tr_b16 v[120:121], v21 offset:40960
    v_mfma_f32_16x16x32_bf16 v[180:183], v[76:79], v[60:63], v[180:183]
    ds_read_b64_tr_b16 v[122:123], v21 offset:41984
    v_mfma_f32_16x16x32_bf16 v[184:187], v[56:59], v[80:83], 0
    ds_read_b64_tr_b16 v[124:125], v21 offset:57344
    v_mfma_f32_16x16x32_bf16 v[184:187], v[60:63], v[84:87], v[184:187]
    ds_read_b64_tr_b16 v[126:127], v21 offset:58368
    v_mfma_f32_16x16x32_bf16 v[188:191], v[56:59], v[88:91], 0
    v_mfma_f32_16x16x32_bf16 v[188:191], v[60:63], v[92:95], v[188:191]
    ds_read_b128 v[56:59], v16 offset:14336
    ds_read_b128 v[60:63], v17 offset:14336
    s_waitcnt lgkmcnt(15)
    v_mfma_f32_16x16x32_bf16 v[192:195], v[64:67], v[32:35], 0
    v_mfma_f32_16x16x32_bf16 v[192:195], v[68:71], v[36:39], v[192:195]
    v_mfma_f32_16x16x32_bf16 v[196:199], v[72:75], v[32:35], 0
    v_mfma_f32_16x16x32_bf16 v[196:199], v[76:79], v[36:39], v[196:199]
    v_mfma_f32_16x16x32_bf16 v[200:203], v[32:35], v[80:83], 0
    v_mfma_f32_16x16x32_bf16 v[200:203], v[36:39], v[84:87], v[200:203]
    v_mfma_f32_16x16x32_bf16 v[204:207], v[32:35], v[88:91], 0
    s_waitcnt lgkmcnt(0)
    s_waitcnt vmcnt(4)
    s_barrier
    v_mfma_f32_16x16x32_bf16 v[204:207], v[36:39], v[92:95], v[204:207]
    ds_read_b128 v[32:35], v16 offset:32768
    ds_read_b128 v[36:39], v17 offset:32768
    v_mfma_f32_16x16x32_bf16 v[208:211], v[64:67], v[40:43], 0
    s_cmp_lg_u32 s59, 1
    s_cbranch_scc1 m_c_notok1
    s_mov_b64 exec, 1
    buffer_atomic_cmpswap_x2 v[22:25], off, s[68:71], 0 sc0 sc1
    s_mov_b64 exec, -1
m_c_notok1:
    v_mfma_f32_16x16x32_bf16 v[208:211], v[68:71], v[44:47], v[208:211]
    v_mfma_f32_16x16x32_bf16 v[212:215], v[72:75], v[40:43], 0
    v_mfma_f32_16x16x32_bf16 v[212:215], v[76:79], v[44:47], v[212:215]
    v_mfma_f32_16x16x32_bf16 v[216:219], v[40:43], v[80:83], 0
    v_mfma_f32_16x16x32_bf16 v[216:219], v[44:47], v[84:87], v[216:219]
    v_mfma_f32_16x16x32_bf16 v[220:223], v[40:43], v[88:91], 0
    v_mfma_f32_16x16x32_bf16 v[220:223], v[44:47], v[92:95], v[220:223]
    ds_read_b128 v[40:43], v16 offset:34816
    ds_read_b128 v[44:47], v17 offset:34816
    v_mfma_f32_16x16x32_bf16 v[224:227], v[64:67], v[48:51], 0
    v_mfma_f32_16x16x32_bf16 v[224:227], v[68:71], v[52:55], v[224:227]
    v_mfma_f32_16x16x32_bf16 v[228:231], v[72:75], v[48:51], 0
    v_mfma_f32_16x16x32_bf16 v[228:231], v[76:79], v[52:55], v[228:231]
    v_mfma_f32_16x16x32_bf16 v[232:235], v[48:51], v[80:83], 0
    v_mfma_f32_16x16x32_bf16 v[232:235], v[52:55], v[84:87], v[232:235]
    v_mfma_f32_16x16x32_bf16 v[236:239], v[48:51], v[88:91], 0
    v_mfma_f32_16x16x32_bf16 v[236:239], v[52:55], v[92:95], v[236:239]
    ds_read_b128 v[48:51], v16 offset:36864
    ds_read_b128 v[52:55], v17 offset:36864
    v_mfma_f32_16x16x32_bf16 v[240:243], v[64:67], v[56:59], 0
    v_mfma_f32_16x16x32_bf16 v[240:243], v[68:71], v[60:63], v[240:243]
    v_mfma_f32_16x16x32_bf16 v[244:247], v[72:75], v[56:59], 0
    v_mfma_f32_16x16x32_bf16 v[244:247], v[76:79], v[60:63], v[244:247]
    v_mfma_f32_16x16x32_bf16 v[248:251], v[56:59], v[80:83], 0
    v_mfma_f32_16x16x32_bf16 v[248:251], v[60:63], v[84:87], v[248:251]
    v_mfma_f32_16x16x32_bf16 v[252:255], v[56:59], v[88:91], 0
    v_mfma_f32_16x16x32_bf16 v[252:255], v[60:63], v[92:95], v[252:255]
    ds_read_b128 v[56:59], v16 offset:38912
    ds_read_b128 v[60:63], v17 offset:38912
    s_waitcnt lgkmcnt(6)
    v_mfma_f32_16x16x32_bf16 v[128:131], v[96:99], v[32:35], v[128:131]
    v_mfma_f32_16x16x32_bf16 v[128:131], v[100:103], v[36:39], v[128:131]
    s_barrier
    v_mfma_f32_16x16x32_bf16 v[132:135], v[104:107], v[32:35], v[132:135]
    ds_read_b64_tr_b16 v[64:65], v20 offset:0
    v_mfma_f32_16x16x32_bf16 v[132:135], v[108:111], v[36:39], v[132:135]
    ds_read_b64_tr_b16 v[66:67], v20 offset:1024
    v_mfma_f32_16x16x32_bf16 v[136:139], v[32:35], v[112:115], v[136:139]
    ds_read_b64_tr_b16 v[68:69], v20 offset:16384
    v_mfma_f32_16x16x32_bf16 v[136:139], v[36:39], v[116:119], v[136:139]
    ds_read_b64_tr_b16 v[70:71], v20 offset:17408
    v_mfma_f32_16x16x32_bf16 v[140:143], v[32:35], v[120:123], v[140:143]
    s_cmp_lg_u32 s59, 2
    s_cbranch_scc1 m_c_notok2
    s_mov_b64 exec, 1
    buffer_atomic_cmpswap_x2 v[22:25], off, s[68:71], 0 sc0 sc1
    s_mov_b64 exec, -1
m_c_notok2:
    v_mfma_f32_16x16x32_bf16 v[140:143], v[36:39], v[124:127], v[140:143]
    ds_read_b128 v[32:35], v16 offset:40960
    ds_read_b128 v[36:39], v17 offset:40960
    s_waitcnt lgkmcnt(10)
    v_mfma_f32_16x16x32_bf16 v[144:147], v[96:99], v[40:43], v[144:147]
    v_mfma_f32_16x16x32_bf16 v[144:147], v[100:103], v[44:47], v[144:147]
    v_mfma_f32_16x16x32_bf16 v[148:151], v[104:107], v[40:43], v[148:151]
    ds_read_b64_tr_b16 v[72:73], v21 offset:0
    v_mfma_f32_16x16x32_bf16 v[148:151], v[108:111], v[44:47], v[148:151]
    ds_read_b64_tr_b16 v[74:75], v21 offset:1024
    v_mfma_f32_16x16x32_bf16 v[152:155], v[40:43], v[112:115], v[152:155]
    ds_read_b64_tr_b16 v[76:77], v21 offset:16384
    v_mfma_f32_16x16x32_bf16 v[152:155], v[44:47], v[116:119], v[152:155]
    ds_read_b64_tr_b16 v[78:79], v21 offset:17408
    v_mfma_f32_16x16x32_bf16 v[156:159], v[40:43], v[120:123], v[156:159]
    v_mfma_f32_16x16x32_bf16 v[156:159], v[44:47], v[124:127], v[156:159]
    ds_read_b128 v[40:43], v16 offset:43008
    ds_read_b128 v[44:47], v17 offset:43008
    s_waitcnt lgkmcnt(14)
    v_mfma_f32_16x16x32_bf16 v[160:163], v[96:99], v[48:51], v[160:163]
    v_mfma_f32_16x16x32_bf16 v[160:163], v[100:103], v[52:55], v[160:163]
    v_mfma_f32_16x16x32_bf16 v[164:167], v[104:107], v[48:51], v[164:167]
    ds_read_b64_tr_b16 v[80:81], v20 offset:8192
    v_mfma_f32_16x16x32_bf16 v[164:167], v[108:111], v[52:55], v[164:167]
    ds_read_b64_tr_b16 v[82:83], v20 offset:9216
    v_mfma_f32_16x16x32_bf16 v[168:171], v[48:51], v[112:115], v[168:171]
    ds_read_b64_tr_b16 v[84:85], v20 offset:24576
    v_mfma_f32_16x16x32_bf16 v[168:171], v[52:55], v[116:119], v[168:171]
    ds_read_b64_tr_b16 v[86:87], v20 offset:25600
    v_mfma_f32_16x16x32_bf16 v[172:175], v[48:51], v[120:123], v[172:175]
    v_mfma_f32_16x16x32_bf16 v[172:175], v[52:55], v[124:127], v[172:175]
    ds_read_b128 v[48:51], v16 offset:45056
    ds_read_b128 v[52:55], v17 offset:45056
    s_waitcnt lgkmcnt(15)
    v_mfma_f32_16x16x32_bf16 v[176:179], v[96:99], v[56:59], v[176:179]
    v_mfma_f32_16x16x32_bf16 v[176:179], v[100:103], v[60:63], v[176:179]
    v_mfma_f32_16x16x32_bf16 v[180:183], v[104:107], v[56:59], v[180:183]
    ds_read_b64_tr_b16 v[88:89], v21 offset:8192
    v_mfma_f32_16x16x32_bf16 v[180:183], v[108:111], v[60:63], v[180:183]
    ds_read_b64_tr_b16 v[90:91], v21 offset:9216
    v_mfma_f32_16x16x32_bf16 v[184:187], v[56:59], v[112:115], v[184:187]
    ds_read_b64_tr_b16 v[92:93], v21 offset:24576
    v_mfma_f32_16x16x32_bf16 v[184:187], v[60:63], v[116:119], v[184:187]
    ds_read_b64_tr_b16 v[94:95], v21 offset:25600
    v_mfma_f32_16x16x32_bf16 v[188:191], v[56:59], v[120:123], v[188:191]
    v_mfma_f32_16x16x32_bf16 v[188:191], v[60:63], v[124:127], v[188:191]
    ds_read_b128 v[56:59], v16 offset:47104
    ds_read_b128 v[60:63], v17 offset:47104
    s_waitcnt lgkmcnt(15)
    v_mfma_f32_16x16x32_bf16 v[192:195], v[96:99], v[32:35], v[192:195]
    v_mfma_f32_16x16x32_bf16 v[192:195], v[100:103], v[36:39], v[192:195]
    v_mfma_f32_16x16x32_bf16 v[196:199], v[104:107], v[32:35], v[196:199]
    v_mfma_f32_16x16x32_bf16 v[196:199], v[108:111], v[36:39], v[196:199]
    v_mfma_f32_16x16x32_bf16 v[200:203], v[32:35], v[112:115], v[200:203]
    v_mfma_f32_16x16x32_bf16 v[200:203], v[36:39], v[116:119], v[200:203]
    v_mfma_f32_16x16x32_bf16 v[204:207], v[32:35], v[120:123], v[204:207]
    s_waitcnt lgkmcnt(0)
    s_waitcnt vmcnt(0)
    s_barrier
    v_mfma_f32_16x16x32_bf16 v[204:207], v[36:39], v[124:127], v[204:207]
    ds_read_b128 v[32:35], v18 offset:0
    ds_read_b128 v[36:39], v19 offset:0
    v_mfma_f32_16x16x32_bf16 v[208:211], v[96:99], v[40:43], v[208:211]
    buffer_load_dwordx4 v[28:31], v1, s[12:15], s62 offen offset:0
    v_mfma_f32_16x16x32_bf16 v[208:211], v[100:103], v[44:47], v[208:211]
    v_mfma_f32_16x16x32_bf16 v[212:215], v[104:107], v[40:43], v[212:215]
    v_mfma_f32_16x16x32_bf16 v[212:215], v[108:111], v[44:47], v[212:215]
    v_mfma_f32_16x16x32_bf16 v[216:219], v[40:43], v[112:115], v[216:219]
    v_mfma_f32_16x16x32_bf16 v[216:219], v[44:47], v[116:119], v[216:219]
    v_mfma_f32_16x16x32_bf16 v[220:223], v[40:43], v[120:123], v[220:223]
    v_mfma_f32_16x16x32_bf16 v[220:223], v[44:47], v[124:127], v[220:223]
    ds_read_b128 v[40:43], v18 offset:2048
    ds_read_b128 v[44:47], v19 offset:2048
    v_mfma_f32_16x16x32_bf16 v[224:227], v[96:99], v[48:51], v[224:227]
    v_mfma_f32_16x16x32_bf16 v[224:227], v[100:103], v[52:55], v[224:227]
    v_mfma_f32_16x16x32_bf16 v[228:231], v[104:107], v[48:51], v[228:231]
    v_mfma_f32_16x16x32_bf16 v[228:231], v[108:111], v[52:55], v[228:231]
    s_cmp_lg_u32 s59, 3
    s_cbranch_scc1 m_c_notok3
    s_mov_b64 exec, 1
    buffer_atomic_cmpswap_x2 v[22:25], off, s[68:71], 0 sc0 sc1
    s_mov_b64 exec, -1
m_c_notok3:
    v_mfma_f32_16x16x32_bf16 v[232:235], v[48:51], v[112:115], v[232:235]
    v_mfma_f32_16x16x32_bf16 v[232:235], v[52:55], v[116:119], v[232:235]
    v_mfma_f32_16x16x32_bf16 v[236:239], v[48:51], v[120:123], v[236:239]
    v_mfma_f32_16x16x32_bf16 v[236:239], v[52:55], v[124:127], v[236:239]
    ds_read_b128 v[48:51], v18 offset:4096
    ds_read_b128 v[52:55], v19 offset:4096
    v_mfma_f32_16x16x32_bf16 v[240:243], v[96:99], v[56:59], v[240:243]
    v_mfma_f32_16x16x32_bf16 v[240:243], v[100:103], v[60:63], v[240:243]
    v_mfma_f32_16x16x32_bf16 v[244:247], v[104:107], v[56:59], v[244:247]
    v_mfma_f32_16x16x32_bf16 v[244:247], v[108:111], v[60:63], v[244:247]
    v_mfma_f32_16x16x32_bf16 v[248:251], v[56:59], v[112:115], v[248:251]
    v_mfma_f32_16x16x32_bf16 v[248:251], v[60:63], v[116:119], v[248:251]
    v_mfma_f32_16x16x32_bf16 v[252:255], v[56:59], v[120:123], v[252:255]
    v_mfma_f32_16x16x32_bf16 v[252:255], v[60:63], v[124:127], v[252:255]
    ds_read_b128 v[56:59], v18 offset:6144
    ds_read_b128 v[60:63], v19 offset:6144
    s_waitcnt lgkmcnt(6)
    v_mfma_f32_16x16x32_bf16 v[128:131], v[64:67], v[32:35], v[128:131]
    v_mfma_f32_16x16x32_bf16 v[128:131], v[68:71], v[36:39], v[128:131]
    s_barrier
    v_mfma_f32_16x16x32_bf16 v[132:135], v[72:75], v[32:35], v[132:135]
    ds_read_b64_tr_b16 v[96:97], v20 offset:32768
    v_mfma_f32_16x16x32_bf16 v[132:135], v[76:79], v[36:39], v[132:135]
    ds_read_b64_tr_b16 v[98:99], v20 offset:33792
    v_mfma_f32_16x16x32_bf16 v[136:139], v[32:35], v[80:83], v[136:139]
    ds_read_b64_tr_b16 v[100:101], v20 offset:49152
    v_mfma_f32_16x16x32_bf16 v[136:139], v[36:39], v[84:87], v[136:139]
    ds_read_b64_tr_b16 v[102:103], v20 offset:50176
    v_mfma_f32_16x16x32_bf16 v[140:143], v[32:35], v[88:91], v[140:143]
    buffer_load_dwordx4 v[28:31], v1, s[12:15], s62 offen offset:1024
    v_mfma_f32_16x16x32_bf16 v[140:143], v[36:39], v[92:95], v[140:143]
    ds_read_b128 v[32:35], v18 offset:8192
    ds_read_b128 v[36:39], v19 offset:8192
    s_waitcnt lgkmcnt(10)
    v_mfma_f32_16x16x32_bf16 v[144:147], v[64:67], v[40:43], v[144:147]
    v_mfma_f32_16x16x32_bf16 v[144:147], v[68:71], v[44:47], v[144:147]
    v_mfma_f32_16x16x32_bf16 v[148:151], v[72:75], v[40:43], v[148:151]
    ds_read_b64_tr_b16 v[104:105], v21 offset:32768
    v_mfma_f32_16x16x32_bf16 v[148:151], v[76:79], v[44:47], v[148:151]
    ds_read_b64_tr_b16 v[106:107], v21 offset:33792
    v_mfma_f32_16x16x32_bf16 v[152:155], v[40:43], v[80:83], v[152:155]
    ds_read_b64_tr_b16 v[108:109], v21 offset:49152
    v_mfma_f32_16x16x32_bf16 v[152:155], v[44:47], v[84:87], v[152:155]
    ds_read_b64_tr_b16 v[110:111], v21 offset:50176
    v_mfma_f32_16x16x32_bf16 v[156:159], v[40:43], v[88:91], v[156:159]
    v_mfma_f32_16x16x32_bf16 v[156:159], v[44:47], v[92:95], v[156:159]
    ds_read_b128 v[40:43], v18 offset:10240
    ds_read_b128 v[44:47], v19 offset:10240
    s_waitcnt lgkmcnt(14)
    v_mfma_f32_16x16x32_bf16 v[160:163], v[64:67], v[48:51], v[160:163]
    v_mfma_f32_16x16x32_bf16 v[160:163], v[68:71], v[52:55], v[160:163]
    s_cmp_lg_u32 s59, 4
    s_cbranch_scc1 m_c_notok4
    s_mov_b64 exec, 1
    buffer_atomic_cmpswap_x2 v[22:25], off, s[68:71], 0 sc0 sc1
    s_mov_b64 exec, -1
m_c_notok4:
    v_mfma_f32_16x16x32_bf16 v[164:167], v[72:75], v[48:51], v[164:167]
    ds_read_b64_tr_b16 v[112:113], v20 offset:40960
    v_mfma_f32_16x16x32_bf16 v[164:167], v[76:79], v[52:55], v[164:167]
    ds_read_b64_tr_b16 v[114:115], v20 offset:41984
    v_mfma_f32_16x16x32_bf16 v[168:171], v[48:51], v[80:83], v[168:171]
    ds_read_b64_tr_b16 v[116:117], v20 offset:57344
    v_mfma_f32_16x16x32_bf16 v[168:171], v[52:55], v[84:87], v[168:171]
    ds_read_b64_tr_b16 v[118:119], v20 offset:58368
    v_mfma_f32_16x16x32_bf16 v[172:175], v[48:51], v[88:91], v[172:175]
    v_mfma_f32_16x16x32_bf16 v[172:175], v[52:55], v[92:95], v[172:175]
    ds_read_b128 v[48:51], v18 offset:12288
    ds_read_b128 v[52:55], v19 offset:12288
    s_waitcnt lgkmcnt(15)
    v_mfma_f32_16x16x32_bf16 v[176:179], v[64:67], v[56:59], v[176:179]
    v_mfma_f32_16x16x32_bf16 v[176:179], v[68:71], v[60:63], v[176:179]
    v_mfma_f32_16x16x32_bf16 v[180:183], v[72:75], v[56:59], v[180:183]
    ds_read_b64_tr_b16 v[120:121], v21 offset:40960
    v_mfma_f32_16x16x32_bf16 v[180:183], v[76:79], v[60:63], v[180:183]
    ds_read_b64_tr_b16 v[122:123], v21 offset:41984
    v_mfma_f32_16x16x32_bf16 v[184:187], v[56:59], v[80:83], v[184:187]
    ds_read_b64_tr_b16 v[124:125], v21 offset:57344
    v_mfma_f32_16x16x32_bf16 v[184:187], v[60:63], v[84:87], v[184:187]
    ds_read_b64_tr_b16 v[126:127], v21 offset:58368
    v_mfma_f32_16x16x32_bf16 v[188:191], v[56:59], v[88:91], v[188:191]
    v_mfma_f32_16x16x32_bf16 v[188:191], v[60:63], v[92:95], v[188:191]
    ds_read_b128 v[56:59], v18 offset:14336
    ds_read_b128 v[60:63], v19 offset:14336
    s_waitcnt lgkmcnt(15)
    v_mfma_f32_16x16x32_bf16 v[192:195], v[64:67], v[32:35], v[192:195]
    v_mfma_f32_16x16x32_bf16 v[192:195], v[68:71], v[36:39], v[192:195]
    v_mfma_f32_16x16x32_bf16 v[196:199], v[72:75], v[32:35], v[196:199]
    v_mfma_f32_16x16x32_bf16 v[196:199], v[76:79], v[36:39], v[196:199]
    v_mfma_f32_16x16x32_bf16 v[200:203], v[32:35], v[80:83], v[200:203]
    v_mfma_f32_16x16x32_bf16 v[200:203], v[36:39], v[84:87], v[200:203]
    v_mfma_f32_16x16x32_bf16 v[204:207], v[32:35], v[88:91], v[204:207]
    s_waitcnt lgkmcnt(0)
    s_barrier
    v_mfma_f32_16x16x32_bf16 v[204:207], v[36:39], v[92:95], v[204:207]
    ds_read_b128 v[32:35], v16 offset:0
    ds_read_b128 v[36:39], v17 offset:0
    v_mfma_f32_16x16x32_bf16 v[208:211], v[64:67], v[40:43], v[208:211]
    buffer_load_dwordx4 v[28:31], v1, s[28:31], s62 offen offset:0
    v_mfma_f32_16x16x32_bf16 v[208:211], v[68:71], v[44:47], v[208:211]
    v_mfma_f32_16x16x32_bf16 v[212:215], v[72:75], v[40:43], v[212:215]
    v_mfma_f32_16x16x32_bf16 v[212:215], v[76:79], v[44:47], v[212:215]
    v_mfma_f32_16x16x32_bf16 v[216:219], v[40:43], v[80:83], v[216:219]
    v_mfma_f32_16x16x32_bf16 v[216:219], v[44:47], v[84:87], v[216:219]
    v_mfma_f32_16x16x32_bf16 v[220:223], v[40:43], v[88:91], v[220:223]
    v_mfma_f32_16x16x32_bf16 v[220:223], v[44:47], v[92:95], v[220:223]
    ds_read_b128 v[40:43], v16 offset:2048
    ds_read_b128 v[44:47], v17 offset:2048
    v_mfma_f32_16x16x32_bf16 v[224:227], v[64:67], v[48:51], v[224:227]
    v_mfma_f32_16x16x32_bf16 v[224:227], v[68:71], v[52:55], v[224:227]
    v_mfma_f32_16x16x32_bf16 v[228:231], v[72:75], v[48:51], v[228:231]
    v_mfma_f32_16x16x32_bf16 v[228:231], v[76:79], v[52:55], v[228:231]
    s_cmp_lg_u32 s59, 5
    s_cbranch_scc1 m_c_notok5
    s_mov_b64 exec, 1
    buffer_atomic_cmpswap_x2 v[22:25], off, s[68:71], 0 sc0 sc1
    s_mov_b64 exec, -1
m_c_notok5:
    v_mfma_f32_16x16x32_bf16 v[232:235], v[48:51], v[80:83], v[232:235]
    v_mfma_f32_16x16x32_bf16 v[232:235], v[52:55], v[84:87], v[232:235]
    v_mfma_f32_16x16x32_bf16 v[236:239], v[48:51], v[88:91], v[236:239]
    v_mfma_f32_16x16x32_bf16 v[236:239], v[52:55], v[92:95], v[236:239]
    ds_read_b128 v[48:51], v16 offset:4096
    ds_read_b128 v[52:55], v17 offset:4096
    v_mfma_f32_16x16x32_bf16 v[240:243], v[64:67], v[56:59], v[240:243]
    v_mfma_f32_16x16x32_bf16 v[240:243], v[68:71], v[60:63], v[240:243]
    v_mfma_f32_16x16x32_bf16 v[244:247], v[72:75], v[56:59], v[244:247]
    v_mfma_f32_16x16x32_bf16 v[244:247], v[76:79], v[60:63], v[244:247]
    v_mfma_f32_16x16x32_bf16 v[248:251], v[56:59], v[80:83], v[248:251]
    v_mfma_f32_16x16x32_bf16 v[248:251], v[60:63], v[84:87], v[248:251]
    v_mfma_f32_16x16x32_bf16 v[252:255], v[56:59], v[88:91], v[252:255]
    v_mfma_f32_16x16x32_bf16 v[252:255], v[60:63], v[92:95], v[252:255]
    ds_read_b128 v[56:59], v16 offset:6144
    ds_read_b128 v[60:63], v17 offset:6144
    s_waitcnt lgkmcnt(6)
    v_mfma_f32_16x16x32_bf16 v[128:131], v[96:99], v[32:35], v[128:131]
    v_mfma_f32_16x16x32_bf16 v[128:131], v[100:103], v[36:39], v[128:131]
    s_barrier
    v_mfma_f32_16x16x32_bf16 v[132:135], v[104:107], v[32:35], v[132:135]
    ds_read_b64_tr_b16 v[64:65], v20 offset:0
    v_mfma_f32_16x16x32_bf16 v[132:135], v[108:111], v[36:39], v[132:135]
    ds_read_b64_tr_b16 v[66:67], v20 offset:1024
    v_mfma_f32_16x16x32_bf16 v[136:139], v[32:35], v[112:115], v[136:139]
    ds_read_b64_tr_b16 v[68:69], v20 offset:16384
    v_mfma_f32_16x16x32_bf16 v[136:139], v[36:39], v[116:119], v[136:139]
    ds_read_b64_tr_b16 v[70:71], v20 offset:17408
    v_mfma_f32_16x16x32_bf16 v[140:143], v[32:35], v[120:123], v[140:143]
    buffer_load_dwordx4 v[28:31], v1, s[28:31], s62 offen offset:1024
    v_mfma_f32_16x16x32_bf16 v[140:143], v[36:39], v[124:127], v[140:143]
    ds_read_b128 v[32:35], v16 offset:8192
    ds_read_b128 v[36:39], v17 offset:8192
    s_waitcnt lgkmcnt(10)
    v_mfma_f32_16x16x32_bf16 v[144:147], v[96:99], v[40:43], v[144:147]
    v_mfma_f32_16x16x32_bf16 v[144:147], v[100:103], v[44:47], v[144:147]
    v_mfma_f32_16x16x32_bf16 v[148:151], v[104:107], v[40:43], v[148:151]
    ds_read_b64_tr_b16 v[72:73], v21 offset:0
    v_mfma_f32_16x16x32_bf16 v[148:151], v[108:111], v[44:47], v[148:151]
    ds_read_b64_tr_b16 v[74:75], v21 offset:1024
    v_mfma_f32_16x16x32_bf16 v[152:155], v[40:43], v[112:115], v[152:155]
    ds_read_b64_tr_b16 v[76:77], v21 offset:16384
    v_mfma_f32_16x16x32_bf16 v[152:155], v[44:47], v[116:119], v[152:155]
    ds_read_b64_tr_b16 v[78:79], v21 offset:17408
    v_mfma_f32_16x16x32_bf16 v[156:159], v[40:43], v[120:123], v[156:159]
    v_mfma_f32_16x16x32_bf16 v[156:159], v[44:47], v[124:127], v[156:159]
    ds_read_b128 v[40:43], v16 offset:10240
    ds_read_b128 v[44:47], v17 offset:10240
    s_waitcnt lgkmcnt(14)
    v_mfma_f32_16x16x32_bf16 v[160:163], v[96:99], v[48:51], v[160:163]
    v_mfma_f32_16x16x32_bf16 v[160:163], v[100:103], v[52:55], v[160:163]
    s_cmp_lg_u32 s59, 6
    s_cbranch_scc1 m_c_notok6
    s_mov_b64 exec, 1
    buffer_atomic_cmpswap_x2 v[22:25], off, s[68:71], 0 sc0 sc1
    s_mov_b64 exec, -1
m_c_notok6:
    v_mfma_f32_16x16x32_bf16 v[164:167], v[104:107], v[48:51], v[164:167]
    ds_read_b64_tr_b16 v[80:81], v20 offset:8192
    v_mfma_f32_16x16x32_bf16 v[164:167], v[108:111], v[52:55], v[164:167]
    ds_read_b64_tr_b16 v[82:83], v20 offset:9216
    v_mfma_f32_16x16x32_bf16 v[168:171], v[48:51], v[112:115], v[168:171]
    ds_read_b64_tr_b16 v[84:85], v20 offset:24576
    v_mfma_f32_16x16x32_bf16 v[168:171], v[52:55], v[116:119], v[168:171]
    ds_read_b64_tr_b16 v[86:87], v20 offset:25600
    v_mfma_f32_16x16x32_bf16 v[172:175], v[48:51], v[120:123], v[172:175]
    v_mfma_f32_16x16x32_bf16 v[172:175], v[52:55], v[124:127], v[172:175]
    ds_read_b128 v[48:51], v16 offset:12288
    ds_read_b128 v[52:55], v17 offset:12288
    s_waitcnt lgkmcnt(15)
    v_mfma_f32_16x16x32_bf16 v[176:179], v[96:99], v[56:59], v[176:179]
    v_mfma_f32_16x16x32_bf16 v[176:179], v[100:103], v[60:63], v[176:179]
    v_mfma_f32_16x16x32_bf16 v[180:183], v[104:107], v[56:59], v[180:183]
    ds_read_b64_tr_b16 v[88:89], v21 offset:8192
    v_mfma_f32_16x16x32_bf16 v[180:183], v[108:111], v[60:63], v[180:183]
    ds_read_b64_tr_b16 v[90:91], v21 offset:9216
    v_mfma_f32_16x16x32_bf16 v[184:187], v[56:59], v[112:115], v[184:187]
    ds_read_b64_tr_b16 v[92:93], v21 offset:24576
    v_mfma_f32_16x16x32_bf16 v[184:187], v[60:63], v[116:119], v[184:187]
    ds_read_b64_tr_b16 v[94:95], v21 offset:25600
    v_mfma_f32_16x16x32_bf16 v[188:191], v[56:59], v[120:123], v[188:191]
    v_mfma_f32_16x16x32_bf16 v[188:191], v[60:63], v[124:127], v[188:191]
    ds_read_b128 v[56:59], v16 offset:14336
    ds_read_b128 v[60:63], v17 offset:14336
    s_waitcnt lgkmcnt(15)
    v_mfma_f32_16x16x32_bf16 v[192:195], v[96:99], v[32:35], v[192:195]
    v_mfma_f32_16x16x32_bf16 v[192:195], v[100:103], v[36:39], v[192:195]
    v_mfma_f32_16x16x32_bf16 v[196:199], v[104:107], v[32:35], v[196:199]
    v_mfma_f32_16x16x32_bf16 v[196:199], v[108:111], v[36:39], v[196:199]
    v_mfma_f32_16x16x32_bf16 v[200:203], v[32:35], v[112:115], v[200:203]
    v_mfma_f32_16x16x32_bf16 v[200:203], v[36:39], v[116:119], v[200:203]
    v_mfma_f32_16x16x32_bf16 v[204:207], v[32:35], v[120:123], v[204:207]
    s_waitcnt lgkmcnt(0)
    s_barrier
    v_mfma_f32_16x16x32_bf16 v[204:207], v[36:39], v[124:127], v[204:207]
    ds_read_b128 v[32:35], v16 offset:32768
    ds_read_b128 v[36:39], v17 offset:32768
    v_mfma_f32_16x16x32_bf16 v[208:211], v[96:99], v[40:43], v[208:211]
    s_cmp_lg_u32 s59, 7
    s_cbranch_scc1 m_c_notok7
    s_mov_b64 exec, 1
    buffer_atomic_cmpswap_x2 v[22:25], off, s[68:71], 0 sc0 sc1
    s_mov_b64 exec, -1
m_c_notok7:
    v_mfma_f32_16x16x32_bf16 v[208:211], v[100:103], v[44:47], v[208:211]
    v_mfma_f32_16x16x32_bf16 v[212:215], v[104:107], v[40:43], v[212:215]
    v_mfma_f32_16x16x32_bf16 v[212:215], v[108:111], v[44:47], v[212:215]
    v_mfma_f32_16x16x32_bf16 v[216:219], v[40:43], v[112:115], v[216:219]
    v_mfma_f32_16x16x32_bf16 v[216:219], v[44:47], v[116:119], v[216:219]
    v_mfma_f32_16x16x32_bf16 v[220:223], v[40:43], v[120:123], v[220:223]
    v_mfma_f32_16x16x32_bf16 v[220:223], v[44:47], v[124:127], v[220:223]
    ds_read_b128 v[40:43], v16 offset:34816
    ds_read_b128 v[44:47], v17 offset:34816
    v_mfma_f32_16x16x32_bf16 v[224:227], v[96:99], v[48:51], v[224:227]
    v_mfma_f32_16x16x32_bf16 v[224:227], v[100:103], v[52:55], v[224:227]
    v_mfma_f32_16x16x32_bf16 v[228:231], v[104:107], v[48:51], v[228:231]
    v_mfma_f32_16x16x32_bf16 v[228:231], v[108:111], v[52:55], v[228:231]
    v_mfma_f32_16x16x32_bf16 v[232:235], v[48:51], v[112:115], v[232:235]
    v_mfma_f32_16x16x32_bf16 v[232:235], v[52:55], v[116:119], v[232:235]
    v_mfma_f32_16x16x32_bf16 v[236:239], v[48:51], v[120:123], v[236:239]
    v_mfma_f32_16x16x32_bf16 v[236:239], v[52:55], v[124:127], v[236:239]
    ds_read_b128 v[48:51], v16 offset:36864
    ds_read_b128 v[52:55], v17 offset:36864
    v_mfma_f32_16x16x32_bf16 v[240:243], v[96:99], v[56:59], v[240:243]
    v_mfma_f32_16x16x32_bf16 v[240:243], v[100:103], v[60:63], v[240:243]
    v_mfma_f32_16x16x32_bf16 v[244:247], v[104:107], v[56:59], v[244:247]
    v_mfma_f32_16x16x32_bf16 v[244:247], v[108:111], v[60:63], v[244:247]
    v_mfma_f32_16x16x32_bf16 v[248:251], v[56:59], v[112:115], v[248:251]
    v_mfma_f32_16x16x32_bf16 v[248:251], v[60:63], v[116:119], v[248:251]
    v_mfma_f32_16x16x32_bf16 v[252:255], v[56:59], v[120:123], v[252:255]
    v_mfma_f32_16x16x32_bf16 v[252:255], v[60:63], v[124:127], v[252:255]
    ds_read_b128 v[56:59], v16 offset:38912
    ds_read_b128 v[60:63], v17 offset:38912
    s_waitcnt lgkmcnt(6)
    v_mfma_f32_16x16x32_bf16 v[128:131], v[64:67], v[32:35], v[128:131]
    v_mfma_f32_16x16x32_bf16 v[128:131], v[68:71], v[36:39], v[128:131]
    s_barrier
    v_mfma_f32_16x16x32_bf16 v[132:135], v[72:75], v[32:35], v[132:135]
    ds_read_b64_tr_b16 v[96:97], v20 offset:32768
    v_mfma_f32_16x16x32_bf16 v[132:135], v[76:79], v[36:39], v[132:135]
    ds_read_b64_tr_b16 v[98:99], v20 offset:33792
    v_mfma_f32_16x16x32_bf16 v[136:139], v[32:35], v[80:83], v[136:139]
    ds_read_b64_tr_b16 v[100:101], v20 offset:49152
    v_mfma_f32_16x16x32_bf16 v[136:139], v[36:39], v[84:87], v[136:139]
    ds_read_b64_tr_b16 v[102:103], v20 offset:50176
    v_mfma_f32_16x16x32_bf16 v[140:143], v[32:35], v[88:91], v[140:143]
    s_mov_b32 s68, s4
    s_mov_b32 s69, s5
    s_mov_b32 s70, 0x200000
    s_mov_b32 s71, 0x20000
    buffer_load_dwordx4 v[28:31], v1, s[68:71], s62 offen offset:0
    v_mfma_f32_16x16x32_bf16 v[140:143], v[36:39], v[92:95], v[140:143]
    ds_read_b128 v[32:35], v16 offset:40960
    ds_read_b128 v[36:39], v17 offset:40960
    s_waitcnt lgkmcnt(10)
    v_mfma_f32_16x16x32_bf16 v[144:147], v[64:67], v[40:43], v[144:147]
    v_mfma_f32_16x16x32_bf16 v[144:147], v[68:71], v[44:47], v[144:147]
    v_mfma_f32_16x16x32_bf16 v[148:151], v[72:75], v[40:43], v[148:151]
    ds_read_b64_tr_b16 v[104:105], v21 offset:32768
    v_mfma_f32_16x16x32_bf16 v[148:151], v[76:79], v[44:47], v[148:151]
    ds_read_b64_tr_b16 v[106:107], v21 offset:33792
    v_mfma_f32_16x16x32_bf16 v[152:155], v[40:43], v[80:83], v[152:155]
    ds_read_b64_tr_b16 v[108:109], v21 offset:49152
    v_mfma_f32_16x16x32_bf16 v[152:155], v[44:47], v[84:87], v[152:155]
    ds_read_b64_tr_b16 v[110:111], v21 offset:50176
    v_mfma_f32_16x16x32_bf16 v[156:159], v[40:43], v[88:91], v[156:159]
    v_mfma_f32_16x16x32_bf16 v[156:159], v[44:47], v[92:95], v[156:159]
    ds_read_b128 v[40:43], v16 offset:43008
    ds_read_b128 v[44:47], v17 offset:43008
    s_waitcnt lgkmcnt(14)
    v_mfma_f32_16x16x32_bf16 v[160:163], v[64:67], v[48:51], v[160:163]
    v_mfma_f32_16x16x32_bf16 v[160:163], v[68:71], v[52:55], v[160:163]
    buffer_load_dwordx4 v[28:31], v1, s[68:71], s62 offen offset:1024
    v_mfma_f32_16x16x32_bf16 v[164:167], v[72:75], v[48:51], v[164:167]
    ds_read_b64_tr_b16 v[112:113], v20 offset:40960
    v_mfma_f32_16x16x32_bf16 v[164:167], v[76:79], v[52:55], v[164:167]
    ds_read_b64_tr_b16 v[114:115], v20 offset:41984
    v_mfma_f32_16x16x32_bf16 v[168:171], v[48:51], v[80:83], v[168:171]
    ds_read_b64_tr_b16 v[116:117], v20 offset:57344
    v_mfma_f32_16x16x32_bf16 v[168:171], v[52:55], v[84:87], v[168:171]
    ds_read_b64_tr_b16 v[118:119], v20 offset:58368
    v_mfma_f32_16x16x32_bf16 v[172:175], v[48:51], v[88:91], v[172:175]
    v_mfma_f32_16x16x32_bf16 v[172:175], v[52:55], v[92:95], v[172:175]
    ds_read_b128 v[48:51], v16 offset:45056
    ds_read_b128 v[52:55], v17 offset:45056
    s_waitcnt lgkmcnt(15)
    v_mfma_f32_16x16x32_bf16 v[176:179], v[64:67], v[56:59], v[176:179]
    v_mfma_f32_16x16x32_bf16 v[176:179], v[68:71], v[60:63], v[176:179]
    v_mfma_f32_16x16x32_bf16 v[180:183], v[72:75], v[56:59], v[180:183]
    ds_read_b64_tr_b16 v[120:121], v21 offset:40960
    v_mfma_f32_16x16x32_bf16 v[180:183], v[76:79], v[60:63], v[180:183]
    ds_read_b64_tr_b16 v[122:123], v21 offset:41984
    v_mfma_f32_16x16x32_bf16 v[184:187], v[56:59], v[80:83], v[184:187]
    ds_read_b64_tr_b16 v[124:125], v21 offset:57344
    v_mfma_f32_16x16x32_bf16 v[184:187], v[60:63], v[84:87], v[184:187]
    ds_read_b64_tr_b16 v[126:127], v21 offset:58368
    v_mfma_f32_16x16x32_bf16 v[188:191], v[56:59], v[88:91], v[188:191]
    v_mfma_f32_16x16x32_bf16 v[188:191], v[60:63], v[92:95], v[188:191]
    ds_read_b128 v[56:59], v16 offset:47104
    ds_read_b128 v[60:63], v17 offset:47104
    s_waitcnt lgkmcnt(15)
    v_mfma_f32_16x16x32_bf16 v[192:195], v[64:67], v[32:35], v[192:195]
    v_mfma_f32_16x16x32_bf16 v[192:195], v[68:71], v[36:39], v[192:195]
    v_mfma_f32_16x16x32_bf16 v[196:199], v[72:75], v[32:35], v[196:199]
    v_mfma_f32_16x16x32_bf16 v[196:199], v[76:79], v[36:39], v[196:199]
    v_mfma_f32_16x16x32_bf16 v[200:203], v[32:35], v[80:83], v[200:203]
    v_mfma_f32_16x16x32_bf16 v[200:203], v[36:39], v[84:87], v[200:203]
    v_mfma_f32_16x16x32_bf16 v[204:207], v[32:35], v[88:91], v[204:207]
    s_waitcnt lgkmcnt(0)
    s_barrier
    v_mfma_f32_16x16x32_bf16 v[204:207], v[36:39], v[92:95], v[204:207]
    ds_read_b128 v[32:35], v18 offset:0
    ds_read_b128 v[36:39], v19 offset:0
    v_mfma_f32_16x16x32_bf16 v[208:211], v[64:67], v[40:43], v[208:211]
    s_mov_b32 s68, s8
    s_mov_b32 s69, s9
    s_mov_b32 s70, 0x400000
    s_mov_b32 s71, 0x20000
    buffer_load_dwordx4 v[28:31], v1, s[68:71], s63 offen offset:0
    v_mfma_f32_16x16x32_bf16 v[208:211], v[68:71], v[44:47], v[208:211]
    v_mfma_f32_16x16x32_bf16 v[212:215], v[72:75], v[40:43], v[212:215]
    v_mfma_f32_16x16x32_bf16 v[212:215], v[76:79], v[44:47], v[212:215]
    v_mfma_f32_16x16x32_bf16 v[216:219], v[40:43], v[80:83], v[216:219]
    v_mfma_f32_16x16x32_bf16 v[216:219], v[44:47], v[84:87], v[216:219]
    v_mfma_f32_16x16x32_bf16 v[220:223], v[40:43], v[88:91], v[220:223]
    v_mfma_f32_16x16x32_bf16 v[220:223], v[44:47], v[92:95], v[220:223]
    ds_read_b128 v[40:43], v18 offset:2048
    ds_read_b128 v[44:47], v19 offset:2048
    v_mfma_f32_16x16x32_bf16 v[224:227], v[64:67], v[48:51], v[224:227]
    v_mfma_f32_16x16x32_bf16 v[224:227], v[68:71], v[52:55], v[224:227]
    v_mfma_f32_16x16x32_bf16 v[228:231], v[72:75], v[48:51], v[228:231]
    v_mfma_f32_16x16x32_bf16 v[228:231], v[76:79], v[52:55], v[228:231]
    v_mfma_f32_16x16x32_bf16 v[232:235], v[48:51], v[80:83], v[232:235]
    v_mfma_f32_16x16x32_bf16 v[232:235], v[52:55], v[84:87], v[232:235]
    v_mfma_f32_16x16x32_bf16 v[236:239], v[48:51], v[88:91], v[236:239]
    v_mfma_f32_16x16x32_bf16 v[236:239], v[52:55], v[92:95], v[236:239]
    ds_read_b128 v[48:51], v18 offset:4096
    ds_read_b128 v[52:55], v19 offset:4096
    v_mfma_f32_16x16x32_bf16 v[240:243], v[64:67], v[56:59], v[240:243]
    v_mfma_f32_16x16x32_bf16 v[240:243], v[68:71], v[60:63], v[240:243]
    v_mfma_f32_16x16x32_bf16 v[244:247], v[72:75], v[56:59], v[244:247]
    v_mfma_f32_16x16x32_bf16 v[244:247], v[76:79], v[60:63], v[244:247]
    v_mfma_f32_16x16x32_bf16 v[248:251], v[56:59], v[80:83], v[248:251]
    v_mfma_f32_16x16x32_bf16 v[248:251], v[60:63], v[84:87], v[248:251]
    v_mfma_f32_16x16x32_bf16 v[252:255], v[56:59], v[88:91], v[252:255]
    v_mfma_f32_16x16x32_bf16 v[252:255], v[60:63], v[92:95], v[252:255]
    ds_read_b128 v[56:59], v18 offset:6144
    ds_read_b128 v[60:63], v19 offset:6144
    s_waitcnt lgkmcnt(6)
    v_mfma_f32_16x16x32_bf16 v[128:131], v[96:99], v[32:35], v[128:131]
    v_mfma_f32_16x16x32_bf16 v[128:131], v[100:103], v[36:39], v[128:131]
    s_barrier
    v_mfma_f32_16x16x32_bf16 v[132:135], v[104:107], v[32:35], v[132:135]
    ds_read_b64_tr_b16 v[64:65], v20 offset:0
    v_mfma_f32_16x16x32_bf16 v[132:135], v[108:111], v[36:39], v[132:135]
    ds_read_b64_tr_b16 v[66:67], v20 offset:1024
    v_mfma_f32_16x16x32_bf16 v[136:139], v[32:35], v[112:115], v[136:139]
    ds_read_b64_tr_b16 v[68:69], v20 offset:16384
    v_mfma_f32_16x16x32_bf16 v[136:139], v[36:39], v[116:119], v[136:139]
    ds_read_b64_tr_b16 v[70:71], v20 offset:17408
    v_mfma_f32_16x16x32_bf16 v[140:143], v[32:35], v[120:123], v[140:143]
    buffer_load_dwordx4 v[28:31], v1, s[68:71], s63 offen offset:1024
    v_mfma_f32_16x16x32_bf16 v[140:143], v[36:39], v[124:127], v[140:143]
    ds_read_b128 v[32:35], v18 offset:8192
    ds_read_b128 v[36:39], v19 offset:8192
    s_waitcnt lgkmcnt(10)
    v_mfma_f32_16x16x32_bf16 v[144:147], v[96:99], v[40:43], v[144:147]
    v_mfma_f32_16x16x32_bf16 v[144:147], v[100:103], v[44:47], v[144:147]
    v_mfma_f32_16x16x32_bf16 v[148:151], v[104:107], v[40:43], v[148:151]
    ds_read_b64_tr_b16 v[72:73], v21 offset:0
    v_mfma_f32_16x16x32_bf16 v[148:151], v[108:111], v[44:47], v[148:151]
    ds_read_b64_tr_b16 v[74:75], v21 offset:1024
    v_mfma_f32_16x16x32_bf16 v[152:155], v[40:43], v[112:115], v[152:155]
    ds_read_b64_tr_b16 v[76:77], v21 offset:16384
    v_mfma_f32_16x16x32_bf16 v[152:155], v[44:47], v[116:119], v[152:155]
    ds_read_b64_tr_b16 v[78:79], v21 offset:17408
    v_mfma_f32_16x16x32_bf16 v[156:159], v[40:43], v[120:123], v[156:159]
    v_mfma_f32_16x16x32_bf16 v[156:159], v[44:47], v[124:127], v[156:159]
    ds_read_b128 v[40:43], v18 offset:10240
    ds_read_b128 v[44:47], v19 offset:10240
    s_waitcnt lgkmcnt(14)
    v_mfma_f32_16x16x32_bf16 v[160:163], v[96:99], v[48:51], v[160:163]
    v_mfma_f32_16x16x32_bf16 v[160:163], v[100:103], v[52:55], v[160:163]
    v_mfma_f32_16x16x32_bf16 v[164:167], v[104:107], v[48:51], v[164:167]
    ds_read_b64_tr_b16 v[80:81], v20 offset:8192
    v_mfma_f32_16x16x32_bf16 v[164:167], v[108:111], v[52:55], v[164:167]
    ds_read_b64_tr_b16 v[82:83], v20 offset:9216
    v_mfma_f32_16x16x32_bf16 v[168:171], v[48:51], v[112:115], v[168:171]
    ds_read_b64_tr_b16 v[84:85], v20 offset:24576
    v_mfma_f32_16x16x32_bf16 v[168:171], v[52:55], v[116:119], v[168:171]
    ds_read_b64_tr_b16 v[86:87], v20 offset:25600
    v_mfma_f32_16x16x32_bf16 v[172:175], v[48:51], v[120:123], v[172:175]
    v_mfma_f32_16x16x32_bf16 v[172:175], v[52:55], v[124:127], v[172:175]
    ds_read_b128 v[48:51], v18 offset:12288
    ds_read_b128 v[52:55], v19 offset:12288
    s_waitcnt lgkmcnt(15)
    v_mfma_f32_16x16x32_bf16 v[176:179], v[96:99], v[56:59], v[176:179]
    v_mfma_f32_16x16x32_bf16 v[176:179], v[100:103], v[60:63], v[176:179]
    v_mfma_f32_16x16x32_bf16 v[180:183], v[104:107], v[56:59], v[180:183]
    ds_read_b64_tr_b16 v[88:89], v21 offset:8192
    v_mfma_f32_16x16x32_bf16 v[180:183], v[108:111], v[60:63], v[180:183]
    ds_read_b64_tr_b16 v[90:91], v21 offset:9216
    v_mfma_f32_16x16x32_bf16 v[184:187], v[56:59], v[112:115], v[184:187]
    ds_read_b64_tr_b16 v[92:93], v21 offset:24576
    v_mfma_f32_16x16x32_bf16 v[184:187], v[60:63], v[116:119], v[184:187]
    ds_read_b64_tr_b16 v[94:95], v21 offset:25600
    v_mfma_f32_16x16x32_bf16 v[188:191], v[56:59], v[120:123], v[188:191]
    v_mfma_f32_16x16x32_bf16 v[188:191], v[60:63], v[124:127], v[188:191]
    ds_read_b128 v[56:59], v18 offset:14336
    ds_read_b128 v[60:63], v19 offset:14336
    s_waitcnt lgkmcnt(15)
    v_mfma_f32_16x16x32_bf16 v[192:195], v[96:99], v[32:35], v[192:195]
    v_mfma_f32_16x16x32_bf16 v[192:195], v[100:103], v[36:39], v[192:195]
    v_mfma_f32_16x16x32_bf16 v[196:199], v[104:107], v[32:35], v[196:199]
    v_mfma_f32_16x16x32_bf16 v[196:199], v[108:111], v[36:39], v[196:199]
    v_mfma_f32_16x16x32_bf16 v[200:203], v[32:35], v[112:115], v[200:203]
    v_mfma_f32_16x16x32_bf16 v[200:203], v[36:39], v[116:119], v[200:203]
    v_mfma_f32_16x16x32_bf16 v[204:207], v[32:35], v[120:123], v[204:207]
    s_waitcnt lgkmcnt(0)
    s_barrier
    v_mfma_f32_16x16x32_bf16 v[204:207], v[36:39], v[124:127], v[204:207]
    ds_read_b128 v[32:35], v16 offset:0
    ds_read_b128 v[36:39], v17 offset:0
    v_mfma_f32_16x16x32_bf16 v[208:211], v[96:99], v[40:43], v[208:211]
    buffer_load_dwordx4 v[28:31], v1, s[68:71], s63 offen offset:2048
    v_mfma_f32_16x16x32_bf16 v[208:211], v[100:103], v[44:47], v[208:211]
    v_mfma_f32_16x16x32_bf16 v[212:215], v[104:107], v[40:43], v[212:215]
    v_mfma_f32_16x16x32_bf16 v[212:215], v[108:111], v[44:47], v[212:215]
    v_mfma_f32_16x16x32_bf16 v[216:219], v[40:43], v[112:115], v[216:219]
    v_mfma_f32_16x16x32_bf16 v[216:219], v[44:47], v[116:119], v[216:219]
    v_mfma_f32_16x16x32_bf16 v[220:223], v[40:43], v[120:123], v[220:223]
    v_mfma_f32_16x16x32_bf16 v[220:223], v[44:47], v[124:127], v[220:223]
    ds_read_b128 v[40:43], v16 offset:2048
    ds_read_b128 v[44:47], v17 offset:2048
    v_mfma_f32_16x16x32_bf16 v[224:227], v[96:99], v[48:51], v[224:227]
    v_mfma_f32_16x16x32_bf16 v[224:227], v[100:103], v[52:55], v[224:227]
    v_mfma_f32_16x16x32_bf16 v[228:231], v[104:107], v[48:51], v[228:231]
    v_mfma_f32_16x16x32_bf16 v[228:231], v[108:111], v[52:55], v[228:231]
    v_mfma_f32_16x16x32_bf16 v[232:235], v[48:51], v[112:115], v[232:235]
    v_mfma_f32_16x16x32_bf16 v[232:235], v[52:55], v[116:119], v[232:235]
    v_mfma_f32_16x16x32_bf16 v[236:239], v[48:51], v[120:123], v[236:239]
    v_mfma_f32_16x16x32_bf16 v[236:239], v[52:55], v[124:127], v[236:239]
    ds_read_b128 v[48:51], v16 offset:4096
    ds_read_b128 v[52:55], v17 offset:4096
    v_mfma_f32_16x16x32_bf16 v[240:243], v[96:99], v[56:59], v[240:243]
    v_mfma_f32_16x16x32_bf16 v[240:243], v[100:103], v[60:63], v[240:243]
    v_mfma_f32_16x16x32_bf16 v[244:247], v[104:107], v[56:59], v[244:247]
    v_mfma_f32_16x16x32_bf16 v[244:247], v[108:111], v[60:63], v[244:247]
    v_mfma_f32_16x16x32_bf16 v[248:251], v[56:59], v[112:115], v[248:251]
    v_mfma_f32_16x16x32_bf16 v[248:251], v[60:63], v[116:119], v[248:251]
    v_mfma_f32_16x16x32_bf16 v[252:255], v[56:59], v[120:123], v[252:255]
    v_mfma_f32_16x16x32_bf16 v[252:255], v[60:63], v[124:127], v[252:255]
    ds_read_b128 v[56:59], v16 offset:6144
    ds_read_b128 v[60:63], v17 offset:6144
    s_waitcnt lgkmcnt(6)
    v_mfma_f32_16x16x32_bf16 v[128:131], v[64:67], v[32:35], v[128:131]
    v_mfma_f32_16x16x32_bf16 v[128:131], v[68:71], v[36:39], v[128:131]
    s_barrier
    v_mfma_f32_16x16x32_bf16 v[132:135], v[72:75], v[32:35], v[132:135]
    ds_read_b64_tr_b16 v[96:97], v20 offset:32768
    v_mfma_f32_16x16x32_bf16 v[132:135], v[76:79], v[36:39], v[132:135]
    ds_read_b64_tr_b16 v[98:99], v20 offset:33792
    v_mfma_f32_16x16x32_bf16 v[136:139], v[32:35], v[80:83], v[136:139]
    ds_read_b64_tr_b16 v[100:101], v20 offset:49152
    v_mfma_f32_16x16x32_bf16 v[136:139], v[36:39], v[84:87], v[136:139]
    ds_read_b64_tr_b16 v[102:103], v20 offset:50176
    v_mfma_f32_16x16x32_bf16 v[140:143], v[32:35], v[88:91], v[140:143]
    buffer_load_dwordx4 v[28:31], v1, s[68:71], s63 offen offset:3072
    v_mfma_f32_16x16x32_bf16 v[140:143], v[36:39], v[92:95], v[140:143]
    ds_read_b128 v[32:35], v16 offset:8192
    ds_read_b128 v[36:39], v17 offset:8192
    s_waitcnt lgkmcnt(10)
    v_mfma_f32_16x16x32_bf16 v[144:147], v[64:67], v[40:43], v[144:147]
    v_mfma_f32_16x16x32_bf16 v[144:147], v[68:71], v[44:47], v[144:147]
    v_mfma_f32_16x16x32_bf16 v[148:151], v[72:75], v[40:43], v[148:151]
    ds_read_b64_tr_b16 v[104:105], v21 offset:32768
    v_mfma_f32_16x16x32_bf16 v[148:151], v[76:79], v[44:47], v[148:151]
    ds_read_b64_tr_b16 v[106:107], v21 offset:33792
    v_mfma_f32_16x16x32_bf16 v[152:155], v[40:43], v[80:83], v[152:155]
    ds_read_b64_tr_b16 v[108:109], v21 offset:49152
    v_mfma_f32_16x16x32_bf16 v[152:155], v[44:47], v[84:87], v[152:155]
    ds_read_b64_tr_b16 v[110:111], v21 offset:50176
    v_mfma_f32_16x16x32_bf16 v[156:159], v[40:43], v[88:91], v[156:159]
    v_mfma_f32_16x16x32_bf16 v[156:159], v[44:47], v[92:95], v[156:159]
    ds_read_b128 v[40:43], v16 offset:10240
    ds_read_b128 v[44:47], v17 offset:10240
    s_waitcnt lgkmcnt(14)
    v_mfma_f32_16x16x32_bf16 v[160:163], v[64:67], v[48:51], v[160:163]
    v_mfma_f32_16x16x32_bf16 v[160:163], v[68:71], v[52:55], v[160:163]
    v_mfma_f32_16x16x32_bf16 v[164:167], v[72:75], v[48:51], v[164:167]
    ds_read_b64_tr_b16 v[112:113], v20 offset:40960
    v_mfma_f32_16x16x32_bf16 v[164:167], v[76:79], v[52:55], v[164:167]
    ds_read_b64_tr_b16 v[114:115], v20 offset:41984
    v_mfma_f32_16x16x32_bf16 v[168:171], v[48:51], v[80:83], v[168:171]
    ds_read_b64_tr_b16 v[116:117], v20 offset:57344
    v_mfma_f32_16x16x32_bf16 v[168:171], v[52:55], v[84:87], v[168:171]
    ds_read_b64_tr_b16 v[118:119], v20 offset:58368
    v_mfma_f32_16x16x32_bf16 v[172:175], v[48:51], v[88:91], v[172:175]
    v_mfma_f32_16x16x32_bf16 v[172:175], v[52:55], v[92:95], v[172:175]
    ds_read_b128 v[48:51], v16 offset:12288
    ds_read_b128 v[52:55], v17 offset:12288
    s_waitcnt lgkmcnt(15)
    v_mfma_f32_16x16x32_bf16 v[176:179], v[64:67], v[56:59], v[176:179]
    v_mfma_f32_16x16x32_bf16 v[176:179], v[68:71], v[60:63], v[176:179]
    v_mfma_f32_16x16x32_bf16 v[180:183], v[72:75], v[56:59], v[180:183]
    ds_read_b64_tr_b16 v[120:121], v21 offset:40960
    v_mfma_f32_16x16x32_bf16 v[180:183], v[76:79], v[60:63], v[180:183]
    ds_read_b64_tr_b16 v[122:123], v21 offset:41984
    v_mfma_f32_16x16x32_bf16 v[184:187], v[56:59], v[80:83], v[184:187]
    ds_read_b64_tr_b16 v[124:125], v21 offset:57344
    v_mfma_f32_16x16x32_bf16 v[184:187], v[60:63], v[84:87], v[184:187]
    ds_read_b64_tr_b16 v[126:127], v21 offset:58368
    v_mfma_f32_16x16x32_bf16 v[188:191], v[56:59], v[88:91], v[188:191]
    v_mfma_f32_16x16x32_bf16 v[188:191], v[60:63], v[92:95], v[188:191]
    ds_read_b128 v[56:59], v16 offset:14336
    ds_read_b128 v[60:63], v17 offset:14336
    s_waitcnt lgkmcnt(15)
    v_mfma_f32_16x16x32_bf16 v[192:195], v[64:67], v[32:35], v[192:195]
    v_mfma_f32_16x16x32_bf16 v[192:195], v[68:71], v[36:39], v[192:195]
    v_mfma_f32_16x16x32_bf16 v[196:199], v[72:75], v[32:35], v[196:199]
    v_mfma_f32_16x16x32_bf16 v[196:199], v[76:79], v[36:39], v[196:199]
    v_mfma_f32_16x16x32_bf16 v[200:203], v[32:35], v[80:83], v[200:203]
    v_mfma_f32_16x16x32_bf16 v[200:203], v[36:39], v[84:87], v[200:203]
    v_mfma_f32_16x16x32_bf16 v[204:207], v[32:35], v[88:91], v[204:207]
    s_waitcnt lgkmcnt(0)
    s_barrier
    v_mfma_f32_16x16x32_bf16 v[204:207], v[36:39], v[92:95], v[204:207]
    ds_read_b128 v[32:35], v16 offset:32768
    ds_read_b128 v[36:39], v17 offset:32768
    v_mfma_f32_16x16x32_bf16 v[208:211], v[64:67], v[40:43], v[208:211]
    s_cmp_lg_u32 s48, 3
    s_cbranch_scc1 m_c_tc1
    buffer_load_dword v9, v10, s[28:31], s67 offen offset:512
m_c_tc1:
    v_mfma_f32_16x16x32_bf16 v[208:211], v[68:71], v[44:47], v[208:211]
    v_mfma_f32_16x16x32_bf16 v[212:215], v[72:75], v[40:43], v[212:215]
    v_mfma_f32_16x16x32_bf16 v[212:215], v[76:79], v[44:47], v[212:215]
    v_mfma_f32_16x16x32_bf16 v[216:219], v[40:43], v[80:83], v[216:219]
    v_mfma_f32_16x16x32_bf16 v[216:219], v[44:47], v[84:87], v[216:219]
    v_mfma_f32_16x16x32_bf16 v[220:223], v[40:43], v[88:91], v[220:223]
    v_mfma_f32_16x16x32_bf16 v[220:223], v[44:47], v[92:95], v[220:223]
    ds_read_b128 v[40:43], v16 offset:34816
    ds_read_b128 v[44:47], v17 offset:34816
    v_mfma_f32_16x16x32_bf16 v[224:227], v[64:67], v[48:51], v[224:227]
    v_mfma_f32_16x16x32_bf16 v[224:227], v[68:71], v[52:55], v[224:227]
    v_mfma_f32_16x16x32_bf16 v[228:231], v[72:75], v[48:51], v[228:231]
    v_mfma_f32_16x16x32_bf16 v[228:231], v[76:79], v[52:55], v[228:231]
    v_mfma_f32_16x16x32_bf16 v[232:235], v[48:51], v[80:83], v[232:235]
    v_mfma_f32_16x16x32_bf16 v[232:235], v[52:55], v[84:87], v[232:235]
    v_mfma_f32_16x16x32_bf16 v[236:239], v[48:51], v[88:91], v[236:239]
    v_mfma_f32_16x16x32_bf16 v[236:239], v[52:55], v[92:95], v[236:239]
    ds_read_b128 v[48:51], v16 offset:36864
    ds_read_b128 v[52:55], v17 offset:36864
    v_mfma_f32_16x16x32_bf16 v[240:243], v[64:67], v[56:59], v[240:243]
    v_mfma_f32_16x16x32_bf16 v[240:243], v[68:71], v[60:63], v[240:243]
    v_mfma_f32_16x16x32_bf16 v[244:247], v[72:75], v[56:59], v[244:247]
    v_mfma_f32_16x16x32_bf16 v[244:247], v[76:79], v[60:63], v[244:247]
    v_mfma_f32_16x16x32_bf16 v[248:251], v[56:59], v[80:83], v[248:251]
    v_mfma_f32_16x16x32_bf16 v[248:251], v[60:63], v[84:87], v[248:251]
    v_mfma_f32_16x16x32_bf16 v[252:255], v[56:59], v[88:91], v[252:255]
    v_mfma_f32_16x16x32_bf16 v[252:255], v[60:63], v[92:95], v[252:255]
    ds_read_b128 v[56:59], v16 offset:38912
    ds_read_b128 v[60:63], v17 offset:38912
    s_waitcnt lgkmcnt(6)
    v_mfma_f32_16x16x32_bf16 v[128:131], v[96:99], v[32:35], v[128:131]
    v_mfma_f32_16x16x32_bf16 v[128:131], v[100:103], v[36:39], v[128:131]
    v_mfma_f32_16x16x32_bf16 v[132:135], v[104:107], v[32:35], v[132:135]
    v_mfma_f32_16x16x32_bf16 v[132:135], v[108:111], v[36:39], v[132:135]
    v_mfma_f32_16x16x32_bf16 v[136:139], v[32:35], v[112:115], v[136:139]
    v_mfma_f32_16x16x32_bf16 v[136:139], v[36:39], v[116:119], v[136:139]
    v_mfma_f32_16x16x32_bf16 v[140:143], v[32:35], v[120:123], v[140:143]
    v_mfma_f32_16x16x32_bf16 v[140:143], v[36:39], v[124:127], v[140:143]
    ds_read_b128 v[32:35], v16 offset:40960
    ds_read_b128 v[36:39], v17 offset:40960
    s_waitcnt lgkmcnt(6)
    v_mfma_f32_16x16x32_bf16 v[144:147], v[96:99], v[40:43], v[144:147]
    v_mfma_f32_16x16x32_bf16 v[144:147], v[100:103], v[44:47], v[144:147]
    v_mfma_f32_16x16x32_bf16 v[148:151], v[104:107], v[40:43], v[148:151]
    v_mfma_f32_16x16x32_bf16 v[148:151], v[108:111], v[44:47], v[148:151]
    v_mfma_f32_16x16x32_bf16 v[152:155], v[40:43], v[112:115], v[152:155]
    v_mfma_f32_16x16x32_bf16 v[152:155], v[44:47], v[116:119], v[152:155]
    v_mfma_f32_16x16x32_bf16 v[156:159], v[40:43], v[120:123], v[156:159]
    v_mfma_f32_16x16x32_bf16 v[156:159], v[44:47], v[124:127], v[156:159]
    ds_read_b128 v[40:43], v16 offset:43008
    ds_read_b128 v[44:47], v17 offset:43008
    s_waitcnt lgkmcnt(6)
    v_mfma_f32_16x16x32_bf16 v[160:163], v[96:99], v[48:51], v[160:163]
    v_mfma_f32_16x16x32_bf16 v[160:163], v[100:103], v[52:55], v[160:163]
    v_mfma_f32_16x16x32_bf16 v[164:167], v[104:107], v[48:51], v[164:167]
    v_mfma_f32_16x16x32_bf16 v[164:167], v[108:111], v[52:55], v[164:167]
    v_mfma_f32_16x16x32_bf16 v[168:171], v[48:51], v[112:115], v[168:171]
    v_mfma_f32_16x16x32_bf16 v[168:171], v[52:55], v[116:119], v[168:171]
    v_mfma_f32_16x16x32_bf16 v[172:175], v[48:51], v[120:123], v[172:175]
    v_mfma_f32_16x16x32_bf16 v[172:175], v[52:55], v[124:127], v[172:175]
    ds_read_b128 v[48:51], v16 offset:45056
    ds_read_b128 v[52:55], v17 offset:45056
    s_waitcnt lgkmcnt(6)
    v_mfma_f32_16x16x32_bf16 v[176:179], v[96:99], v[56:59], v[176:179]
    v_mfma_f32_16x16x32_bf16 v[176:179], v[100:103], v[60:63], v[176:179]
    v_mfma_f32_16x16x32_bf16 v[180:183], v[104:107], v[56:59], v[180:183]
    v_mfma_f32_16x16x32_bf16 v[180:183], v[108:111], v[60:63], v[180:183]
    v_mfma_f32_16x16x32_bf16 v[184:187], v[56:59], v[112:115], v[184:187]
    v_mfma_f32_16x16x32_bf16 v[184:187], v[60:63], v[116:119], v[184:187]
    v_mfma_f32_16x16x32_bf16 v[188:191], v[56:59], v[120:123], v[188:191]
    v_mfma_f32_16x16x32_bf16 v[188:191], v[60:63], v[124:127], v[188:191]
    ds_read_b128 v[56:59], v16 offset:47104
    ds_read_b128 v[60:63], v17 offset:47104
    s_waitcnt lgkmcnt(6)
    v_mfma_f32_16x16x32_bf16 v[192:195], v[96:99], v[32:35], v[192:195]
    v_mfma_f32_16x16x32_bf16 v[192:195], v[100:103], v[36:39], v[192:195]
    v_mfma_f32_16x16x32_bf16 v[196:199], v[104:107], v[32:35], v[196:199]
    v_mfma_f32_16x16x32_bf16 v[196:199], v[108:111], v[36:39], v[196:199]
    v_mfma_f32_16x16x32_bf16 v[200:203], v[32:35], v[112:115], v[200:203]
    v_mfma_f32_16x16x32_bf16 v[200:203], v[36:39], v[116:119], v[200:203]
    v_mfma_f32_16x16x32_bf16 v[204:207], v[32:35], v[120:123], v[204:207]
    s_waitcnt lgkmcnt(0)
    s_barrier
    v_mfma_f32_16x16x32_bf16 v[204:207], v[36:39], v[124:127], v[204:207]
    v_mfma_f32_16x16x32_bf16 v[208:211], v[96:99], v[40:43], v[208:211]
    v_mfma_f32_16x16x32_bf16 v[208:211], v[100:103], v[44:47], v[208:211]
    v_mfma_f32_16x16x32_bf16 v[212:215], v[104:107], v[40:43], v[212:215]
    v_mfma_f32_16x16x32_bf16 v[212:215], v[108:111], v[44:47], v[212:215]
    v_mfma_f32_16x16x32_bf16 v[216:219], v[40:43], v[112:115], v[216:219]
    v_mfma_f32_16x16x32_bf16 v[216:219], v[44:47], v[116:119], v[216:219]
    v_mfma_f32_16x16x32_bf16 v[220:223], v[40:43], v[120:123], v[220:223]
    v_mfma_f32_16x16x32_bf16 v[220:223], v[44:47], v[124:127], v[220:223]
    v_mfma_f32_16x16x32_bf16 v[224:227], v[96:99], v[48:51], v[224:227]
    v_mfma_f32_16x16x32_bf16 v[224:227], v[100:103], v[52:55], v[224:227]
    v_mfma_f32_16x16x32_bf16 v[228:231], v[104:107], v[48:51], v[228:231]
    v_mfma_f32_16x16x32_bf16 v[228:231], v[108:111], v[52:55], v[228:231]
    v_mfma_f32_16x16x32_bf16 v[232:235], v[48:51], v[112:115], v[232:235]
    v_mfma_f32_16x16x32_bf16 v[232:235], v[52:55], v[116:119], v[232:235]
    v_mfma_f32_16x16x32_bf16 v[236:239], v[48:51], v[120:123], v[236:239]
    v_mfma_f32_16x16x32_bf16 v[236:239], v[52:55], v[124:127], v[236:239]
    v_mfma_f32_16x16x32_bf16 v[240:243], v[96:99], v[56:59], v[240:243]
    v_mfma_f32_16x16x32_bf16 v[240:243], v[100:103], v[60:63], v[240:243]
    v_mfma_f32_16x16x32_bf16 v[244:247], v[104:107], v[56:59], v[244:247]
    v_mfma_f32_16x16x32_bf16 v[244:247], v[108:111], v[60:63], v[244:247]
    v_mfma_f32_16x16x32_bf16 v[248:251], v[56:59], v[112:115], v[248:251]
    v_mfma_f32_16x16x32_bf16 v[248:251], v[60:63], v[116:119], v[248:251]
    v_mfma_f32_16x16x32_bf16 v[252:255], v[56:59], v[120:123], v[252:255]
    v_mfma_f32_16x16x32_bf16 v[252:255], v[60:63], v[124:127], v[252:255]
    s_waitcnt vmcnt(0)
    s_barrier
    ds_read_b128 v[32:35], v12 offset:0
    ds_read_b128 v[36:39], v12 offset:2048
    ds_read_b64_tr_b16 v[40:41], v15 offset:0
    ds_read_b64_tr_b16 v[42:43], v15 offset:256
    ds_read_b64_tr_b16 v[44:45], v15 offset:8192
    ds_read_b64_tr_b16 v[46:47], v15 offset:8448
    ds_read_b64_tr_b16 v[48:49], v15 offset:16384
    ds_read_b64_tr_b16 v[50:51], v15 offset:16640
    ds_read_b128 v[52:55], v13 offset:0
    ds_read_b128 v[56:59], v13 offset:2048
    ds_read_b64_tr_b16 v[60:61], v15 offset:2048
    ds_read_b64_tr_b16 v[62:63], v15 offset:2304
    ds_read_b64_tr_b16 v[64:65], v15 offset:10240
    ds_read_b64_tr_b16 v[66:67], v15 offset:10496
    ds_read_b64_tr_b16 v[68:69], v15 offset:18432
    ds_read_b64_tr_b16 v[70:71], v15 offset:18688
    s_mov_b32 s36, s4
    s_mov_b32 s37, s5
    s_mov_b32 s38, 0x200000
    s_mov_b32 s39, 0x20000
    s_mov_b32 s40, s8
    s_mov_b32 s41, s9
    s_mov_b32 s42, 0x400000
    s_mov_b32 s43, 0x20000
    v_readfirstlane_b32 s68, v22
    v_readfirstlane_b32 s69, v23
    s_nop 0
    s_cmp_eq_u32 s68, 0
    s_cselect_b64 s[68:69], s[64:65], s[68:69]
    s_lshl_b32 s52, s49, 6
    s_lshl_b32 s53, s50, 3
    s_add_u32 s52, s52, s53
    s_lshl_b32 s52, s52, 13
    s_add_u32 s64, s51, s52
    s_add_u32 s65, s64, s51
    s_add_u32 s65, s65, 16777216
    v_cvt_pk_bf16_f32 v72, v128, v129
    v_cvt_pk_bf16_f32 v73, v130, v131
    v_cvt_pk_bf16_f32 v74, v132, v133
    v_cvt_pk_bf16_f32 v75, v134, v135
    v_cvt_pk_bf16_f32 v76, v144, v145
    v_cvt_pk_bf16_f32 v77, v146, v147
    v_cvt_pk_bf16_f32 v78, v148, v149
    v_cvt_pk_bf16_f32 v79, v150, v151
    v_cvt_pk_bf16_f32 v80, v136, v137
    v_cvt_pk_bf16_f32 v81, v138, v139
    v_cvt_pk_bf16_f32 v82, v152, v153
    v_cvt_pk_bf16_f32 v83, v154, v155
    v_cvt_pk_bf16_f32 v84, v140, v141
    v_cvt_pk_bf16_f32 v85, v142, v143
    v_cvt_pk_bf16_f32 v86, v156, v157
    v_cvt_pk_bf16_f32 v87, v158, v159
    s_lshl_b32 s60, s55, 17
    s_lshl_b32 s61, s50, 17
    s_waitcnt lgkmcnt(8)
    s_barrier
    v_mfma_f32_16x16x32_bf16 v[88:91], v[40:43], v[32:35], 0
    ds_read_b128 v[112:115], v12 offset:16384
    v_cvt_pk_bf16_f32 v136, v160, v161
    s_add_u32 s54, s64, 0
    buffer_store_dwordx4 v[72:75], v1, s[44:47], s54 offen sc1
    v_mfma_f32_16x16x32_bf16 v[92:95], v[40:43], v[36:39], 0
    ds_read_b128 v[116:119], v12 offset:18432
    v_cvt_pk_bf16_f32 v137, v162, v163
    v_mfma_f32_16x16x32_bf16 v[96:99], v[44:47], v[32:35], 0
    ds_read_b64_tr_b16 v[120:121], v15 offset:4096
    v_cvt_pk_bf16_f32 v138, v164, v165
    v_mfma_f32_16x16x32_bf16 v[100:103], v[44:47], v[36:39], 0
    ds_read_b64_tr_b16 v[122:123], v15 offset:4352
    v_cvt_pk_bf16_f32 v139, v166, v167
    v_mfma_f32_16x16x32_bf16 v[104:107], v[32:35], v[48:51], 0
    ds_read_b64_tr_b16 v[124:125], v15 offset:12288
    ds_read_b64_tr_b16 v[126:127], v15 offset:12544
    v_cvt_pk_bf16_f32 v140, v176, v177
    v_mfma_f32_16x16x32_bf16 v[108:111], v[36:39], v[48:51], 0
    ds_read_b64_tr_b16 v[128:129], v15 offset:20480
    ds_read_b64_tr_b16 v[130:131], v15 offset:20736
    v_cvt_pk_bf16_f32 v141, v178, v179
    s_waitcnt lgkmcnt(8)
    v_mfma_f32_16x16x32_bf16 v[88:91], v[60:63], v[52:55], v[88:91]
    ds_read_b128 v[32:35], v13 offset:16384
    v_cvt_pk_bf16_f32 v142, v180, v181
    v_mfma_f32_16x16x32_bf16 v[92:95], v[60:63], v[56:59], v[92:95]
    ds_read_b128 v[36:39], v13 offset:18432
    v_cvt_pk_bf16_f32 v143, v182, v183
    v_mfma_f32_16x16x32_bf16 v[96:99], v[64:67], v[52:55], v[96:99]
    ds_read_b64_tr_b16 v[40:41], v15 offset:6144
    v_cvt_pk_bf16_f32 v144, v168, v169
    v_mfma_f32_16x16x32_bf16 v[100:103], v[64:67], v[56:59], v[100:103]
    ds_read_b64_tr_b16 v[42:43], v15 offset:6400
    v_cvt_pk_bf16_f32 v145, v170, v171
    v_mfma_f32_16x16x32_bf16 v[104:107], v[52:55], v[68:71], v[104:107]
    ds_read_b64_tr_b16 v[44:45], v15 offset:14336
    ds_read_b64_tr_b16 v[46:47], v15 offset:14592
    v_cvt_pk_bf16_f32 v146, v184, v185
    v_mfma_f32_16x16x32_bf16 v[108:111], v[56:59], v[68:71], v[108:111]
    ds_read_b64_tr_b16 v[48:49], v15 offset:22528
    ds_read_b64_tr_b16 v[50:51], v15 offset:22784
    v_cvt_pk_bf16_f32 v147, v186, v187
    s_waitcnt lgkmcnt(8)
    s_barrier
    v_mfma_f32_16x16x32_bf16 v[88:91], v[120:123], v[112:115], v[88:91]
    ds_read_b128 v[52:55], v12 offset:32768
    v_cvt_pk_bf16_f32 v148, v172, v173
    s_cmp_lt_u32 s50, 2
    s_cbranch_scc0 m_c_g1
    s_add_u32 s54, s64, 4096
    buffer_store_dwordx4 v[76:79], v1, s[44:47], s54 offen sc1
m_c_g1:
    v_mfma_f32_16x16x32_bf16 v[92:95], v[120:123], v[116:119], v[92:95]
    ds_read_b128 v[56:59], v12 offset:34816
    v_cvt_pk_bf16_f32 v149, v174, v175
    v_mfma_f32_16x16x32_bf16 v[96:99], v[124:127], v[112:115], v[96:99]
    ds_read_b64_tr_b16 v[60:61], v15 offset:24576
    v_cvt_pk_bf16_f32 v150, v188, v189
    v_mfma_f32_16x16x32_bf16 v[100:103], v[124:127], v[116:119], v[100:103]
    ds_read_b64_tr_b16 v[62:63], v15 offset:24832
    v_cvt_pk_bf16_f32 v151, v190, v191
    v_mfma_f32_16x16x32_bf16 v[104:107], v[112:115], v[128:131], v[104:107]
    ds_read_b64_tr_b16 v[64:65], v14 offset:0
    ds_read_b64_tr_b16 v[66:67], v14 offset:256
    v_cvt_pk_bf16_f32 v152, v192, v193
    v_mfma_f32_16x16x32_bf16 v[108:111], v[116:119], v[128:131], v[108:111]
    ds_read_b64_tr_b16 v[68:69], v14 offset:8192
    ds_read_b64_tr_b16 v[70:71], v14 offset:8448
    v_cvt_pk_bf16_f32 v153, v194, v195
    s_waitcnt lgkmcnt(8)
    v_mfma_f32_16x16x32_bf16 v[88:91], v[40:43], v[32:35], v[88:91]
    ds_read_b128 v[112:115], v13 offset:32768
    v_cvt_pk_bf16_f32 v154, v196, v197
    v_mfma_f32_16x16x32_bf16 v[92:95], v[40:43], v[36:39], v[92:95]
    ds_read_b128 v[116:119], v13 offset:34816
    v_cvt_pk_bf16_f32 v155, v198, v199
    v_mfma_f32_16x16x32_bf16 v[96:99], v[44:47], v[32:35], v[96:99]
    ds_read_b64_tr_b16 v[120:121], v15 offset:26624
    v_cvt_pk_bf16_f32 v156, v208, v209
    v_mfma_f32_16x16x32_bf16 v[100:103], v[44:47], v[36:39], v[100:103]
    ds_read_b64_tr_b16 v[122:123], v15 offset:26880
    v_cvt_pk_bf16_f32 v157, v210, v211
    v_mfma_f32_16x16x32_bf16 v[104:107], v[32:35], v[48:51], v[104:107]
    ds_read_b64_tr_b16 v[124:125], v14 offset:2048
    ds_read_b64_tr_b16 v[126:127], v14 offset:2304
    v_cvt_pk_bf16_f32 v158, v212, v213
    v_mfma_f32_16x16x32_bf16 v[108:111], v[36:39], v[48:51], v[108:111]
    ds_read_b64_tr_b16 v[128:129], v14 offset:10240
    ds_read_b64_tr_b16 v[130:131], v14 offset:10496
    v_cvt_pk_bf16_f32 v159, v214, v215
    s_waitcnt lgkmcnt(8)
    s_barrier
    v_mfma_f32_16x16x32_bf16 v[88:91], v[60:63], v[52:55], v[88:91]
    ds_read_b128 v[32:35], v12 offset:49152
    v_cvt_pk_bf16_f32 v160, v200, v201
    s_cmp_lt_u32 s50, 2
    s_cbranch_scc1 m_c_g2
    s_add_u32 s54, s64, 4096
    buffer_store_dwordx4 v[76:79], v1, s[44:47], s54 offen sc1
m_c_g2:
    v_mfma_f32_16x16x32_bf16 v[92:95], v[60:63], v[56:59], v[92:95]
    ds_read_b128 v[36:39], v12 offset:51200
    v_cvt_pk_bf16_f32 v161, v202, v203
    v_mfma_f32_16x16x32_bf16 v[96:99], v[64:67], v[52:55], v[96:99]
    ds_read_b64_tr_b16 v[40:41], v15 offset:28672
    v_cvt_pk_bf16_f32 v162, v216, v217
    v_mfma_f32_16x16x32_bf16 v[100:103], v[64:67], v[56:59], v[100:103]
    ds_read_b64_tr_b16 v[42:43], v15 offset:28928
    v_cvt_pk_bf16_f32 v163, v218, v219
    v_mfma_f32_16x16x32_bf16 v[104:107], v[52:55], v[68:71], v[104:107]
    ds_read_b64_tr_b16 v[44:45], v14 offset:4096
    ds_read_b64_tr_b16 v[46:47], v14 offset:4352
    v_cvt_pk_bf16_f32 v164, v204, v205
    v_mfma_f32_16x16x32_bf16 v[108:111], v[56:59], v[68:71], v[108:111]
    ds_read_b64_tr_b16 v[48:49], v14 offset:12288
    ds_read_b64_tr_b16 v[50:51], v14 offset:12544
    v_cvt_pk_bf16_f32 v165, v206, v207
    s_waitcnt lgkmcnt(8)
    v_mfma_f32_16x16x32_bf16 v[88:91], v[120:123], v[112:115], v[88:91]
    ds_read_b128 v[52:55], v13 offset:49152
    v_cvt_pk_bf16_f32 v166, v220, v221
    s_cmp_lt_u32 s50, 2
    s_cbranch_scc0 m_c_g3
    s_add_u32 s54, s65, 0
    buffer_store_dwordx4 v[80:83], v1, s[44:47], s54 offen sc1
m_c_g3:
    v_mfma_f32_16x16x32_bf16 v[92:95], v[120:123], v[116:119], v[92:95]
    ds_read_b128 v[56:59], v13 offset:51200
    v_cvt_pk_bf16_f32 v167, v222, v223
    v_mfma_f32_16x16x32_bf16 v[96:99], v[124:127], v[112:115], v[96:99]
    ds_read_b64_tr_b16 v[60:61], v15 offset:30720
    v_cvt_pk_bf16_f32 v172, v224, v225
    v_mfma_f32_16x16x32_bf16 v[100:103], v[124:127], v[116:119], v[100:103]
    ds_read_b64_tr_b16 v[62:63], v15 offset:30976
    v_cvt_pk_bf16_f32 v173, v226, v227
    v_mfma_f32_16x16x32_bf16 v[104:107], v[112:115], v[128:131], v[104:107]
    ds_read_b64_tr_b16 v[64:65], v14 offset:6144
    ds_read_b64_tr_b16 v[66:67], v14 offset:6400
    v_cvt_pk_bf16_f32 v174, v228, v229
    v_mfma_f32_16x16x32_bf16 v[108:111], v[116:119], v[128:131], v[108:111]
    ds_read_b64_tr_b16 v[68:69], v14 offset:14336
    ds_read_b64_tr_b16 v[70:71], v14 offset:14592
    v_cvt_pk_bf16_f32 v175, v230, v231
    s_waitcnt lgkmcnt(8)
    s_barrier
    v_mfma_f32_16x16x32_bf16 v[88:91], v[40:43], v[32:35], v[88:91]
    ds_read_b128 v[112:115], v12 offset:0
    v_cvt_pk_bf16_f32 v176, v240, v241
    s_cmp_lt_u32 s50, 2
    s_cbranch_scc0 m_c_g4
    s_add_u32 s54, s65, 1024
    buffer_store_dwordx4 v[84:87], v1, s[44:47], s54 offen sc1
m_c_g4:
    v_mfma_f32_16x16x32_bf16 v[92:95], v[40:43], v[36:39], v[92:95]
    ds_read_b128 v[116:119], v12 offset:2048
    v_cvt_pk_bf16_f32 v177, v242, v243
    v_mfma_f32_16x16x32_bf16 v[96:99], v[44:47], v[32:35], v[96:99]
    ds_read_b64_tr_b16 v[120:121], v14 offset:16384
    v_cvt_pk_bf16_f32 v178, v244, v245
    v_mfma_f32_16x16x32_bf16 v[100:103], v[44:47], v[36:39], v[100:103]
    ds_read_b64_tr_b16 v[122:123], v14 offset:16640
    v_cvt_pk_bf16_f32 v179, v246, v247
    v_mfma_f32_16x16x32_bf16 v[104:107], v[32:35], v[48:51], v[104:107]
    ds_read_b64_tr_b16 v[124:125], v14 offset:24576
    ds_read_b64_tr_b16 v[126:127], v14 offset:24832
    v_cvt_pk_bf16_f32 v180, v232, v233
    v_mfma_f32_16x16x32_bf16 v[108:111], v[36:39], v[48:51], v[108:111]
    ds_read_b64_tr_b16 v[128:129], v14 offset:32768
    ds_read_b64_tr_b16 v[130:131], v14 offset:33024
    v_cvt_pk_bf16_f32 v181, v234, v235
    s_waitcnt lgkmcnt(8)
    v_mfma_f32_16x16x32_bf16 v[88:91], v[60:63], v[52:55], v[88:91]
    ds_read_b128 v[32:35], v13 offset:0
    v_cvt_pk_bf16_f32 v182, v248, v249
    v_mfma_f32_16x16x32_bf16 v[92:95], v[60:63], v[56:59], v[92:95]
    ds_read_b128 v[36:39], v13 offset:2048
    v_cvt_pk_bf16_f32 v183, v250, v251
    v_mfma_f32_16x16x32_bf16 v[96:99], v[64:67], v[52:55], v[96:99]
    ds_read_b64_tr_b16 v[40:41], v14 offset:18432
    v_cvt_pk_bf16_f32 v248, v236, v237
    v_mfma_f32_16x16x32_bf16 v[100:103], v[64:67], v[56:59], v[100:103]
    ds_read_b64_tr_b16 v[42:43], v14 offset:18688
    v_cvt_pk_bf16_f32 v249, v238, v239
    v_mfma_f32_16x16x32_bf16 v[104:107], v[52:55], v[68:71], v[104:107]
    ds_read_b64_tr_b16 v[44:45], v14 offset:26624
    ds_read_b64_tr_b16 v[46:47], v14 offset:26880
    v_cvt_pk_bf16_f32 v250, v252, v253
    v_mfma_f32_16x16x32_bf16 v[108:111], v[56:59], v[68:71], v[108:111]
    ds_read_b64_tr_b16 v[48:49], v14 offset:34816
    ds_read_b64_tr_b16 v[50:51], v14 offset:35072
    v_cvt_pk_bf16_f32 v251, v254, v255
    s_waitcnt lgkmcnt(8)
    s_barrier
    v_mfma_f32_16x16x32_bf16 v[88:91], v[120:123], v[112:115], v[88:91]
    ds_read_b128 v[52:55], v12 offset:16384
    s_cmp_lt_u32 s50, 2
    s_cbranch_scc1 m_c_g5
    s_add_u32 s54, s65, 0
    buffer_store_dwordx4 v[80:83], v1, s[44:47], s54 offen sc1
m_c_g5:
    v_mfma_f32_16x16x32_bf16 v[92:95], v[120:123], v[116:119], v[92:95]
    ds_read_b128 v[56:59], v12 offset:18432
    v_mfma_f32_16x16x32_bf16 v[96:99], v[124:127], v[112:115], v[96:99]
    ds_read_b64_tr_b16 v[60:61], v14 offset:20480
    v_mfma_f32_16x16x32_bf16 v[100:103], v[124:127], v[116:119], v[100:103]
    ds_read_b64_tr_b16 v[62:63], v14 offset:20736
    v_mfma_f32_16x16x32_bf16 v[104:107], v[112:115], v[128:131], v[104:107]
    ds_read_b64_tr_b16 v[64:65], v14 offset:28672
    ds_read_b64_tr_b16 v[66:67], v14 offset:28928
    v_mfma_f32_16x16x32_bf16 v[108:111], v[116:119], v[128:131], v[108:111]
    ds_read_b64_tr_b16 v[68:69], v14 offset:36864
    ds_read_b64_tr_b16 v[70:71], v14 offset:37120
    s_waitcnt lgkmcnt(8)
    v_mfma_f32_16x16x32_bf16 v[88:91], v[40:43], v[32:35], v[88:91]
    ds_read_b128 v[112:115], v13 offset:16384
    s_cmp_lt_u32 s50, 2
    s_cbranch_scc0 m_c_g6
    s_add_u32 s54, s64, 8192
    buffer_store_dwordx4 v[136:139], v1, s[44:47], s54 offen sc1
m_c_g6:
    v_mfma_f32_16x16x32_bf16 v[92:95], v[40:43], v[36:39], v[92:95]
    ds_read_b128 v[116:119], v13 offset:18432
    v_mfma_f32_16x16x32_bf16 v[96:99], v[44:47], v[32:35], v[96:99]
    ds_read_b64_tr_b16 v[120:121], v14 offset:22528
    v_mfma_f32_16x16x32_bf16 v[100:103], v[44:47], v[36:39], v[100:103]
    ds_read_b64_tr_b16 v[122:123], v14 offset:22784
    v_mfma_f32_16x16x32_bf16 v[104:107], v[32:35], v[48:51], v[104:107]
    ds_read_b64_tr_b16 v[124:125], v14 offset:30720
    ds_read_b64_tr_b16 v[126:127], v14 offset:30976
    v_mfma_f32_16x16x32_bf16 v[108:111], v[36:39], v[48:51], v[108:111]
    ds_read_b64_tr_b16 v[128:129], v14 offset:38912
    ds_read_b64_tr_b16 v[130:131], v14 offset:39168
    s_waitcnt lgkmcnt(8)
    s_barrier
    v_mfma_f32_16x16x32_bf16 v[88:91], v[60:63], v[52:55], v[88:91]
    ds_read_b128 v[32:35], v12 offset:32768
    s_cmp_lt_u32 s50, 2
    s_cbranch_scc0 m_c_g7
    s_add_u32 s54, s64, 12288
    buffer_store_dwordx4 v[140:143], v1, s[44:47], s54 offen sc1
m_c_g7:
    v_mfma_f32_16x16x32_bf16 v[92:95], v[60:63], v[56:59], v[92:95]
    ds_read_b128 v[36:39], v12 offset:34816
    v_mfma_f32_16x16x32_bf16 v[96:99], v[64:67], v[52:55], v[96:99]
    ds_read_b64_tr_b16 v[40:41], v14 offset:40960
    v_mfma_f32_16x16x32_bf16 v[100:103], v[64:67], v[56:59], v[100:103]
    ds_read_b64_tr_b16 v[42:43], v14 offset:41216
    v_mfma_f32_16x16x32_bf16 v[104:107], v[52:55], v[68:71], v[104:107]
    ds_read_b64_tr_b16 v[44:45], v14 offset:49152
    ds_read_b64_tr_b16 v[46:47], v14 offset:49408
    v_mfma_f32_16x16x32_bf16 v[108:111], v[56:59], v[68:71], v[108:111]
    ds_read_b64_tr_b16 v[48:49], v14 offset:57344
    ds_read_b64_tr_b16 v[50:51], v14 offset:57600
    s_waitcnt lgkmcnt(8)
    v_mfma_f32_16x16x32_bf16 v[88:91], v[120:123], v[112:115], v[88:91]
    ds_read_b128 v[52:55], v13 offset:32768
    v_mfma_f32_16x16x32_bf16 v[92:95], v[120:123], v[116:119], v[92:95]
    ds_read_b128 v[56:59], v13 offset:34816
    v_mfma_f32_16x16x32_bf16 v[96:99], v[124:127], v[112:115], v[96:99]
    ds_read_b64_tr_b16 v[60:61], v14 offset:43008
    v_mfma_f32_16x16x32_bf16 v[100:103], v[124:127], v[116:119], v[100:103]
    ds_read_b64_tr_b16 v[62:63], v14 offset:43264
    v_mfma_f32_16x16x32_bf16 v[104:107], v[112:115], v[128:131], v[104:107]
    ds_read_b64_tr_b16 v[64:65], v14 offset:51200
    ds_read_b64_tr_b16 v[66:67], v14 offset:51456
    v_mfma_f32_16x16x32_bf16 v[108:111], v[116:119], v[128:131], v[108:111]
    ds_read_b64_tr_b16 v[68:69], v14 offset:59392
    ds_read_b64_tr_b16 v[70:71], v14 offset:59648
    s_waitcnt lgkmcnt(8)
    s_barrier
    v_mfma_f32_16x16x32_bf16 v[88:91], v[40:43], v[32:35], v[88:91]
    ds_read_b128 v[112:115], v12 offset:49152
    s_cmp_lt_u32 s50, 2
    s_cbranch_scc1 m_c_g8
    s_add_u32 s54, s65, 1024
    buffer_store_dwordx4 v[84:87], v1, s[44:47], s54 offen sc1
m_c_g8:
    v_mfma_f32_16x16x32_bf16 v[92:95], v[40:43], v[36:39], v[92:95]
    ds_read_b128 v[116:119], v12 offset:51200
    v_mfma_f32_16x16x32_bf16 v[96:99], v[44:47], v[32:35], v[96:99]
    ds_read_b64_tr_b16 v[120:121], v14 offset:45056
    v_mfma_f32_16x16x32_bf16 v[100:103], v[44:47], v[36:39], v[100:103]
    ds_read_b64_tr_b16 v[122:123], v14 offset:45312
    v_mfma_f32_16x16x32_bf16 v[104:107], v[32:35], v[48:51], v[104:107]
    ds_read_b64_tr_b16 v[124:125], v14 offset:53248
    ds_read_b64_tr_b16 v[126:127], v14 offset:53504
    v_mfma_f32_16x16x32_bf16 v[108:111], v[36:39], v[48:51], v[108:111]
    ds_read_b64_tr_b16 v[128:129], v14 offset:61440
    ds_read_b64_tr_b16 v[130:131], v14 offset:61696
    s_waitcnt lgkmcnt(8)
    v_mfma_f32_16x16x32_bf16 v[88:91], v[60:63], v[52:55], v[88:91]
    ds_read_b128 v[32:35], v13 offset:49152
    s_cmp_lt_u32 s50, 2
    s_cbranch_scc0 m_c_g9
    s_add_u32 s54, s65, 8192
    buffer_store_dwordx4 v[144:147], v1, s[44:47], s54 offen sc1
m_c_g9:
    v_mfma_f32_16x16x32_bf16 v[92:95], v[60:63], v[56:59], v[92:95]
    ds_read_b128 v[36:39], v13 offset:51200
    v_mfma_f32_16x16x32_bf16 v[96:99], v[64:67], v[52:55], v[96:99]
    ds_read_b64_tr_b16 v[40:41], v14 offset:47104
    v_mfma_f32_16x16x32_bf16 v[100:103], v[64:67], v[56:59], v[100:103]
    ds_read_b64_tr_b16 v[42:43], v14 offset:47360
    v_mfma_f32_16x16x32_bf16 v[104:107], v[52:55], v[68:71], v[104:107]
    ds_read_b64_tr_b16 v[44:45], v14 offset:55296
    ds_read_b64_tr_b16 v[46:47], v14 offset:55552
    v_mfma_f32_16x16x32_bf16 v[108:111], v[56:59], v[68:71], v[108:111]
    ds_read_b64_tr_b16 v[48:49], v14 offset:63488
    ds_read_b64_tr_b16 v[50:51], v14 offset:63744
    s_waitcnt lgkmcnt(0)
    s_barrier
    v_mfma_f32_16x16x32_bf16 v[88:91], v[120:123], v[112:115], v[88:91]
    v_mfma_f32_16x16x32_bf16 v[92:95], v[120:123], v[116:119], v[92:95]
    v_mfma_f32_16x16x32_bf16 v[96:99], v[124:127], v[112:115], v[96:99]
    v_mfma_f32_16x16x32_bf16 v[100:103], v[124:127], v[116:119], v[100:103]
    v_mfma_f32_16x16x32_bf16 v[104:107], v[112:115], v[128:131], v[104:107]
    v_mfma_f32_16x16x32_bf16 v[108:111], v[116:119], v[128:131], v[108:111]
    s_waitcnt lgkmcnt(0)
    v_mfma_f32_16x16x32_bf16 v[88:91], v[40:43], v[32:35], v[88:91]
    v_mfma_f32_16x16x32_bf16 v[92:95], v[40:43], v[36:39], v[92:95]
    v_mfma_f32_16x16x32_bf16 v[96:99], v[44:47], v[32:35], v[96:99]
    v_mfma_f32_16x16x32_bf16 v[100:103], v[44:47], v[36:39], v[100:103]
    v_mfma_f32_16x16x32_bf16 v[104:107], v[32:35], v[48:51], v[104:107]
    v_mfma_f32_16x16x32_bf16 v[108:111], v[36:39], v[48:51], v[108:111]
    s_lshl_b32 s59, s55, 2
    s_add_u32 s59, s59, s48
    s_add_u32 s52, s56, 65536
    v_add_u32 v16, s52, v26
    v_xor_b32 v17, 64, v16
    v_add_u32 v18, 65536, v16
    v_add_u32 v19, 65536, v17
    v_mov_b32 v20, v27
    v_xor_b32 v21, 32, v20
    v_xor_b32 v22, 64, v20
    v_xor_b32 v23, 96, v20
    v_xor_b32 v24, 128, v20
    v_xor_b32 v25, 160, v20
    v_xor_b32 v26, 192, v20
    v_xor_b32 v27, 224, v20
    s_lshl_b32 s52, s98, 1
    s_add_u32 s52, s52, 0
    s_lshl_b32 s52, s52, 4
    s_add_u32 s52, s52, s99
    s_lshl_b32 s52, s52, 12
    s_add_u32 s52, s52, s51
    s_mov_b32 s54, 0x3eb8aa3b
    v_mul_f32 v88, s54, v88
    v_mul_f32 v89, s54, v89
    v_mul_f32 v90, s54, v90
    v_mul_f32 v91, s54, v91
    v_mul_f32 v92, s54, v92
    v_mul_f32 v93, s54, v93
    v_mul_f32 v94, s54, v94
    v_mul_f32 v95, s54, v95
    v_cvt_pk_bf16_f32 v32, v88, v89
    v_cvt_pk_bf16_f32 v33, v90, v91
    v_cvt_pk_bf16_f32 v34, v92, v93
    v_cvt_pk_bf16_f32 v35, v94, v95
    v_cvt_pk_bf16_f32 v36, v96, v97
    v_cvt_pk_bf16_f32 v37, v98, v99
    v_cvt_pk_bf16_f32 v38, v100, v101
    v_cvt_pk_bf16_f32 v39, v102, v103
    v_cvt_pk_bf16_f32 v40, v104, v105
    v_cvt_pk_bf16_f32 v41, v106, v107
    v_cvt_pk_bf16_f32 v42, v108, v109
    v_cvt_pk_bf16_f32 v43, v110, v111
    s_barrier
    ds_read_b128 v[120:123], v16 offset:0
    ds_read_b128 v[124:127], v17 offset:0
    ds_read_b128 v[128:131], v16 offset:2048
    ds_read_b128 v[132:135], v17 offset:2048
    ds_read_b64_tr_b16 v[88:89], v20 offset:0
    ds_read_b64_tr_b16 v[90:91], v20 offset:1024
    ds_read_b64_tr_b16 v[92:93], v20 offset:8192
    ds_read_b64_tr_b16 v[94:95], v20 offset:9216
    ds_read_b64_tr_b16 v[96:97], v21 offset:0
    ds_read_b64_tr_b16 v[98:99], v21 offset:1024
    ds_read_b64_tr_b16 v[100:101], v21 offset:8192
    ds_read_b64_tr_b16 v[102:103], v21 offset:9216
    ds_read_b64_tr_b16 v[104:105], v22 offset:0
    ds_read_b64_tr_b16 v[106:107], v22 offset:1024
    ds_read_b64_tr_b16 v[108:109], v22 offset:8192
    ds_read_b64_tr_b16 v[110:111], v22 offset:9216
    ds_read_b64_tr_b16 v[112:113], v23 offset:0
    ds_read_b64_tr_b16 v[114:115], v23 offset:1024
    ds_read_b64_tr_b16 v[116:117], v23 offset:8192
    ds_read_b64_tr_b16 v[118:119], v23 offset:9216
    s_mov_b32 s100, s52
    v_add_u32 v4, 98304, v1
    v_mov_b32 v30, s68
    v_mov_b32 v31, s69
    v_and_b32 v7, 15, v0
    v_lshlrev_b32 v9, 3, v7
    v_and_b32 v10, 8, v9
    s_bfe_u32 s70, s2, 0x40001
    s_lshl_b32 s70, s70, 7
    s_add_u32 s70, s70, 63967232
    s_lshl_b32 s71, s49, 7
    s_add_u32 s71, s71, 63963136
    s_lshl_b32 s52, s49, 19
    s_add_u32 s28, s26, s52
    s_addc_u32 s29, s27, 0
    s_add_u32 s52, s55, 1
    s_lshl_b32 s30, s52, 15
    s_mov_b32 s31, 0x20000
    s_add_u32 s8, s28, 16777216
    s_addc_u32 s9, s29, 0
    s_mov_b32 s10, s30
    s_mov_b32 s11, 0x20000
    s_waitcnt lgkmcnt(12)
    v_mfma_f32_16x16x32_bf16 v[184:187], v[88:91], v[120:123], 0
    s_add_u32 s54, s100, 57671680
    buffer_store_dwordx4 v[32:35], v1, s[44:47], s54 offen sc1
    v_mfma_f32_16x16x32_bf16 v[184:187], v[92:95], v[124:127], v[184:187]
    v_mfma_f32_16x16x32_bf16 v[216:219], v[88:91], v[128:131], 0
    v_mfma_f32_16x16x32_bf16 v[216:219], v[92:95], v[132:135], v[216:219]
    ds_read_b64_tr_b16 v[88:89], v24 offset:0
    s_waitcnt lgkmcnt(9)
    v_mfma_f32_16x16x32_bf16 v[188:191], v[96:99], v[120:123], 0
    ds_read_b64_tr_b16 v[90:91], v24 offset:1024
    s_cmp_lt_u32 s50, 2
    s_cbranch_scc0 m_c_g10
    s_add_u32 s54, s65, 9216
    buffer_store_dwordx4 v[148:151], v1, s[44:47], s54 offen sc1
m_c_g10:
    v_mfma_f32_16x16x32_bf16 v[188:191], v[100:103], v[124:127], v[188:191]
    ds_read_b64_tr_b16 v[92:93], v24 offset:8192
    v_mfma_f32_16x16x32_bf16 v[220:223], v[96:99], v[128:131], 0
    ds_read_b64_tr_b16 v[94:95], v24 offset:9216
    v_mfma_f32_16x16x32_bf16 v[220:223], v[100:103], v[132:135], v[220:223]
    ds_read_b64_tr_b16 v[96:97], v25 offset:0
    s_waitcnt lgkmcnt(9)
    v_mfma_f32_16x16x32_bf16 v[192:195], v[104:107], v[120:123], 0
    ds_read_b64_tr_b16 v[98:99], v25 offset:1024
    s_add_u32 s54, s100, 59768832
    buffer_store_dwordx4 v[36:39], v1, s[44:47], s54 offen sc1
    v_mfma_f32_16x16x32_bf16 v[192:195], v[108:111], v[124:127], v[192:195]
    ds_read_b64_tr_b16 v[100:101], v25 offset:8192
    v_mfma_f32_16x16x32_bf16 v[224:227], v[104:107], v[128:131], 0
    ds_read_b64_tr_b16 v[102:103], v25 offset:9216
    v_mfma_f32_16x16x32_bf16 v[224:227], v[108:111], v[132:135], v[224:227]
    ds_read_b64_tr_b16 v[104:105], v26 offset:0
    s_waitcnt lgkmcnt(9)
    v_mfma_f32_16x16x32_bf16 v[196:199], v[112:115], v[120:123], 0
    ds_read_b64_tr_b16 v[106:107], v26 offset:1024
    s_add_u32 s54, s100, 61865984
    buffer_store_dwordx4 v[40:43], v1, s[44:47], s54 offen sc1
    v_mfma_f32_16x16x32_bf16 v[196:199], v[116:119], v[124:127], v[196:199]
    ds_read_b64_tr_b16 v[108:109], v26 offset:8192
    v_mfma_f32_16x16x32_bf16 v[228:231], v[112:115], v[128:131], 0
    ds_read_b64_tr_b16 v[110:111], v26 offset:9216
    v_mfma_f32_16x16x32_bf16 v[228:231], v[116:119], v[132:135], v[228:231]
    ds_read_b64_tr_b16 v[112:113], v27 offset:0
    ds_read_b64_tr_b16 v[114:115], v27 offset:1024
    ds_read_b64_tr_b16 v[116:117], v27 offset:8192
    ds_read_b64_tr_b16 v[118:119], v27 offset:9216
    s_waitcnt lgkmcnt(12)
    v_mfma_f32_16x16x32_bf16 v[200:203], v[88:91], v[120:123], 0
    v_mfma_f32_16x16x32_bf16 v[200:203], v[92:95], v[124:127], v[200:203]
    v_mfma_f32_16x16x32_bf16 v[232:235], v[88:91], v[128:131], 0
    v_mfma_f32_16x16x32_bf16 v[232:235], v[92:95], v[132:135], v[232:235]
    s_waitcnt lgkmcnt(0)
    s_barrier
    ds_read_b64_tr_b16 v[88:89], v20 offset:16384
    v_mfma_f32_16x16x32_bf16 v[204:207], v[96:99], v[120:123], 0
    ds_read_b64_tr_b16 v[90:91], v20 offset:17408
    s_cmp_lt_u32 s50, 2
    s_cbranch_scc1 m_c_g11
    s_add_u32 s54, s64, 8192
    buffer_store_dwordx4 v[136:139], v1, s[44:47], s54 offen sc1
m_c_g11:
    v_mfma_f32_16x16x32_bf16 v[204:207], v[100:103], v[124:127], v[204:207]
    ds_read_b64_tr_b16 v[92:93], v20 offset:24576
    v_mfma_f32_16x16x32_bf16 v[236:239], v[96:99], v[128:131], 0
    ds_read_b64_tr_b16 v[94:95], v20 offset:25600
    ds_read_b128 v[44:47], v16 offset:32768
    v_mfma_f32_16x16x32_bf16 v[236:239], v[100:103], v[132:135], v[236:239]
    ds_read_b64_tr_b16 v[96:97], v21 offset:16384
    v_mfma_f32_16x16x32_bf16 v[208:211], v[104:107], v[120:123], 0
    ds_read_b64_tr_b16 v[98:99], v21 offset:17408
    ds_read_b128 v[48:51], v17 offset:32768
    v_mfma_f32_16x16x32_bf16 v[208:211], v[108:111], v[124:127], v[208:211]
    ds_read_b64_tr_b16 v[100:101], v21 offset:24576
    v_mfma_f32_16x16x32_bf16 v[240:243], v[104:107], v[128:131], 0
    ds_read_b64_tr_b16 v[102:103], v21 offset:25600
    ds_read_b128 v[52:55], v16 offset:34816
    s_cmp_lt_u32 s50, 2
    s_cbranch_scc0 m_c_g12
    s_add_u32 s54, s64, 16384
    buffer_store_dwordx4 v[152:155], v1, s[44:47], s54 offen sc1
m_c_g12:
    v_mfma_f32_16x16x32_bf16 v[240:243], v[108:111], v[132:135], v[240:243]
    ds_read_b64_tr_b16 v[104:105], v22 offset:16384
    v_mfma_f32_16x16x32_bf16 v[212:215], v[112:115], v[120:123], 0
    ds_read_b64_tr_b16 v[106:107], v22 offset:17408
    ds_read_b128 v[56:59], v17 offset:34816
    v_mfma_f32_16x16x32_bf16 v[212:215], v[116:119], v[124:127], v[212:215]
    ds_read_b64_tr_b16 v[108:109], v22 offset:24576
    v_mfma_f32_16x16x32_bf16 v[244:247], v[112:115], v[128:131], 0
    ds_read_b64_tr_b16 v[110:111], v22 offset:25600
    v_mfma_f32_16x16x32_bf16 v[244:247], v[116:119], v[132:135], v[244:247]
    ds_read_b64_tr_b16 v[112:113], v23 offset:16384
    s_waitcnt lgkmcnt(3)
    v_mfma_f32_16x16x32_bf16 v[184:187], v[88:91], v[44:47], v[184:187]
    ds_read_b64_tr_b16 v[114:115], v23 offset:17408
    s_cmp_lt_u32 s50, 2
    s_cbranch_scc1 m_c_g13
    s_add_u32 s54, s64, 12288
    buffer_store_dwordx4 v[140:143], v1, s[44:47], s54 offen sc1
m_c_g13:
    v_mfma_f32_16x16x32_bf16 v[184:187], v[92:95], v[48:51], v[184:187]
    ds_read_b64_tr_b16 v[116:117], v23 offset:24576
    v_mfma_f32_16x16x32_bf16 v[216:219], v[88:91], v[52:55], v[216:219]
    ds_read_b64_tr_b16 v[118:119], v23 offset:25600
    v_mfma_f32_16x16x32_bf16 v[216:219], v[92:95], v[56:59], v[216:219]
    ds_read_b64_tr_b16 v[88:89], v24 offset:16384
    v_mfma_f32_16x16x32_bf16 v[188:191], v[96:99], v[44:47], v[188:191]
    ds_read_b64_tr_b16 v[90:91], v24 offset:17408
    v_mfma_f32_16x16x32_bf16 v[188:191], v[100:103], v[48:51], v[188:191]
    ds_read_b64_tr_b16 v[92:93], v24 offset:24576
    v_mfma_f32_16x16x32_bf16 v[220:223], v[96:99], v[52:55], v[220:223]
    ds_read_b64_tr_b16 v[94:95], v24 offset:25600
    v_mfma_f32_16x16x32_bf16 v[220:223], v[100:103], v[56:59], v[220:223]
    ds_read_b64_tr_b16 v[96:97], v25 offset:16384
    s_waitcnt lgkmcnt(9)
    v_mfma_f32_16x16x32_bf16 v[192:195], v[104:107], v[44:47], v[192:195]
    ds_read_b64_tr_b16 v[98:99], v25 offset:17408
    s_cmp_lt_u32 s50, 2
    s_cbranch_scc0 m_c_g14
    s_add_u32 s54, s64, 20480
    buffer_store_dwordx4 v[156:159], v1, s[44:47], s54 offen sc1
m_c_g14:
    v_mfma_f32_16x16x32_bf16 v[192:195], v[108:111], v[48:51], v[192:195]
    ds_read_b64_tr_b16 v[100:101], v25 offset:24576
    v_mfma_f32_16x16x32_bf16 v[224:227], v[104:107], v[52:55], v[224:227]
    ds_read_b64_tr_b16 v[102:103], v25 offset:25600
    v_mfma_f32_16x16x32_bf16 v[224:227], v[108:111], v[56:59], v[224:227]
    ds_read_b64_tr_b16 v[104:105], v26 offset:16384
    s_waitcnt lgkmcnt(9)
    v_mfma_f32_16x16x32_bf16 v[196:199], v[112:115], v[44:47], v[196:199]
    ds_read_b64_tr_b16 v[106:107], v26 offset:17408
    v_mfma_f32_16x16x32_bf16 v[196:199], v[116:119], v[48:51], v[196:199]
    ds_read_b64_tr_b16 v[108:109], v26 offset:24576
    v_mfma_f32_16x16x32_bf16 v[228:231], v[112:115], v[52:55], v[228:231]
    ds_read_b64_tr_b16 v[110:111], v26 offset:25600
    v_mfma_f32_16x16x32_bf16 v[228:231], v[116:119], v[56:59], v[228:231]
    ds_read_b64_tr_b16 v[112:113], v27 offset:16384
    ds_read_b64_tr_b16 v[114:115], v27 offset:17408
    ds_read_b64_tr_b16 v[116:117], v27 offset:24576
    ds_read_b64_tr_b16 v[118:119], v27 offset:25600
    s_waitcnt lgkmcnt(12)
    v_mfma_f32_16x16x32_bf16 v[200:203], v[88:91], v[44:47], v[200:203]
    v_mfma_f32_16x16x32_bf16 v[200:203], v[92:95], v[48:51], v[200:203]
    v_mfma_f32_16x16x32_bf16 v[232:235], v[88:91], v[52:55], v[232:235]
    v_mfma_f32_16x16x32_bf16 v[232:235], v[92:95], v[56:59], v[232:235]
    s_waitcnt lgkmcnt(0)
    s_barrier
    ds_read_b64_tr_b16 v[88:89], v20 offset:32768
    v_mfma_f32_16x16x32_bf16 v[204:207], v[96:99], v[44:47], v[204:207]
    ds_read_b64_tr_b16 v[90:91], v20 offset:33792
    s_cmp_lt_u32 s50, 2
    s_cbranch_scc1 m_c_g15
    s_add_u32 s54, s65, 8192
    buffer_store_dwordx4 v[144:147], v1, s[44:47], s54 offen sc1
m_c_g15:
    v_mfma_f32_16x16x32_bf16 v[204:207], v[100:103], v[48:51], v[204:207]
    ds_read_b64_tr_b16 v[92:93], v20 offset:40960
    v_mfma_f32_16x16x32_bf16 v[236:239], v[96:99], v[52:55], v[236:239]
    ds_read_b64_tr_b16 v[94:95], v20 offset:41984
    ds_read_b128 v[120:123], v18 offset:0
    v_mfma_f32_16x16x32_bf16 v[236:239], v[100:103], v[56:59], v[236:239]
    ds_read_b64_tr_b16 v[96:97], v21 offset:32768
    v_mfma_f32_16x16x32_bf16 v[208:211], v[104:107], v[44:47], v[208:211]
    ds_read_b64_tr_b16 v[98:99], v21 offset:33792
    ds_read_b128 v[124:127], v19 offset:0
    v_mfma_f32_16x16x32_bf16 v[208:211], v[108:111], v[48:51], v[208:211]
    ds_read_b64_tr_b16 v[100:101], v21 offset:40960
    v_mfma_f32_16x16x32_bf16 v[240:243], v[104:107], v[52:55], v[240:243]
    ds_read_b64_tr_b16 v[102:103], v21 offset:41984
    ds_read_b128 v[128:131], v18 offset:2048
    s_cmp_lt_u32 s50, 2
    s_cbranch_scc0 m_c_g16
    s_add_u32 s54, s65, 16384
    buffer_store_dwordx4 v[160:163], v1, s[44:47], s54 offen sc1
m_c_g16:
    v_mfma_f32_16x16x32_bf16 v[240:243], v[108:111], v[56:59], v[240:243]
    ds_read_b64_tr_b16 v[104:105], v22 offset:32768
    v_mfma_f32_16x16x32_bf16 v[212:215], v[112:115], v[44:47], v[212:215]
    ds_read_b64_tr_b16 v[106:107], v22 offset:33792
    ds_read_b128 v[132:135], v19 offset:2048
    v_mfma_f32_16x16x32_bf16 v[212:215], v[116:119], v[48:51], v[212:215]
    ds_read_b64_tr_b16 v[108:109], v22 offset:40960
    v_mfma_f32_16x16x32_bf16 v[244:247], v[112:115], v[52:55], v[244:247]
    ds_read_b64_tr_b16 v[110:111], v22 offset:41984
    v_mfma_f32_16x16x32_bf16 v[244:247], v[116:119], v[56:59], v[244:247]
    ds_read_b64_tr_b16 v[112:113], v23 offset:32768
    s_waitcnt lgkmcnt(3)
    v_mfma_f32_16x16x32_bf16 v[184:187], v[88:91], v[120:123], v[184:187]
    ds_read_b64_tr_b16 v[114:115], v23 offset:33792
    s_cmp_lt_u32 s50, 2
    s_cbranch_scc1 m_c_g17
    s_add_u32 s54, s65, 9216
    buffer_store_dwordx4 v[148:151], v1, s[44:47], s54 offen sc1
m_c_g17:
    v_mfma_f32_16x16x32_bf16 v[184:187], v[92:95], v[124:127], v[184:187]
    ds_read_b64_tr_b16 v[116:117], v23 offset:40960
    v_mfma_f32_16x16x32_bf16 v[216:219], v[88:91], v[128:131], v[216:219]
    ds_read_b64_tr_b16 v[118:119], v23 offset:41984
    v_mfma_f32_16x16x32_bf16 v[216:219], v[92:95], v[132:135], v[216:219]
    ds_read_b64_tr_b16 v[88:89], v24 offset:32768
    v_mfma_f32_16x16x32_bf16 v[188:191], v[96:99], v[120:123], v[188:191]
    ds_read_b64_tr_b16 v[90:91], v24 offset:33792
    v_mfma_f32_16x16x32_bf16 v[188:191], v[100:103], v[124:127], v[188:191]
    ds_read_b64_tr_b16 v[92:93], v24 offset:40960
    v_mfma_f32_16x16x32_bf16 v[220:223], v[96:99], v[128:131], v[220:223]
    ds_read_b64_tr_b16 v[94:95], v24 offset:41984
    v_mfma_f32_16x16x32_bf16 v[220:223], v[100:103], v[132:135], v[220:223]
    ds_read_b64_tr_b16 v[96:97], v25 offset:32768
    s_waitcnt lgkmcnt(9)
    v_mfma_f32_16x16x32_bf16 v[192:195], v[104:107], v[120:123], v[192:195]
    ds_read_b64_tr_b16 v[98:99], v25 offset:33792
    s_cmp_lt_u32 s50, 2
    s_cbranch_scc0 m_c_g18
    s_add_u32 s54, s65, 17408
    buffer_store_dwordx4 v[164:167], v1, s[44:47], s54 offen sc1
m_c_g18:
    v_mfma_f32_16x16x32_bf16 v[192:195], v[108:111], v[124:127], v[192:195]
    ds_read_b64_tr_b16 v[100:101], v25 offset:40960
    v_mfma_f32_16x16x32_bf16 v[224:227], v[104:107], v[128:131], v[224:227]
    ds_read_b64_tr_b16 v[102:103], v25 offset:41984
    v_mfma_f32_16x16x32_bf16 v[224:227], v[108:111], v[132:135], v[224:227]
    ds_read_b64_tr_b16 v[104:105], v26 offset:32768
    s_waitcnt lgkmcnt(9)
    v_mfma_f32_16x16x32_bf16 v[196:199], v[112:115], v[120:123], v[196:199]
    ds_read_b64_tr_b16 v[106:107], v26 offset:33792
    v_mfma_f32_16x16x32_bf16 v[196:199], v[116:119], v[124:127], v[196:199]
    ds_read_b64_tr_b16 v[108:109], v26 offset:40960
    v_mfma_f32_16x16x32_bf16 v[228:231], v[112:115], v[128:131], v[228:231]
    ds_read_b64_tr_b16 v[110:111], v26 offset:41984
    v_mfma_f32_16x16x32_bf16 v[228:231], v[116:119], v[132:135], v[228:231]
    ds_read_b64_tr_b16 v[112:113], v27 offset:32768
    ds_read_b64_tr_b16 v[114:115], v27 offset:33792
    ds_read_b64_tr_b16 v[116:117], v27 offset:40960
    ds_read_b64_tr_b16 v[118:119], v27 offset:41984
    s_waitcnt lgkmcnt(12)
    v_mfma_f32_16x16x32_bf16 v[200:203], v[88:91], v[120:123], v[200:203]
    v_mfma_f32_16x16x32_bf16 v[200:203], v[92:95], v[124:127], v[200:203]
    v_mfma_f32_16x16x32_bf16 v[232:235], v[88:91], v[128:131], v[232:235]
    v_mfma_f32_16x16x32_bf16 v[232:235], v[92:95], v[132:135], v[232:235]
    s_waitcnt lgkmcnt(0)
    s_waitcnt vmcnt(0)
    s_barrier
    ds_read_b64_tr_b16 v[88:89], v20 offset:0
    v_mfma_f32_16x16x32_bf16 v[204:207], v[96:99], v[120:123], v[204:207]
    ds_read_b64_tr_b16 v[90:91], v20 offset:1024
    s_cmp_lt_u32 s50, 2
    s_cbranch_scc1 m_c_g19
    s_add_u32 s54, s64, 16384
    buffer_store_dwordx4 v[152:155], v1, s[44:47], s54 offen sc1
m_c_g19:
    v_mfma_f32_16x16x32_bf16 v[204:207], v[100:103], v[124:127], v[204:207]
    ds_read_b64_tr_b16 v[92:93], v20 offset:8192
    v_mfma_f32_16x16x32_bf16 v[236:239], v[96:99], v[128:131], v[236:239]
    ds_read_b64_tr_b16 v[94:95], v20 offset:9216
    ds_read_b128 v[44:47], v16 offset:0
    v_mfma_f32_16x16x32_bf16 v[236:239], v[100:103], v[132:135], v[236:239]
    ds_read_b64_tr_b16 v[96:97], v21 offset:0
    v_mfma_f32_16x16x32_bf16 v[208:211], v[104:107], v[120:123], v[208:211]
    ds_read_b64_tr_b16 v[98:99], v21 offset:1024
    ds_read_b128 v[48:51], v17 offset:0
    v_mfma_f32_16x16x32_bf16 v[208:211], v[108:111], v[124:127], v[208:211]
    ds_read_b64_tr_b16 v[100:101], v21 offset:8192
    v_mfma_f32_16x16x32_bf16 v[240:243], v[104:107], v[128:131], v[240:243]
    ds_read_b64_tr_b16 v[102:103], v21 offset:9216
    ds_read_b128 v[52:55], v16 offset:2048
    s_cmp_lt_u32 s50, 2
    s_cbranch_scc0 m_c_g20
    s_add_u32 s54, s64, 24576
    buffer_store_dwordx4 v[172:175], v1, s[44:47], s54 offen sc1
m_c_g20:
    v_mfma_f32_16x16x32_bf16 v[240:243], v[108:111], v[132:135], v[240:243]
    ds_read_b64_tr_b16 v[104:105], v22 offset:0
    v_mfma_f32_16x16x32_bf16 v[212:215], v[112:115], v[120:123], v[212:215]
    ds_read_b64_tr_b16 v[106:107], v22 offset:1024
    ds_read_b128 v[56:59], v17 offset:2048
    v_mfma_f32_16x16x32_bf16 v[212:215], v[116:119], v[124:127], v[212:215]
    ds_read_b64_tr_b16 v[108:109], v22 offset:8192
    v_mfma_f32_16x16x32_bf16 v[244:247], v[112:115], v[128:131], v[244:247]
    ds_read_b64_tr_b16 v[110:111], v22 offset:9216
    v_mfma_f32_16x16x32_bf16 v[244:247], v[116:119], v[132:135], v[244:247]
    ds_read_b64_tr_b16 v[112:113], v23 offset:0
    s_waitcnt lgkmcnt(3)
    v_mfma_f32_16x16x32_bf16 v[184:187], v[88:91], v[44:47], v[184:187]
    ds_read_b64_tr_b16 v[114:115], v23 offset:1024
    s_cmp_lt_u32 s50, 2
    s_cbranch_scc1 m_c_g21
    s_add_u32 s54, s64, 20480
    buffer_store_dwordx4 v[156:159], v1, s[44:47], s54 offen sc1
m_c_g21:
    v_mfma_f32_16x16x32_bf16 v[184:187], v[92:95], v[48:51], v[184:187]
    ds_read_b64_tr_b16 v[116:117], v23 offset:8192
    v_mfma_f32_16x16x32_bf16 v[216:219], v[88:91], v[52:55], v[216:219]
    ds_read_b64_tr_b16 v[118:119], v23 offset:9216
    v_mfma_f32_16x16x32_bf16 v[216:219], v[92:95], v[56:59], v[216:219]
    ds_read_b64_tr_b16 v[88:89], v24 offset:0
    v_mfma_f32_16x16x32_bf16 v[188:191], v[96:99], v[44:47], v[188:191]
    ds_read_b64_tr_b16 v[90:91], v24 offset:1024
    v_mfma_f32_16x16x32_bf16 v[188:191], v[100:103], v[48:51], v[188:191]
    ds_read_b64_tr_b16 v[92:93], v24 offset:8192
    s_cmp_lt_u32 s50, 2
    s_cbranch_scc0 m_c_g22
    s_add_u32 s54, s64, 28672
    buffer_store_dwordx4 v[176:179], v1, s[44:47], s54 offen sc1
m_c_g22:
    v_mfma_f32_16x16x32_bf16 v[220:223], v[96:99], v[52:55], v[220:223]
    ds_read_b64_tr_b16 v[94:95], v24 offset:9216
    v_mfma_f32_16x16x32_bf16 v[220:223], v[100:103], v[56:59], v[220:223]
    ds_read_b64_tr_b16 v[96:97], v25 offset:0
    s_waitcnt lgkmcnt(9)
    v_mfma_f32_16x16x32_bf16 v[192:195], v[104:107], v[44:47], v[192:195]
    ds_read_b64_tr_b16 v[98:99], v25 offset:1024
    v_mfma_f32_16x16x32_bf16 v[192:195], v[108:111], v[48:51], v[192:195]
    ds_read_b64_tr_b16 v[100:101], v25 offset:8192
    v_mfma_f32_16x16x32_bf16 v[224:227], v[104:107], v[52:55], v[224:227]
    ds_read_b64_tr_b16 v[102:103], v25 offset:9216
    s_cmp_lg_u32 s48, 0
    s_cbranch_scc1 m_c_sigb
    s_lshl_b32 s52, s98, 4
    s_add_u32 s52, s52, s99
    s_lshl_b32 s52, s52, 3
    s_add_u32 s52, s52, 63967232
    s_mov_b64 exec, 1
    buffer_store_dwordx2 v[30:31], off, s[44:47], s52 sc1
    s_mov_b64 exec, -1
m_c_sigb:
    v_mfma_f32_16x16x32_bf16 v[224:227], v[108:111], v[56:59], v[224:227]
    ds_read_b64_tr_b16 v[104:105], v26 offset:0
    s_waitcnt lgkmcnt(9)
    v_mfma_f32_16x16x32_bf16 v[196:199], v[112:115], v[44:47], v[196:199]
    ds_read_b64_tr_b16 v[106:107], v26 offset:1024
    v_mfma_f32_16x16x32_bf16 v[196:199], v[116:119], v[48:51], v[196:199]
    ds_read_b64_tr_b16 v[108:109], v26 offset:8192
    v_mfma_f32_16x16x32_bf16 v[228:231], v[112:115], v[52:55], v[228:231]
    ds_read_b64_tr_b16 v[110:111], v26 offset:9216
    v_mfma_f32_16x16x32_bf16 v[228:231], v[116:119], v[56:59], v[228:231]
    ds_read_b64_tr_b16 v[112:113], v27 offset:0
    ds_read_b64_tr_b16 v[114:115], v27 offset:1024
    ds_read_b64_tr_b16 v[116:117], v27 offset:8192
    ds_read_b64_tr_b16 v[118:119], v27 offset:9216
    s_waitcnt lgkmcnt(12)
    v_mfma_f32_16x16x32_bf16 v[200:203], v[88:91], v[44:47], v[200:203]
    v_mfma_f32_16x16x32_bf16 v[200:203], v[92:95], v[48:51], v[200:203]
    v_mfma_f32_16x16x32_bf16 v[232:235], v[88:91], v[52:55], v[232:235]
    v_mfma_f32_16x16x32_bf16 v[232:235], v[92:95], v[56:59], v[232:235]
    s_waitcnt lgkmcnt(0)
    s_barrier
    ds_read_b64_tr_b16 v[88:89], v20 offset:16384
    v_mfma_f32_16x16x32_bf16 v[204:207], v[96:99], v[44:47], v[204:207]
    ds_read_b64_tr_b16 v[90:91], v20 offset:17408
    s_cmp_lt_u32 s50, 2
    s_cbranch_scc1 m_c_g23
    s_add_u32 s54, s65, 16384
    buffer_store_dwordx4 v[160:163], v1, s[44:47], s54 offen sc1
m_c_g23:
    v_mfma_f32_16x16x32_bf16 v[204:207], v[100:103], v[48:51], v[204:207]
    ds_read_b64_tr_b16 v[92:93], v20 offset:24576
    v_mfma_f32_16x16x32_bf16 v[236:239], v[96:99], v[52:55], v[236:239]
    ds_read_b64_tr_b16 v[94:95], v20 offset:25600
    ds_read_b128 v[120:123], v16 offset:32768
    v_mfma_f32_16x16x32_bf16 v[236:239], v[100:103], v[56:59], v[236:239]
    ds_read_b64_tr_b16 v[96:97], v21 offset:16384
    v_mfma_f32_16x16x32_bf16 v[208:211], v[104:107], v[44:47], v[208:211]
    ds_read_b64_tr_b16 v[98:99], v21 offset:17408
    ds_read_b128 v[124:127], v17 offset:32768
    v_mfma_f32_16x16x32_bf16 v[208:211], v[108:111], v[48:51], v[208:211]
    ds_read_b64_tr_b16 v[100:101], v21 offset:24576
    v_mfma_f32_16x16x32_bf16 v[240:243], v[104:107], v[52:55], v[240:243]
    ds_read_b64_tr_b16 v[102:103], v21 offset:25600
    ds_read_b128 v[128:131], v16 offset:34816
    s_cmp_lt_u32 s50, 2
    s_cbranch_scc0 m_c_g24
    s_add_u32 s54, s65, 24576
    buffer_store_dwordx4 v[180:183], v1, s[44:47], s54 offen sc1
m_c_g24:
    v_mfma_f32_16x16x32_bf16 v[240:243], v[108:111], v[56:59], v[240:243]
    ds_read_b64_tr_b16 v[104:105], v22 offset:16384
    v_mfma_f32_16x16x32_bf16 v[212:215], v[112:115], v[44:47], v[212:215]
    ds_read_b64_tr_b16 v[106:107], v22 offset:17408
    ds_read_b128 v[132:135], v17 offset:34816
    v_mfma_f32_16x16x32_bf16 v[212:215], v[116:119], v[48:51], v[212:215]
    ds_read_b64_tr_b16 v[108:109], v22 offset:24576
    v_mfma_f32_16x16x32_bf16 v[244:247], v[112:115], v[52:55], v[244:247]
    ds_read_b64_tr_b16 v[110:111], v22 offset:25600
    v_mfma_f32_16x16x32_bf16 v[244:247], v[116:119], v[56:59], v[244:247]
    ds_read_b64_tr_b16 v[112:113], v23 offset:16384
    s_waitcnt lgkmcnt(3)
    v_mfma_f32_16x16x32_bf16 v[184:187], v[88:91], v[120:123], v[184:187]
    ds_read_b64_tr_b16 v[114:115], v23 offset:17408
    s_cmp_lt_u32 s50, 2
    s_cbranch_scc1 m_c_g25
    s_add_u32 s54, s65, 17408
    buffer_store_dwordx4 v[164:167], v1, s[44:47], s54 offen sc1
m_c_g25:
    v_mfma_f32_16x16x32_bf16 v[184:187], v[92:95], v[124:127], v[184:187]
    ds_read_b64_tr_b16 v[116:117], v23 offset:24576
    v_mfma_f32_16x16x32_bf16 v[216:219], v[88:91], v[128:131], v[216:219]
    ds_read_b64_tr_b16 v[118:119], v23 offset:25600
    v_mfma_f32_16x16x32_bf16 v[216:219], v[92:95], v[132:135], v[216:219]
    ds_read_b64_tr_b16 v[88:89], v24 offset:16384
    v_mfma_f32_16x16x32_bf16 v[188:191], v[96:99], v[120:123], v[188:191]
    ds_read_b64_tr_b16 v[90:91], v24 offset:17408
    v_mfma_f32_16x16x32_bf16 v[188:191], v[100:103], v[124:127], v[188:191]
    ds_read_b64_tr_b16 v[92:93], v24 offset:24576
    v_mfma_f32_16x16x32_bf16 v[220:223], v[96:99], v[128:131], v[220:223]
    ds_read_b64_tr_b16 v[94:95], v24 offset:25600
    v_mfma_f32_16x16x32_bf16 v[220:223], v[100:103], v[132:135], v[220:223]
    ds_read_b64_tr_b16 v[96:97], v25 offset:16384
    s_waitcnt lgkmcnt(9)
    v_mfma_f32_16x16x32_bf16 v[192:195], v[104:107], v[120:123], v[192:195]
    ds_read_b64_tr_b16 v[98:99], v25 offset:17408
    s_cmp_lt_u32 s50, 2
    s_cbranch_scc0 m_c_g26
    s_add_u32 s54, s65, 25600
    buffer_store_dwordx4 v[248:251], v1, s[44:47], s54 offen sc1
m_c_g26:
    v_mfma_f32_16x16x32_bf16 v[192:195], v[108:111], v[124:127], v[192:195]
    ds_read_b64_tr_b16 v[100:101], v25 offset:24576
    v_mfma_f32_16x16x32_bf16 v[224:227], v[104:107], v[128:131], v[224:227]
    ds_read_b64_tr_b16 v[102:103], v25 offset:25600
    v_mfma_f32_16x16x32_bf16 v[224:227], v[108:111], v[132:135], v[224:227]
    ds_read_b64_tr_b16 v[104:105], v26 offset:16384
    s_waitcnt lgkmcnt(9)
    v_mfma_f32_16x16x32_bf16 v[196:199], v[112:115], v[120:123], v[196:199]
    ds_read_b64_tr_b16 v[106:107], v26 offset:17408
    v_mfma_f32_16x16x32_bf16 v[196:199], v[116:119], v[124:127], v[196:199]
    ds_read_b64_tr_b16 v[108:109], v26 offset:24576
    v_mfma_f32_16x16x32_bf16 v[228:231], v[112:115], v[128:131], v[228:231]
    ds_read_b64_tr_b16 v[110:111], v26 offset:25600
    v_mfma_f32_16x16x32_bf16 v[228:231], v[116:119], v[132:135], v[228:231]
    ds_read_b64_tr_b16 v[112:113], v27 offset:16384
    ds_read_b64_tr_b16 v[114:115], v27 offset:17408
    ds_read_b64_tr_b16 v[116:117], v27 offset:24576
    ds_read_b64_tr_b16 v[118:119], v27 offset:25600
    s_waitcnt lgkmcnt(12)
    v_mfma_f32_16x16x32_bf16 v[200:203], v[88:91], v[120:123], v[200:203]
    v_mfma_f32_16x16x32_bf16 v[200:203], v[92:95], v[124:127], v[200:203]
    v_mfma_f32_16x16x32_bf16 v[232:235], v[88:91], v[128:131], v[232:235]
    v_mfma_f32_16x16x32_bf16 v[232:235], v[92:95], v[132:135], v[232:235]
    s_waitcnt lgkmcnt(0)
    s_barrier
    ds_read_b64_tr_b16 v[88:89], v20 offset:32768
    v_mfma_f32_16x16x32_bf16 v[204:207], v[96:99], v[120:123], v[204:207]
    ds_read_b64_tr_b16 v[90:91], v20 offset:33792
    s_cmp_lt_u32 s50, 2
    s_cbranch_scc1 m_c_g27
    s_add_u32 s54, s64, 24576
    buffer_store_dwordx4 v[172:175], v1, s[44:47], s54 offen sc1
m_c_g27:
    v_mfma_f32_16x16x32_bf16 v[204:207], v[100:103], v[124:127], v[204:207]
    ds_read_b64_tr_b16 v[92:93], v20 offset:40960
    v_mfma_f32_16x16x32_bf16 v[236:239], v[96:99], v[128:131], v[236:239]
    ds_read_b64_tr_b16 v[94:95], v20 offset:41984
    ds_read_b128 v[44:47], v18 offset:0
    v_mfma_f32_16x16x32_bf16 v[236:239], v[100:103], v[132:135], v[236:239]
    ds_read_b64_tr_b16 v[96:97], v21 offset:32768
    v_mfma_f32_16x16x32_bf16 v[208:211], v[104:107], v[120:123], v[208:211]
    ds_read_b64_tr_b16 v[98:99], v21 offset:33792
    ds_read_b128 v[48:51], v19 offset:0
    v_mfma_f32_16x16x32_bf16 v[208:211], v[108:111], v[124:127], v[208:211]
    ds_read_b64_tr_b16 v[100:101], v21 offset:40960
    v_mfma_f32_16x16x32_bf16 v[240:243], v[104:107], v[128:131], v[240:243]
    ds_read_b64_tr_b16 v[102:103], v21 offset:41984
    ds_read_b128 v[52:55], v18 offset:2048
    v_mfma_f32_16x16x32_bf16 v[240:243], v[108:111], v[132:135], v[240:243]
    ds_read_b64_tr_b16 v[104:105], v22 offset:32768
    v_mfma_f32_16x16x32_bf16 v[212:215], v[112:115], v[120:123], v[212:215]
    ds_read_b64_tr_b16 v[106:107], v22 offset:33792
    ds_read_b128 v[56:59], v19 offset:2048
    v_mfma_f32_16x16x32_bf16 v[212:215], v[116:119], v[124:127], v[212:215]
    ds_read_b64_tr_b16 v[108:109], v22 offset:40960
    v_mfma_f32_16x16x32_bf16 v[244:247], v[112:115], v[128:131], v[244:247]
    ds_read_b64_tr_b16 v[110:111], v22 offset:41984
    v_mfma_f32_16x16x32_bf16 v[244:247], v[116:119], v[132:135], v[244:247]
    ds_read_b64_tr_b16 v[112:113], v23 offset:32768
    s_waitcnt lgkmcnt(3)
    v_mfma_f32_16x16x32_bf16 v[184:187], v[88:91], v[44:47], v[184:187]
    ds_read_b64_tr_b16 v[114:115], v23 offset:33792
    s_cmp_lt_u32 s50, 2
    s_cbranch_scc1 m_c_g28
    s_add_u32 s54, s64, 28672
    buffer_store_dwordx4 v[176:179], v1, s[44:47], s54 offen sc1
m_c_g28:
    v_mfma_f32_16x16x32_bf16 v[184:187], v[92:95], v[48:51], v[184:187]
    ds_read_b64_tr_b16 v[116:117], v23 offset:40960
    v_mfma_f32_16x16x32_bf16 v[216:219], v[88:91], v[52:55], v[216:219]
    ds_read_b64_tr_b16 v[118:119], v23 offset:41984
    v_mfma_f32_16x16x32_bf16 v[216:219], v[92:95], v[56:59], v[216:219]
    ds_read_b64_tr_b16 v[88:89], v24 offset:32768
    v_mfma_f32_16x16x32_bf16 v[188:191], v[96:99], v[44:47], v[188:191]
    ds_read_b64_tr_b16 v[90:91], v24 offset:33792
    v_mfma_f32_16x16x32_bf16 v[188:191], v[100:103], v[48:51], v[188:191]
    ds_read_b64_tr_b16 v[92:93], v24 offset:40960
    v_mfma_f32_16x16x32_bf16 v[220:223], v[96:99], v[52:55], v[220:223]
    ds_read_b64_tr_b16 v[94:95], v24 offset:41984
    v_mfma_f32_16x16x32_bf16 v[220:223], v[100:103], v[56:59], v[220:223]
    ds_read_b64_tr_b16 v[96:97], v25 offset:32768
    s_waitcnt lgkmcnt(9)
    v_mfma_f32_16x16x32_bf16 v[192:195], v[104:107], v[44:47], v[192:195]
    ds_read_b64_tr_b16 v[98:99], v25 offset:33792
    v_mfma_f32_16x16x32_bf16 v[192:195], v[108:111], v[48:51], v[192:195]
    ds_read_b64_tr_b16 v[100:101], v25 offset:40960
    v_mfma_f32_16x16x32_bf16 v[224:227], v[104:107], v[52:55], v[224:227]
    ds_read_b64_tr_b16 v[102:103], v25 offset:41984
    v_mfma_f32_16x16x32_bf16 v[224:227], v[108:111], v[56:59], v[224:227]
    ds_read_b64_tr_b16 v[104:105], v26 offset:32768
    s_waitcnt lgkmcnt(9)
    v_mfma_f32_16x16x32_bf16 v[196:199], v[112:115], v[44:47], v[196:199]
    ds_read_b64_tr_b16 v[106:107], v26 offset:33792
    v_mfma_f32_16x16x32_bf16 v[196:199], v[116:119], v[48:51], v[196:199]
    ds_read_b64_tr_b16 v[108:109], v26 offset:40960
    v_mfma_f32_16x16x32_bf16 v[228:231], v[112:115], v[52:55], v[228:231]
    ds_read_b64_tr_b16 v[110:111], v26 offset:41984
    v_mfma_f32_16x16x32_bf16 v[228:231], v[116:119], v[56:59], v[228:231]
    ds_read_b64_tr_b16 v[112:113], v27 offset:32768
    ds_read_b64_tr_b16 v[114:115], v27 offset:33792
    ds_read_b64_tr_b16 v[116:117], v27 offset:40960
    ds_read_b64_tr_b16 v[118:119], v27 offset:41984
    s_waitcnt lgkmcnt(12)
    v_mfma_f32_16x16x32_bf16 v[200:203], v[88:91], v[44:47], v[200:203]
    v_mfma_f32_16x16x32_bf16 v[200:203], v[92:95], v[48:51], v[200:203]
    v_mfma_f32_16x16x32_bf16 v[232:235], v[88:91], v[52:55], v[232:235]
    v_mfma_f32_16x16x32_bf16 v[232:235], v[92:95], v[56:59], v[232:235]
    s_waitcnt lgkmcnt(0)
    s_waitcnt vmcnt(0)
    s_barrier
    ds_read_b64_tr_b16 v[88:89], v20 offset:0
    v_mfma_f32_16x16x32_bf16 v[204:207], v[96:99], v[44:47], v[204:207]
    ds_read_b64_tr_b16 v[90:91], v20 offset:1024
    s_cmp_lt_u32 s50, 2
    s_cbranch_scc1 m_c_g30
    s_add_u32 s54, s65, 24576
    buffer_store_dwordx4 v[180:183], v1, s[44:47], s54 offen sc1
m_c_g30:
    v_mfma_f32_16x16x32_bf16 v[204:207], v[100:103], v[48:51], v[204:207]
    ds_read_b64_tr_b16 v[92:93], v20 offset:8192
    v_mfma_f32_16x16x32_bf16 v[236:239], v[96:99], v[52:55], v[236:239]
    ds_read_b64_tr_b16 v[94:95], v20 offset:9216
    ds_read_b128 v[120:123], v16 offset:0
    v_mfma_f32_16x16x32_bf16 v[236:239], v[100:103], v[56:59], v[236:239]
    ds_read_b64_tr_b16 v[96:97], v21 offset:0
    v_mfma_f32_16x16x32_bf16 v[208:211], v[104:107], v[44:47], v[208:211]
    ds_read_b64_tr_b16 v[98:99], v21 offset:1024
    ds_read_b128 v[124:127], v17 offset:0
    v_mfma_f32_16x16x32_bf16 v[208:211], v[108:111], v[48:51], v[208:211]
    ds_read_b64_tr_b16 v[100:101], v21 offset:8192
    v_mfma_f32_16x16x32_bf16 v[240:243], v[104:107], v[52:55], v[240:243]
    ds_read_b64_tr_b16 v[102:103], v21 offset:9216
    ds_read_b128 v[128:131], v16 offset:2048
    v_mfma_f32_16x16x32_bf16 v[240:243], v[108:111], v[56:59], v[240:243]
    ds_read_b64_tr_b16 v[104:105], v22 offset:0
    v_mfma_f32_16x16x32_bf16 v[212:215], v[112:115], v[44:47], v[212:215]
    ds_read_b64_tr_b16 v[106:107], v22 offset:1024
    ds_read_b128 v[132:135], v17 offset:2048
    v_mfma_f32_16x16x32_bf16 v[212:215], v[116:119], v[48:51], v[212:215]
    ds_read_b64_tr_b16 v[108:109], v22 offset:8192
    v_mfma_f32_16x16x32_bf16 v[244:247], v[112:115], v[52:55], v[244:247]
    ds_read_b64_tr_b16 v[110:111], v22 offset:9216
    v_mfma_f32_16x16x32_bf16 v[244:247], v[116:119], v[56:59], v[244:247]
    ds_read_b64_tr_b16 v[112:113], v23 offset:0
    s_waitcnt lgkmcnt(3)
    v_mfma_f32_16x16x32_bf16 v[184:187], v[88:91], v[120:123], v[184:187]
    ds_read_b64_tr_b16 v[114:115], v23 offset:1024
    s_cmp_lt_u32 s50, 2
    s_cbranch_scc0 m_c_g29
    s_cmp_lg_u32 s48, 0
    s_cbranch_scc1 m_c_sigk
    s_lshl_b32 s52, s50, 3
    s_add_u32 s52, s52, s71
    s_mov_b64 exec, 1
    buffer_store_dwordx2 v[30:31], off, s[44:47], s52 sc1
    s_mov_b64 exec, -1
m_c_sigk:
m_c_g29:
    v_mfma_f32_16x16x32_bf16 v[184:187], v[92:95], v[124:127], v[184:187]
    ds_read_b64_tr_b16 v[116:117], v23 offset:8192
    v_mfma_f32_16x16x32_bf16 v[216:219], v[88:91], v[128:131], v[216:219]
    ds_read_b64_tr_b16 v[118:119], v23 offset:9216
    v_mfma_f32_16x16x32_bf16 v[216:219], v[92:95], v[132:135], v[216:219]
    ds_read_b64_tr_b16 v[88:89], v24 offset:0
    v_mfma_f32_16x16x32_bf16 v[188:191], v[96:99], v[120:123], v[188:191]
    ds_read_b64_tr_b16 v[90:91], v24 offset:1024
    v_mfma_f32_16x16x32_bf16 v[188:191], v[100:103], v[124:127], v[188:191]
    ds_read_b64_tr_b16 v[92:93], v24 offset:8192
    s_cmp_lt_u32 s50, 2
    s_cbranch_scc1 m_c_g31
    s_add_u32 s54, s65, 25600
    buffer_store_dwordx4 v[248:251], v1, s[44:47], s54 offen sc1
m_c_g31:
    v_mfma_f32_16x16x32_bf16 v[220:223], v[96:99], v[128:131], v[220:223]
    ds_read_b64_tr_b16 v[94:95], v24 offset:9216
    v_mfma_f32_16x16x32_bf16 v[220:223], v[100:103], v[132:135], v[220:223]
    ds_read_b64_tr_b16 v[96:97], v25 offset:0
    s_waitcnt lgkmcnt(9)
    v_mfma_f32_16x16x32_bf16 v[192:195], v[104:107], v[120:123], v[192:195]
    ds_read_b64_tr_b16 v[98:99], v25 offset:1024
    v_mfma_f32_16x16x32_bf16 v[192:195], v[108:111], v[124:127], v[192:195]
    ds_read_b64_tr_b16 v[100:101], v25 offset:8192
    v_mfma_f32_16x16x32_bf16 v[224:227], v[104:107], v[128:131], v[224:227]
    ds_read_b64_tr_b16 v[102:103], v25 offset:9216
    s_cmp_lg_u32 s48, 0
    s_cbranch_scc1 m_c_plk
    buffer_load_dwordx2 v[28:29], v10, s[44:47], s71 offen sc1
m_c_plk:
    v_mfma_f32_16x16x32_bf16 v[224:227], v[108:111], v[132:135], v[224:227]
    ds_read_b64_tr_b16 v[104:105], v26 offset:0
    s_waitcnt lgkmcnt(9)
    v_mfma_f32_16x16x32_bf16 v[196:199], v[112:115], v[120:123], v[196:199]
    ds_read_b64_tr_b16 v[106:107], v26 offset:1024
    v_mfma_f32_16x16x32_bf16 v[196:199], v[116:119], v[124:127], v[196:199]
    ds_read_b64_tr_b16 v[108:109], v26 offset:8192
    v_mfma_f32_16x16x32_bf16 v[228:231], v[112:115], v[128:131], v[228:231]
    ds_read_b64_tr_b16 v[110:111], v26 offset:9216
    v_mfma_f32_16x16x32_bf16 v[228:231], v[116:119], v[132:135], v[228:231]
    ds_read_b64_tr_b16 v[112:113], v27 offset:0
    ds_read_b64_tr_b16 v[114:115], v27 offset:1024
    ds_read_b64_tr_b16 v[116:117], v27 offset:8192
    ds_read_b64_tr_b16 v[118:119], v27 offset:9216
    s_waitcnt lgkmcnt(12)
    v_mfma_f32_16x16x32_bf16 v[200:203], v[88:91], v[120:123], v[200:203]
    v_mfma_f32_16x16x32_bf16 v[200:203], v[92:95], v[124:127], v[200:203]
    v_mfma_f32_16x16x32_bf16 v[232:235], v[88:91], v[128:131], v[232:235]
    v_mfma_f32_16x16x32_bf16 v[232:235], v[92:95], v[132:135], v[232:235]
    s_waitcnt lgkmcnt(0)
    s_cmp_lg_u32 s48, 0
    s_cbranch_scc1 m_c_pkw
    s_waitcnt vmcnt(0)
    v_cmp_ne_u64 vcc, s[68:69], v[28:29]
    s_mov_b32 s54, 0
    s_nop 0
    s_cbranch_vccz m_c_pk_ok
m_c_pk_spin:
    s_sleep 1
    buffer_load_dwordx2 v[28:29], v10, s[44:47], s71 offen sc1
    s_waitcnt vmcnt(0)
    v_cmp_ne_u64 vcc, s[68:69], v[28:29]
    s_add_u32 s54, s54, 1
    s_cmp_ge_u32 s54, 0x200000
    s_cbranch_scc1 m_c_pk_ok
    s_cbranch_vccnz m_c_pk_spin
m_c_pk_ok:
m_c_pkw:
    s_barrier
    ds_read_b64_tr_b16 v[88:89], v20 offset:16384
    v_mfma_f32_16x16x32_bf16 v[204:207], v[96:99], v[120:123], v[204:207]
    ds_read_b64_tr_b16 v[90:91], v20 offset:17408
    v_mfma_f32_16x16x32_bf16 v[204:207], v[100:103], v[124:127], v[204:207]
    ds_read_b64_tr_b16 v[92:93], v20 offset:24576
    v_mfma_f32_16x16x32_bf16 v[236:239], v[96:99], v[128:131], v[236:239]
    ds_read_b64_tr_b16 v[94:95], v20 offset:25600
    ds_read_b128 v[44:47], v16 offset:32768
    v_mfma_f32_16x16x32_bf16 v[236:239], v[100:103], v[132:135], v[236:239]
    ds_read_b64_tr_b16 v[96:97], v21 offset:16384
    v_mfma_f32_16x16x32_bf16 v[208:211], v[104:107], v[120:123], v[208:211]
    ds_read_b64_tr_b16 v[98:99], v21 offset:17408
    ds_read_b128 v[48:51], v17 offset:32768
    v_mfma_f32_16x16x32_bf16 v[208:211], v[108:111], v[124:127], v[208:211]
    ds_read_b64_tr_b16 v[100:101], v21 offset:24576
    v_mfma_f32_16x16x32_bf16 v[240:243], v[104:107], v[128:131], v[240:243]
    ds_read_b64_tr_b16 v[102:103], v21 offset:25600
    ds_read_b128 v[52:55], v16 offset:34816
    v_mfma_f32_16x16x32_bf16 v[240:243], v[108:111], v[132:135], v[240:243]
    ds_read_b64_tr_b16 v[104:105], v22 offset:16384
    v_mfma_f32_16x16x32_bf16 v[212:215], v[112:115], v[120:123], v[212:215]
    ds_read_b64_tr_b16 v[106:107], v22 offset:17408
    ds_read_b128 v[56:59], v17 offset:34816
    v_mfma_f32_16x16x32_bf16 v[212:215], v[116:119], v[124:127], v[212:215]
    ds_read_b64_tr_b16 v[108:109], v22 offset:24576
    v_mfma_f32_16x16x32_bf16 v[244:247], v[112:115], v[128:131], v[244:247]
    ds_read_b64_tr_b16 v[110:111], v22 offset:25600
    v_mfma_f32_16x16x32_bf16 v[244:247], v[116:119], v[132:135], v[244:247]
    ds_read_b64_tr_b16 v[112:113], v23 offset:16384
    s_waitcnt lgkmcnt(3)
    v_mfma_f32_16x16x32_bf16 v[184:187], v[88:91], v[44:47], v[184:187]
    ds_read_b64_tr_b16 v[114:115], v23 offset:17408
    v_mfma_f32_16x16x32_bf16 v[184:187], v[92:95], v[48:51], v[184:187]
    ds_read_b64_tr_b16 v[116:117], v23 offset:24576
    v_mfma_f32_16x16x32_bf16 v[216:219], v[88:91], v[52:55], v[216:219]
    ds_read_b64_tr_b16 v[118:119], v23 offset:25600
    v_mfma_f32_16x16x32_bf16 v[216:219], v[92:95], v[56:59], v[216:219]
    ds_read_b64_tr_b16 v[88:89], v24 offset:16384
    v_mfma_f32_16x16x32_bf16 v[188:191], v[96:99], v[44:47], v[188:191]
    ds_read_b64_tr_b16 v[90:91], v24 offset:17408
    v_mfma_f32_16x16x32_bf16 v[188:191], v[100:103], v[48:51], v[188:191]
    ds_read_b64_tr_b16 v[92:93], v24 offset:24576
    v_mfma_f32_16x16x32_bf16 v[220:223], v[96:99], v[52:55], v[220:223]
    ds_read_b64_tr_b16 v[94:95], v24 offset:25600
    v_mfma_f32_16x16x32_bf16 v[220:223], v[100:103], v[56:59], v[220:223]
    ds_read_b64_tr_b16 v[96:97], v25 offset:16384
    s_waitcnt lgkmcnt(9)
    v_mfma_f32_16x16x32_bf16 v[192:195], v[104:107], v[44:47], v[192:195]
    ds_read_b64_tr_b16 v[98:99], v25 offset:17408
    v_mfma_f32_16x16x32_bf16 v[192:195], v[108:111], v[48:51], v[192:195]
    ds_read_b64_tr_b16 v[100:101], v25 offset:24576
    v_mfma_f32_16x16x32_bf16 v[224:227], v[104:107], v[52:55], v[224:227]
    ds_read_b64_tr_b16 v[102:103], v25 offset:25600
    v_mfma_f32_16x16x32_bf16 v[224:227], v[108:111], v[56:59], v[224:227]
    ds_read_b64_tr_b16 v[104:105], v26 offset:16384
    s_waitcnt lgkmcnt(9)
    v_mfma_f32_16x16x32_bf16 v[196:199], v[112:115], v[44:47], v[196:199]
    ds_read_b64_tr_b16 v[106:107], v26 offset:17408
    v_mfma_f32_16x16x32_bf16 v[196:199], v[116:119], v[48:51], v[196:199]
    ds_read_b64_tr_b16 v[108:109], v26 offset:24576
    v_mfma_f32_16x16x32_bf16 v[228:231], v[112:115], v[52:55], v[228:231]
    ds_read_b64_tr_b16 v[110:111], v26 offset:25600
    v_mfma_f32_16x16x32_bf16 v[228:231], v[116:119], v[56:59], v[228:231]
    ds_read_b64_tr_b16 v[112:113], v27 offset:16384
    ds_read_b64_tr_b16 v[114:115], v27 offset:17408
    ds_read_b64_tr_b16 v[116:117], v27 offset:24576
    ds_read_b64_tr_b16 v[118:119], v27 offset:25600
    s_waitcnt lgkmcnt(12)
    v_mfma_f32_16x16x32_bf16 v[200:203], v[88:91], v[44:47], v[200:203]
    v_mfma_f32_16x16x32_bf16 v[200:203], v[92:95], v[48:51], v[200:203]
    v_mfma_f32_16x16x32_bf16 v[232:235], v[88:91], v[52:55], v[232:235]
    v_mfma_f32_16x16x32_bf16 v[232:235], v[92:95], v[56:59], v[232:235]
    s_waitcnt lgkmcnt(8)
    v_mfma_f32_16x16x32_bf16 v[204:207], v[96:99], v[44:47], v[204:207]
    v_mfma_f32_16x16x32_bf16 v[204:207], v[100:103], v[48:51], v[204:207]
    v_mfma_f32_16x16x32_bf16 v[236:239], v[96:99], v[52:55], v[236:239]
    v_mfma_f32_16x16x32_bf16 v[236:239], v[100:103], v[56:59], v[236:239]
    s_waitcnt lgkmcnt(4)
    v_mfma_f32_16x16x32_bf16 v[208:211], v[104:107], v[44:47], v[208:211]
    v_mfma_f32_16x16x32_bf16 v[208:211], v[108:111], v[48:51], v[208:211]
    v_mfma_f32_16x16x32_bf16 v[240:243], v[104:107], v[52:55], v[240:243]
    v_mfma_f32_16x16x32_bf16 v[240:243], v[108:111], v[56:59], v[240:243]
    s_waitcnt lgkmcnt(0)
    v_mfma_f32_16x16x32_bf16 v[212:215], v[112:115], v[44:47], v[212:215]
    v_mfma_f32_16x16x32_bf16 v[212:215], v[116:119], v[48:51], v[212:215]
    v_mfma_f32_16x16x32_bf16 v[244:247], v[112:115], v[52:55], v[244:247]
    v_mfma_f32_16x16x32_bf16 v[244:247], v[116:119], v[56:59], v[244:247]
    s_lshl_b32 s60, s55, 1
    s_add_u32 s60, s60, 2
    v_mov_b32 v6, 0x3e0293ee
    v_mov_b32 v7, 0x3e0293ee
    s_nop 2
    v_pk_mul_f32 v[184:185], v[184:185], v[6:7]
    v_pk_mul_f32 v[186:187], v[186:187], v[6:7]
    v_cvt_pk_bf16_f32 v152, v184, v185
    v_cvt_pk_bf16_f32 v153, v186, v187
    v_pk_mul_f32 v[188:189], v[188:189], v[6:7]
    v_pk_mul_f32 v[190:191], v[190:191], v[6:7]
    v_cvt_pk_bf16_f32 v154, v188, v189
    v_cvt_pk_bf16_f32 v155, v190, v191
    v_pk_mul_f32 v[192:193], v[192:193], v[6:7]
    v_pk_mul_f32 v[194:195], v[194:195], v[6:7]
    v_cvt_pk_bf16_f32 v156, v192, v193
    v_cvt_pk_bf16_f32 v157, v194, v195
    v_pk_mul_f32 v[196:197], v[196:197], v[6:7]
    v_pk_mul_f32 v[198:199], v[198:199], v[6:7]
    v_cvt_pk_bf16_f32 v158, v196, v197
    v_cvt_pk_bf16_f32 v159, v198, v199
    v_pk_mul_f32 v[200:201], v[200:201], v[6:7]
    v_pk_mul_f32 v[202:203], v[202:203], v[6:7]
    v_cvt_pk_bf16_f32 v160, v200, v201
    v_cvt_pk_bf16_f32 v161, v202, v203
    v_pk_mul_f32 v[204:205], v[204:205], v[6:7]
    v_pk_mul_f32 v[206:207], v[206:207], v[6:7]
    v_cvt_pk_bf16_f32 v162, v204, v205
    v_cvt_pk_bf16_f32 v163, v206, v207
    v_pk_mul_f32 v[208:209], v[208:209], v[6:7]
    v_pk_mul_f32 v[210:211], v[210:211], v[6:7]
    v_cvt_pk_bf16_f32 v164, v208, v209
    v_cvt_pk_bf16_f32 v165, v210, v211
    v_pk_mul_f32 v[212:213], v[212:213], v[6:7]
    v_pk_mul_f32 v[214:215], v[214:215], v[6:7]
    v_cvt_pk_bf16_f32 v166, v212, v213
    v_cvt_pk_bf16_f32 v167, v214, v215
    v_pk_mul_f32 v[216:217], v[216:217], v[6:7]
    v_pk_mul_f32 v[218:219], v[218:219], v[6:7]
    v_cvt_pk_bf16_f32 v168, v216, v217
    v_cvt_pk_bf16_f32 v169, v218, v219
    v_pk_mul_f32 v[220:221], v[220:221], v[6:7]
    v_pk_mul_f32 v[222:223], v[222:223], v[6:7]
    v_cvt_pk_bf16_f32 v170, v220, v221
    v_cvt_pk_bf16_f32 v171, v222, v223
    v_pk_mul_f32 v[224:225], v[224:225], v[6:7]
    v_pk_mul_f32 v[226:227], v[226:227], v[6:7]
    v_cvt_pk_bf16_f32 v172, v224, v225
    v_cvt_pk_bf16_f32 v173, v226, v227
    v_pk_mul_f32 v[228:229], v[228:229], v[6:7]
    v_pk_mul_f32 v[230:231], v[230:231], v[6:7]
    v_cvt_pk_bf16_f32 v174, v228, v229
    v_cvt_pk_bf16_f32 v175, v230, v231
    v_pk_mul_f32 v[232:233], v[232:233], v[6:7]
    v_pk_mul_f32 v[234:235], v[234:235], v[6:7]
    v_cvt_pk_bf16_f32 v176, v232, v233
    v_cvt_pk_bf16_f32 v177, v234, v235
    v_pk_mul_f32 v[236:237], v[236:237], v[6:7]
    v_pk_mul_f32 v[238:239], v[238:239], v[6:7]
    v_cvt_pk_bf16_f32 v178, v236, v237
    v_cvt_pk_bf16_f32 v179, v238, v239
    v_pk_mul_f32 v[240:241], v[240:241], v[6:7]
    v_pk_mul_f32 v[242:243], v[242:243], v[6:7]
    v_cvt_pk_bf16_f32 v180, v240, v241
    v_cvt_pk_bf16_f32 v181, v242, v243
    v_pk_mul_f32 v[244:245], v[244:245], v[6:7]
    v_pk_mul_f32 v[246:247], v[246:247], v[6:7]
    v_cvt_pk_bf16_f32 v182, v244, v245
    v_cvt_pk_bf16_f32 v183, v246, v247
    s_cmp_lg_u32 s48, 0
    s_cbranch_scc1 m_c_plb
    buffer_load_dwordx2 v[254:255], v9, s[44:47], s70 offen sc1
m_c_plb:
    s_cmp_lg_u32 s48, 0
    s_cbranch_scc1 m_c_tokw
    v_mov_b32 v7, 0x10000
    v_mov_b32 v8, 0
    ds_write_b64 v7, v[30:31]
    ds_write_b32 v7, v8 offset:16
    ds_write_b32 v7, v8 offset:2064
    ds_write_b32 v7, v8 offset:4112
    ds_write_b32 v7, v8 offset:6160
    s_waitcnt lgkmcnt(0)
m_c_tokw:
    s_mov_b32 s61, 1
    s_mov_b32 s62, 0xc000
    s_mov_b32 s63, 0x8000
    s_mov_b32 s66, s56
    s_add_u32 s64, s66, 49152
    s_add_u32 s65, s66, 32768
    s_mov_b32 s67, s59
    v_add_u32 v2, 0xc000, v4
    v_add_u32 v3, 0x8000, v1
    s_lshl_b32 s98, s48, 1
    s_add_u32 s98, s98, 6
    v_mov_b32 v6, 0xf149f2ca
    v_mov_b32 v7, 0x10000
    v_mov_b32 v12, 0x3f803f80
    v_mov_b32 v13, 0x3f803f80
    v_mov_b32 v14, 0x3f803f80
    v_mov_b32 v15, 0x3f803f80
    v_mov_b64 v[24:25], 0
    v_mov_b64 v[26:27], 0
    v_mov_b64 v[28:29], 0
    v_mov_b64 v[30:31], 0
    v_mov_b64 v[32:33], 0
    v_mov_b64 v[34:35], 0
    v_mov_b64 v[36:37], 0
    v_mov_b64 v[38:39], 0
m_join:
    s_barrier
    ds_read_b64 v[250:251], v7
    ds_read_b128 v[88:91], v4 offset:32768
    ds_read_b128 v[92:95], v4 offset:33792
    ds_read_b128 v[96:99], v4 offset:34816
    ds_read_b128 v[100:103], v4 offset:35840
    ds_read_b128 v[104:107], v4 offset:36864
    ds_read_b128 v[108:111], v4 offset:37888
    ds_read_b128 v[112:115], v4 offset:38912
    ds_read_b128 v[116:119], v4 offset:39936
    s_cmp_lt_u32 s48, 4
    s_cbranch_scc0 m_ld0
m_ld0_back:
    s_cmp_lg_u32 s59, 0
    s_cbranch_scc1 m_nomask0
    v_cmp_gt_i32 vcc, 0, v5
    v_mov_b32 v32, v6
    s_nop 0
    v_cndmask_b32 v24, v24, v6, vcc
    v_cndmask_b32 v36, v36, v6, vcc
    v_cmp_gt_i32 vcc, 1, v5
    v_mov_b32 v33, v6
    s_nop 0
    v_cndmask_b32 v25, v25, v6, vcc
    v_cndmask_b32 v37, v37, v6, vcc
    v_cmp_gt_i32 vcc, 2, v5
    v_mov_b32 v34, v6
    s_nop 0
    v_cndmask_b32 v26, v26, v6, vcc
    v_cndmask_b32 v38, v38, v6, vcc
    v_cmp_gt_i32 vcc, 3, v5
    v_mov_b32 v35, v6
    s_nop 0
    v_cndmask_b32 v27, v27, v6, vcc
    v_cndmask_b32 v39, v39, v6, vcc
    s_nop 1
m_nomask0:
    s_waitcnt lgkmcnt(0)
    v_mfma_f32_16x16x32_bf16 v[56:59], v[88:91], v[152:155], v[24:27]
    v_mov_b64 v[184:185], 0
    v_mov_b64 v[186:187], 0
    v_mfma_f32_16x16x32_bf16 v[56:59], v[92:95], v[156:159], v[56:59]
    v_mov_b64 v[188:189], 0
    v_mov_b64 v[190:191], 0
    v_mfma_f32_16x16x32_bf16 v[56:59], v[96:99], v[160:163], v[56:59]
    v_mov_b64 v[192:193], 0
    v_mov_b64 v[194:195], 0
    v_mfma_f32_16x16x32_bf16 v[56:59], v[100:103], v[164:167], v[56:59]
    v_mov_b64 v[196:197], 0
    v_mov_b64 v[198:199], 0
    v_mfma_f32_16x16x32_bf16 v[64:67], v[88:91], v[168:171], v[28:31]
    ds_read_b128 v[88:91], v4 offset:40960
    v_mov_b64 v[200:201], 0
    v_mov_b64 v[202:203], 0
    v_mfma_f32_16x16x32_bf16 v[64:67], v[92:95], v[172:175], v[64:67]
    ds_read_b128 v[92:95], v4 offset:41984
    v_mov_b64 v[204:205], 0
    v_mov_b64 v[206:207], 0
    v_mfma_f32_16x16x32_bf16 v[64:67], v[96:99], v[176:179], v[64:67]
    ds_read_b128 v[96:99], v4 offset:43008
    v_mov_b64 v[208:209], 0
    v_mov_b64 v[210:211], 0
    v_mfma_f32_16x16x32_bf16 v[64:67], v[100:103], v[180:183], v[64:67]
    ds_read_b128 v[100:103], v4 offset:44032
    v_mov_b64 v[212:213], 0
    v_mov_b64 v[214:215], 0
    v_mfma_f32_16x16x32_bf16 v[60:63], v[104:107], v[152:155], v[32:35]
    v_mov_b64 v[216:217], 0
    v_mov_b64 v[218:219], 0
    v_mfma_f32_16x16x32_bf16 v[60:63], v[108:111], v[156:159], v[60:63]
    v_mov_b64 v[220:221], 0
    v_mov_b64 v[222:223], 0
    v_mfma_f32_16x16x32_bf16 v[60:63], v[112:115], v[160:163], v[60:63]
    v_mov_b64 v[224:225], 0
    v_mov_b64 v[226:227], 0
    v_mfma_f32_16x16x32_bf16 v[60:63], v[116:119], v[164:167], v[60:63]
    v_mov_b64 v[228:229], 0
    v_mov_b64 v[230:231], 0
    v_mfma_f32_16x16x32_bf16 v[68:71], v[104:107], v[168:171], v[36:39]
    ds_read_b128 v[104:107], v4 offset:45056
    v_mov_b64 v[232:233], 0
    v_mov_b64 v[234:235], 0
    v_mfma_f32_16x16x32_bf16 v[68:71], v[108:111], v[172:175], v[68:71]
    ds_read_b128 v[108:111], v4 offset:46080
    v_mov_b64 v[236:237], 0
    v_mov_b64 v[238:239], 0
    v_mfma_f32_16x16x32_bf16 v[68:71], v[112:115], v[176:179], v[68:71]
    ds_read_b128 v[112:115], v4 offset:47104
    v_mov_b64 v[240:241], 0
    v_mov_b64 v[242:243], 0
    v_mfma_f32_16x16x32_bf16 v[68:71], v[116:119], v[180:183], v[68:71]
    ds_read_b128 v[116:119], v4 offset:48128
    v_mov_b64 v[244:245], 0
    v_mov_b64 v[246:247], 0
    v_mov_b64 v[16:17], 0
    v_mov_b64 v[18:19], 0
    v_mov_b64 v[20:21], 0
    v_mov_b64 v[22:23], 0
    v_readfirstlane_b32 s68, v250
    v_readfirstlane_b32 s69, v251
    s_nop 1
    v_max3_f32 v8, v56, v57, v58
    v_max3_f32 v8, v8, v59, v60
    v_max3_f32 v8, v8, v61, v62
    v_max_f32 v8, v8, v63
    v_mov_b32 v7, v8
    s_nop 1
    v_permlane16_swap_b32 v8, v7
    v_max_f32 v8, v8, v7
    v_mov_b32 v7, v8
    s_nop 1
    v_permlane32_swap_b32 v8, v7
    v_max_f32 v8, v8, v7
    v_max3_f32 v10, v64, v65, v66
    v_max3_f32 v10, v10, v67, v68
    v_max3_f32 v10, v10, v69, v70
    v_max_f32 v10, v10, v71
    v_mov_b32 v7, v10
    s_nop 1
    v_permlane16_swap_b32 v10, v7
    v_max_f32 v10, v10, v7
    v_mov_b32 v7, v10
    s_nop 1
    v_permlane32_swap_b32 v10, v7
    v_max_f32 v10, v10, v7
    v_pk_add_f32 v[56:57], v[56:57], v[8:9] op_sel_hi:[1,0] neg_lo:[0,1] neg_hi:[0,1]
    v_pk_add_f32 v[58:59], v[58:59], v[8:9] op_sel_hi:[1,0] neg_lo:[0,1] neg_hi:[0,1]
    v_pk_add_f32 v[60:61], v[60:61], v[8:9] op_sel_hi:[1,0] neg_lo:[0,1] neg_hi:[0,1]
    v_pk_add_f32 v[62:63], v[62:63], v[8:9] op_sel_hi:[1,0] neg_lo:[0,1] neg_hi:[0,1]
    v_sub_f32 v8, 0, v8
    v_pk_mov_b32 v[24:25], v[8:9], v[8:9] op_sel:[0,0]
    v_pk_mov_b32 v[26:27], v[8:9], v[8:9] op_sel:[0,0]
    v_pk_mov_b32 v[32:33], v[8:9], v[8:9] op_sel:[0,0]
    v_pk_mov_b32 v[34:35], v[8:9], v[8:9] op_sel:[0,0]
    v_pk_add_f32 v[64:65], v[64:65], v[10:11] op_sel_hi:[1,0] neg_lo:[0,1] neg_hi:[0,1]
    v_pk_add_f32 v[66:67], v[66:67], v[10:11] op_sel_hi:[1,0] neg_lo:[0,1] neg_hi:[0,1]
    v_pk_add_f32 v[68:69], v[68:69], v[10:11] op_sel_hi:[1,0] neg_lo:[0,1] neg_hi:[0,1]
    v_pk_add_f32 v[70:71], v[70:71], v[10:11] op_sel_hi:[1,0] neg_lo:[0,1] neg_hi:[0,1]
    v_sub_f32 v10, 0, v10
    v_pk_mov_b32 v[28:29], v[10:11], v[10:11] op_sel:[0,0]
    v_pk_mov_b32 v[30:31], v[10:11], v[10:11] op_sel:[0,0]
    v_pk_mov_b32 v[36:37], v[10:11], v[10:11] op_sel:[0,0]
    v_pk_mov_b32 v[38:39], v[10:11], v[10:11] op_sel:[0,0]
    s_cmp_lg_u32 s67, 1
    s_cbranch_scc1 m_nomask1
    v_cmp_gt_i32 vcc, 0, v5
    v_mov_b32 v32, v6
    s_nop 0
    v_cndmask_b32 v24, v24, v6, vcc
    v_cndmask_b32 v36, v36, v6, vcc
    v_cmp_gt_i32 vcc, 1, v5
    v_mov_b32 v33, v6
    s_nop 0
    v_cndmask_b32 v25, v25, v6, vcc
    v_cndmask_b32 v37, v37, v6, vcc
    v_cmp_gt_i32 vcc, 2, v5
    v_mov_b32 v34, v6
    s_nop 0
    v_cndmask_b32 v26, v26, v6, vcc
    v_cndmask_b32 v38, v38, v6, vcc
    v_cmp_gt_i32 vcc, 3, v5
    v_mov_b32 v35, v6
    s_nop 0
    v_cndmask_b32 v27, v27, v6, vcc
    v_cndmask_b32 v39, v39, v6, vcc
    s_nop 1
m_nomask1:
    s_nop 0
    s_waitcnt lgkmcnt(0)
    v_mfma_f32_16x16x32_bf16 v[72:75], v[88:91], v[152:155], v[24:27]
    v_exp_f32 v56, v56
    v_mfma_f32_16x16x32_bf16 v[72:75], v[92:95], v[156:159], v[72:75]
    v_exp_f32 v57, v57
    v_mfma_f32_16x16x32_bf16 v[72:75], v[96:99], v[160:163], v[72:75]
    v_exp_f32 v58, v58
    v_mfma_f32_16x16x32_bf16 v[72:75], v[100:103], v[164:167], v[72:75]
    v_exp_f32 v59, v59
    v_cvt_pk_bf16_f32 v40, v56, v57
    v_mfma_f32_16x16x32_bf16 v[80:83], v[88:91], v[168:171], v[28:31]
    ds_read_b128 v[88:91], v2 offset:0
    v_exp_f32 v60, v60
    v_mfma_f32_16x16x32_bf16 v[80:83], v[92:95], v[172:175], v[80:83]
    ds_read_b128 v[92:95], v2 offset:1024
    v_exp_f32 v61, v61
    v_cvt_pk_bf16_f32 v41, v58, v59
    v_mfma_f32_16x16x32_bf16 v[80:83], v[96:99], v[176:179], v[80:83]
    ds_read_b128 v[96:99], v2 offset:2048
    v_exp_f32 v62, v62
    v_mfma_f32_16x16x32_bf16 v[80:83], v[100:103], v[180:183], v[80:83]
    ds_read_b128 v[100:103], v2 offset:3072
    v_exp_f32 v63, v63
    v_cvt_pk_bf16_f32 v42, v60, v61
    v_mfma_f32_16x16x32_bf16 v[76:79], v[104:107], v[152:155], v[32:35]
    v_exp_f32 v64, v64
    v_mfma_f32_16x16x32_bf16 v[76:79], v[108:111], v[156:159], v[76:79]
    v_exp_f32 v65, v65
    v_cvt_pk_bf16_f32 v43, v62, v63
    v_mfma_f32_16x16x32_bf16 v[76:79], v[112:115], v[160:163], v[76:79]
    v_exp_f32 v66, v66
    v_mfma_f32_16x16x32_bf16 v[76:79], v[116:119], v[164:167], v[76:79]
    v_exp_f32 v67, v67
    v_cvt_pk_bf16_f32 v44, v64, v65
    v_mfma_f32_16x16x32_bf16 v[84:87], v[104:107], v[168:171], v[36:39]
    ds_read_b128 v[104:107], v2 offset:4096
    v_exp_f32 v68, v68
    v_mfma_f32_16x16x32_bf16 v[84:87], v[108:111], v[172:175], v[84:87]
    ds_read_b128 v[108:111], v2 offset:5120
    v_exp_f32 v69, v69
    v_cvt_pk_bf16_f32 v45, v66, v67
    v_mfma_f32_16x16x32_bf16 v[84:87], v[112:115], v[176:179], v[84:87]
    ds_read_b128 v[112:115], v2 offset:6144
    v_exp_f32 v70, v70
    v_mfma_f32_16x16x32_bf16 v[84:87], v[116:119], v[180:183], v[84:87]
    ds_read_b128 v[116:119], v2 offset:7168
    v_exp_f32 v71, v71
    v_cvt_pk_bf16_f32 v46, v68, v69
    ds_read_b128 v[120:123], v3 offset:0
    ds_read_b128 v[124:127], v3 offset:1024
    ds_read_b128 v[128:131], v3 offset:2048
    ds_read_b128 v[132:135], v3 offset:3072
    ds_read_b128 v[136:139], v3 offset:4096
    ds_read_b128 v[140:143], v3 offset:5120
    ds_read_b128 v[144:147], v3 offset:6144
    ds_read_b128 v[148:151], v3 offset:7168
    v_cvt_pk_bf16_f32 v47, v70, v71
    s_branch m_odd
m_ld0:
    s_add_u32 m0, s56, 98304
    s_add_u32 s53, s56, 32768
    buffer_load_dwordx4 v1, s[28:31], s53 offen offset:0 sc1 lds
    buffer_load_dwordx4 v1, s[28:31], s53 offen offset:1024 sc1 lds
    buffer_load_dwordx4 v1, s[28:31], s53 offen offset:2048 sc1 lds
    buffer_load_dwordx4 v1, s[28:31], s53 offen offset:3072 sc1 lds
    s_cmp_lg_u32 s62, s98
    s_cbranch_scc1 m_tga1
    buffer_load_dwordx2 v[252:253], v254, s[44:47], s71 offen sc1
m_tga1:
    s_cmp_lg_u32 s62, s99
    s_cbranch_scc1 m_tgb1
    s_lshr_b32 s53, s64, 16
    s_mov_b32 s54, 0
    s_waitcnt vmcnt(8)
m_tgs1:
    v_cmp_ne_u64 vcc, s[68:69], v[252:253]
    s_add_u32 s54, s54, 1
    s_cmp_ge_u32 s54, 0x200000
    s_cbranch_scc1 m_tgb1
    s_bitcmp0_b64 vcc, s53
    s_cbranch_scc1 m_tgc1
    buffer_load_dwordx2 v[252:253], v254, s[44:47], s71 offen sc1
    s_waitcnt vmcnt(0)
    s_branch m_tgs1
m_tgc1:
    s_cbranch_vccnz m_tgb1
    s_mov_b32 s98, 1
    s_mov_b32 s99, 1
m_tgb1:
    s_xor_b32 s53, s62, 0x8000
    s_add_u32 s53, s53, s66
    s_add_u32 m0, s53, 98304
    s_nop 0
    buffer_load_dwordx4 v1, s[28:31], s64 offen offset:0 sc1 lds
    buffer_load_dwordx4 v1, s[28:31], s64 offen offset:1024 sc1 lds
    buffer_load_dwordx4 v1, s[28:31], s64 offen offset:2048 sc1 lds
    buffer_load_dwordx4 v1, s[28:31], s64 offen offset:3072 sc1 lds
    s_add_u32 s64, s64, 0x4000
    s_xor_b32 s53, s63, 0x8000
    s_add_u32 s53, s53, s66
    s_add_u32 m0, s53, 0
    s_nop 0
    buffer_load_dwordx4 v1, s[8:11], s65 offen offset:0 sc1 lds
    buffer_load_dwordx4 v1, s[8:11], s65 offen offset:1024 sc1 lds
    buffer_load_dwordx4 v1, s[8:11], s65 offen offset:2048 sc1 lds
    buffer_load_dwordx4 v1, s[8:11], s65 offen offset:3072 sc1 lds
    s_add_u32 s65, s65, 0x4000
    s_branch m_ld0_back
.p2align 6
m_hot_long:
    s_waitcnt lgkmcnt(8)
    v_mfma_f32_16x16x32_bf16 v[72:75], v[88:91], v[152:155], v[24:27]
    v_exp_f32 v56, v56
    v_mfma_f32_16x16x32_bf16 v[72:75], v[92:95], v[156:159], v[72:75]
    v_exp_f32 v57, v57
    v_mfma_f32_16x16x32_bf16 v[72:75], v[96:99], v[160:163], v[72:75]
    v_exp_f32 v58, v58
    v_mfma_f32_16x16x32_bf16 v[72:75], v[100:103], v[164:167], v[72:75]
    v_exp_f32 v59, v59
    v_mfma_f32_16x16x32_bf16 v[80:83], v[88:91], v[168:171], v[28:31]
    ds_read_b128 v[88:91], v2 offset:0
    v_cvt_pk_bf16_f32 v40, v56, v57
    v_mfma_f32_16x16x32_bf16 v[80:83], v[92:95], v[172:175], v[80:83]
    ds_read_b128 v[92:95], v2 offset:1024
    v_cvt_pk_bf16_f32 v41, v58, v59
    v_mfma_f32_16x16x32_bf16 v[80:83], v[96:99], v[176:179], v[80:83]
    ds_read_b128 v[96:99], v2 offset:2048
    v_add_u32 v3, s63, v1
    v_mfma_f32_16x16x32_bf16 v[80:83], v[100:103], v[180:183], v[80:83]
    ds_read_b128 v[100:103], v2 offset:3072
    v_mfma_f32_16x16x32_bf16 v[76:79], v[104:107], v[152:155], v[32:35]
    v_exp_f32 v60, v60
    v_mfma_f32_16x16x32_bf16 v[76:79], v[108:111], v[156:159], v[76:79]
    v_exp_f32 v61, v61
    v_mfma_f32_16x16x32_bf16 v[76:79], v[112:115], v[160:163], v[76:79]
    v_exp_f32 v62, v62
    v_mfma_f32_16x16x32_bf16 v[76:79], v[116:119], v[164:167], v[76:79]
    v_exp_f32 v63, v63
    v_mfma_f32_16x16x32_bf16 v[84:87], v[104:107], v[168:171], v[36:39]
    ds_read_b128 v[104:107], v2 offset:4096
    v_cvt_pk_bf16_f32 v42, v60, v61
    v_mfma_f32_16x16x32_bf16 v[84:87], v[108:111], v[172:175], v[84:87]
    ds_read_b128 v[108:111], v2 offset:5120
    v_cvt_pk_bf16_f32 v43, v62, v63
    v_mfma_f32_16x16x32_bf16 v[84:87], v[112:115], v[176:179], v[84:87]
    ds_read_b128 v[112:115], v2 offset:6144
    v_mfma_f32_16x16x32_bf16 v[84:87], v[116:119], v[180:183], v[84:87]
    ds_read_b128 v[116:119], v2 offset:7168
    s_waitcnt lgkmcnt(8)
    v_mfma_f32_16x16x32_bf16 v[184:187], v[120:123], v[48:51], v[184:187]
    v_exp_f32 v64, v64
    v_mfma_f32_16x16x32_bf16 v[188:191], v[120:123], v[52:55], v[188:191]
    ds_read_b128 v[120:123], v3 offset:0
    v_mfma_f32_16x16x32_bf16 v[192:195], v[124:127], v[48:51], v[192:195]
    v_exp_f32 v65, v65
    v_mfma_f32_16x16x32_bf16 v[196:199], v[124:127], v[52:55], v[196:199]
    ds_read_b128 v[124:127], v3 offset:1024
    v_cvt_pk_bf16_f32 v44, v64, v65
    v_mfma_f32_16x16x32_bf16 v[200:203], v[128:131], v[48:51], v[200:203]
    v_exp_f32 v66, v66
    v_mfma_f32_16x16x32_bf16 v[204:207], v[128:131], v[52:55], v[204:207]
    ds_read_b128 v[128:131], v3 offset:2048
    v_mfma_f32_16x16x32_bf16 v[208:211], v[132:135], v[48:51], v[208:211]
    v_exp_f32 v67, v67
    v_mfma_f32_16x16x32_bf16 v[212:215], v[132:135], v[52:55], v[212:215]
    ds_read_b128 v[132:135], v3 offset:3072
    v_cvt_pk_bf16_f32 v45, v66, v67
    v_mfma_f32_16x16x32_bf16 v[216:219], v[136:139], v[48:51], v[216:219]
    v_exp_f32 v68, v68
    v_mfma_f32_16x16x32_bf16 v[220:223], v[136:139], v[52:55], v[220:223]
    ds_read_b128 v[136:139], v3 offset:4096
    s_cmp_eq_u32 s61, s98
    s_cbranch_scc1 m_wo
m_wo_back:
    v_mfma_f32_16x16x32_bf16 v[224:227], v[140:143], v[48:51], v[224:227]
    v_exp_f32 v69, v69
    v_mfma_f32_16x16x32_bf16 v[228:231], v[140:143], v[52:55], v[228:231]
    ds_read_b128 v[140:143], v3 offset:5120
    v_cvt_pk_bf16_f32 v46, v68, v69
    v_mfma_f32_16x16x32_bf16 v[232:235], v[144:147], v[48:51], v[232:235]
    v_exp_f32 v70, v70
    v_mfma_f32_16x16x32_bf16 v[236:239], v[144:147], v[52:55], v[236:239]
    ds_read_b128 v[144:147], v3 offset:6144
    v_mfma_f32_16x16x32_bf16 v[240:243], v[148:151], v[48:51], v[240:243]
    v_exp_f32 v71, v71
    v_mfma_f32_16x16x32_bf16 v[244:247], v[148:151], v[52:55], v[244:247]
    ds_read_b128 v[148:151], v3 offset:7168
    v_cvt_pk_bf16_f32 v47, v70, v71
    v_mfma_f32_16x16x32_bf16 v[16:19], v[12:15], v[48:51], v[16:19]
    v_mfma_f32_16x16x32_bf16 v[20:23], v[12:15], v[52:55], v[20:23]
    s_waitcnt lgkmcnt(8)
    v_mfma_f32_16x16x32_bf16 v[56:59], v[88:91], v[152:155], v[24:27]
    v_exp_f32 v72, v72
    v_mfma_f32_16x16x32_bf16 v[56:59], v[92:95], v[156:159], v[56:59]
    v_exp_f32 v73, v73
    v_mfma_f32_16x16x32_bf16 v[56:59], v[96:99], v[160:163], v[56:59]
    v_exp_f32 v74, v74
    v_mfma_f32_16x16x32_bf16 v[56:59], v[100:103], v[164:167], v[56:59]
    v_exp_f32 v75, v75
    v_mfma_f32_16x16x32_bf16 v[64:67], v[88:91], v[168:171], v[28:31]
    ds_read_b128 v[88:91], v2 offset:8192
    v_cvt_pk_bf16_f32 v48, v72, v73
    v_mfma_f32_16x16x32_bf16 v[64:67], v[92:95], v[172:175], v[64:67]
    ds_read_b128 v[92:95], v2 offset:9216
    v_cvt_pk_bf16_f32 v49, v74, v75
    v_mfma_f32_16x16x32_bf16 v[64:67], v[96:99], v[176:179], v[64:67]
    ds_read_b128 v[96:99], v2 offset:10240
    s_add_u32 s62, s62, 0x4000
    v_mfma_f32_16x16x32_bf16 v[64:67], v[100:103], v[180:183], v[64:67]
    ds_read_b128 v[100:103], v2 offset:11264
    s_and_b32 s62, s62, 0xffff
    v_mfma_f32_16x16x32_bf16 v[60:63], v[104:107], v[152:155], v[32:35]
    v_exp_f32 v76, v76
    v_mfma_f32_16x16x32_bf16 v[60:63], v[108:111], v[156:159], v[60:63]
    v_exp_f32 v77, v77
    v_mfma_f32_16x16x32_bf16 v[60:63], v[112:115], v[160:163], v[60:63]
    v_exp_f32 v78, v78
    v_mfma_f32_16x16x32_bf16 v[60:63], v[116:119], v[164:167], v[60:63]
    v_exp_f32 v79, v79
    v_mfma_f32_16x16x32_bf16 v[68:71], v[104:107], v[168:171], v[36:39]
    ds_read_b128 v[104:107], v2 offset:12288
    v_cvt_pk_bf16_f32 v50, v76, v77
    v_mfma_f32_16x16x32_bf16 v[68:71], v[108:111], v[172:175], v[68:71]
    ds_read_b128 v[108:111], v2 offset:13312
    v_cvt_pk_bf16_f32 v51, v78, v79
    v_mfma_f32_16x16x32_bf16 v[68:71], v[112:115], v[176:179], v[68:71]
    ds_read_b128 v[112:115], v2 offset:14336
    s_add_u32 s63, s63, 0x4000
    v_mfma_f32_16x16x32_bf16 v[68:71], v[116:119], v[180:183], v[68:71]
    ds_read_b128 v[116:119], v2 offset:15360
    s_and_b32 s63, s63, 0xffff
    s_waitcnt lgkmcnt(8)
    v_mfma_f32_16x16x32_bf16 v[184:187], v[120:123], v[40:43], v[184:187]
    v_exp_f32 v80, v80
    v_mfma_f32_16x16x32_bf16 v[188:191], v[120:123], v[44:47], v[188:191]
    ds_read_b128 v[120:123], v3 offset:8192
    v_add_u32 v2, s62, v4
    v_mfma_f32_16x16x32_bf16 v[192:195], v[124:127], v[40:43], v[192:195]
    v_exp_f32 v81, v81
    v_mfma_f32_16x16x32_bf16 v[196:199], v[124:127], v[44:47], v[196:199]
    ds_read_b128 v[124:127], v3 offset:9216
    v_cvt_pk_bf16_f32 v52, v80, v81
    v_mfma_f32_16x16x32_bf16 v[200:203], v[128:131], v[40:43], v[200:203]
    v_exp_f32 v82, v82
    v_mfma_f32_16x16x32_bf16 v[204:207], v[128:131], v[44:47], v[204:207]
    ds_read_b128 v[128:131], v3 offset:10240
    s_add_u32 s61, s61, 1
    v_mfma_f32_16x16x32_bf16 v[208:211], v[132:135], v[40:43], v[208:211]
    v_exp_f32 v83, v83
    v_mfma_f32_16x16x32_bf16 v[212:215], v[132:135], v[44:47], v[212:215]
    ds_read_b128 v[132:135], v3 offset:11264
    v_cvt_pk_bf16_f32 v53, v82, v83
    v_mfma_f32_16x16x32_bf16 v[216:219], v[136:139], v[40:43], v[216:219]
    v_exp_f32 v84, v84
    v_mfma_f32_16x16x32_bf16 v[220:223], v[136:139], v[44:47], v[220:223]
    ds_read_b128 v[136:139], v3 offset:12288
    s_sub_u32 s67, s67, 2
    v_mfma_f32_16x16x32_bf16 v[224:227], v[140:143], v[40:43], v[224:227]
    v_exp_f32 v85, v85
    v_mfma_f32_16x16x32_bf16 v[228:231], v[140:143], v[44:47], v[228:231]
    ds_read_b128 v[140:143], v3 offset:13312
    v_cvt_pk_bf16_f32 v54, v84, v85
    v_mfma_f32_16x16x32_bf16 v[232:235], v[144:147], v[40:43], v[232:235]
    v_exp_f32 v86, v86
    v_mfma_f32_16x16x32_bf16 v[236:239], v[144:147], v[44:47], v[236:239]
    ds_read_b128 v[144:147], v3 offset:14336
    s_cmp_ge_i32 s67, 3
    v_mfma_f32_16x16x32_bf16 v[240:243], v[148:151], v[40:43], v[240:243]
    v_exp_f32 v87, v87
    v_mfma_f32_16x16x32_bf16 v[244:247], v[148:151], v[44:47], v[244:247]
    ds_read_b128 v[148:151], v3 offset:15360
    v_cvt_pk_bf16_f32 v55, v86, v87
    v_mfma_f32_16x16x32_bf16 v[16:19], v[12:15], v[40:43], v[16:19]
    s_barrier
    v_mfma_f32_16x16x32_bf16 v[20:23], v[12:15], v[44:47], v[20:23]
    s_cbranch_scc1 m_hot_long
    v_add_u32 v3, s63, v1
    s_branch m_even_ns
.p2align 6
m_hot_short:
    s_waitcnt lgkmcnt(8)
    v_mfma_f32_16x16x32_bf16 v[72:75], v[88:91], v[152:155], v[24:27]
    v_exp_f32 v56, v56
    v_mfma_f32_16x16x32_bf16 v[72:75], v[92:95], v[156:159], v[72:75]
    v_exp_f32 v57, v57
    v_mfma_f32_16x16x32_bf16 v[72:75], v[96:99], v[160:163], v[72:75]
    v_exp_f32 v58, v58
    v_mfma_f32_16x16x32_bf16 v[72:75], v[100:103], v[164:167], v[72:75]
    v_exp_f32 v59, v59
    v_mfma_f32_16x16x32_bf16 v[80:83], v[88:91], v[168:171], v[28:31]
    ds_read_b128 v[88:91], v2 offset:0
    v_cvt_pk_bf16_f32 v40, v56, v57
    v_mfma_f32_16x16x32_bf16 v[80:83], v[92:95], v[172:175], v[80:83]
    ds_read_b128 v[92:95], v2 offset:1024
    v_cvt_pk_bf16_f32 v41, v58, v59
    v_mfma_f32_16x16x32_bf16 v[80:83], v[96:99], v[176:179], v[80:83]
    ds_read_b128 v[96:99], v2 offset:2048
    v_add_u32 v3, s63, v1
    v_mfma_f32_16x16x32_bf16 v[80:83], v[100:103], v[180:183], v[80:83]
    ds_read_b128 v[100:103], v2 offset:3072
    s_cmp_lg_u32 s62, s98
    s_cbranch_scc1 m_tga2
    buffer_load_dwordx2 v[252:253], v254, s[44:47], s71 offen sc1
m_tga2:
    s_cmp_lg_u32 s62, s99
    s_cbranch_scc1 m_tgb2
    s_lshr_b32 s53, s64, 16
    s_mov_b32 s54, 0
    s_waitcnt vmcnt(8)
m_tgs2:
    v_cmp_ne_u64 vcc, s[68:69], v[252:253]
    s_add_u32 s54, s54, 1
    s_cmp_ge_u32 s54, 0x200000
    s_cbranch_scc1 m_tgb2
    s_bitcmp0_b64 vcc, s53
    s_cbranch_scc1 m_tgc2
    buffer_load_dwordx2 v[252:253], v254, s[44:47], s71 offen sc1
    s_waitcnt vmcnt(0)
    s_branch m_tgs2
m_tgc2:
    s_cbranch_vccnz m_tgb2
    s_mov_b32 s98, 1
    s_mov_b32 s99, 1
m_tgb2:
    s_xor_b32 s53, s62, 0x8000
    s_add_u32 s53, s53, s66
    s_add_u32 m0, s53, 98304
    s_nop 0
    buffer_load_dwordx4 v1, s[28:31], s64 offen offset:0 sc1 lds
    v_mfma_f32_16x16x32_bf16 v[76:79], v[104:107], v[152:155], v[32:35]
    v_exp_f32 v60, v60
    v_mfma_f32_16x16x32_bf16 v[76:79], v[108:111], v[156:159], v[76:79]
    v_exp_f32 v61, v61
    v_mfma_f32_16x16x32_bf16 v[76:79], v[112:115], v[160:163], v[76:79]
    v_exp_f32 v62, v62
    v_mfma_f32_16x16x32_bf16 v[76:79], v[116:119], v[164:167], v[76:79]
    v_exp_f32 v63, v63
    v_mfma_f32_16x16x32_bf16 v[84:87], v[104:107], v[168:171], v[36:39]
    ds_read_b128 v[104:107], v2 offset:4096
    v_cvt_pk_bf16_f32 v42, v60, v61
    v_mfma_f32_16x16x32_bf16 v[84:87], v[108:111], v[172:175], v[84:87]
    ds_read_b128 v[108:111], v2 offset:5120
    v_cvt_pk_bf16_f32 v43, v62, v63
    v_mfma_f32_16x16x32_bf16 v[84:87], v[112:115], v[176:179], v[84:87]
    ds_read_b128 v[112:115], v2 offset:6144
    buffer_load_dwordx4 v1, s[28:31], s64 offen offset:1024 sc1 lds
    v_mfma_f32_16x16x32_bf16 v[84:87], v[116:119], v[180:183], v[84:87]
    ds_read_b128 v[116:119], v2 offset:7168
    buffer_load_dwordx4 v1, s[28:31], s64 offen offset:2048 sc1 lds
    s_waitcnt lgkmcnt(8)
    v_mfma_f32_16x16x32_bf16 v[184:187], v[120:123], v[48:51], v[184:187]
    v_exp_f32 v64, v64
    v_mfma_f32_16x16x32_bf16 v[188:191], v[120:123], v[52:55], v[188:191]
    ds_read_b128 v[120:123], v3 offset:0
    buffer_load_dwordx4 v1, s[28:31], s64 offen offset:3072 sc1 lds
    s_add_u32 s64, s64, 0x4000
    v_mfma_f32_16x16x32_bf16 v[192:195], v[124:127], v[48:51], v[192:195]
    v_exp_f32 v65, v65
    v_mfma_f32_16x16x32_bf16 v[196:199], v[124:127], v[52:55], v[196:199]
    ds_read_b128 v[124:127], v3 offset:1024
    v_cvt_pk_bf16_f32 v44, v64, v65
    v_mfma_f32_16x16x32_bf16 v[200:203], v[128:131], v[48:51], v[200:203]
    v_exp_f32 v66, v66
    v_mfma_f32_16x16x32_bf16 v[204:207], v[128:131], v[52:55], v[204:207]
    ds_read_b128 v[128:131], v3 offset:2048
    s_xor_b32 s53, s63, 0x8000
    s_add_u32 s53, s53, s66
    s_add_u32 m0, s53, 0
    s_nop 0
    buffer_load_dwordx4 v1, s[8:11], s65 offen offset:0 sc1 lds
    v_mfma_f32_16x16x32_bf16 v[208:211], v[132:135], v[48:51], v[208:211]
    v_exp_f32 v67, v67
    v_mfma_f32_16x16x32_bf16 v[212:215], v[132:135], v[52:55], v[212:215]
    ds_read_b128 v[132:135], v3 offset:3072
    v_cvt_pk_bf16_f32 v45, v66, v67
    v_mfma_f32_16x16x32_bf16 v[216:219], v[136:139], v[48:51], v[216:219]
    v_exp_f32 v68, v68
    v_mfma_f32_16x16x32_bf16 v[220:223], v[136:139], v[52:55], v[220:223]
    ds_read_b128 v[136:139], v3 offset:4096
    buffer_load_dwordx4 v1, s[8:11], s65 offen offset:1024 sc1 lds
    v_mfma_f32_16x16x32_bf16 v[224:227], v[140:143], v[48:51], v[224:227]
    v_exp_f32 v69, v69
    v_mfma_f32_16x16x32_bf16 v[228:231], v[140:143], v[52:55], v[228:231]
    ds_read_b128 v[140:143], v3 offset:5120
    v_cvt_pk_bf16_f32 v46, v68, v69
    v_mfma_f32_16x16x32_bf16 v[232:235], v[144:147], v[48:51], v[232:235]
    v_exp_f32 v70, v70
    v_mfma_f32_16x16x32_bf16 v[236:239], v[144:147], v[52:55], v[236:239]
    ds_read_b128 v[144:147], v3 offset:6144
    buffer_load_dwordx4 v1, s[8:11], s65 offen offset:2048 sc1 lds
    v_mfma_f32_16x16x32_bf16 v[240:243], v[148:151], v[48:51], v[240:243]
    v_exp_f32 v71, v71
    v_mfma_f32_16x16x32_bf16 v[244:247], v[148:151], v[52:55], v[244:247]
    ds_read_b128 v[148:151], v3 offset:7168
    v_cvt_pk_bf16_f32 v47, v70, v71
    v_mfma_f32_16x16x32_bf16 v[16:19], v[12:15], v[48:51], v[16:19]
    buffer_load_dwordx4 v1, s[8:11], s65 offen offset:3072 sc1 lds
    s_add_u32 s65, s65, 0x4000
    v_mfma_f32_16x16x32_bf16 v[20:23], v[12:15], v[52:55], v[20:23]
    s_waitcnt lgkmcnt(8)
    v_mfma_f32_16x16x32_bf16 v[56:59], v[88:91], v[152:155], v[24:27]
    v_exp_f32 v72, v72
    v_mfma_f32_16x16x32_bf16 v[56:59], v[92:95], v[156:159], v[56:59]
    v_exp_f32 v73, v73
    v_mfma_f32_16x16x32_bf16 v[56:59], v[96:99], v[160:163], v[56:59]
    v_exp_f32 v74, v74
    v_mfma_f32_16x16x32_bf16 v[56:59], v[100:103], v[164:167], v[56:59]
    v_exp_f32 v75, v75
    v_mfma_f32_16x16x32_bf16 v[64:67], v[88:91], v[168:171], v[28:31]
    ds_read_b128 v[88:91], v2 offset:8192
    v_cvt_pk_bf16_f32 v48, v72, v73
    v_mfma_f32_16x16x32_bf16 v[64:67], v[92:95], v[172:175], v[64:67]
    ds_read_b128 v[92:95], v2 offset:9216
    v_cvt_pk_bf16_f32 v49, v74, v75
    v_mfma_f32_16x16x32_bf16 v[64:67], v[96:99], v[176:179], v[64:67]
    ds_read_b128 v[96:99], v2 offset:10240
    s_add_u32 s62, s62, 0x4000
    v_mfma_f32_16x16x32_bf16 v[64:67], v[100:103], v[180:183], v[64:67]
    ds_read_b128 v[100:103], v2 offset:11264
    s_and_b32 s62, s62, 0xffff
    v_mfma_f32_16x16x32_bf16 v[60:63], v[104:107], v[152:155], v[32:35]
    v_exp_f32 v76, v76
    v_mfma_f32_16x16x32_bf16 v[60:63], v[108:111], v[156:159], v[60:63]
    v_exp_f32 v77, v77
    v_mfma_f32_16x16x32_bf16 v[60:63], v[112:115], v[160:163], v[60:63]
    v_exp_f32 v78, v78
    v_mfma_f32_16x16x32_bf16 v[60:63], v[116:119], v[164:167], v[60:63]
    v_exp_f32 v79, v79
    v_mfma_f32_16x16x32_bf16 v[68:71], v[104:107], v[168:171], v[36:39]
    ds_read_b128 v[104:107], v2 offset:12288
    v_cvt_pk_bf16_f32 v50, v76, v77
    v_mfma_f32_16x16x32_bf16 v[68:71], v[108:111], v[172:175], v[68:71]
    ds_read_b128 v[108:111], v2 offset:13312
    v_cvt_pk_bf16_f32 v51, v78, v79
    v_mfma_f32_16x16x32_bf16 v[68:71], v[112:115], v[176:179], v[68:71]
    ds_read_b128 v[112:115], v2 offset:14336
    s_add_u32 s63, s63, 0x4000
    v_mfma_f32_16x16x32_bf16 v[68:71], v[116:119], v[180:183], v[68:71]
    ds_read_b128 v[116:119], v2 offset:15360
    s_and_b32 s63, s63, 0xffff
    s_waitcnt lgkmcnt(8)
    v_mfma_f32_16x16x32_bf16 v[184:187], v[120:123], v[40:43], v[184:187]
    v_exp_f32 v80, v80
    v_mfma_f32_16x16x32_bf16 v[188:191], v[120:123], v[44:47], v[188:191]
    ds_read_b128 v[120:123], v3 offset:8192
    v_add_u32 v2, s62, v4
    v_mfma_f32_16x16x32_bf16 v[192:195], v[124:127], v[40:43], v[192:195]
    v_exp_f32 v81, v81
    v_mfma_f32_16x16x32_bf16 v[196:199], v[124:127], v[44:47], v[196:199]
    ds_read_b128 v[124:127], v3 offset:9216
    v_cvt_pk_bf16_f32 v52, v80, v81
    v_mfma_f32_16x16x32_bf16 v[200:203], v[128:131], v[40:43], v[200:203]
    v_exp_f32 v82, v82
    v_mfma_f32_16x16x32_bf16 v[204:207], v[128:131], v[44:47], v[204:207]
    ds_read_b128 v[128:131], v3 offset:10240
    s_add_u32 s61, s61, 1
    v_mfma_f32_16x16x32_bf16 v[208:211], v[132:135], v[40:43], v[208:211]
    v_exp_f32 v83, v83
    v_mfma_f32_16x16x32_bf16 v[212:215], v[132:135], v[44:47], v[212:215]
    ds_read_b128 v[132:135], v3 offset:11264
    v_cvt_pk_bf16_f32 v53, v82, v83
    v_mfma_f32_16x16x32_bf16 v[216:219], v[136:139], v[40:43], v[216:219]
    v_exp_f32 v84, v84
    v_mfma_f32_16x16x32_bf16 v[220:223], v[136:139], v[44:47], v[220:223]
    ds_read_b128 v[136:139], v3 offset:12288
    s_sub_u32 s67, s67, 2
    v_mfma_f32_16x16x32_bf16 v[224:227], v[140:143], v[40:43], v[224:227]
    v_exp_f32 v85, v85
    v_mfma_f32_16x16x32_bf16 v[228:231], v[140:143], v[44:47], v[228:231]
    ds_read_b128 v[140:143], v3 offset:13312
    v_cvt_pk_bf16_f32 v54, v84, v85
    v_mfma_f32_16x16x32_bf16 v[232:235], v[144:147], v[40:43], v[232:235]
    v_exp_f32 v86, v86
    v_mfma_f32_16x16x32_bf16 v[236:239], v[144:147], v[44:47], v[236:239]
    ds_read_b128 v[144:147], v3 offset:14336
    s_cmp_ge_i32 s67, 3
    v_mfma_f32_16x16x32_bf16 v[240:243], v[148:151], v[40:43], v[240:243]
    v_exp_f32 v87, v87
    v_mfma_f32_16x16x32_bf16 v[244:247], v[148:151], v[44:47], v[244:247]
    ds_read_b128 v[148:151], v3 offset:15360
    v_cvt_pk_bf16_f32 v55, v86, v87
    v_mfma_f32_16x16x32_bf16 v[16:19], v[12:15], v[40:43], v[16:19]
    s_waitcnt vmcnt(8)
    s_barrier
    v_mfma_f32_16x16x32_bf16 v[20:23], v[12:15], v[44:47], v[20:23]
    s_cbranch_scc1 m_hot_short
    v_add_u32 v3, s63, v1
    s_branch m_even_ns
m_even:
    s_cmp_ge_u32 s48, 4
    s_cbranch_scc1 m_ev1
    s_waitcnt vmcnt(0)
    s_cmp_lg_u32 s48, 0
    s_cbranch_scc1 m_ev1
    v_and_b32 v10, 15, v0
    v_lshlrev_b32 v10, 3, v10
    s_mov_b32 s54, 0
m_pbs:
    v_cmp_ne_u64 vcc, s[68:69], v[254:255]
    s_add_u32 s54, s54, 1
    s_cmp_ge_u32 s54, 0x200000
    s_cbranch_scc1 m_ev1
    s_cbranch_vccz m_ev1
    buffer_load_dwordx2 v[254:255], v10, s[44:47], s70 offen sc1
    s_waitcnt vmcnt(0)
    s_branch m_pbs
m_ev1:
    s_add_u32 s62, s62, 0x4000
    s_and_b32 s62, s62, 0xffff
    s_add_u32 s63, s63, 0x4000
    s_and_b32 s63, s63, 0xffff
    v_add_u32 v2, s62, v4
    v_add_u32 v3, s63, v1
    s_waitcnt vmcnt(8)
    s_barrier
    s_add_u32 s61, s61, 1
    s_cmp_lg_u32 s48, 0
    s_cbranch_scc1 m_ev2
    v_mov_b32 v8, s68
    v_mov_b32 v9, s69
    s_mov_b64 exec, 1
    s_lshl_b32 s52, s50, 3
    s_add_u32 s52, s52, s71
    buffer_store_dwordx2 v[8:9], off, s[44:47], s52 sc1
    s_mov_b64 exec, -1
m_ev2:
    s_cmp_lt_i32 s67, 3
    s_cbranch_scc1 m_even_ns
    s_cmp_lt_u32 s48, 4
    s_cbranch_scc1 m_hot_long
    s_setprio 1
    s_branch m_hot_short
m_wo:
    s_mov_b32 s36, s22
    s_mov_b32 s37, s23
    s_mov_b32 s38, 0x400000
    s_mov_b32 s39, 0x20000
    s_mov_b32 s40, s20
    s_mov_b32 s41, s21
    s_mov_b32 s42, 0x80000
    s_mov_b32 s43, 0x20000
    s_lshl_b32 s52, s2, 14
    s_add_u32 s52, s52, s66
    s_lshl_b32 s53, s2, 11
    s_add_u32 s53, s53, s51
    buffer_load_dwordx4 v[248:251], v1, s[36:39], s52 offen offset:0
    buffer_load_dwordx4 v[248:251], v1, s[36:39], s52 offen offset:1024
    buffer_load_dwordx4 v[248:251], v1, s[36:39], s52 offen offset:2048
    buffer_load_dwordx4 v[248:251], v1, s[36:39], s52 offen offset:3072
    s_cmp_ge_u32 s48, 2
    s_cbranch_scc1 m_wo_back
    buffer_load_dwordx4 v[248:251], v1, s[40:43], s53 offen
    s_branch m_wo_back
m_even_ns:
    s_cmp_lt_u32 s48, 4
    s_cbranch_scc1 m_sy1
    s_cmp_lg_u32 s62, s98
    s_cbranch_scc1 m_tga3
    buffer_load_dwordx2 v[252:253], v254, s[44:47], s71 offen sc1
m_tga3:
    s_cmp_lg_u32 s62, s99
    s_cbranch_scc1 m_tgb3
    s_lshr_b32 s53, s64, 16
    s_mov_b32 s54, 0
    s_waitcnt vmcnt(8)
m_tgs3:
    v_cmp_ne_u64 vcc, s[68:69], v[252:253]
    s_add_u32 s54, s54, 1
    s_cmp_ge_u32 s54, 0x200000
    s_cbranch_scc1 m_tgb3
    s_bitcmp0_b64 vcc, s53
    s_cbranch_scc1 m_tgc3
    buffer_load_dwordx2 v[252:253], v254, s[44:47], s71 offen sc1
    s_waitcnt vmcnt(0)
    s_branch m_tgs3
m_tgc3:
    s_cbranch_vccnz m_tgb3
    s_mov_b32 s98, 1
    s_mov_b32 s99, 1
m_tgb3:
    s_xor_b32 s53, s62, 0x8000
    s_add_u32 s53, s53, s66
    s_add_u32 m0, s53, 98304
    s_nop 0
    buffer_load_dwordx4 v1, s[28:31], s64 offen offset:0 sc1 lds
    buffer_load_dwordx4 v1, s[28:31], s64 offen offset:1024 sc1 lds
    buffer_load_dwordx4 v1, s[28:31], s64 offen offset:2048 sc1 lds
    buffer_load_dwordx4 v1, s[28:31], s64 offen offset:3072 sc1 lds
    s_add_u32 s64, s64, 0x4000
    s_xor_b32 s53, s63, 0x8000
    s_add_u32 s53, s53, s66
    s_add_u32 m0, s53, 0
    s_nop 0
    buffer_load_dwordx4 v1, s[8:11], s65 offen offset:0 sc1 lds
    buffer_load_dwordx4 v1, s[8:11], s65 offen offset:1024 sc1 lds
    buffer_load_dwordx4 v1, s[8:11], s65 offen offset:2048 sc1 lds
    buffer_load_dwordx4 v1, s[8:11], s65 offen offset:3072 sc1 lds
    s_add_u32 s65, s65, 0x4000
m_sy1:
    s_cmp_eq_u32 s67, 0
    s_cbranch_scc1 m_e_tail1
    s_cmp_lg_u32 s67, 1
    s_cbranch_scc1 m_nomask2
    v_cmp_gt_i32 vcc, 0, v5
    v_mov_b32 v32, v6
    s_nop 0
    v_cndmask_b32 v24, v24, v6, vcc
    v_cndmask_b32 v36, v36, v6, vcc
    v_cmp_gt_i32 vcc, 1, v5
    v_mov_b32 v33, v6
    s_nop 0
    v_cndmask_b32 v25, v25, v6, vcc
    v_cndmask_b32 v37, v37, v6, vcc
    v_cmp_gt_i32 vcc, 2, v5
    v_mov_b32 v34, v6
    s_nop 0
    v_cndmask_b32 v26, v26, v6, vcc
    v_cndmask_b32 v38, v38, v6, vcc
    v_cmp_gt_i32 vcc, 3, v5
    v_mov_b32 v35, v6
    s_nop 0
    v_cndmask_b32 v27, v27, v6, vcc
    v_cndmask_b32 v39, v39, v6, vcc
    s_nop 1
m_nomask2:
    s_waitcnt lgkmcnt(8)
    v_mfma_f32_16x16x32_bf16 v[72:75], v[88:91], v[152:155], v[24:27]
    v_exp_f32 v56, v56
    v_mfma_f32_16x16x32_bf16 v[72:75], v[92:95], v[156:159], v[72:75]
    v_exp_f32 v57, v57
    v_mfma_f32_16x16x32_bf16 v[72:75], v[96:99], v[160:163], v[72:75]
    v_exp_f32 v58, v58
    v_mfma_f32_16x16x32_bf16 v[72:75], v[100:103], v[164:167], v[72:75]
    v_exp_f32 v59, v59
    v_mfma_f32_16x16x32_bf16 v[80:83], v[88:91], v[168:171], v[28:31]
    ds_read_b128 v[88:91], v2 offset:0
    v_cvt_pk_bf16_f32 v40, v56, v57
    v_mfma_f32_16x16x32_bf16 v[80:83], v[92:95], v[172:175], v[80:83]
    ds_read_b128 v[92:95], v2 offset:1024
    v_cvt_pk_bf16_f32 v41, v58, v59
    v_mfma_f32_16x16x32_bf16 v[80:83], v[96:99], v[176:179], v[80:83]
    ds_read_b128 v[96:99], v2 offset:2048
    v_mfma_f32_16x16x32_bf16 v[80:83], v[100:103], v[180:183], v[80:83]
    ds_read_b128 v[100:103], v2 offset:3072
    v_mfma_f32_16x16x32_bf16 v[76:79], v[104:107], v[152:155], v[32:35]
    v_exp_f32 v60, v60
    v_mfma_f32_16x16x32_bf16 v[76:79], v[108:111], v[156:159], v[76:79]
    v_exp_f32 v61, v61
    v_mfma_f32_16x16x32_bf16 v[76:79], v[112:115], v[160:163], v[76:79]
    v_exp_f32 v62, v62
    v_mfma_f32_16x16x32_bf16 v[76:79], v[116:119], v[164:167], v[76:79]
    v_exp_f32 v63, v63
    v_mfma_f32_16x16x32_bf16 v[84:87], v[104:107], v[168:171], v[36:39]
    ds_read_b128 v[104:107], v2 offset:4096
    v_cvt_pk_bf16_f32 v42, v60, v61
    v_mfma_f32_16x16x32_bf16 v[84:87], v[108:111], v[172:175], v[84:87]
    ds_read_b128 v[108:111], v2 offset:5120
    v_cvt_pk_bf16_f32 v43, v62, v63
    v_mfma_f32_16x16x32_bf16 v[84:87], v[112:115], v[176:179], v[84:87]
    ds_read_b128 v[112:115], v2 offset:6144
    v_mfma_f32_16x16x32_bf16 v[84:87], v[116:119], v[180:183], v[84:87]
    ds_read_b128 v[116:119], v2 offset:7168
    s_waitcnt lgkmcnt(8)
    v_mfma_f32_16x16x32_bf16 v[184:187], v[120:123], v[48:51], v[184:187]
    v_exp_f32 v64, v64
    v_mfma_f32_16x16x32_bf16 v[188:191], v[120:123], v[52:55], v[188:191]
    ds_read_b128 v[120:123], v3 offset:0
    v_mfma_f32_16x16x32_bf16 v[192:195], v[124:127], v[48:51], v[192:195]
    v_exp_f32 v65, v65
    v_mfma_f32_16x16x32_bf16 v[196:199], v[124:127], v[52:55], v[196:199]
    ds_read_b128 v[124:127], v3 offset:1024
    v_cvt_pk_bf16_f32 v44, v64, v65
    v_mfma_f32_16x16x32_bf16 v[200:203], v[128:131], v[48:51], v[200:203]
    v_exp_f32 v66, v66
    v_mfma_f32_16x16x32_bf16 v[204:207], v[128:131], v[52:55], v[204:207]
    ds_read_b128 v[128:131], v3 offset:2048
    v_mfma_f32_16x16x32_bf16 v[208:211], v[132:135], v[48:51], v[208:211]
    v_exp_f32 v67, v67
    v_mfma_f32_16x16x32_bf16 v[212:215], v[132:135], v[52:55], v[212:215]
    ds_read_b128 v[132:135], v3 offset:3072
    v_cvt_pk_bf16_f32 v45, v66, v67
    v_mfma_f32_16x16x32_bf16 v[216:219], v[136:139], v[48:51], v[216:219]
    v_exp_f32 v68, v68
    v_mfma_f32_16x16x32_bf16 v[220:223], v[136:139], v[52:55], v[220:223]
    ds_read_b128 v[136:139], v3 offset:4096
    v_mfma_f32_16x16x32_bf16 v[224:227], v[140:143], v[48:51], v[224:227]
    v_exp_f32 v69, v69
    v_mfma_f32_16x16x32_bf16 v[228:231], v[140:143], v[52:55], v[228:231]
    ds_read_b128 v[140:143], v3 offset:5120
    v_cvt_pk_bf16_f32 v46, v68, v69
    v_mfma_f32_16x16x32_bf16 v[232:235], v[144:147], v[48:51], v[232:235]
    v_exp_f32 v70, v70
    v_mfma_f32_16x16x32_bf16 v[236:239], v[144:147], v[52:55], v[236:239]
    ds_read_b128 v[144:147], v3 offset:6144
    v_mfma_f32_16x16x32_bf16 v[240:243], v[148:151], v[48:51], v[240:243]
    v_exp_f32 v71, v71
    v_mfma_f32_16x16x32_bf16 v[244:247], v[148:151], v[52:55], v[244:247]
    ds_read_b128 v[148:151], v3 offset:7168
    v_cvt_pk_bf16_f32 v47, v70, v71
    v_mfma_f32_16x16x32_bf16 v[16:19], v[12:15], v[48:51], v[16:19]
    v_mfma_f32_16x16x32_bf16 v[20:23], v[12:15], v[52:55], v[20:23]
m_odd:
    s_sub_u32 s67, s67, 1
    s_cmp_lt_i32 s67, 0
    s_cbranch_scc1 m_o_tail2
    s_cmp_eq_u32 s67, 0
    s_cbranch_scc1 m_o_tail1
    s_cmp_lg_u32 s67, 1
    s_cbranch_scc1 m_nomask3
    v_cmp_gt_i32 vcc, 0, v5
    v_mov_b32 v32, v6
    s_nop 0
    v_cndmask_b32 v24, v24, v6, vcc
    v_cndmask_b32 v36, v36, v6, vcc
    v_cmp_gt_i32 vcc, 1, v5
    v_mov_b32 v33, v6
    s_nop 0
    v_cndmask_b32 v25, v25, v6, vcc
    v_cndmask_b32 v37, v37, v6, vcc
    v_cmp_gt_i32 vcc, 2, v5
    v_mov_b32 v34, v6
    s_nop 0
    v_cndmask_b32 v26, v26, v6, vcc
    v_cndmask_b32 v38, v38, v6, vcc
    v_cmp_gt_i32 vcc, 3, v5
    v_mov_b32 v35, v6
    s_nop 0
    v_cndmask_b32 v27, v27, v6, vcc
    v_cndmask_b32 v39, v39, v6, vcc
    s_nop 1
m_nomask3:
    s_waitcnt lgkmcnt(8)
    v_mfma_f32_16x16x32_bf16 v[56:59], v[88:91], v[152:155], v[24:27]
    v_exp_f32 v72, v72
    v_mfma_f32_16x16x32_bf16 v[56:59], v[92:95], v[156:159], v[56:59]
    v_exp_f32 v73, v73
    v_mfma_f32_16x16x32_bf16 v[56:59], v[96:99], v[160:163], v[56:59]
    v_exp_f32 v74, v74
    v_mfma_f32_16x16x32_bf16 v[56:59], v[100:103], v[164:167], v[56:59]
    v_exp_f32 v75, v75
    v_mfma_f32_16x16x32_bf16 v[64:67], v[88:91], v[168:171], v[28:31]
    ds_read_b128 v[88:91], v2 offset:8192
    v_cvt_pk_bf16_f32 v48, v72, v73
    v_mfma_f32_16x16x32_bf16 v[64:67], v[92:95], v[172:175], v[64:67]
    ds_read_b128 v[92:95], v2 offset:9216
    v_cvt_pk_bf16_f32 v49, v74, v75
    v_mfma_f32_16x16x32_bf16 v[64:67], v[96:99], v[176:179], v[64:67]
    ds_read_b128 v[96:99], v2 offset:10240
    v_mfma_f32_16x16x32_bf16 v[64:67], v[100:103], v[180:183], v[64:67]
    ds_read_b128 v[100:103], v2 offset:11264
    v_mfma_f32_16x16x32_bf16 v[60:63], v[104:107], v[152:155], v[32:35]
    v_exp_f32 v76, v76
    v_mfma_f32_16x16x32_bf16 v[60:63], v[108:111], v[156:159], v[60:63]
    v_exp_f32 v77, v77
    v_mfma_f32_16x16x32_bf16 v[60:63], v[112:115], v[160:163], v[60:63]
    v_exp_f32 v78, v78
    v_mfma_f32_16x16x32_bf16 v[60:63], v[116:119], v[164:167], v[60:63]
    v_exp_f32 v79, v79
    v_mfma_f32_16x16x32_bf16 v[68:71], v[104:107], v[168:171], v[36:39]
    ds_read_b128 v[104:107], v2 offset:12288
    v_cvt_pk_bf16_f32 v50, v76, v77
    v_mfma_f32_16x16x32_bf16 v[68:71], v[108:111], v[172:175], v[68:71]
    ds_read_b128 v[108:111], v2 offset:13312
    v_cvt_pk_bf16_f32 v51, v78, v79
    v_mfma_f32_16x16x32_bf16 v[68:71], v[112:115], v[176:179], v[68:71]
    ds_read_b128 v[112:115], v2 offset:14336
    v_mfma_f32_16x16x32_bf16 v[68:71], v[116:119], v[180:183], v[68:71]
    ds_read_b128 v[116:119], v2 offset:15360
    s_waitcnt lgkmcnt(8)
    v_mfma_f32_16x16x32_bf16 v[184:187], v[120:123], v[40:43], v[184:187]
    v_exp_f32 v80, v80
    v_mfma_f32_16x16x32_bf16 v[188:191], v[120:123], v[44:47], v[188:191]
    ds_read_b128 v[120:123], v3 offset:8192
    v_mfma_f32_16x16x32_bf16 v[192:195], v[124:127], v[40:43], v[192:195]
    v_exp_f32 v81, v81
    v_mfma_f32_16x16x32_bf16 v[196:199], v[124:127], v[44:47], v[196:199]
    ds_read_b128 v[124:127], v3 offset:9216
    v_cvt_pk_bf16_f32 v52, v80, v81
    v_mfma_f32_16x16x32_bf16 v[200:203], v[128:131], v[40:43], v[200:203]
    v_exp_f32 v82, v82
    v_mfma_f32_16x16x32_bf16 v[204:207], v[128:131], v[44:47], v[204:207]
    ds_read_b128 v[128:131], v3 offset:10240
    v_mfma_f32_16x16x32_bf16 v[208:211], v[132:135], v[40:43], v[208:211]
    v_exp_f32 v83, v83
    v_mfma_f32_16x16x32_bf16 v[212:215], v[132:135], v[44:47], v[212:215]
    ds_read_b128 v[132:135], v3 offset:11264
    v_cvt_pk_bf16_f32 v53, v82, v83
    v_mfma_f32_16x16x32_bf16 v[216:219], v[136:139], v[40:43], v[216:219]
    v_exp_f32 v84, v84
    v_mfma_f32_16x16x32_bf16 v[220:223], v[136:139], v[44:47], v[220:223]
    ds_read_b128 v[136:139], v3 offset:12288
    v_mfma_f32_16x16x32_bf16 v[224:227], v[140:143], v[40:43], v[224:227]
    v_exp_f32 v85, v85
    v_mfma_f32_16x16x32_bf16 v[228:231], v[140:143], v[44:47], v[228:231]
    ds_read_b128 v[140:143], v3 offset:13312
    v_cvt_pk_bf16_f32 v54, v84, v85
    v_mfma_f32_16x16x32_bf16 v[232:235], v[144:147], v[40:43], v[232:235]
    v_exp_f32 v86, v86
    v_mfma_f32_16x16x32_bf16 v[236:239], v[144:147], v[44:47], v[236:239]
    ds_read_b128 v[144:147], v3 offset:14336
    v_mfma_f32_16x16x32_bf16 v[240:243], v[148:151], v[40:43], v[240:243]
    v_exp_f32 v87, v87
    v_mfma_f32_16x16x32_bf16 v[244:247], v[148:151], v[44:47], v[244:247]
    ds_read_b128 v[148:151], v3 offset:15360
    v_cvt_pk_bf16_f32 v55, v86, v87
    v_mfma_f32_16x16x32_bf16 v[16:19], v[12:15], v[40:43], v[16:19]
    v_mfma_f32_16x16x32_bf16 v[20:23], v[12:15], v[44:47], v[20:23]
    s_sub_u32 s67, s67, 1
    s_branch m_even
m_o_tail1:
    s_waitcnt lgkmcnt(0)
    v_mfma_f32_16x16x32_bf16 v[184:187], v[120:123], v[40:43], v[184:187]
    v_exp_f32 v72, v72
    v_mfma_f32_16x16x32_bf16 v[188:191], v[120:123], v[44:47], v[188:191]
    ds_read_b128 v[120:123], v3 offset:8192
    v_exp_f32 v73, v73
    v_mfma_f32_16x16x32_bf16 v[192:195], v[124:127], v[40:43], v[192:195]
    v_exp_f32 v74, v74
    v_mfma_f32_16x16x32_bf16 v[196:199], v[124:127], v[44:47], v[196:199]
    ds_read_b128 v[124:127], v3 offset:9216
    v_exp_f32 v75, v75
    v_cvt_pk_bf16_f32 v48, v72, v73
    v_mfma_f32_16x16x32_bf16 v[200:203], v[128:131], v[40:43], v[200:203]
    v_exp_f32 v76, v76
    v_mfma_f32_16x16x32_bf16 v[204:207], v[128:131], v[44:47], v[204:207]
    ds_read_b128 v[128:131], v3 offset:10240
    v_exp_f32 v77, v77
    v_cvt_pk_bf16_f32 v49, v74, v75
    v_mfma_f32_16x16x32_bf16 v[208:211], v[132:135], v[40:43], v[208:211]
    v_exp_f32 v78, v78
    v_mfma_f32_16x16x32_bf16 v[212:215], v[132:135], v[44:47], v[212:215]
    ds_read_b128 v[132:135], v3 offset:11264
    v_exp_f32 v79, v79
    v_cvt_pk_bf16_f32 v50, v76, v77
    v_mfma_f32_16x16x32_bf16 v[216:219], v[136:139], v[40:43], v[216:219]
    v_exp_f32 v80, v80
    v_mfma_f32_16x16x32_bf16 v[220:223], v[136:139], v[44:47], v[220:223]
    ds_read_b128 v[136:139], v3 offset:12288
    v_exp_f32 v81, v81
    v_cvt_pk_bf16_f32 v51, v78, v79
    v_mfma_f32_16x16x32_bf16 v[224:227], v[140:143], v[40:43], v[224:227]
    v_exp_f32 v82, v82
    v_mfma_f32_16x16x32_bf16 v[228:231], v[140:143], v[44:47], v[228:231]
    ds_read_b128 v[140:143], v3 offset:13312
    v_exp_f32 v83, v83
    v_cvt_pk_bf16_f32 v52, v80, v81
    v_mfma_f32_16x16x32_bf16 v[232:235], v[144:147], v[40:43], v[232:235]
    v_exp_f32 v84, v84
    v_mfma_f32_16x16x32_bf16 v[236:239], v[144:147], v[44:47], v[236:239]
    ds_read_b128 v[144:147], v3 offset:14336
    v_exp_f32 v85, v85
    v_cvt_pk_bf16_f32 v53, v82, v83
    v_mfma_f32_16x16x32_bf16 v[240:243], v[148:151], v[40:43], v[240:243]
    v_exp_f32 v86, v86
    v_mfma_f32_16x16x32_bf16 v[244:247], v[148:151], v[44:47], v[244:247]
    ds_read_b128 v[148:151], v3 offset:15360
    v_exp_f32 v87, v87
    v_cvt_pk_bf16_f32 v54, v84, v85
    v_mfma_f32_16x16x32_bf16 v[16:19], v[12:15], v[40:43], v[16:19]
    v_mfma_f32_16x16x32_bf16 v[20:23], v[12:15], v[44:47], v[20:23]
    v_cvt_pk_bf16_f32 v55, v86, v87
    s_cmp_ge_u32 s61, s60
    s_cbranch_scc1 m_ms2
    s_add_u32 s62, s62, 0x4000
    s_and_b32 s62, s62, 0xffff
    s_add_u32 s63, s63, 0x4000
    s_and_b32 s63, s63, 0xffff
    v_add_u32 v2, s62, v4
    v_add_u32 v3, s63, v1
    s_waitcnt vmcnt(8)
    s_barrier
    s_add_u32 s61, s61, 1
    s_cmp_lt_u32 s48, 4
    s_cbranch_scc1 m_sy3
    s_cmp_lg_u32 s62, s98
    s_cbranch_scc1 m_tga4
    buffer_load_dwordx2 v[252:253], v254, s[44:47], s71 offen sc1
m_tga4:
    s_cmp_lg_u32 s62, s99
    s_cbranch_scc1 m_tgb4
    s_lshr_b32 s53, s64, 16
    s_mov_b32 s54, 0
    s_waitcnt vmcnt(8)
m_tgs4:
    v_cmp_ne_u64 vcc, s[68:69], v[252:253]
    s_add_u32 s54, s54, 1
    s_cmp_ge_u32 s54, 0x200000
    s_cbranch_scc1 m_tgb4
    s_bitcmp0_b64 vcc, s53
    s_cbranch_scc1 m_tgc4
    buffer_load_dwordx2 v[252:253], v254, s[44:47], s71 offen sc1
    s_waitcnt vmcnt(0)
    s_branch m_tgs4
m_tgc4:
    s_cbranch_vccnz m_tgb4
    s_mov_b32 s98, 1
    s_mov_b32 s99, 1
m_tgb4:
    s_xor_b32 s53, s62, 0x8000
    s_add_u32 s53, s53, s66
    s_add_u32 m0, s53, 98304
    s_nop 0
    buffer_load_dwordx4 v1, s[28:31], s64 offen offset:0 sc1 lds
    buffer_load_dwordx4 v1, s[28:31], s64 offen offset:1024 sc1 lds
    buffer_load_dwordx4 v1, s[28:31], s64 offen offset:2048 sc1 lds
    buffer_load_dwordx4 v1, s[28:31], s64 offen offset:3072 sc1 lds
    s_add_u32 s64, s64, 0x4000
    s_xor_b32 s53, s63, 0x8000
    s_add_u32 s53, s53, s66
    s_add_u32 m0, s53, 0
    s_nop 0
    buffer_load_dwordx4 v1, s[8:11], s65 offen offset:0 sc1 lds
    buffer_load_dwordx4 v1, s[8:11], s65 offen offset:1024 sc1 lds
    buffer_load_dwordx4 v1, s[8:11], s65 offen offset:2048 sc1 lds
    buffer_load_dwordx4 v1, s[8:11], s65 offen offset:3072 sc1 lds
    s_add_u32 s65, s65, 0x4000
m_sy3:
m_ms2:
    s_waitcnt lgkmcnt(0)
    s_nop 1
    v_mfma_f32_16x16x32_bf16 v[184:187], v[120:123], v[48:51], v[184:187]
    v_mfma_f32_16x16x32_bf16 v[188:191], v[120:123], v[52:55], v[188:191]
    v_mfma_f32_16x16x32_bf16 v[192:195], v[124:127], v[48:51], v[192:195]
    v_mfma_f32_16x16x32_bf16 v[196:199], v[124:127], v[52:55], v[196:199]
    v_mfma_f32_16x16x32_bf16 v[200:203], v[128:131], v[48:51], v[200:203]
    v_mfma_f32_16x16x32_bf16 v[204:207], v[128:131], v[52:55], v[204:207]
    v_mfma_f32_16x16x32_bf16 v[208:211], v[132:135], v[48:51], v[208:211]
    v_mfma_f32_16x16x32_bf16 v[212:215], v[132:135], v[52:55], v[212:215]
    v_mfma_f32_16x16x32_bf16 v[216:219], v[136:139], v[48:51], v[216:219]
    v_mfma_f32_16x16x32_bf16 v[220:223], v[136:139], v[52:55], v[220:223]
    v_mfma_f32_16x16x32_bf16 v[224:227], v[140:143], v[48:51], v[224:227]
    v_mfma_f32_16x16x32_bf16 v[228:231], v[140:143], v[52:55], v[228:231]
    v_mfma_f32_16x16x32_bf16 v[232:235], v[144:147], v[48:51], v[232:235]
    v_mfma_f32_16x16x32_bf16 v[236:239], v[144:147], v[52:55], v[236:239]
    v_mfma_f32_16x16x32_bf16 v[240:243], v[148:151], v[48:51], v[240:243]
    v_mfma_f32_16x16x32_bf16 v[244:247], v[148:151], v[52:55], v[244:247]
    v_mfma_f32_16x16x32_bf16 v[16:19], v[12:15], v[48:51], v[16:19]
    v_mfma_f32_16x16x32_bf16 v[20:23], v[12:15], v[52:55], v[20:23]
    s_branch m_fin
m_e_tail1:
    s_waitcnt lgkmcnt(0)
    v_mfma_f32_16x16x32_bf16 v[184:187], v[120:123], v[48:51], v[184:187]
    v_exp_f32 v56, v56
    v_mfma_f32_16x16x32_bf16 v[188:191], v[120:123], v[52:55], v[188:191]
    ds_read_b128 v[120:123], v3 offset:0
    v_exp_f32 v57, v57
    v_mfma_f32_16x16x32_bf16 v[192:195], v[124:127], v[48:51], v[192:195]
    v_exp_f32 v58, v58
    v_mfma_f32_16x16x32_bf16 v[196:199], v[124:127], v[52:55], v[196:199]
    ds_read_b128 v[124:127], v3 offset:1024
    v_exp_f32 v59, v59
    v_cvt_pk_bf16_f32 v40, v56, v57
    v_mfma_f32_16x16x32_bf16 v[200:203], v[128:131], v[48:51], v[200:203]
    v_exp_f32 v60, v60
    v_mfma_f32_16x16x32_bf16 v[204:207], v[128:131], v[52:55], v[204:207]
    ds_read_b128 v[128:131], v3 offset:2048
    v_exp_f32 v61, v61
    v_cvt_pk_bf16_f32 v41, v58, v59
    v_mfma_f32_16x16x32_bf16 v[208:211], v[132:135], v[48:51], v[208:211]
    v_exp_f32 v62, v62
    v_mfma_f32_16x16x32_bf16 v[212:215], v[132:135], v[52:55], v[212:215]
    ds_read_b128 v[132:135], v3 offset:3072
    v_exp_f32 v63, v63
    v_cvt_pk_bf16_f32 v42, v60, v61
    v_mfma_f32_16x16x32_bf16 v[216:219], v[136:139], v[48:51], v[216:219]
    v_exp_f32 v64, v64
    v_mfma_f32_16x16x32_bf16 v[220:223], v[136:139], v[52:55], v[220:223]
    ds_read_b128 v[136:139], v3 offset:4096
    v_exp_f32 v65, v65
    v_cvt_pk_bf16_f32 v43, v62, v63
    v_mfma_f32_16x16x32_bf16 v[224:227], v[140:143], v[48:51], v[224:227]
    v_exp_f32 v66, v66
    v_mfma_f32_16x16x32_bf16 v[228:231], v[140:143], v[52:55], v[228:231]
    ds_read_b128 v[140:143], v3 offset:5120
    v_exp_f32 v67, v67
    v_cvt_pk_bf16_f32 v44, v64, v65
    v_mfma_f32_16x16x32_bf16 v[232:235], v[144:147], v[48:51], v[232:235]
    v_exp_f32 v68, v68
    v_mfma_f32_16x16x32_bf16 v[236:239], v[144:147], v[52:55], v[236:239]
    ds_read_b128 v[144:147], v3 offset:6144
    v_exp_f32 v69, v69
    v_cvt_pk_bf16_f32 v45, v66, v67
    v_mfma_f32_16x16x32_bf16 v[240:243], v[148:151], v[48:51], v[240:243]
    v_exp_f32 v70, v70
    v_mfma_f32_16x16x32_bf16 v[244:247], v[148:151], v[52:55], v[244:247]
    ds_read_b128 v[148:151], v3 offset:7168
    v_exp_f32 v71, v71
    v_cvt_pk_bf16_f32 v46, v68, v69
    v_mfma_f32_16x16x32_bf16 v[16:19], v[12:15], v[48:51], v[16:19]
    v_mfma_f32_16x16x32_bf16 v[20:23], v[12:15], v[52:55], v[20:23]
    v_cvt_pk_bf16_f32 v47, v70, v71
m_o_tail2:
    s_waitcnt lgkmcnt(0)
    s_nop 1
    v_mfma_f32_16x16x32_bf16 v[184:187], v[120:123], v[40:43], v[184:187]
    v_mfma_f32_16x16x32_bf16 v[188:191], v[120:123], v[44:47], v[188:191]
    v_mfma_f32_16x16x32_bf16 v[192:195], v[124:127], v[40:43], v[192:195]
    v_mfma_f32_16x16x32_bf16 v[196:199], v[124:127], v[44:47], v[196:199]
    v_mfma_f32_16x16x32_bf16 v[200:203], v[128:131], v[40:43], v[200:203]
    v_mfma_f32_16x16x32_bf16 v[204:207], v[128:131], v[44:47], v[204:207]
    v_mfma_f32_16x16x32_bf16 v[208:211], v[132:135], v[40:43], v[208:211]
    v_mfma_f32_16x16x32_bf16 v[212:215], v[132:135], v[44:47], v[212:215]
    v_mfma_f32_16x16x32_bf16 v[216:219], v[136:139], v[40:43], v[216:219]
    v_mfma_f32_16x16x32_bf16 v[220:223], v[136:139], v[44:47], v[220:223]
    v_mfma_f32_16x16x32_bf16 v[224:227], v[140:143], v[40:43], v[224:227]
    v_mfma_f32_16x16x32_bf16 v[228:231], v[140:143], v[44:47], v[228:231]
    v_mfma_f32_16x16x32_bf16 v[232:235], v[144:147], v[40:43], v[232:235]
    v_mfma_f32_16x16x32_bf16 v[236:239], v[144:147], v[44:47], v[236:239]
    v_mfma_f32_16x16x32_bf16 v[240:243], v[148:151], v[40:43], v[240:243]
    v_mfma_f32_16x16x32_bf16 v[244:247], v[148:151], v[44:47], v[244:247]
    v_mfma_f32_16x16x32_bf16 v[16:19], v[12:15], v[40:43], v[16:19]
    v_mfma_f32_16x16x32_bf16 v[20:23], v[12:15], v[44:47], v[20:23]
m_fin:
    s_setprio 0
    s_cmp_ge_u32 s61, s60
    s_cbranch_scc1 m_ms4
    s_add_u32 s62, s62, 0x4000
    s_and_b32 s62, s62, 0xffff
    s_add_u32 s63, s63, 0x4000
    s_and_b32 s63, s63, 0xffff
    v_add_u32 v2, s62, v4
    v_add_u32 v3, s63, v1
    s_waitcnt vmcnt(8)
    s_barrier
    s_add_u32 s61, s61, 1
    s_cmp_lt_u32 s48, 4
    s_cbranch_scc1 m_sy5
    s_cmp_lg_u32 s62, s98
    s_cbranch_scc1 m_tga5
    buffer_load_dwordx2 v[252:253], v254, s[44:47], s71 offen sc1
m_tga5:
    s_cmp_lg_u32 s62, s99
    s_cbranch_scc1 m_tgb5
    s_lshr_b32 s53, s64, 16
    s_mov_b32 s54, 0
    s_waitcnt vmcnt(8)
m_tgs5:
    v_cmp_ne_u64 vcc, s[68:69], v[252:253]
    s_add_u32 s54, s54, 1
    s_cmp_ge_u32 s54, 0x200000
    s_cbranch_scc1 m_tgb5
    s_bitcmp0_b64 vcc, s53
    s_cbranch_scc1 m_tgc5
    buffer_load_dwordx2 v[252:253], v254, s[44:47], s71 offen sc1
    s_waitcnt vmcnt(0)
    s_branch m_tgs5
m_tgc5:
    s_cbranch_vccnz m_tgb5
    s_mov_b32 s98, 1
    s_mov_b32 s99, 1
m_tgb5:
    s_xor_b32 s53, s62, 0x8000
    s_add_u32 s53, s53, s66
    s_add_u32 m0, s53, 98304
    s_nop 0
    buffer_load_dwordx4 v1, s[28:31], s64 offen offset:0 sc1 lds
    buffer_load_dwordx4 v1, s[28:31], s64 offen offset:1024 sc1 lds
    buffer_load_dwordx4 v1, s[28:31], s64 offen offset:2048 sc1 lds
    buffer_load_dwordx4 v1, s[28:31], s64 offen offset:3072 sc1 lds
    s_add_u32 s64, s64, 0x4000
    s_xor_b32 s53, s63, 0x8000
    s_add_u32 s53, s53, s66
    s_add_u32 m0, s53, 0
    s_nop 0
    buffer_load_dwordx4 v1, s[8:11], s65 offen offset:0 sc1 lds
    buffer_load_dwordx4 v1, s[8:11], s65 offen offset:1024 sc1 lds
    buffer_load_dwordx4 v1, s[8:11], s65 offen offset:2048 sc1 lds
    buffer_load_dwordx4 v1, s[8:11], s65 offen offset:3072 sc1 lds
    s_add_u32 s65, s65, 0x4000
m_sy5:
m_ms4:
    s_nop 7
    v_mov_b32 v8, 0
    v_mov_b32 v9, 0
    v_mov_b32 v10, 0
    v_mov_b32 v11, 0
    v_pk_fma_f32 v[8:9], v[184:185], v[10:11], v[8:9]
    v_pk_fma_f32 v[8:9], v[186:187], v[10:11], v[8:9]
    v_pk_fma_f32 v[8:9], v[188:189], v[10:11], v[8:9]
    v_pk_fma_f32 v[8:9], v[190:191], v[10:11], v[8:9]
    v_pk_fma_f32 v[8:9], v[192:193], v[10:11], v[8:9]
    v_pk_fma_f32 v[8:9], v[194:195], v[10:11], v[8:9]
    v_pk_fma_f32 v[8:9], v[196:197], v[10:11], v[8:9]
    v_pk_fma_f32 v[8:9], v[198:199], v[10:11], v[8:9]
    v_pk_fma_f32 v[8:9], v[200:201], v[10:11], v[8:9]
    v_pk_fma_f32 v[8:9], v[202:203], v[10:11], v[8:9]
    v_pk_fma_f32 v[8:9], v[204:205], v[10:11], v[8:9]
    v_pk_fma_f32 v[8:9], v[206:207], v[10:11], v[8:9]
    v_pk_fma_f32 v[8:9], v[208:209], v[10:11], v[8:9]
    v_pk_fma_f32 v[8:9], v[210:211], v[10:11], v[8:9]
    v_pk_fma_f32 v[8:9], v[212:213], v[10:11], v[8:9]
    v_pk_fma_f32 v[8:9], v[214:215], v[10:11], v[8:9]
    v_pk_fma_f32 v[8:9], v[216:217], v[10:11], v[8:9]
    v_pk_fma_f32 v[8:9], v[218:219], v[10:11], v[8:9]
    v_pk_fma_f32 v[8:9], v[220:221], v[10:11], v[8:9]
    v_pk_fma_f32 v[8:9], v[222:223], v[10:11], v[8:9]
    v_pk_fma_f32 v[8:9], v[224:225], v[10:11], v[8:9]
    v_pk_fma_f32 v[8:9], v[226:227], v[10:11], v[8:9]
    v_pk_fma_f32 v[8:9], v[228:229], v[10:11], v[8:9]
    v_pk_fma_f32 v[8:9], v[230:231], v[10:11], v[8:9]
    v_pk_fma_f32 v[8:9], v[232:233], v[10:11], v[8:9]
    v_pk_fma_f32 v[8:9], v[234:235], v[10:11], v[8:9]
    v_pk_fma_f32 v[8:9], v[236:237], v[10:11], v[8:9]
    v_pk_fma_f32 v[8:9], v[238:239], v[10:11], v[8:9]
    v_pk_fma_f32 v[8:9], v[240:241], v[10:11], v[8:9]
    v_pk_fma_f32 v[8:9], v[242:243], v[10:11], v[8:9]
    v_pk_fma_f32 v[8:9], v[244:245], v[10:11], v[8:9]
    v_pk_fma_f32 v[8:9], v[246:247], v[10:11], v[8:9]
    v_add_f32 v8, v8, v9
    v_add_f32 v9, v16, v20
    v_add_f32 v8, v8, v9
    s_mov_b32 s52, 0x71800000
    v_cmp_ngt_f32 vcc, s52, v8
    s_nop 4
    s_cbranch_vccnz m_slow
m_store:
    v_rcp_f32 v7, v16
    v_rcp_f32 v8, v20
    s_lshl_b32 s57, s59, 18
    s_lshl_b32 s53, s49, 12
    s_add_u32 s57, s57, s53
    s_add_u32 s57, s57, 33554432
    s_cmp_ge_u32 s61, s60
    s_cbranch_scc1 m_ms6
    s_add_u32 s62, s62, 0x4000
    s_and_b32 s62, s62, 0xffff
    s_add_u32 s63, s63, 0x4000
    s_and_b32 s63, s63, 0xffff
    v_add_u32 v2, s62, v4
    v_add_u32 v3, s63, v1
    s_waitcnt vmcnt(8)
    s_barrier
    s_add_u32 s61, s61, 1
    s_cmp_lt_u32 s48, 4
    s_cbranch_scc1 m_sy7
    s_cmp_lg_u32 s62, s98
    s_cbranch_scc1 m_tga6
    buffer_load_dwordx2 v[252:253], v254, s[44:47], s71 offen sc1
m_tga6:
    s_cmp_lg_u32 s62, s99
    s_cbranch_scc1 m_tgb6
    s_lshr_b32 s53, s64, 16
    s_mov_b32 s54, 0
    s_waitcnt vmcnt(8)
m_tgs6:
    v_cmp_ne_u64 vcc, s[68:69], v[252:253]
    s_add_u32 s54, s54, 1
    s_cmp_ge_u32 s54, 0x200000
    s_cbranch_scc1 m_tgb6
    s_bitcmp0_b64 vcc, s53
    s_cbranch_scc1 m_tgc6
    buffer_load_dwordx2 v[252:253], v254, s[44:47], s71 offen sc1
    s_waitcnt vmcnt(0)
    s_branch m_tgs6
m_tgc6:
    s_cbranch_vccnz m_tgb6
    s_mov_b32 s98, 1
    s_mov_b32 s99, 1
m_tgb6:
    s_xor_b32 s53, s62, 0x8000
    s_add_u32 s53, s53, s66
    s_add_u32 m0, s53, 98304
    s_nop 0
    buffer_load_dwordx4 v1, s[28:31], s64 offen offset:0 sc1 lds
    buffer_load_dwordx4 v1, s[28:31], s64 offen offset:1024 sc1 lds
    buffer_load_dwordx4 v1, s[28:31], s64 offen offset:2048 sc1 lds
    buffer_load_dwordx4 v1, s[28:31], s64 offen offset:3072 sc1 lds
    s_add_u32 s64, s64, 0x4000
    s_xor_b32 s53, s63, 0x8000
    s_add_u32 s53, s53, s66
    s_add_u32 m0, s53, 0
    s_nop 0
    buffer_load_dwordx4 v1, s[8:11], s65 offen offset:0 sc1 lds
    buffer_load_dwordx4 v1, s[8:11], s65 offen offset:1024 sc1 lds
    buffer_load_dwordx4 v1, s[8:11], s65 offen offset:2048 sc1 lds
    buffer_load_dwordx4 v1, s[8:11], s65 offen offset:3072 sc1 lds
    s_add_u32 s65, s65, 0x4000
m_sy7:
m_ms6:
    v_mul_f32 v184, v7, v184
    v_mul_f32 v185, v7, v185
    v_mul_f32 v186, v7, v186
    v_mul_f32 v187, v7, v187
    v_cvt_pk_bf16_f32 v56, v184, v185
    v_cvt_pk_bf16_f32 v57, v186, v187
    v_mul_f32 v192, v7, v192
    v_mul_f32 v193, v7, v193
    v_mul_f32 v194, v7, v194
    v_mul_f32 v195, v7, v195
    v_cvt_pk_bf16_f32 v58, v192, v193
    v_cvt_pk_bf16_f32 v59, v194, v195
    buffer_store_dwordx4 v[56:59], v1, s[44:47], s57 offen offset:0 sc1
    v_mul_f32 v200, v7, v200
    v_mul_f32 v201, v7, v201
    v_mul_f32 v202, v7, v202
    v_mul_f32 v203, v7, v203
    v_cvt_pk_bf16_f32 v60, v200, v201
    v_cvt_pk_bf16_f32 v61, v202, v203
    v_mul_f32 v208, v7, v208
    v_mul_f32 v209, v7, v209
    v_mul_f32 v210, v7, v210
    v_mul_f32 v211, v7, v211
    v_cvt_pk_bf16_f32 v62, v208, v209
    v_cvt_pk_bf16_f32 v63, v210, v211
    buffer_store_dwordx4 v[60:63], v1, s[44:47], s57 offen offset:1024 sc1
    s_cmp_ge_u32 s61, s60
    s_cbranch_scc1 m_ms8
    s_add_u32 s62, s62, 0x4000
    s_and_b32 s62, s62, 0xffff
    s_add_u32 s63, s63, 0x4000
    s_and_b32 s63, s63, 0xffff
    v_add_u32 v2, s62, v4
    v_add_u32 v3, s63, v1
    s_waitcnt vmcnt(10)
    s_barrier
    s_add_u32 s61, s61, 1
    s_cmp_lt_u32 s48, 4
    s_cbranch_scc1 m_sy9
    s_cmp_lg_u32 s62, s98
    s_cbranch_scc1 m_tga7
    buffer_load_dwordx2 v[252:253], v254, s[44:47], s71 offen sc1
m_tga7:
    s_cmp_lg_u32 s62, s99
    s_cbranch_scc1 m_tgb7
    s_lshr_b32 s53, s64, 16
    s_mov_b32 s54, 0
    s_waitcnt vmcnt(8)
m_tgs7:
    v_cmp_ne_u64 vcc, s[68:69], v[252:253]
    s_add_u32 s54, s54, 1
    s_cmp_ge_u32 s54, 0x200000
    s_cbranch_scc1 m_tgb7
    s_bitcmp0_b64 vcc, s53
    s_cbranch_scc1 m_tgc7
    buffer_load_dwordx2 v[252:253], v254, s[44:47], s71 offen sc1
    s_waitcnt vmcnt(0)
    s_branch m_tgs7
m_tgc7:
    s_cbranch_vccnz m_tgb7
    s_mov_b32 s98, 1
    s_mov_b32 s99, 1
m_tgb7:
    s_xor_b32 s53, s62, 0x8000
    s_add_u32 s53, s53, s66
    s_add_u32 m0, s53, 98304
    s_nop 0
    buffer_load_dwordx4 v1, s[28:31], s64 offen offset:0 sc1 lds
    buffer_load_dwordx4 v1, s[28:31], s64 offen offset:1024 sc1 lds
    buffer_load_dwordx4 v1, s[28:31], s64 offen offset:2048 sc1 lds
    buffer_load_dwordx4 v1, s[28:31], s64 offen offset:3072 sc1 lds
    s_add_u32 s64, s64, 0x4000
    s_xor_b32 s53, s63, 0x8000
    s_add_u32 s53, s53, s66
    s_add_u32 m0, s53, 0
    s_nop 0
    buffer_load_dwordx4 v1, s[8:11], s65 offen offset:0 sc1 lds
    buffer_load_dwordx4 v1, s[8:11], s65 offen offset:1024 sc1 lds
    buffer_load_dwordx4 v1, s[8:11], s65 offen offset:2048 sc1 lds
    buffer_load_dwordx4 v1, s[8:11], s65 offen offset:3072 sc1 lds
    s_add_u32 s65, s65, 0x4000
m_sy9:
m_ms8:
    v_mul_f32 v216, v7, v216
    v_mul_f32 v217, v7, v217
    v_mul_f32 v218, v7, v218
    v_mul_f32 v219, v7, v219
    v_cvt_pk_bf16_f32 v64, v216, v217
    v_cvt_pk_bf16_f32 v65, v218, v219
    v_mul_f32 v224, v7, v224
    v_mul_f32 v225, v7, v225
    v_mul_f32 v226, v7, v226
    v_mul_f32 v227, v7, v227
    v_cvt_pk_bf16_f32 v66, v224, v225
    v_cvt_pk_bf16_f32 v67, v226, v227
    buffer_store_dwordx4 v[64:67], v1, s[44:47], s57 offen offset:2048 sc1
    v_mul_f32 v232, v7, v232
    v_mul_f32 v233, v7, v233
    v_mul_f32 v234, v7, v234
    v_mul_f32 v235, v7, v235
    v_cvt_pk_bf16_f32 v68, v232, v233
    v_cvt_pk_bf16_f32 v69, v234, v235
    v_mul_f32 v240, v7, v240
    v_mul_f32 v241, v7, v241
    v_mul_f32 v242, v7, v242
    v_mul_f32 v243, v7, v243
    v_cvt_pk_bf16_f32 v70, v240, v241
    v_cvt_pk_bf16_f32 v71, v242, v243
    buffer_store_dwordx4 v[68:71], v1, s[44:47], s57 offen offset:3072 sc1
    s_add_u32 s57, s57, 131072
    s_cmp_ge_u32 s61, s60
    s_cbranch_scc1 m_ms10
    s_add_u32 s62, s62, 0x4000
    s_and_b32 s62, s62, 0xffff
    s_add_u32 s63, s63, 0x4000
    s_and_b32 s63, s63, 0xffff
    v_add_u32 v2, s62, v4
    v_add_u32 v3, s63, v1
    s_waitcnt vmcnt(12)
    s_barrier
    s_add_u32 s61, s61, 1
    s_cmp_lt_u32 s48, 4
    s_cbranch_scc1 m_sy11
    s_cmp_lg_u32 s62, s98
    s_cbranch_scc1 m_tga8
    buffer_load_dwordx2 v[252:253], v254, s[44:47], s71 offen sc1
m_tga8:
    s_cmp_lg_u32 s62, s99
    s_cbranch_scc1 m_tgb8
    s_lshr_b32 s53, s64, 16
    s_mov_b32 s54, 0
    s_waitcnt vmcnt(8)
m_tgs8:
    v_cmp_ne_u64 vcc, s[68:69], v[252:253]
    s_add_u32 s54, s54, 1
    s_cmp_ge_u32 s54, 0x200000
    s_cbranch_scc1 m_tgb8
    s_bitcmp0_b64 vcc, s53
    s_cbranch_scc1 m_tgc8
    buffer_load_dwordx2 v[252:253], v254, s[44:47], s71 offen sc1
    s_waitcnt vmcnt(0)
    s_branch m_tgs8
m_tgc8:
    s_cbranch_vccnz m_tgb8
    s_mov_b32 s98, 1
    s_mov_b32 s99, 1
m_tgb8:
    s_xor_b32 s53, s62, 0x8000
    s_add_u32 s53, s53, s66
    s_add_u32 m0, s53, 98304
    s_nop 0
    buffer_load_dwordx4 v1, s[28:31], s64 offen offset:0 sc1 lds
    buffer_load_dwordx4 v1, s[28:31], s64 offen offset:1024 sc1 lds
    buffer_load_dwordx4 v1, s[28:31], s64 offen offset:2048 sc1 lds
    buffer_load_dwordx4 v1, s[28:31], s64 offen offset:3072 sc1 lds
    s_add_u32 s64, s64, 0x4000
    s_xor_b32 s53, s63, 0x8000
    s_add_u32 s53, s53, s66
    s_add_u32 m0, s53, 0
    s_nop 0
    buffer_load_dwordx4 v1, s[8:11], s65 offen offset:0 sc1 lds
    buffer_load_dwordx4 v1, s[8:11], s65 offen offset:1024 sc1 lds
    buffer_load_dwordx4 v1, s[8:11], s65 offen offset:2048 sc1 lds
    buffer_load_dwordx4 v1, s[8:11], s65 offen offset:3072 sc1 lds
    s_add_u32 s65, s65, 0x4000
m_sy11:
m_ms10:
    v_mul_f32 v188, v8, v188
    v_mul_f32 v189, v8, v189
    v_mul_f32 v190, v8, v190
    v_mul_f32 v191, v8, v191
    v_cvt_pk_bf16_f32 v72, v188, v189
    v_cvt_pk_bf16_f32 v73, v190, v191
    v_mul_f32 v196, v8, v196
    v_mul_f32 v197, v8, v197
    v_mul_f32 v198, v8, v198
    v_mul_f32 v199, v8, v199
    v_cvt_pk_bf16_f32 v74, v196, v197
    v_cvt_pk_bf16_f32 v75, v198, v199
    buffer_store_dwordx4 v[72:75], v1, s[44:47], s57 offen offset:0 sc1
    v_mul_f32 v204, v8, v204
    v_mul_f32 v205, v8, v205
    v_mul_f32 v206, v8, v206
    v_mul_f32 v207, v8, v207
    v_cvt_pk_bf16_f32 v76, v204, v205
    v_cvt_pk_bf16_f32 v77, v206, v207
    v_mul_f32 v212, v8, v212
    v_mul_f32 v213, v8, v213
    v_mul_f32 v214, v8, v214
    v_mul_f32 v215, v8, v215
    v_cvt_pk_bf16_f32 v78, v212, v213
    v_cvt_pk_bf16_f32 v79, v214, v215
    buffer_store_dwordx4 v[76:79], v1, s[44:47], s57 offen offset:1024 sc1
    s_cmp_ge_u32 s61, s60
    s_cbranch_scc1 m_ms12
    s_add_u32 s62, s62, 0x4000
    s_and_b32 s62, s62, 0xffff
    s_add_u32 s63, s63, 0x4000
    s_and_b32 s63, s63, 0xffff
    v_add_u32 v2, s62, v4
    v_add_u32 v3, s63, v1
    s_waitcnt vmcnt(12)
    s_barrier
    s_add_u32 s61, s61, 1
    s_cmp_lt_u32 s48, 4
    s_cbranch_scc1 m_sy13
    s_cmp_lg_u32 s62, s98
    s_cbranch_scc1 m_tga9
    buffer_load_dwordx2 v[252:253], v254, s[44:47], s71 offen sc1
m_tga9:
    s_cmp_lg_u32 s62, s99
    s_cbranch_scc1 m_tgb9
    s_lshr_b32 s53, s64, 16
    s_mov_b32 s54, 0
    s_waitcnt vmcnt(8)
m_tgs9:
    v_cmp_ne_u64 vcc, s[68:69], v[252:253]
    s_add_u32 s54, s54, 1
    s_cmp_ge_u32 s54, 0x200000
    s_cbranch_scc1 m_tgb9
    s_bitcmp0_b64 vcc, s53
    s_cbranch_scc1 m_tgc9
    buffer_load_dwordx2 v[252:253], v254, s[44:47], s71 offen sc1
    s_waitcnt vmcnt(0)
    s_branch m_tgs9
m_tgc9:
    s_cbranch_vccnz m_tgb9
    s_mov_b32 s98, 1
    s_mov_b32 s99, 1
m_tgb9:
    s_xor_b32 s53, s62, 0x8000
    s_add_u32 s53, s53, s66
    s_add_u32 m0, s53, 98304
    s_nop 0
    buffer_load_dwordx4 v1, s[28:31], s64 offen offset:0 sc1 lds
    buffer_load_dwordx4 v1, s[28:31], s64 offen offset:1024 sc1 lds
    buffer_load_dwordx4 v1, s[28:31], s64 offen offset:2048 sc1 lds
    buffer_load_dwordx4 v1, s[28:31], s64 offen offset:3072 sc1 lds
    s_add_u32 s64, s64, 0x4000
    s_xor_b32 s53, s63, 0x8000
    s_add_u32 s53, s53, s66
    s_add_u32 m0, s53, 0
    s_nop 0
    buffer_load_dwordx4 v1, s[8:11], s65 offen offset:0 sc1 lds
    buffer_load_dwordx4 v1, s[8:11], s65 offen offset:1024 sc1 lds
    buffer_load_dwordx4 v1, s[8:11], s65 offen offset:2048 sc1 lds
    buffer_load_dwordx4 v1, s[8:11], s65 offen offset:3072 sc1 lds
    s_add_u32 s65, s65, 0x4000
m_sy13:
m_ms12:
    v_mul_f32 v220, v8, v220
    v_mul_f32 v221, v8, v221
    v_mul_f32 v222, v8, v222
    v_mul_f32 v223, v8, v223
    v_cvt_pk_bf16_f32 v80, v220, v221
    v_cvt_pk_bf16_f32 v81, v222, v223
    v_mul_f32 v228, v8, v228
    v_mul_f32 v229, v8, v229
    v_mul_f32 v230, v8, v230
    v_mul_f32 v231, v8, v231
    v_cvt_pk_bf16_f32 v82, v228, v229
    v_cvt_pk_bf16_f32 v83, v230, v231
    buffer_store_dwordx4 v[80:83], v1, s[44:47], s57 offen offset:2048 sc1
    v_mul_f32 v236, v8, v236
    v_mul_f32 v237, v8, v237
    v_mul_f32 v238, v8, v238
    v_mul_f32 v239, v8, v239
    v_cvt_pk_bf16_f32 v84, v236, v237
    v_cvt_pk_bf16_f32 v85, v238, v239
    v_mul_f32 v244, v8, v244
    v_mul_f32 v245, v8, v245
    v_mul_f32 v246, v8, v246
    v_mul_f32 v247, v8, v247
    v_cvt_pk_bf16_f32 v86, v244, v245
    v_cvt_pk_bf16_f32 v87, v246, v247
    buffer_store_dwordx4 v[84:87], v1, s[44:47], s57 offen offset:3072 sc1
    s_cmp_ge_u32 s61, s60
    s_cbranch_scc1 m_ms14
    s_add_u32 s62, s62, 0x4000
    s_and_b32 s62, s62, 0xffff
    s_add_u32 s63, s63, 0x4000
    s_and_b32 s63, s63, 0xffff
    v_add_u32 v2, s62, v4
    v_add_u32 v3, s63, v1
    s_waitcnt vmcnt(12)
    s_barrier
    s_add_u32 s61, s61, 1
    s_cmp_lt_u32 s48, 4
    s_cbranch_scc1 m_sy15
    s_cmp_lg_u32 s62, s98
    s_cbranch_scc1 m_tga10
    buffer_load_dwordx2 v[252:253], v254, s[44:47], s71 offen sc1
m_tga10:
    s_cmp_lg_u32 s62, s99
    s_cbranch_scc1 m_tgb10
    s_lshr_b32 s53, s64, 16
    s_mov_b32 s54, 0
    s_waitcnt vmcnt(8)
m_tgs10:
    v_cmp_ne_u64 vcc, s[68:69], v[252:253]
    s_add_u32 s54, s54, 1
    s_cmp_ge_u32 s54, 0x200000
    s_cbranch_scc1 m_tgb10
    s_bitcmp0_b64 vcc, s53
    s_cbranch_scc1 m_tgc10
    buffer_load_dwordx2 v[252:253], v254, s[44:47], s71 offen sc1
    s_waitcnt vmcnt(0)
    s_branch m_tgs10
m_tgc10:
    s_cbranch_vccnz m_tgb10
    s_mov_b32 s98, 1
    s_mov_b32 s99, 1
m_tgb10:
    s_xor_b32 s53, s62, 0x8000
    s_add_u32 s53, s53, s66
    s_add_u32 m0, s53, 98304
    s_nop 0
    buffer_load_dwordx4 v1, s[28:31], s64 offen offset:0 sc1 lds
    buffer_load_dwordx4 v1, s[28:31], s64 offen offset:1024 sc1 lds
    buffer_load_dwordx4 v1, s[28:31], s64 offen offset:2048 sc1 lds
    buffer_load_dwordx4 v1, s[28:31], s64 offen offset:3072 sc1 lds
    s_add_u32 s64, s64, 0x4000
    s_xor_b32 s53, s63, 0x8000
    s_add_u32 s53, s53, s66
    s_add_u32 m0, s53, 0
    s_nop 0
    buffer_load_dwordx4 v1, s[8:11], s65 offen offset:0 sc1 lds
    buffer_load_dwordx4 v1, s[8:11], s65 offen offset:1024 sc1 lds
    buffer_load_dwordx4 v1, s[8:11], s65 offen offset:2048 sc1 lds
    buffer_load_dwordx4 v1, s[8:11], s65 offen offset:3072 sc1 lds
    s_add_u32 s65, s65, 0x4000
m_sy15:
m_ms14:
    s_cmp_ge_u32 s61, s60
    s_cbranch_scc1 m_ms16
    s_add_u32 s62, s62, 0x4000
    s_and_b32 s62, s62, 0xffff
    s_add_u32 s63, s63, 0x4000
    s_and_b32 s63, s63, 0xffff
    v_add_u32 v2, s62, v4
    v_add_u32 v3, s63, v1
    s_waitcnt vmcnt(10)
    s_barrier
    s_add_u32 s61, s61, 1
    s_cmp_lt_u32 s48, 4
    s_cbranch_scc1 m_sy17
    s_cmp_lg_u32 s62, s98
    s_cbranch_scc1 m_tga11
    buffer_load_dwordx2 v[252:253], v254, s[44:47], s71 offen sc1
m_tga11:
    s_cmp_lg_u32 s62, s99
    s_cbranch_scc1 m_tgb11
    s_lshr_b32 s53, s64, 16
    s_mov_b32 s54, 0
    s_waitcnt vmcnt(8)
m_tgs11:
    v_cmp_ne_u64 vcc, s[68:69], v[252:253]
    s_add_u32 s54, s54, 1
    s_cmp_ge_u32 s54, 0x200000
    s_cbranch_scc1 m_tgb11
    s_bitcmp0_b64 vcc, s53
    s_cbranch_scc1 m_tgc11
    buffer_load_dwordx2 v[252:253], v254, s[44:47], s71 offen sc1
    s_waitcnt vmcnt(0)
    s_branch m_tgs11
m_tgc11:
    s_cbranch_vccnz m_tgb11
    s_mov_b32 s98, 1
    s_mov_b32 s99, 1
m_tgb11:
    s_xor_b32 s53, s62, 0x8000
    s_add_u32 s53, s53, s66
    s_add_u32 m0, s53, 98304
    s_nop 0
    buffer_load_dwordx4 v1, s[28:31], s64 offen offset:0 sc1 lds
    buffer_load_dwordx4 v1, s[28:31], s64 offen offset:1024 sc1 lds
    buffer_load_dwordx4 v1, s[28:31], s64 offen offset:2048 sc1 lds
    buffer_load_dwordx4 v1, s[28:31], s64 offen offset:3072 sc1 lds
    s_add_u32 s64, s64, 0x4000
    s_xor_b32 s53, s63, 0x8000
    s_add_u32 s53, s53, s66
    s_add_u32 m0, s53, 0
    s_nop 0
    buffer_load_dwordx4 v1, s[8:11], s65 offen offset:0 sc1 lds
    buffer_load_dwordx4 v1, s[8:11], s65 offen offset:1024 sc1 lds
    buffer_load_dwordx4 v1, s[8:11], s65 offen offset:2048 sc1 lds
    buffer_load_dwordx4 v1, s[8:11], s65 offen offset:3072 sc1 lds
    s_add_u32 s65, s65, 0x4000
m_sy17:
m_ms16:
m_idle:
    s_cmp_ge_u32 s61, s60
    s_cbranch_scc1 m_done
    s_add_u32 s62, s62, 0x4000
    s_and_b32 s62, s62, 0xffff
    s_add_u32 s63, s63, 0x4000
    s_and_b32 s63, s63, 0xffff
    v_add_u32 v2, s62, v4
    v_add_u32 v3, s63, v1
    s_waitcnt vmcnt(8)
    s_barrier
    s_add_u32 s61, s61, 1
    s_cmp_lg_u32 s62, s98
    s_cbranch_scc1 m_tga12
    buffer_load_dwordx2 v[252:253], v254, s[44:47], s71 offen sc1
m_tga12:
    s_cmp_lg_u32 s62, s99
    s_cbranch_scc1 m_tgb12
    s_lshr_b32 s53, s64, 16
    s_mov_b32 s54, 0
    s_waitcnt vmcnt(8)
m_tgs12:
    v_cmp_ne_u64 vcc, s[68:69], v[252:253]
    s_add_u32 s54, s54, 1
    s_cmp_ge_u32 s54, 0x200000
    s_cbranch_scc1 m_tgb12
    s_bitcmp0_b64 vcc, s53
    s_cbranch_scc1 m_tgc12
    buffer_load_dwordx2 v[252:253], v254, s[44:47], s71 offen sc1
    s_waitcnt vmcnt(0)
    s_branch m_tgs12
m_tgc12:
    s_cbranch_vccnz m_tgb12
    s_mov_b32 s98, 1
    s_mov_b32 s99, 1
m_tgb12:
    s_xor_b32 s53, s62, 0x8000
    s_add_u32 s53, s53, s66
    s_add_u32 m0, s53, 98304
    s_nop 0
    buffer_load_dwordx4 v1, s[28:31], s64 offen offset:0 sc1 lds
    buffer_load_dwordx4 v1, s[28:31], s64 offen offset:1024 sc1 lds
    buffer_load_dwordx4 v1, s[28:31], s64 offen offset:2048 sc1 lds
    buffer_load_dwordx4 v1, s[28:31], s64 offen offset:3072 sc1 lds
    s_add_u32 s64, s64, 0x4000
    s_xor_b32 s53, s63, 0x8000
    s_add_u32 s53, s53, s66
    s_add_u32 m0, s53, 0
    s_nop 0
    buffer_load_dwordx4 v1, s[8:11], s65 offen offset:0 sc1 lds
    buffer_load_dwordx4 v1, s[8:11], s65 offen offset:1024 sc1 lds
    buffer_load_dwordx4 v1, s[8:11], s65 offen offset:2048 sc1 lds
    buffer_load_dwordx4 v1, s[8:11], s65 offen offset:3072 sc1 lds
    s_add_u32 s65, s65, 0x4000
    s_branch m_idle
m_done:
    s_cmp_lt_u32 s48, 4
    s_cbranch_scc1 m_nodrain
    s_waitcnt vmcnt(0)
m_nodrain:
    s_and_b32 s16, s2, 31
    s_lshl_b32 s16, s16, 3
    s_add_u32 s16, s16, s50
    s_lshl_b32 s16, s16, 3
    s_add_u32 s16, s16, s48
    s_lshl_b32 s16, s16, 10
    s_add_u32 s17, s16, 57671680
    buffer_load_dwordx4 v[160:163], v1, s[44:47], s17 offen sc1
    s_load_dwordx4 s[4:7], s[0:1], 64
    s_lshl_b32 s52, s49, 3
    s_add_u32 s52, s52, 63979520
    s_lshl_b32 s70, s55, 8
    s_add_u32 s70, s70, s52
    s_lshl_b32 s71, s50, 8
    s_add_u32 s71, s71, s52
    s_lshl_b32 s15, s50, 3
    s_add_u32 s15, s15, s48
    s_and_b32 s65, s2, 31
    s_and_b32 s14, s2, 1
    s_lshl_b32 s14, s14, 2
    s_bfe_u32 s53, s2, 0x20004
    s_add_u32 s14, s14, s53
    s_lshl_b32 s14, s14, 8
    s_add_u32 s14, s14, 63983616
    v_and_b32 v4, 31, v0
    s_add_u32 s17, s16, 59768832
    buffer_load_dwordx4 v[120:123], v1, s[44:47], s17 offen offset:0 sc1
    v_lshlrev_b32 v4, 3, v4
    s_bfe_u32 s49, s2, 0x20001
    s_and_b32 s50, s2, 1
    s_lshl_b32 s50, s50, 3
    s_bfe_u32 s52, s2, 0x30003
    s_add_u32 s50, s50, s52
    s_lshr_b32 s55, s2, 6
    s_lshl_b32 s57, s50, 2
    s_add_u32 s57, s57, s55
    s_lshl_b32 s51, s48, 10
    s_lshl_b32 s56, s48, 11
    s_lshl_b32 s64, s50, 8
    s_lshl_b32 s52, s49, 6
    s_add_u32 s64, s64, s52
    s_add_u32 s64, s64, 63979520
    v_lshrrev_b32 v11, 4, v0
    s_lshl_b32 s58, s50, 3
    s_add_u32 s58, s58, s48
    s_add_u32 s17, s16, 59764736
    buffer_load_dwordx4 v[116:119], v1, s[44:47], s17 offen offset:3072 sc1
    s_lshl_b32 s58, s58, 17
    s_lshl_b32 s52, s49, 15
    s_add_u32 s58, s58, s52
    s_add_u32 s58, s58, 33554432
    s_lshl_b32 s59, s50, 3
    s_lshr_b32 s52, s49, 1
    s_lshl_b32 s52, s52, 2
    s_add_u32 s59, s59, s52
    s_lshr_b32 s52, s48, 1
    s_add_u32 s59, s59, s52
    s_lshl_b32 s59, s59, 14
    s_and_b32 s52, s48, 1
    s_lshl_b32 s52, s52, 11
    s_add_u32 s59, s59, s52
    s_add_u32 s59, s59, 50331648
    s_and_b32 s52, s48, 1
    s_lshl_b32 s52, s52, 2
    buffer_load_dwordx4 v[112:115], v1, s[44:47], s17 offen offset:2048 sc1
    v_add_u32 v7, s52, v11
    v_lshlrev_b32 v7, 1, v7
    v_and_b32 v8, 15, v0
    v_xor_b32 v7, v7, v8
    v_lshlrev_b32 v7, 4, v7
    v_lshl_add_u32 v2, v11, 10, v7
    v_lshlrev_b32 v7, 1, v11
    v_and_b32 v9, 7, v0
    v_xor_b32 v7, v7, v9
    v_lshlrev_b32 v7, 4, v7
    v_lshrrev_b32 v9, 3, v0
    v_lshl_add_u32 v3, v9, 10, v7
    v_add_u32 v54, 7168, v3
    s_lshl_b32 s60, s49, 20
    s_lshl_b32 s52, s55, 8
    s_add_u32 s60, s60, s52
    s_lshl_b32 s53, s48, 12
    s_add_u32 s60, s60, s53
    buffer_load_dwordx4 v[108:111], v1, s[44:47], s17 offen offset:1024 sc1
    s_and_b32 s61, s49, 1
    s_lshl_b32 s61, s61, 7
    s_add_u32 s61, s61, s52
    s_lshl_b32 s53, s48, 14
    s_add_u32 s61, s61, s53
    s_lshr_b32 s52, s48, 2
    s_lshl_b32 s53, s52, 13
    v_add_u32 v26, s53, v1
    v_lshrrev_b32 v7, 2, v8
    v_lshl_add_u32 v7, v11, 2, v7
    v_and_b32 v9, 3, v0
    v_lshlrev_b32 v9, 3, v9
    s_and_b32 s52, s48, 3
    s_lshl_b32 s53, s52, 1
    v_and_b32 v10, 7, v7
    v_xor_b32 v10, s53, v10
    v_lshlrev_b32 v10, 5, v10
    buffer_load_dwordx4 v[104:107], v1, s[44:47], s17 offen offset:0 sc1
    v_lshl_add_u32 v10, v7, 8, v10
    v_add_u32 v32, v10, v9
    v_add_u32 v32, 16384, v32
    v_xor_b32 v35, 32, v32
    v_bfe_u32 v10, v7, 1, 2
    v_xor_b32 v10, s52, v10
    v_lshlrev_b32 v10, 5, v10
    v_lshl_add_u32 v10, v7, 7, v10
    v_add_u32 v10, v10, v9
    v_add_u32 v38, 16384, v10
    v_add_u32 v27, 0x10000, v26
    v_add_u32 v28, 0x20000, v26
    v_add_u32 v33, 0x10000, v32
    v_add_u32 v34, 0x20000, v32
    v_add_u32 v36, 0x10000, v35
    v_add_u32 v37, 0x20000, v35
    v_add_u32 v39, 0x10000, v38
    v_add_u32 v40, 0x20000, v38
    s_add_u32 s17, s16, 59760640
    buffer_load_dwordx4 v[100:103], v1, s[44:47], s17 offen offset:3072 sc1
    v_and_b32 v7, 1, v11
    v_lshl_add_u32 v7, v7, 4, v8
    v_lshlrev_b32 v7, 11, v7
    v_lshrrev_b32 v10, 1, v11
    v_lshl_add_u32 v41, v10, 4, v7
    v_and_b32 v10, 7, v0
    v_lshlrev_b32 v10, 3, v10
    v_mov_b32 v42, s68
    v_mov_b32 v43, s69
    s_lshl_b32 s66, s57, 17
    s_add_u32 s66, s66, 65011712
    s_lshl_b32 s67, s57, 7
    s_add_u32 s67, s67, 63971328
    s_waitcnt lgkmcnt(0)
    s_mov_b32 s32, s4
    s_mov_b32 s33, s5
    s_mov_b32 s34, 0x80000
    buffer_load_dwordx4 v[96:99], v1, s[44:47], s17 offen offset:2048 sc1
    s_mov_b32 s35, 0x20000
    s_mov_b32 s28, s22
    s_mov_b32 s29, s23
    s_mov_b32 s30, 0x400000
    s_mov_b32 s31, 0x20000
    s_mov_b32 s36, s6
    s_mov_b32 s37, s7
    s_mov_b32 s38, 0x400000
    s_mov_b32 s39, 0x20000
    v_cmp_gt_i32 vcc, 0, v5
    v_mov_b32 v224, v6
    v_mov_b32 v236, v6
    v_mov_b64 v[220:221], 0
    v_mov_b64 v[222:223], 0
    v_mov_b64 v[240:241], 0
    v_mov_b64 v[242:243], 0
    v_cndmask_b32 v216, 0, v6, vcc
    v_cndmask_b32 v228, 0, v6, vcc
    buffer_load_dwordx4 v[92:95], v1, s[44:47], s17 offen offset:1024 sc1
    v_cndmask_b32 v232, v6, v220, vcc
    v_cndmask_b32 v244, v6, v220, vcc
    v_cmp_gt_i32 vcc, 1, v5
    v_mov_b32 v225, v6
    v_mov_b32 v237, v6
    v_cndmask_b32 v217, 0, v6, vcc
    v_cndmask_b32 v229, 0, v6, vcc
    v_cndmask_b32 v233, v6, v220, vcc
    v_cndmask_b32 v245, v6, v220, vcc
    v_cmp_gt_i32 vcc, 2, v5
    v_mov_b32 v226, v6
    v_mov_b32 v238, v6
    v_cndmask_b32 v218, 0, v6, vcc
    v_cndmask_b32 v230, 0, v6, vcc
    v_cndmask_b32 v234, v6, v220, vcc
    v_cndmask_b32 v246, v6, v220, vcc
    v_cmp_gt_i32 vcc, 3, v5
    buffer_load_dwordx4 v[88:91], v1, s[44:47], s17 offen offset:0 sc1
    v_mov_b32 v227, v6
    v_mov_b32 v239, v6
    v_cndmask_b32 v219, 0, v6, vcc
    v_cndmask_b32 v231, 0, v6, vcc
    v_cndmask_b32 v235, v6, v220, vcc
    v_cndmask_b32 v247, v6, v220, vcc
    v_mov_b64 v[172:173], 0
    v_mov_b64 v[174:175], 0
    v_mov_b64 v[176:177], 0
    v_mov_b64 v[178:179], 0
    v_mov_b64 v[16:17], 0
    v_mov_b64 v[18:19], 0
    v_mov_b64 v[20:21], 0
    v_mov_b64 v[22:23], 0
    v_mov_b32 v180, v6
    v_mov_b32 v182, v6
    s_mov_b32 s18, 7
    s_lshr_b32 s19, s48, 2
    s_waitcnt vmcnt(10)
    v_lshlrev_b32 v7, 11, v0
    v_add_u32 v7, 0x10010, v7
    v_mov_b32 v8, 1
    s_mov_b64 exec, 15
    ds_add_rtn_u32 v8, v7, v8
    s_mov_b64 exec, -1
    s_add_u32 s17, s16, 61865984
    buffer_load_dwordx4 v[156:159], v1, s[44:47], s17 offen offset:0 sc1
    s_add_u32 s17, s16, 61861888
    buffer_load_dwordx4 v[152:155], v1, s[44:47], s17 offen offset:3072 sc1
    buffer_load_dwordx4 v[148:151], v1, s[44:47], s17 offen offset:2048 sc1
    buffer_load_dwordx4 v[144:147], v1, s[44:47], s17 offen offset:1024 sc1
    buffer_load_dwordx4 v[140:143], v1, s[44:47], s17 offen offset:0 sc1
    s_add_u32 s17, s16, 61857792
    buffer_load_dwordx4 v[136:139], v1, s[44:47], s17 offen offset:3072 sc1
    buffer_load_dwordx4 v[132:135], v1, s[44:47], s17 offen offset:2048 sc1
    buffer_load_dwordx4 v[128:131], v1, s[44:47], s17 offen offset:1024 sc1
    buffer_load_dwordx4 v[124:127], v1, s[44:47], s17 offen offset:0 sc1
    s_waitcnt lgkmcnt(0)
    v_readfirstlane_b32 s52, v8
    s_nop 0
    s_cmp_lg_u32 s52, 7
    s_cbranch_scc1 m_p5_sigc
    s_mov_b64 exec, 1
    buffer_store_dwordx2 v[42:43], off, s[44:47], s70 sc1
    s_mov_b64 exec, -1
    s_mov_b64 exec, 1
    buffer_store_dwordx2 v[42:43], off, s[44:47], s71 sc1
    s_mov_b64 exec, -1
m_p5_sigc:
    s_waitcnt vmcnt(9)
m_p5_bagain:
    v_mfma_f32_16x16x16_bf16 v[184:187], v[120:121], v[160:161], v[216:219]
    v_mfma_f32_16x16x16_bf16 v[192:195], v[120:121], v[162:163], v[220:223]
    v_mfma_f32_16x16x16_bf16 v[188:191], v[122:123], v[160:161], v[224:227]
    v_mfma_f32_16x16x16_bf16 v[196:199], v[122:123], v[162:163], v[228:231]
    s_cmp_lt_u32 s15, 1
    s_cbranch_scc1 m_p5_bp1_0
    v_mfma_f32_16x16x16_bf16 v[200:203], v[116:117], v[160:161], 0
    v_mfma_f32_16x16x16_bf16 v[208:211], v[116:117], v[162:163], 0
    v_mfma_f32_16x16x16_bf16 v[204:207], v[118:119], v[160:161], 0
    v_mfma_f32_16x16x16_bf16 v[212:215], v[118:119], v[162:163], 0
    s_nop 3
    v_max3_f32 v180, v180, v184, v185
    v_max3_f32 v182, v182, v192, v193
    v_max3_f32 v180, v180, v186, v187
    v_max3_f32 v182, v182, v194, v195
    v_max3_f32 v180, v180, v188, v189
    v_max3_f32 v182, v182, v196, v197
    v_max3_f32 v180, v180, v190, v191
    v_max3_f32 v182, v182, v198, v199
    s_cmp_lt_u32 s15, 2
    s_cbranch_scc1 m_p5_bp1_1
    s_cmp_gt_u32 s18, 6
    s_cbranch_scc1 m_p5_bp1_1
    v_mfma_f32_16x16x16_bf16 v[184:187], v[112:113], v[160:161], 0
    v_mfma_f32_16x16x16_bf16 v[192:195], v[112:113], v[162:163], 0
    v_mfma_f32_16x16x16_bf16 v[188:191], v[114:115], v[160:161], 0
    v_mfma_f32_16x16x16_bf16 v[196:199], v[114:115], v[162:163], 0
    s_nop 3
    v_max3_f32 v180, v180, v200, v201
    v_max3_f32 v182, v182, v208, v209
    v_max3_f32 v180, v180, v202, v203
    v_max3_f32 v182, v182, v210, v211
    v_max3_f32 v180, v180, v204, v205
    v_max3_f32 v182, v182, v212, v213
    v_max3_f32 v180, v180, v206, v207
    v_max3_f32 v182, v182, v214, v215
    s_cmp_lt_u32 s15, 3
    s_cbranch_scc1 m_p5_bp1_0
    s_cmp_gt_u32 s18, 5
    s_cbranch_scc1 m_p5_bp1_0
    v_mfma_f32_16x16x16_bf16 v[200:203], v[108:109], v[160:161], 0
    v_mfma_f32_16x16x16_bf16 v[208:211], v[108:109], v[162:163], 0
    v_mfma_f32_16x16x16_bf16 v[204:207], v[110:111], v[160:161], 0
    v_mfma_f32_16x16x16_bf16 v[212:215], v[110:111], v[162:163], 0
    s_nop 3
    v_max3_f32 v180, v180, v184, v185
    v_max3_f32 v182, v182, v192, v193
    v_max3_f32 v180, v180, v186, v187
    v_max3_f32 v182, v182, v194, v195
    v_max3_f32 v180, v180, v188, v189
    v_max3_f32 v182, v182, v196, v197
    v_max3_f32 v180, v180, v190, v191
    v_max3_f32 v182, v182, v198, v199
    s_cmp_lt_u32 s15, 4
    s_cbranch_scc1 m_p5_bp1_1
    s_cmp_gt_u32 s18, 4
    s_cbranch_scc1 m_p5_bp1_1
    v_mfma_f32_16x16x16_bf16 v[184:187], v[104:105], v[160:161], 0
    v_mfma_f32_16x16x16_bf16 v[192:195], v[104:105], v[162:163], 0
    v_mfma_f32_16x16x16_bf16 v[188:191], v[106:107], v[160:161], 0
    v_mfma_f32_16x16x16_bf16 v[196:199], v[106:107], v[162:163], 0
    s_nop 3
    v_max3_f32 v180, v180, v200, v201
    v_max3_f32 v182, v182, v208, v209
    v_max3_f32 v180, v180, v202, v203
    v_max3_f32 v182, v182, v210, v211
    v_max3_f32 v180, v180, v204, v205
    v_max3_f32 v182, v182, v212, v213
    v_max3_f32 v180, v180, v206, v207
    v_max3_f32 v182, v182, v214, v215
    s_cmp_lt_u32 s15, 5
    s_cbranch_scc1 m_p5_bp1_0
    s_cmp_gt_u32 s18, 3
    s_cbranch_scc1 m_p5_bp1_0
    v_mfma_f32_16x16x16_bf16 v[200:203], v[100:101], v[160:161], 0
    v_mfma_f32_16x16x16_bf16 v[208:211], v[100:101], v[162:163], 0
    v_mfma_f32_16x16x16_bf16 v[204:207], v[102:103], v[160:161], 0
    v_mfma_f32_16x16x16_bf16 v[212:215], v[102:103], v[162:163], 0
    s_nop 3
    v_max3_f32 v180, v180, v184, v185
    v_max3_f32 v182, v182, v192, v193
    v_max3_f32 v180, v180, v186, v187
    v_max3_f32 v182, v182, v194, v195
    v_max3_f32 v180, v180, v188, v189
    v_max3_f32 v182, v182, v196, v197
    v_max3_f32 v180, v180, v190, v191
    v_max3_f32 v182, v182, v198, v199
    s_cmp_lt_u32 s15, 6
    s_cbranch_scc1 m_p5_bp1_1
    s_cmp_gt_u32 s18, 2
    s_cbranch_scc1 m_p5_bp1_1
    v_mfma_f32_16x16x16_bf16 v[184:187], v[96:97], v[160:161], 0
    v_mfma_f32_16x16x16_bf16 v[192:195], v[96:97], v[162:163], 0
    v_mfma_f32_16x16x16_bf16 v[188:191], v[98:99], v[160:161], 0
    v_mfma_f32_16x16x16_bf16 v[196:199], v[98:99], v[162:163], 0
    s_nop 3
    v_max3_f32 v180, v180, v200, v201
    v_max3_f32 v182, v182, v208, v209
    v_max3_f32 v180, v180, v202, v203
    v_max3_f32 v182, v182, v210, v211
    v_max3_f32 v180, v180, v204, v205
    v_max3_f32 v182, v182, v212, v213
    v_max3_f32 v180, v180, v206, v207
    v_max3_f32 v182, v182, v214, v215
    s_cmp_lt_u32 s15, 7
    s_cbranch_scc1 m_p5_bp1_0
    s_cmp_gt_u32 s18, 1
    s_cbranch_scc1 m_p5_bp1_0
    v_mfma_f32_16x16x16_bf16 v[200:203], v[92:93], v[160:161], 0
    v_mfma_f32_16x16x16_bf16 v[208:211], v[92:93], v[162:163], 0
    v_mfma_f32_16x16x16_bf16 v[204:207], v[94:95], v[160:161], 0
    v_mfma_f32_16x16x16_bf16 v[212:215], v[94:95], v[162:163], 0
    s_nop 3
    v_max3_f32 v180, v180, v184, v185
    v_max3_f32 v182, v182, v192, v193
    v_max3_f32 v180, v180, v186, v187
    v_max3_f32 v182, v182, v194, v195
    v_max3_f32 v180, v180, v188, v189
    v_max3_f32 v182, v182, v196, v197
    v_max3_f32 v180, v180, v190, v191
    v_max3_f32 v182, v182, v198, v199
    s_cmp_lt_u32 s15, 8
    s_cbranch_scc1 m_p5_bp1_1
    s_cmp_gt_u32 s18, 0
    s_cbranch_scc1 m_p5_bp1_1
    v_mfma_f32_16x16x16_bf16 v[184:187], v[88:89], v[160:161], v[232:235]
    v_mfma_f32_16x16x16_bf16 v[192:195], v[88:89], v[162:163], v[236:239]
    v_mfma_f32_16x16x16_bf16 v[188:191], v[90:91], v[160:161], v[240:243]
    v_mfma_f32_16x16x16_bf16 v[196:199], v[90:91], v[162:163], v[244:247]
    s_nop 3
    v_max3_f32 v180, v180, v200, v201
    v_max3_f32 v182, v182, v208, v209
    v_max3_f32 v180, v180, v202, v203
    v_max3_f32 v182, v182, v210, v211
    v_max3_f32 v180, v180, v204, v205
    v_max3_f32 v182, v182, v212, v213
    v_max3_f32 v180, v180, v206, v207
    v_max3_f32 v182, v182, v214, v215
m_p5_bp1_0:
    s_nop 7
    v_max3_f32 v180, v180, v184, v185
    v_max3_f32 v182, v182, v192, v193
    v_max3_f32 v180, v180, v186, v187
    v_max3_f32 v182, v182, v194, v195
    v_max3_f32 v180, v180, v188, v189
    v_max3_f32 v182, v182, v196, v197
    v_max3_f32 v180, v180, v190, v191
    v_max3_f32 v182, v182, v198, v199
    s_branch m_p5_bp1_done
m_p5_bp1_1:
    s_nop 7
    v_max3_f32 v180, v180, v200, v201
    v_max3_f32 v182, v182, v208, v209
    v_max3_f32 v180, v180, v202, v203
    v_max3_f32 v182, v182, v210, v211
    v_max3_f32 v180, v180, v204, v205
    v_max3_f32 v182, v182, v212, v213
    v_max3_f32 v180, v180, v206, v207
    v_max3_f32 v182, v182, v214, v215
m_p5_bp1_done:
    v_mov_b32 v7, v180
    s_nop 1
    v_permlane16_swap_b32 v180, v7
    v_max_f32 v180, v180, v7
    v_mov_b32 v7, v180
    s_nop 1
    v_permlane32_swap_b32 v180, v7
    v_max_f32 v180, v180, v7
    v_mov_b32 v7, v182
    s_nop 1
    v_permlane16_swap_b32 v182, v7
    v_max_f32 v182, v182, v7
    v_mov_b32 v7, v182
    s_nop 1
    v_permlane32_swap_b32 v182, v7
    v_max_f32 v182, v182, v7
    v_pk_add_f32 v[216:217], v[216:217], v[180:181] op_sel_hi:[1,0] neg_lo:[0,1] neg_hi:[0,1]
    v_pk_add_f32 v[232:233], v[232:233], v[180:181] op_sel_hi:[1,0] neg_lo:[0,1] neg_hi:[0,1]
    v_pk_add_f32 v[218:219], v[218:219], v[180:181] op_sel_hi:[1,0] neg_lo:[0,1] neg_hi:[0,1]
    v_pk_add_f32 v[234:235], v[234:235], v[180:181] op_sel_hi:[1,0] neg_lo:[0,1] neg_hi:[0,1]
    v_pk_add_f32 v[224:225], v[224:225], v[180:181] op_sel_hi:[1,0] neg_lo:[0,1] neg_hi:[0,1]
    v_pk_add_f32 v[240:241], v[240:241], v[180:181] op_sel_hi:[1,0] neg_lo:[0,1] neg_hi:[0,1]
    v_pk_add_f32 v[226:227], v[226:227], v[180:181] op_sel_hi:[1,0] neg_lo:[0,1] neg_hi:[0,1]
    v_pk_add_f32 v[242:243], v[242:243], v[180:181] op_sel_hi:[1,0] neg_lo:[0,1] neg_hi:[0,1]
    v_pk_add_f32 v[220:221], v[220:221], v[182:183] op_sel_hi:[1,0] neg_lo:[0,1] neg_hi:[0,1]
    v_pk_add_f32 v[236:237], v[236:237], v[182:183] op_sel_hi:[1,0] neg_lo:[0,1] neg_hi:[0,1]
    v_pk_add_f32 v[222:223], v[222:223], v[182:183] op_sel_hi:[1,0] neg_lo:[0,1] neg_hi:[0,1]
    v_pk_add_f32 v[238:239], v[238:239], v[182:183] op_sel_hi:[1,0] neg_lo:[0,1] neg_hi:[0,1]
    v_pk_add_f32 v[228:229], v[228:229], v[182:183] op_sel_hi:[1,0] neg_lo:[0,1] neg_hi:[0,1]
    v_pk_add_f32 v[244:245], v[244:245], v[182:183] op_sel_hi:[1,0] neg_lo:[0,1] neg_hi:[0,1]
    v_pk_add_f32 v[230:231], v[230:231], v[182:183] op_sel_hi:[1,0] neg_lo:[0,1] neg_hi:[0,1]
    v_pk_add_f32 v[246:247], v[246:247], v[182:183] op_sel_hi:[1,0] neg_lo:[0,1] neg_hi:[0,1]
    s_waitcnt vmcnt(0)
    s_nop 0
    v_mfma_f32_16x16x16_bf16 v[184:187], v[120:121], v[160:161], v[216:219]
    v_mfma_f32_16x16x16_bf16 v[192:195], v[120:121], v[162:163], v[220:223]
    v_mfma_f32_16x16x16_bf16 v[188:191], v[122:123], v[160:161], v[224:227]
    v_mfma_f32_16x16x16_bf16 v[196:199], v[122:123], v[162:163], v[228:231]
    s_nop 4
    s_cmp_lt_u32 s15, 1
    s_cbranch_scc1 m_p5_bp2_8
    v_mfma_f32_16x16x16_bf16 v[200:203], v[116:117], v[160:161], v[240:243]
    v_exp_f32 v184, v184
    v_exp_f32 v185, v185
    v_exp_f32 v186, v186
    v_exp_f32 v187, v187
    v_mfma_f32_16x16x16_bf16 v[208:211], v[116:117], v[162:163], v[220:223]
    v_exp_f32 v188, v188
    v_exp_f32 v189, v189
    v_exp_f32 v190, v190
    v_exp_f32 v191, v191
    v_mfma_f32_16x16x16_bf16 v[204:207], v[118:119], v[160:161], v[240:243]
    v_exp_f32 v192, v192
    v_exp_f32 v193, v193
    v_exp_f32 v194, v194
    v_exp_f32 v195, v195
    v_mfma_f32_16x16x16_bf16 v[212:215], v[118:119], v[162:163], v[220:223]
    v_exp_f32 v196, v196
    v_exp_f32 v197, v197
    v_exp_f32 v198, v198
    v_exp_f32 v199, v199
    v_cvt_pk_bf16_f32 v164, v184, v185
    v_cvt_pk_bf16_f32 v165, v186, v187
    v_cvt_pk_bf16_f32 v166, v188, v189
    v_cvt_pk_bf16_f32 v167, v190, v191
    v_cvt_pk_bf16_f32 v168, v192, v193
    v_cvt_pk_bf16_f32 v169, v194, v195
    v_cvt_pk_bf16_f32 v170, v196, v197
    v_cvt_pk_bf16_f32 v171, v198, v199
    s_nop 1
    v_mfma_f32_16x16x32_bf16 v[172:175], v[156:159], v[164:167], v[172:175]
    v_mfma_f32_16x16x32_bf16 v[16:19], v[12:15], v[164:167], v[16:19]
    v_mfma_f32_16x16x32_bf16 v[176:179], v[156:159], v[168:171], v[176:179]
    v_mfma_f32_16x16x32_bf16 v[20:23], v[12:15], v[168:171], v[20:23]
    s_cmp_lt_u32 s15, 2
    s_cbranch_scc1 m_p5_bp2_7
    v_mfma_f32_16x16x16_bf16 v[184:187], v[112:113], v[160:161], v[240:243]
    v_exp_f32 v200, v200
    v_exp_f32 v201, v201
    v_exp_f32 v202, v202
    v_exp_f32 v203, v203
    v_mfma_f32_16x16x16_bf16 v[192:195], v[112:113], v[162:163], v[220:223]
    v_exp_f32 v204, v204
    v_exp_f32 v205, v205
    v_exp_f32 v206, v206
    v_exp_f32 v207, v207
    v_mfma_f32_16x16x16_bf16 v[188:191], v[114:115], v[160:161], v[240:243]
    v_exp_f32 v208, v208
    v_exp_f32 v209, v209
    v_exp_f32 v210, v210
    v_exp_f32 v211, v211
    v_mfma_f32_16x16x16_bf16 v[196:199], v[114:115], v[162:163], v[220:223]
    v_exp_f32 v212, v212
    v_exp_f32 v213, v213
    v_exp_f32 v214, v214
    v_exp_f32 v215, v215
    v_cvt_pk_bf16_f32 v164, v200, v201
    v_cvt_pk_bf16_f32 v165, v202, v203
    v_cvt_pk_bf16_f32 v166, v204, v205
    v_cvt_pk_bf16_f32 v167, v206, v207
    v_cvt_pk_bf16_f32 v168, v208, v209
    v_cvt_pk_bf16_f32 v169, v210, v211
    v_cvt_pk_bf16_f32 v170, v212, v213
    v_cvt_pk_bf16_f32 v171, v214, v215
    s_nop 1
    v_mfma_f32_16x16x32_bf16 v[172:175], v[152:155], v[164:167], v[172:175]
    v_mfma_f32_16x16x32_bf16 v[16:19], v[12:15], v[164:167], v[16:19]
    v_mfma_f32_16x16x32_bf16 v[176:179], v[152:155], v[168:171], v[176:179]
    v_mfma_f32_16x16x32_bf16 v[20:23], v[12:15], v[168:171], v[20:23]
    s_cmp_eq_u32 s19, 0
    s_cbranch_scc1 m_p5_nl1
    s_add_u32 s52, s56, 57360
    v_mov_b32 v7, s52
    s_mov_b32 s54, 0
m_p5_cw1:
    ds_read_b32 v8, v7
    s_add_u32 s54, s54, 1
    s_waitcnt lgkmcnt(0)
    v_readfirstlane_b32 s52, v8
    s_cmp_ge_u32 s54, 0x1000000
    s_cbranch_scc1 m_p5_cwd1
    s_cmp_lt_u32 s52, 8
    s_cbranch_scc1 m_p5_cw1
m_p5_cwd1:
    s_add_u32 m0, s51, 16384
    s_add_u32 s53, s60, 0
    buffer_load_dwordx4 v2, s[28:31], s53 offen lds
    s_add_u32 m0, s51, 24576
    s_add_u32 s53, s60, 32768
    buffer_load_dwordx4 v2, s[28:31], s53 offen lds
    s_add_u32 m0, s51, 12288
    s_add_u32 s53, s60, 4294950912
    buffer_load_dwordx4 v2, s[28:31], s53 offen lds
    s_add_u32 m0, s51, 20480
    s_add_u32 s53, s60, 16384
    buffer_load_dwordx4 v2, s[28:31], s53 offen lds
    s_add_u32 m0, s51, 49152
    s_add_u32 s53, s60, 65536
    buffer_load_dwordx4 v2, s[28:31], s53 offen lds
    s_add_u32 m0, s51, 57344
    s_add_u32 s53, s60, 98304
    buffer_load_dwordx4 v2, s[28:31], s53 offen lds
    s_add_u32 m0, s51, 45056
    s_add_u32 s53, s60, 49152
    buffer_load_dwordx4 v2, s[28:31], s53 offen lds
    s_add_u32 m0, s51, 53248
    s_add_u32 s53, s60, 81920
    buffer_load_dwordx4 v2, s[28:31], s53 offen lds
    s_add_u32 m0, s51, 81920
    s_add_u32 s53, s60, 131072
    buffer_load_dwordx4 v2, s[28:31], s53 offen lds
    s_add_u32 m0, s51, 90112
    s_add_u32 s53, s60, 163840
    buffer_load_dwordx4 v2, s[28:31], s53 offen lds
    s_add_u32 m0, s51, 77824
    s_add_u32 s53, s60, 114688
    buffer_load_dwordx4 v2, s[28:31], s53 offen lds
    s_add_u32 m0, s51, 86016
    s_add_u32 s53, s60, 147456
    buffer_load_dwordx4 v2, s[28:31], s53 offen lds
    s_add_u32 m0, s51, 114688
    s_add_u32 s53, s60, 196608
    buffer_load_dwordx4 v2, s[28:31], s53 offen lds
    s_add_u32 m0, s51, 122880
    s_add_u32 s53, s60, 229376
    buffer_load_dwordx4 v2, s[28:31], s53 offen lds
    s_add_u32 m0, s51, 110592
    s_add_u32 s53, s60, 180224
    buffer_load_dwordx4 v2, s[28:31], s53 offen lds
    s_add_u32 m0, s51, 118784
    s_add_u32 s53, s60, 212992
    buffer_load_dwordx4 v2, s[28:31], s53 offen lds
    s_add_u32 m0, s51, 147456
    s_add_u32 s53, s60, 262144
    buffer_load_dwordx4 v2, s[28:31], s53 offen lds
    s_add_u32 m0, s51, 155648
    s_add_u32 s53, s60, 294912
    buffer_load_dwordx4 v2, s[28:31], s53 offen lds
    s_add_u32 m0, s51, 143360
    s_add_u32 s53, s60, 245760
    buffer_load_dwordx4 v2, s[28:31], s53 offen lds
    s_add_u32 m0, s51, 151552
    s_add_u32 s53, s60, 278528
    buffer_load_dwordx4 v2, s[28:31], s53 offen lds
    buffer_load_dwordx2 v[52:53], v10, s[44:47], s64 offen sc1
m_p5_nl1:
    s_cmp_lt_u32 s15, 3
    s_cbranch_scc1 m_p5_bp2_6
    v_mfma_f32_16x16x16_bf16 v[200:203], v[108:109], v[160:161], v[240:243]
    v_exp_f32 v184, v184
    v_exp_f32 v185, v185
    v_exp_f32 v186, v186
    v_exp_f32 v187, v187
    v_mfma_f32_16x16x16_bf16 v[208:211], v[108:109], v[162:163], v[220:223]
    v_exp_f32 v188, v188
    v_exp_f32 v189, v189
    v_exp_f32 v190, v190
    v_exp_f32 v191, v191
    v_mfma_f32_16x16x16_bf16 v[204:207], v[110:111], v[160:161], v[240:243]
    v_exp_f32 v192, v192
    v_exp_f32 v193, v193
    v_exp_f32 v194, v194
    v_exp_f32 v195, v195
    v_mfma_f32_16x16x16_bf16 v[212:215], v[110:111], v[162:163], v[220:223]
    v_exp_f32 v196, v196
    v_exp_f32 v197, v197
    v_exp_f32 v198, v198
    v_exp_f32 v199, v199
    v_cvt_pk_bf16_f32 v164, v184, v185
    v_cvt_pk_bf16_f32 v165, v186, v187
    v_cvt_pk_bf16_f32 v166, v188, v189
    v_cvt_pk_bf16_f32 v167, v190, v191
    v_cvt_pk_bf16_f32 v168, v192, v193
    v_cvt_pk_bf16_f32 v169, v194, v195
    v_cvt_pk_bf16_f32 v170, v196, v197
    v_cvt_pk_bf16_f32 v171, v198, v199
    s_nop 1
    v_mfma_f32_16x16x32_bf16 v[172:175], v[148:151], v[164:167], v[172:175]
    v_mfma_f32_16x16x32_bf16 v[16:19], v[12:15], v[164:167], v[16:19]
    v_mfma_f32_16x16x32_bf16 v[176:179], v[148:151], v[168:171], v[176:179]
    v_mfma_f32_16x16x32_bf16 v[20:23], v[12:15], v[168:171], v[20:23]
    s_cmp_lt_u32 s15, 4
    s_cbranch_scc1 m_p5_bp2_5
    v_mfma_f32_16x16x16_bf16 v[184:187], v[104:105], v[160:161], v[240:243]
    v_exp_f32 v200, v200
    v_exp_f32 v201, v201
    v_exp_f32 v202, v202
    v_exp_f32 v203, v203
    v_mfma_f32_16x16x16_bf16 v[192:195], v[104:105], v[162:163], v[220:223]
    v_exp_f32 v204, v204
    v_exp_f32 v205, v205
    v_exp_f32 v206, v206
    v_exp_f32 v207, v207
    v_mfma_f32_16x16x16_bf16 v[188:191], v[106:107], v[160:161], v[240:243]
    v_exp_f32 v208, v208
    v_exp_f32 v209, v209
    v_exp_f32 v210, v210
    v_exp_f32 v211, v211
    v_mfma_f32_16x16x16_bf16 v[196:199], v[106:107], v[162:163], v[220:223]
    v_exp_f32 v212, v212
    v_exp_f32 v213, v213
    v_exp_f32 v214, v214
    v_exp_f32 v215, v215
    v_cvt_pk_bf16_f32 v164, v200, v201
    v_cvt_pk_bf16_f32 v165, v202, v203
    v_cvt_pk_bf16_f32 v166, v204, v205
    v_cvt_pk_bf16_f32 v167, v206, v207
    v_cvt_pk_bf16_f32 v168, v208, v209
    v_cvt_pk_bf16_f32 v169, v210, v211
    v_cvt_pk_bf16_f32 v170, v212, v213
    v_cvt_pk_bf16_f32 v171, v214, v215
    s_nop 1
    v_mfma_f32_16x16x32_bf16 v[172:175], v[144:147], v[164:167], v[172:175]
    v_mfma_f32_16x16x32_bf16 v[16:19], v[12:15], v[164:167], v[16:19]
    v_mfma_f32_16x16x32_bf16 v[176:179], v[144:147], v[168:171], v[176:179]
    v_mfma_f32_16x16x32_bf16 v[20:23], v[12:15], v[168:171], v[20:23]
    s_cmp_lt_u32 s15, 5
    s_cbranch_scc1 m_p5_bp2_4
    v_mfma_f32_16x16x16_bf16 v[200:203], v[100:101], v[160:161], v[240:243]
    v_exp_f32 v184, v184
    v_exp_f32 v185, v185
    v_exp_f32 v186, v186
    v_exp_f32 v187, v187
    v_mfma_f32_16x16x16_bf16 v[208:211], v[100:101], v[162:163], v[220:223]
    v_exp_f32 v188, v188
    v_exp_f32 v189, v189
    v_exp_f32 v190, v190
    v_exp_f32 v191, v191
    v_mfma_f32_16x16x16_bf16 v[204:207], v[102:103], v[160:161], v[240:243]
    v_exp_f32 v192, v192
    v_exp_f32 v193, v193
    v_exp_f32 v194, v194
    v_exp_f32 v195, v195
    v_mfma_f32_16x16x16_bf16 v[212:215], v[102:103], v[162:163], v[220:223]
    v_exp_f32 v196, v196
    v_exp_f32 v197, v197
    v_exp_f32 v198, v198
    v_exp_f32 v199, v199
    v_cvt_pk_bf16_f32 v164, v184, v185
    v_cvt_pk_bf16_f32 v165, v186, v187
    v_cvt_pk_bf16_f32 v166, v188, v189
    v_cvt_pk_bf16_f32 v167, v190, v191
    v_cvt_pk_bf16_f32 v168, v192, v193
    v_cvt_pk_bf16_f32 v169, v194, v195
    v_cvt_pk_bf16_f32 v170, v196, v197
    v_cvt_pk_bf16_f32 v171, v198, v199
    s_nop 1
    v_mfma_f32_16x16x32_bf16 v[172:175], v[140:143], v[164:167], v[172:175]
    v_mfma_f32_16x16x32_bf16 v[16:19], v[12:15], v[164:167], v[16:19]
    v_mfma_f32_16x16x32_bf16 v[176:179], v[140:143], v[168:171], v[176:179]
    v_mfma_f32_16x16x32_bf16 v[20:23], v[12:15], v[168:171], v[20:23]
    s_cmp_eq_u32 s19, 0
    s_cbranch_scc1 m_p5_nl2
    s_waitcnt vmcnt(0)
    v_cmp_ne_u64 vcc, s[68:69], v[52:53]
    s_mov_b32 s54, 0
    s_nop 0
    s_cbranch_vccz m_p5_cc2_ok
m_p5_cc2_spin:
    buffer_load_dwordx2 v[52:53], v10, s[44:47], s64 offen sc1
    s_waitcnt vmcnt(0)
    v_cmp_ne_u64 vcc, s[68:69], v[52:53]
    s_add_u32 s54, s54, 1
    s_cmp_ge_u32 s54, 0x200000
    s_cbranch_scc1 m_p5_cc2_ok
    s_cbranch_vccnz m_p5_cc2_spin
m_p5_cc2_ok:
    s_add_u32 m0, s56, 0
    s_add_u32 s53, s58, 0
    buffer_load_dwordx4 v1, s[44:47], s53 offen sc1 lds
    buffer_load_dwordx4 v1, s[44:47], s53 offen offset:1024 sc1 lds
    s_add_u32 m0, s56, 4294959104
    s_add_u32 s53, s58, 4294443008
    buffer_load_dwordx4 v1, s[44:47], s53 offen sc1 lds
    buffer_load_dwordx4 v1, s[44:47], s53 offen offset:1024 sc1 lds
    s_add_u32 m0, s56, 32768
    s_add_u32 s53, s58, 2048
    buffer_load_dwordx4 v1, s[44:47], s53 offen sc1 lds
    buffer_load_dwordx4 v1, s[44:47], s53 offen offset:1024 sc1 lds
    s_add_u32 m0, s56, 24576
    s_add_u32 s53, s58, 4294445056
    buffer_load_dwordx4 v1, s[44:47], s53 offen sc1 lds
    buffer_load_dwordx4 v1, s[44:47], s53 offen offset:1024 sc1 lds
    s_add_u32 m0, s56, 65536
    s_add_u32 s53, s58, 4096
    buffer_load_dwordx4 v1, s[44:47], s53 offen sc1 lds
    buffer_load_dwordx4 v1, s[44:47], s53 offen offset:1024 sc1 lds
    s_add_u32 m0, s56, 57344
    s_add_u32 s53, s58, 4294447104
    buffer_load_dwordx4 v1, s[44:47], s53 offen sc1 lds
    buffer_load_dwordx4 v1, s[44:47], s53 offen offset:1024 sc1 lds
    s_add_u32 m0, s56, 98304
    s_add_u32 s53, s58, 6144
    buffer_load_dwordx4 v1, s[44:47], s53 offen sc1 lds
    buffer_load_dwordx4 v1, s[44:47], s53 offen offset:1024 sc1 lds
    s_add_u32 m0, s56, 90112
    s_add_u32 s53, s58, 4294449152
    buffer_load_dwordx4 v1, s[44:47], s53 offen sc1 lds
    buffer_load_dwordx4 v1, s[44:47], s53 offen offset:1024 sc1 lds
    s_add_u32 m0, s56, 131072
    s_add_u32 s53, s58, 8192
    buffer_load_dwordx4 v1, s[44:47], s53 offen sc1 lds
    buffer_load_dwordx4 v1, s[44:47], s53 offen offset:1024 sc1 lds
    s_add_u32 m0, s56, 122880
    s_add_u32 s53, s58, 4294451200
    buffer_load_dwordx4 v1, s[44:47], s53 offen sc1 lds
    buffer_load_dwordx4 v1, s[44:47], s53 offen offset:1024 sc1 lds
    s_mov_b32 s19, 0
m_p5_nl2:
    s_cmp_lt_u32 s15, 6
    s_cbranch_scc1 m_p5_bp2_3
    v_mfma_f32_16x16x16_bf16 v[184:187], v[96:97], v[160:161], v[240:243]
    v_exp_f32 v200, v200
    v_exp_f32 v201, v201
    v_exp_f32 v202, v202
    v_exp_f32 v203, v203
    v_mfma_f32_16x16x16_bf16 v[192:195], v[96:97], v[162:163], v[220:223]
    v_exp_f32 v204, v204
    v_exp_f32 v205, v205
    v_exp_f32 v206, v206
    v_exp_f32 v207, v207
    v_mfma_f32_16x16x16_bf16 v[188:191], v[98:99], v[160:161], v[240:243]
    v_exp_f32 v208, v208
    v_exp_f32 v209, v209
    v_exp_f32 v210, v210
    v_exp_f32 v211, v211
    v_mfma_f32_16x16x16_bf16 v[196:199], v[98:99], v[162:163], v[220:223]
    v_exp_f32 v212, v212
    v_exp_f32 v213, v213
    v_exp_f32 v214, v214
    v_exp_f32 v215, v215
    v_cvt_pk_bf16_f32 v164, v200, v201
    v_cvt_pk_bf16_f32 v165, v202, v203
    v_cvt_pk_bf16_f32 v166, v204, v205
    v_cvt_pk_bf16_f32 v167, v206, v207
    v_cvt_pk_bf16_f32 v168, v208, v209
    v_cvt_pk_bf16_f32 v169, v210, v211
    v_cvt_pk_bf16_f32 v170, v212, v213
    v_cvt_pk_bf16_f32 v171, v214, v215
    s_nop 1
    v_mfma_f32_16x16x32_bf16 v[172:175], v[136:139], v[164:167], v[172:175]
    v_mfma_f32_16x16x32_bf16 v[16:19], v[12:15], v[164:167], v[16:19]
    v_mfma_f32_16x16x32_bf16 v[176:179], v[136:139], v[168:171], v[176:179]
    v_mfma_f32_16x16x32_bf16 v[20:23], v[12:15], v[168:171], v[20:23]
    s_cmp_lt_u32 s15, 7
    s_cbranch_scc1 m_p5_bp2_2
    v_mfma_f32_16x16x16_bf16 v[200:203], v[92:93], v[160:161], v[240:243]
    v_exp_f32 v184, v184
    v_exp_f32 v185, v185
    v_exp_f32 v186, v186
    v_exp_f32 v187, v187
    v_mfma_f32_16x16x16_bf16 v[208:211], v[92:93], v[162:163], v[220:223]
    v_exp_f32 v188, v188
    v_exp_f32 v189, v189
    v_exp_f32 v190, v190
    v_exp_f32 v191, v191
    v_mfma_f32_16x16x16_bf16 v[204:207], v[94:95], v[160:161], v[240:243]
    v_exp_f32 v192, v192
    v_exp_f32 v193, v193
    v_exp_f32 v194, v194
    v_exp_f32 v195, v195
    v_mfma_f32_16x16x16_bf16 v[212:215], v[94:95], v[162:163], v[220:223]
    v_exp_f32 v196, v196
    v_exp_f32 v197, v197
    v_exp_f32 v198, v198
    v_exp_f32 v199, v199
    v_cvt_pk_bf16_f32 v164, v184, v185
    v_cvt_pk_bf16_f32 v165, v186, v187
    v_cvt_pk_bf16_f32 v166, v188, v189
    v_cvt_pk_bf16_f32 v167, v190, v191
    v_cvt_pk_bf16_f32 v168, v192, v193
    v_cvt_pk_bf16_f32 v169, v194, v195
    v_cvt_pk_bf16_f32 v170, v196, v197
    v_cvt_pk_bf16_f32 v171, v198, v199
    s_nop 1
    v_mfma_f32_16x16x32_bf16 v[172:175], v[132:135], v[164:167], v[172:175]
    v_mfma_f32_16x16x32_bf16 v[16:19], v[12:15], v[164:167], v[16:19]
    v_mfma_f32_16x16x32_bf16 v[176:179], v[132:135], v[168:171], v[176:179]
    v_mfma_f32_16x16x32_bf16 v[20:23], v[12:15], v[168:171], v[20:23]
    s_cmp_lt_u32 s15, 8
    s_cbranch_scc1 m_p5_bp2_1
    v_mfma_f32_16x16x16_bf16 v[184:187], v[88:89], v[160:161], v[232:235]
    v_exp_f32 v200, v200
    v_exp_f32 v201, v201
    v_exp_f32 v202, v202
    v_exp_f32 v203, v203
    v_mfma_f32_16x16x16_bf16 v[192:195], v[88:89], v[162:163], v[236:239]
    v_exp_f32 v204, v204
    v_exp_f32 v205, v205
    v_exp_f32 v206, v206
    v_exp_f32 v207, v207
    v_mfma_f32_16x16x16_bf16 v[188:191], v[90:91], v[160:161], v[240:243]
    v_exp_f32 v208, v208
    v_exp_f32 v209, v209
    v_exp_f32 v210, v210
    v_exp_f32 v211, v211
    v_mfma_f32_16x16x16_bf16 v[196:199], v[90:91], v[162:163], v[244:247]
    v_exp_f32 v212, v212
    v_exp_f32 v213, v213
    v_exp_f32 v214, v214
    v_exp_f32 v215, v215
    v_cvt_pk_bf16_f32 v164, v200, v201
    v_cvt_pk_bf16_f32 v165, v202, v203
    v_cvt_pk_bf16_f32 v166, v204, v205
    v_cvt_pk_bf16_f32 v167, v206, v207
    v_cvt_pk_bf16_f32 v168, v208, v209
    v_cvt_pk_bf16_f32 v169, v210, v211
    v_cvt_pk_bf16_f32 v170, v212, v213
    v_cvt_pk_bf16_f32 v171, v214, v215
    s_nop 1
    v_mfma_f32_16x16x32_bf16 v[172:175], v[128:131], v[164:167], v[172:175]
    v_mfma_f32_16x16x32_bf16 v[16:19], v[12:15], v[164:167], v[16:19]
    v_mfma_f32_16x16x32_bf16 v[176:179], v[128:131], v[168:171], v[176:179]
    v_mfma_f32_16x16x32_bf16 v[20:23], v[12:15], v[168:171], v[20:23]
    v_exp_f32 v184, v184
    v_exp_f32 v185, v185
    v_exp_f32 v186, v186
    v_exp_f32 v187, v187
    v_exp_f32 v188, v188
    v_exp_f32 v189, v189
    v_exp_f32 v190, v190
    v_exp_f32 v191, v191
    v_exp_f32 v192, v192
    v_exp_f32 v193, v193
    v_exp_f32 v194, v194
    v_exp_f32 v195, v195
    v_exp_f32 v196, v196
    v_exp_f32 v197, v197
    v_exp_f32 v198, v198
    v_exp_f32 v199, v199
    v_cvt_pk_bf16_f32 v164, v184, v185
    v_cvt_pk_bf16_f32 v165, v186, v187
    v_cvt_pk_bf16_f32 v166, v188, v189
    v_cvt_pk_bf16_f32 v167, v190, v191
    v_cvt_pk_bf16_f32 v168, v192, v193
    v_cvt_pk_bf16_f32 v169, v194, v195
    v_cvt_pk_bf16_f32 v170, v196, v197
    v_cvt_pk_bf16_f32 v171, v198, v199
    s_nop 1
    v_mfma_f32_16x16x32_bf16 v[172:175], v[124:127], v[164:167], v[172:175]
    v_mfma_f32_16x16x32_bf16 v[16:19], v[12:15], v[164:167], v[16:19]
    v_mfma_f32_16x16x32_bf16 v[176:179], v[124:127], v[168:171], v[176:179]
    v_mfma_f32_16x16x32_bf16 v[20:23], v[12:15], v[168:171], v[20:23]
    s_branch m_p5_bp2_done
m_p5_bp2_8:
    v_exp_f32 v184, v184
    v_exp_f32 v185, v185
    v_exp_f32 v186, v186
    v_exp_f32 v187, v187
    v_exp_f32 v188, v188
    v_exp_f32 v189, v189
    v_exp_f32 v190, v190
    v_exp_f32 v191, v191
    v_exp_f32 v192, v192
    v_exp_f32 v193, v193
    v_exp_f32 v194, v194
    v_exp_f32 v195, v195
    v_exp_f32 v196, v196
    v_exp_f32 v197, v197
    v_exp_f32 v198, v198
    v_exp_f32 v199, v199
    v_cvt_pk_bf16_f32 v164, v184, v185
    v_cvt_pk_bf16_f32 v165, v186, v187
    v_cvt_pk_bf16_f32 v166, v188, v189
    v_cvt_pk_bf16_f32 v167, v190, v191
    v_cvt_pk_bf16_f32 v168, v192, v193
    v_cvt_pk_bf16_f32 v169, v194, v195
    v_cvt_pk_bf16_f32 v170, v196, v197
    v_cvt_pk_bf16_f32 v171, v198, v199
    s_nop 1
    v_mfma_f32_16x16x32_bf16 v[172:175], v[156:159], v[164:167], v[172:175]
    v_mfma_f32_16x16x32_bf16 v[16:19], v[12:15], v[164:167], v[16:19]
    v_mfma_f32_16x16x32_bf16 v[176:179], v[156:159], v[168:171], v[176:179]
    v_mfma_f32_16x16x32_bf16 v[20:23], v[12:15], v[168:171], v[20:23]
    s_cmp_eq_u32 s19, 0
    s_cbranch_scc1 m_p5_nl3
    s_add_u32 s52, s56, 57360
    v_mov_b32 v7, s52
    s_mov_b32 s54, 0
m_p5_cw3:
    ds_read_b32 v8, v7
    s_add_u32 s54, s54, 1
    s_waitcnt lgkmcnt(0)
    v_readfirstlane_b32 s52, v8
    s_cmp_ge_u32 s54, 0x1000000
    s_cbranch_scc1 m_p5_cwd3
    s_cmp_lt_u32 s52, 8
    s_cbranch_scc1 m_p5_cw3
m_p5_cwd3:
    s_add_u32 m0, s51, 16384
    s_add_u32 s53, s60, 0
    buffer_load_dwordx4 v2, s[28:31], s53 offen lds
    s_add_u32 m0, s51, 24576
    s_add_u32 s53, s60, 32768
    buffer_load_dwordx4 v2, s[28:31], s53 offen lds
    s_add_u32 m0, s51, 12288
    s_add_u32 s53, s60, 4294950912
    buffer_load_dwordx4 v2, s[28:31], s53 offen lds
    s_add_u32 m0, s51, 20480
    s_add_u32 s53, s60, 16384
    buffer_load_dwordx4 v2, s[28:31], s53 offen lds
    s_add_u32 m0, s51, 49152
    s_add_u32 s53, s60, 65536
    buffer_load_dwordx4 v2, s[28:31], s53 offen lds
    s_add_u32 m0, s51, 57344
    s_add_u32 s53, s60, 98304
    buffer_load_dwordx4 v2, s[28:31], s53 offen lds
    s_add_u32 m0, s51, 45056
    s_add_u32 s53, s60, 49152
    buffer_load_dwordx4 v2, s[28:31], s53 offen lds
    s_add_u32 m0, s51, 53248
    s_add_u32 s53, s60, 81920
    buffer_load_dwordx4 v2, s[28:31], s53 offen lds
    s_add_u32 m0, s51, 81920
    s_add_u32 s53, s60, 131072
    buffer_load_dwordx4 v2, s[28:31], s53 offen lds
    s_add_u32 m0, s51, 90112
    s_add_u32 s53, s60, 163840
    buffer_load_dwordx4 v2, s[28:31], s53 offen lds
    s_add_u32 m0, s51, 77824
    s_add_u32 s53, s60, 114688
    buffer_load_dwordx4 v2, s[28:31], s53 offen lds
    s_add_u32 m0, s51, 86016
    s_add_u32 s53, s60, 147456
    buffer_load_dwordx4 v2, s[28:31], s53 offen lds
    s_add_u32 m0, s51, 114688
    s_add_u32 s53, s60, 196608
    buffer_load_dwordx4 v2, s[28:31], s53 offen lds
    s_add_u32 m0, s51, 122880
    s_add_u32 s53, s60, 229376
    buffer_load_dwordx4 v2, s[28:31], s53 offen lds
    s_add_u32 m0, s51, 110592
    s_add_u32 s53, s60, 180224
    buffer_load_dwordx4 v2, s[28:31], s53 offen lds
    s_add_u32 m0, s51, 118784
    s_add_u32 s53, s60, 212992
    buffer_load_dwordx4 v2, s[28:31], s53 offen lds
    s_add_u32 m0, s51, 147456
    s_add_u32 s53, s60, 262144
    buffer_load_dwordx4 v2, s[28:31], s53 offen lds
    s_add_u32 m0, s51, 155648
    s_add_u32 s53, s60, 294912
    buffer_load_dwordx4 v2, s[28:31], s53 offen lds
    s_add_u32 m0, s51, 143360
    s_add_u32 s53, s60, 245760
    buffer_load_dwordx4 v2, s[28:31], s53 offen lds
    s_add_u32 m0, s51, 151552
    s_add_u32 s53, s60, 278528
    buffer_load_dwordx4 v2, s[28:31], s53 offen lds
    buffer_load_dwordx2 v[52:53], v10, s[44:47], s64 offen sc1
m_p5_nl3:
    s_cmp_eq_u32 s19, 0
    s_cbranch_scc1 m_p5_nl4
    s_waitcnt vmcnt(0)
    v_cmp_ne_u64 vcc, s[68:69], v[52:53]
    s_mov_b32 s54, 0
    s_nop 0
    s_cbranch_vccz m_p5_cc4_ok
m_p5_cc4_spin:
    buffer_load_dwordx2 v[52:53], v10, s[44:47], s64 offen sc1
    s_waitcnt vmcnt(0)
    v_cmp_ne_u64 vcc, s[68:69], v[52:53]
    s_add_u32 s54, s54, 1
    s_cmp_ge_u32 s54, 0x200000
    s_cbranch_scc1 m_p5_cc4_ok
    s_cbranch_vccnz m_p5_cc4_spin
m_p5_cc4_ok:
    s_add_u32 m0, s56, 0
    s_add_u32 s53, s58, 0
    buffer_load_dwordx4 v1, s[44:47], s53 offen sc1 lds
    buffer_load_dwordx4 v1, s[44:47], s53 offen offset:1024 sc1 lds
    s_add_u32 m0, s56, 4294959104
    s_add_u32 s53, s58, 4294443008
    buffer_load_dwordx4 v1, s[44:47], s53 offen sc1 lds
    buffer_load_dwordx4 v1, s[44:47], s53 offen offset:1024 sc1 lds
    s_add_u32 m0, s56, 32768
    s_add_u32 s53, s58, 2048
    buffer_load_dwordx4 v1, s[44:47], s53 offen sc1 lds
    buffer_load_dwordx4 v1, s[44:47], s53 offen offset:1024 sc1 lds
    s_add_u32 m0, s56, 24576
    s_add_u32 s53, s58, 4294445056
    buffer_load_dwordx4 v1, s[44:47], s53 offen sc1 lds
    buffer_load_dwordx4 v1, s[44:47], s53 offen offset:1024 sc1 lds
    s_add_u32 m0, s56, 65536
    s_add_u32 s53, s58, 4096
    buffer_load_dwordx4 v1, s[44:47], s53 offen sc1 lds
    buffer_load_dwordx4 v1, s[44:47], s53 offen offset:1024 sc1 lds
    s_add_u32 m0, s56, 57344
    s_add_u32 s53, s58, 4294447104
    buffer_load_dwordx4 v1, s[44:47], s53 offen sc1 lds
    buffer_load_dwordx4 v1, s[44:47], s53 offen offset:1024 sc1 lds
    s_add_u32 m0, s56, 98304
    s_add_u32 s53, s58, 6144
    buffer_load_dwordx4 v1, s[44:47], s53 offen sc1 lds
    buffer_load_dwordx4 v1, s[44:47], s53 offen offset:1024 sc1 lds
    s_add_u32 m0, s56, 90112
    s_add_u32 s53, s58, 4294449152
    buffer_load_dwordx4 v1, s[44:47], s53 offen sc1 lds
    buffer_load_dwordx4 v1, s[44:47], s53 offen offset:1024 sc1 lds
    s_add_u32 m0, s56, 131072
    s_add_u32 s53, s58, 8192
    buffer_load_dwordx4 v1, s[44:47], s53 offen sc1 lds
    buffer_load_dwordx4 v1, s[44:47], s53 offen offset:1024 sc1 lds
    s_add_u32 m0, s56, 122880
    s_add_u32 s53, s58, 4294451200
    buffer_load_dwordx4 v1, s[44:47], s53 offen sc1 lds
    buffer_load_dwordx4 v1, s[44:47], s53 offen offset:1024 sc1 lds
    s_mov_b32 s19, 0
m_p5_nl4:
    s_branch m_p5_bp2_done
m_p5_bp2_7:
    v_exp_f32 v200, v200
    v_exp_f32 v201, v201
    v_exp_f32 v202, v202
    v_exp_f32 v203, v203
    v_exp_f32 v204, v204
    v_exp_f32 v205, v205
    v_exp_f32 v206, v206
    v_exp_f32 v207, v207
    v_exp_f32 v208, v208
    v_exp_f32 v209, v209
    v_exp_f32 v210, v210
    v_exp_f32 v211, v211
    v_exp_f32 v212, v212
    v_exp_f32 v213, v213
    v_exp_f32 v214, v214
    v_exp_f32 v215, v215
    v_cvt_pk_bf16_f32 v164, v200, v201
    v_cvt_pk_bf16_f32 v165, v202, v203
    v_cvt_pk_bf16_f32 v166, v204, v205
    v_cvt_pk_bf16_f32 v167, v206, v207
    v_cvt_pk_bf16_f32 v168, v208, v209
    v_cvt_pk_bf16_f32 v169, v210, v211
    v_cvt_pk_bf16_f32 v170, v212, v213
    v_cvt_pk_bf16_f32 v171, v214, v215
    s_nop 1
    v_mfma_f32_16x16x32_bf16 v[172:175], v[152:155], v[164:167], v[172:175]
    v_mfma_f32_16x16x32_bf16 v[16:19], v[12:15], v[164:167], v[16:19]
    v_mfma_f32_16x16x32_bf16 v[176:179], v[152:155], v[168:171], v[176:179]
    v_mfma_f32_16x16x32_bf16 v[20:23], v[12:15], v[168:171], v[20:23]
    s_cmp_eq_u32 s19, 0
    s_cbranch_scc1 m_p5_nl5
    s_add_u32 s52, s56, 57360
    v_mov_b32 v7, s52
    s_mov_b32 s54, 0
m_p5_cw5:
    ds_read_b32 v8, v7
    s_add_u32 s54, s54, 1
    s_waitcnt lgkmcnt(0)
    v_readfirstlane_b32 s52, v8
    s_cmp_ge_u32 s54, 0x1000000
    s_cbranch_scc1 m_p5_cwd5
    s_cmp_lt_u32 s52, 8
    s_cbranch_scc1 m_p5_cw5
m_p5_cwd5:
    s_add_u32 m0, s51, 16384
    s_add_u32 s53, s60, 0
    buffer_load_dwordx4 v2, s[28:31], s53 offen lds
    s_add_u32 m0, s51, 24576
    s_add_u32 s53, s60, 32768
    buffer_load_dwordx4 v2, s[28:31], s53 offen lds
    s_add_u32 m0, s51, 12288
    s_add_u32 s53, s60, 4294950912
    buffer_load_dwordx4 v2, s[28:31], s53 offen lds
    s_add_u32 m0, s51, 20480
    s_add_u32 s53, s60, 16384
    buffer_load_dwordx4 v2, s[28:31], s53 offen lds
    s_add_u32 m0, s51, 49152
    s_add_u32 s53, s60, 65536
    buffer_load_dwordx4 v2, s[28:31], s53 offen lds
    s_add_u32 m0, s51, 57344
    s_add_u32 s53, s60, 98304
    buffer_load_dwordx4 v2, s[28:31], s53 offen lds
    s_add_u32 m0, s51, 45056
    s_add_u32 s53, s60, 49152
    buffer_load_dwordx4 v2, s[28:31], s53 offen lds
    s_add_u32 m0, s51, 53248
    s_add_u32 s53, s60, 81920
    buffer_load_dwordx4 v2, s[28:31], s53 offen lds
    s_add_u32 m0, s51, 81920
    s_add_u32 s53, s60, 131072
    buffer_load_dwordx4 v2, s[28:31], s53 offen lds
    s_add_u32 m0, s51, 90112
    s_add_u32 s53, s60, 163840
    buffer_load_dwordx4 v2, s[28:31], s53 offen lds
    s_add_u32 m0, s51, 77824
    s_add_u32 s53, s60, 114688
    buffer_load_dwordx4 v2, s[28:31], s53 offen lds
    s_add_u32 m0, s51, 86016
    s_add_u32 s53, s60, 147456
    buffer_load_dwordx4 v2, s[28:31], s53 offen lds
    s_add_u32 m0, s51, 114688
    s_add_u32 s53, s60, 196608
    buffer_load_dwordx4 v2, s[28:31], s53 offen lds
    s_add_u32 m0, s51, 122880
    s_add_u32 s53, s60, 229376
    buffer_load_dwordx4 v2, s[28:31], s53 offen lds
    s_add_u32 m0, s51, 110592
    s_add_u32 s53, s60, 180224
    buffer_load_dwordx4 v2, s[28:31], s53 offen lds
    s_add_u32 m0, s51, 118784
    s_add_u32 s53, s60, 212992
    buffer_load_dwordx4 v2, s[28:31], s53 offen lds
    s_add_u32 m0, s51, 147456
    s_add_u32 s53, s60, 262144
    buffer_load_dwordx4 v2, s[28:31], s53 offen lds
    s_add_u32 m0, s51, 155648
    s_add_u32 s53, s60, 294912
    buffer_load_dwordx4 v2, s[28:31], s53 offen lds
    s_add_u32 m0, s51, 143360
    s_add_u32 s53, s60, 245760
    buffer_load_dwordx4 v2, s[28:31], s53 offen lds
    s_add_u32 m0, s51, 151552
    s_add_u32 s53, s60, 278528
    buffer_load_dwordx4 v2, s[28:31], s53 offen lds
    buffer_load_dwordx2 v[52:53], v10, s[44:47], s64 offen sc1
m_p5_nl5:
    s_cmp_eq_u32 s19, 0
    s_cbranch_scc1 m_p5_nl6
    s_waitcnt vmcnt(0)
    v_cmp_ne_u64 vcc, s[68:69], v[52:53]
    s_mov_b32 s54, 0
    s_nop 0
    s_cbranch_vccz m_p5_cc6_ok
m_p5_cc6_spin:
    buffer_load_dwordx2 v[52:53], v10, s[44:47], s64 offen sc1
    s_waitcnt vmcnt(0)
    v_cmp_ne_u64 vcc, s[68:69], v[52:53]
    s_add_u32 s54, s54, 1
    s_cmp_ge_u32 s54, 0x200000
    s_cbranch_scc1 m_p5_cc6_ok
    s_cbranch_vccnz m_p5_cc6_spin
m_p5_cc6_ok:
    s_add_u32 m0, s56, 0
    s_add_u32 s53, s58, 0
    buffer_load_dwordx4 v1, s[44:47], s53 offen sc1 lds
    buffer_load_dwordx4 v1, s[44:47], s53 offen offset:1024 sc1 lds
    s_add_u32 m0, s56, 4294959104
    s_add_u32 s53, s58, 4294443008
    buffer_load_dwordx4 v1, s[44:47], s53 offen sc1 lds
    buffer_load_dwordx4 v1, s[44:47], s53 offen offset:1024 sc1 lds
    s_add_u32 m0, s56, 32768
    s_add_u32 s53, s58, 2048
    buffer_load_dwordx4 v1, s[44:47], s53 offen sc1 lds
    buffer_load_dwordx4 v1, s[44:47], s53 offen offset:1024 sc1 lds
    s_add_u32 m0, s56, 24576
    s_add_u32 s53, s58, 4294445056
    buffer_load_dwordx4 v1, s[44:47], s53 offen sc1 lds
    buffer_load_dwordx4 v1, s[44:47], s53 offen offset:1024 sc1 lds
    s_add_u32 m0, s56, 65536
    s_add_u32 s53, s58, 4096
    buffer_load_dwordx4 v1, s[44:47], s53 offen sc1 lds
    buffer_load_dwordx4 v1, s[44:47], s53 offen offset:1024 sc1 lds
    s_add_u32 m0, s56, 57344
    s_add_u32 s53, s58, 4294447104
    buffer_load_dwordx4 v1, s[44:47], s53 offen sc1 lds
    buffer_load_dwordx4 v1, s[44:47], s53 offen offset:1024 sc1 lds
    s_add_u32 m0, s56, 98304
    s_add_u32 s53, s58, 6144
    buffer_load_dwordx4 v1, s[44:47], s53 offen sc1 lds
    buffer_load_dwordx4 v1, s[44:47], s53 offen offset:1024 sc1 lds
    s_add_u32 m0, s56, 90112
    s_add_u32 s53, s58, 4294449152
    buffer_load_dwordx4 v1, s[44:47], s53 offen sc1 lds
    buffer_load_dwordx4 v1, s[44:47], s53 offen offset:1024 sc1 lds
    s_add_u32 m0, s56, 131072
    s_add_u32 s53, s58, 8192
    buffer_load_dwordx4 v1, s[44:47], s53 offen sc1 lds
    buffer_load_dwordx4 v1, s[44:47], s53 offen offset:1024 sc1 lds
    s_add_u32 m0, s56, 122880
    s_add_u32 s53, s58, 4294451200
    buffer_load_dwordx4 v1, s[44:47], s53 offen sc1 lds
    buffer_load_dwordx4 v1, s[44:47], s53 offen offset:1024 sc1 lds
    s_mov_b32 s19, 0
m_p5_nl6:
    s_branch m_p5_bp2_done
m_p5_bp2_6:
    v_exp_f32 v184, v184
    v_exp_f32 v185, v185
    v_exp_f32 v186, v186
    v_exp_f32 v187, v187
    v_exp_f32 v188, v188
    v_exp_f32 v189, v189
    v_exp_f32 v190, v190
    v_exp_f32 v191, v191
    v_exp_f32 v192, v192
    v_exp_f32 v193, v193
    v_exp_f32 v194, v194
    v_exp_f32 v195, v195
    v_exp_f32 v196, v196
    v_exp_f32 v197, v197
    v_exp_f32 v198, v198
    v_exp_f32 v199, v199
    v_cvt_pk_bf16_f32 v164, v184, v185
    v_cvt_pk_bf16_f32 v165, v186, v187
    v_cvt_pk_bf16_f32 v166, v188, v189
    v_cvt_pk_bf16_f32 v167, v190, v191
    v_cvt_pk_bf16_f32 v168, v192, v193
    v_cvt_pk_bf16_f32 v169, v194, v195
    v_cvt_pk_bf16_f32 v170, v196, v197
    v_cvt_pk_bf16_f32 v171, v198, v199
    s_nop 1
    v_mfma_f32_16x16x32_bf16 v[172:175], v[148:151], v[164:167], v[172:175]
    v_mfma_f32_16x16x32_bf16 v[16:19], v[12:15], v[164:167], v[16:19]
    v_mfma_f32_16x16x32_bf16 v[176:179], v[148:151], v[168:171], v[176:179]
    v_mfma_f32_16x16x32_bf16 v[20:23], v[12:15], v[168:171], v[20:23]
    s_cmp_eq_u32 s19, 0
    s_cbranch_scc1 m_p5_nl7
    s_waitcnt vmcnt(0)
    v_cmp_ne_u64 vcc, s[68:69], v[52:53]
    s_mov_b32 s54, 0
    s_nop 0
    s_cbranch_vccz m_p5_cc7_ok
m_p5_cc7_spin:
    buffer_load_dwordx2 v[52:53], v10, s[44:47], s64 offen sc1
    s_waitcnt vmcnt(0)
    v_cmp_ne_u64 vcc, s[68:69], v[52:53]
    s_add_u32 s54, s54, 1
    s_cmp_ge_u32 s54, 0x200000
    s_cbranch_scc1 m_p5_cc7_ok
    s_cbranch_vccnz m_p5_cc7_spin
m_p5_cc7_ok:
    s_add_u32 m0, s56, 0
    s_add_u32 s53, s58, 0
    buffer_load_dwordx4 v1, s[44:47], s53 offen sc1 lds
    buffer_load_dwordx4 v1, s[44:47], s53 offen offset:1024 sc1 lds
    s_add_u32 m0, s56, 4294959104
    s_add_u32 s53, s58, 4294443008
    buffer_load_dwordx4 v1, s[44:47], s53 offen sc1 lds
    buffer_load_dwordx4 v1, s[44:47], s53 offen offset:1024 sc1 lds
    s_add_u32 m0, s56, 32768
    s_add_u32 s53, s58, 2048
    buffer_load_dwordx4 v1, s[44:47], s53 offen sc1 lds
    buffer_load_dwordx4 v1, s[44:47], s53 offen offset:1024 sc1 lds
    s_add_u32 m0, s56, 24576
    s_add_u32 s53, s58, 4294445056
    buffer_load_dwordx4 v1, s[44:47], s53 offen sc1 lds
    buffer_load_dwordx4 v1, s[44:47], s53 offen offset:1024 sc1 lds
    s_add_u32 m0, s56, 65536
    s_add_u32 s53, s58, 4096
    buffer_load_dwordx4 v1, s[44:47], s53 offen sc1 lds
    buffer_load_dwordx4 v1, s[44:47], s53 offen offset:1024 sc1 lds
    s_add_u32 m0, s56, 57344
    s_add_u32 s53, s58, 4294447104
    buffer_load_dwordx4 v1, s[44:47], s53 offen sc1 lds
    buffer_load_dwordx4 v1, s[44:47], s53 offen offset:1024 sc1 lds
    s_add_u32 m0, s56, 98304
    s_add_u32 s53, s58, 6144
    buffer_load_dwordx4 v1, s[44:47], s53 offen sc1 lds
    buffer_load_dwordx4 v1, s[44:47], s53 offen offset:1024 sc1 lds
    s_add_u32 m0, s56, 90112
    s_add_u32 s53, s58, 4294449152
    buffer_load_dwordx4 v1, s[44:47], s53 offen sc1 lds
    buffer_load_dwordx4 v1, s[44:47], s53 offen offset:1024 sc1 lds
    s_add_u32 m0, s56, 131072
    s_add_u32 s53, s58, 8192
    buffer_load_dwordx4 v1, s[44:47], s53 offen sc1 lds
    buffer_load_dwordx4 v1, s[44:47], s53 offen offset:1024 sc1 lds
    s_add_u32 m0, s56, 122880
    s_add_u32 s53, s58, 4294451200
    buffer_load_dwordx4 v1, s[44:47], s53 offen sc1 lds
    buffer_load_dwordx4 v1, s[44:47], s53 offen offset:1024 sc1 lds
    s_mov_b32 s19, 0
m_p5_nl7:
    s_branch m_p5_bp2_done
m_p5_bp2_5:
    v_exp_f32 v200, v200
    v_exp_f32 v201, v201
    v_exp_f32 v202, v202
    v_exp_f32 v203, v203
    v_exp_f32 v204, v204
    v_exp_f32 v205, v205
    v_exp_f32 v206, v206
    v_exp_f32 v207, v207
    v_exp_f32 v208, v208
    v_exp_f32 v209, v209
    v_exp_f32 v210, v210
    v_exp_f32 v211, v211
    v_exp_f32 v212, v212
    v_exp_f32 v213, v213
    v_exp_f32 v214, v214
    v_exp_f32 v215, v215
    v_cvt_pk_bf16_f32 v164, v200, v201
    v_cvt_pk_bf16_f32 v165, v202, v203
    v_cvt_pk_bf16_f32 v166, v204, v205
    v_cvt_pk_bf16_f32 v167, v206, v207
    v_cvt_pk_bf16_f32 v168, v208, v209
    v_cvt_pk_bf16_f32 v169, v210, v211
    v_cvt_pk_bf16_f32 v170, v212, v213
    v_cvt_pk_bf16_f32 v171, v214, v215
    s_nop 1
    v_mfma_f32_16x16x32_bf16 v[172:175], v[144:147], v[164:167], v[172:175]
    v_mfma_f32_16x16x32_bf16 v[16:19], v[12:15], v[164:167], v[16:19]
    v_mfma_f32_16x16x32_bf16 v[176:179], v[144:147], v[168:171], v[176:179]
    v_mfma_f32_16x16x32_bf16 v[20:23], v[12:15], v[168:171], v[20:23]
    s_cmp_eq_u32 s19, 0
    s_cbranch_scc1 m_p5_nl8
    s_waitcnt vmcnt(0)
    v_cmp_ne_u64 vcc, s[68:69], v[52:53]
    s_mov_b32 s54, 0
    s_nop 0
    s_cbranch_vccz m_p5_cc8_ok
m_p5_cc8_spin:
    buffer_load_dwordx2 v[52:53], v10, s[44:47], s64 offen sc1
    s_waitcnt vmcnt(0)
    v_cmp_ne_u64 vcc, s[68:69], v[52:53]
    s_add_u32 s54, s54, 1
    s_cmp_ge_u32 s54, 0x200000
    s_cbranch_scc1 m_p5_cc8_ok
    s_cbranch_vccnz m_p5_cc8_spin
m_p5_cc8_ok:
    s_add_u32 m0, s56, 0
    s_add_u32 s53, s58, 0
    buffer_load_dwordx4 v1, s[44:47], s53 offen sc1 lds
    buffer_load_dwordx4 v1, s[44:47], s53 offen offset:1024 sc1 lds
    s_add_u32 m0, s56, 4294959104
    s_add_u32 s53, s58, 4294443008
    buffer_load_dwordx4 v1, s[44:47], s53 offen sc1 lds
    buffer_load_dwordx4 v1, s[44:47], s53 offen offset:1024 sc1 lds
    s_add_u32 m0, s56, 32768
    s_add_u32 s53, s58, 2048
    buffer_load_dwordx4 v1, s[44:47], s53 offen sc1 lds
    buffer_load_dwordx4 v1, s[44:47], s53 offen offset:1024 sc1 lds
    s_add_u32 m0, s56, 24576
    s_add_u32 s53, s58, 4294445056
    buffer_load_dwordx4 v1, s[44:47], s53 offen sc1 lds
    buffer_load_dwordx4 v1, s[44:47], s53 offen offset:1024 sc1 lds
    s_add_u32 m0, s56, 65536
    s_add_u32 s53, s58, 4096
    buffer_load_dwordx4 v1, s[44:47], s53 offen sc1 lds
    buffer_load_dwordx4 v1, s[44:47], s53 offen offset:1024 sc1 lds
    s_add_u32 m0, s56, 57344
    s_add_u32 s53, s58, 4294447104
    buffer_load_dwordx4 v1, s[44:47], s53 offen sc1 lds
    buffer_load_dwordx4 v1, s[44:47], s53 offen offset:1024 sc1 lds
    s_add_u32 m0, s56, 98304
    s_add_u32 s53, s58, 6144
    buffer_load_dwordx4 v1, s[44:47], s53 offen sc1 lds
    buffer_load_dwordx4 v1, s[44:47], s53 offen offset:1024 sc1 lds
    s_add_u32 m0, s56, 90112
    s_add_u32 s53, s58, 4294449152
    buffer_load_dwordx4 v1, s[44:47], s53 offen sc1 lds
    buffer_load_dwordx4 v1, s[44:47], s53 offen offset:1024 sc1 lds
    s_add_u32 m0, s56, 131072
    s_add_u32 s53, s58, 8192
    buffer_load_dwordx4 v1, s[44:47], s53 offen sc1 lds
    buffer_load_dwordx4 v1, s[44:47], s53 offen offset:1024 sc1 lds
    s_add_u32 m0, s56, 122880
    s_add_u32 s53, s58, 4294451200
    buffer_load_dwordx4 v1, s[44:47], s53 offen sc1 lds
    buffer_load_dwordx4 v1, s[44:47], s53 offen offset:1024 sc1 lds
    s_mov_b32 s19, 0
m_p5_nl8:
    s_branch m_p5_bp2_done
m_p5_bp2_4:
    v_exp_f32 v184, v184
    v_exp_f32 v185, v185
    v_exp_f32 v186, v186
    v_exp_f32 v187, v187
    v_exp_f32 v188, v188
    v_exp_f32 v189, v189
    v_exp_f32 v190, v190
    v_exp_f32 v191, v191
    v_exp_f32 v192, v192
    v_exp_f32 v193, v193
    v_exp_f32 v194, v194
    v_exp_f32 v195, v195
    v_exp_f32 v196, v196
    v_exp_f32 v197, v197
    v_exp_f32 v198, v198
    v_exp_f32 v199, v199
    v_cvt_pk_bf16_f32 v164, v184, v185
    v_cvt_pk_bf16_f32 v165, v186, v187
    v_cvt_pk_bf16_f32 v166, v188, v189
    v_cvt_pk_bf16_f32 v167, v190, v191
    v_cvt_pk_bf16_f32 v168, v192, v193
    v_cvt_pk_bf16_f32 v169, v194, v195
    v_cvt_pk_bf16_f32 v170, v196, v197
    v_cvt_pk_bf16_f32 v171, v198, v199
    s_nop 1
    v_mfma_f32_16x16x32_bf16 v[172:175], v[140:143], v[164:167], v[172:175]
    v_mfma_f32_16x16x32_bf16 v[16:19], v[12:15], v[164:167], v[16:19]
    v_mfma_f32_16x16x32_bf16 v[176:179], v[140:143], v[168:171], v[176:179]
    v_mfma_f32_16x16x32_bf16 v[20:23], v[12:15], v[168:171], v[20:23]
    s_cmp_eq_u32 s19, 0
    s_cbranch_scc1 m_p5_nl9
    s_waitcnt vmcnt(0)
    v_cmp_ne_u64 vcc, s[68:69], v[52:53]
    s_mov_b32 s54, 0
    s_nop 0
    s_cbranch_vccz m_p5_cc9_ok
m_p5_cc9_spin:
    buffer_load_dwordx2 v[52:53], v10, s[44:47], s64 offen sc1
    s_waitcnt vmcnt(0)
    v_cmp_ne_u64 vcc, s[68:69], v[52:53]
    s_add_u32 s54, s54, 1
    s_cmp_ge_u32 s54, 0x200000
    s_cbranch_scc1 m_p5_cc9_ok
    s_cbranch_vccnz m_p5_cc9_spin
m_p5_cc9_ok:
    s_add_u32 m0, s56, 0
    s_add_u32 s53, s58, 0
    buffer_load_dwordx4 v1, s[44:47], s53 offen sc1 lds
    buffer_load_dwordx4 v1, s[44:47], s53 offen offset:1024 sc1 lds
    s_add_u32 m0, s56, 4294959104
    s_add_u32 s53, s58, 4294443008
    buffer_load_dwordx4 v1, s[44:47], s53 offen sc1 lds
    buffer_load_dwordx4 v1, s[44:47], s53 offen offset:1024 sc1 lds
    s_add_u32 m0, s56, 32768
    s_add_u32 s53, s58, 2048
    buffer_load_dwordx4 v1, s[44:47], s53 offen sc1 lds
    buffer_load_dwordx4 v1, s[44:47], s53 offen offset:1024 sc1 lds
    s_add_u32 m0, s56, 24576
    s_add_u32 s53, s58, 4294445056
    buffer_load_dwordx4 v1, s[44:47], s53 offen sc1 lds
    buffer_load_dwordx4 v1, s[44:47], s53 offen offset:1024 sc1 lds
    s_add_u32 m0, s56, 65536
    s_add_u32 s53, s58, 4096
    buffer_load_dwordx4 v1, s[44:47], s53 offen sc1 lds
    buffer_load_dwordx4 v1, s[44:47], s53 offen offset:1024 sc1 lds
    s_add_u32 m0, s56, 57344
    s_add_u32 s53, s58, 4294447104
    buffer_load_dwordx4 v1, s[44:47], s53 offen sc1 lds
    buffer_load_dwordx4 v1, s[44:47], s53 offen offset:1024 sc1 lds
    s_add_u32 m0, s56, 98304
    s_add_u32 s53, s58, 6144
    buffer_load_dwordx4 v1, s[44:47], s53 offen sc1 lds
    buffer_load_dwordx4 v1, s[44:47], s53 offen offset:1024 sc1 lds
    s_add_u32 m0, s56, 90112
    s_add_u32 s53, s58, 4294449152
    buffer_load_dwordx4 v1, s[44:47], s53 offen sc1 lds
    buffer_load_dwordx4 v1, s[44:47], s53 offen offset:1024 sc1 lds
    s_add_u32 m0, s56, 131072
    s_add_u32 s53, s58, 8192
    buffer_load_dwordx4 v1, s[44:47], s53 offen sc1 lds
    buffer_load_dwordx4 v1, s[44:47], s53 offen offset:1024 sc1 lds
    s_add_u32 m0, s56, 122880
    s_add_u32 s53, s58, 4294451200
    buffer_load_dwordx4 v1, s[44:47], s53 offen sc1 lds
    buffer_load_dwordx4 v1, s[44:47], s53 offen offset:1024 sc1 lds
    s_mov_b32 s19, 0
m_p5_nl9:
    s_branch m_p5_bp2_done
m_p5_bp2_3:
    v_exp_f32 v200, v200
    v_exp_f32 v201, v201
    v_exp_f32 v202, v202
    v_exp_f32 v203, v203
    v_exp_f32 v204, v204
    v_exp_f32 v205, v205
    v_exp_f32 v206, v206
    v_exp_f32 v207, v207
    v_exp_f32 v208, v208
    v_exp_f32 v209, v209
    v_exp_f32 v210, v210
    v_exp_f32 v211, v211
    v_exp_f32 v212, v212
    v_exp_f32 v213, v213
    v_exp_f32 v214, v214
    v_exp_f32 v215, v215
    v_cvt_pk_bf16_f32 v164, v200, v201
    v_cvt_pk_bf16_f32 v165, v202, v203
    v_cvt_pk_bf16_f32 v166, v204, v205
    v_cvt_pk_bf16_f32 v167, v206, v207
    v_cvt_pk_bf16_f32 v168, v208, v209
    v_cvt_pk_bf16_f32 v169, v210, v211
    v_cvt_pk_bf16_f32 v170, v212, v213
    v_cvt_pk_bf16_f32 v171, v214, v215
    s_nop 1
    v_mfma_f32_16x16x32_bf16 v[172:175], v[136:139], v[164:167], v[172:175]
    v_mfma_f32_16x16x32_bf16 v[16:19], v[12:15], v[164:167], v[16:19]
    v_mfma_f32_16x16x32_bf16 v[176:179], v[136:139], v[168:171], v[176:179]
    v_mfma_f32_16x16x32_bf16 v[20:23], v[12:15], v[168:171], v[20:23]
    s_branch m_p5_bp2_done
m_p5_bp2_2:
    v_exp_f32 v184, v184
    v_exp_f32 v185, v185
    v_exp_f32 v186, v186
    v_exp_f32 v187, v187
    v_exp_f32 v188, v188
    v_exp_f32 v189, v189
    v_exp_f32 v190, v190
    v_exp_f32 v191, v191
    v_exp_f32 v192, v192
    v_exp_f32 v193, v193
    v_exp_f32 v194, v194
    v_exp_f32 v195, v195
    v_exp_f32 v196, v196
    v_exp_f32 v197, v197
    v_exp_f32 v198, v198
    v_exp_f32 v199, v199
    v_cvt_pk_bf16_f32 v164, v184, v185
    v_cvt_pk_bf16_f32 v165, v186, v187
    v_cvt_pk_bf16_f32 v166, v188, v189
    v_cvt_pk_bf16_f32 v167, v190, v191
    v_cvt_pk_bf16_f32 v168, v192, v193
    v_cvt_pk_bf16_f32 v169, v194, v195
    v_cvt_pk_bf16_f32 v170, v196, v197
    v_cvt_pk_bf16_f32 v171, v198, v199
    s_nop 1
    v_mfma_f32_16x16x32_bf16 v[172:175], v[132:135], v[164:167], v[172:175]
    v_mfma_f32_16x16x32_bf16 v[16:19], v[12:15], v[164:167], v[16:19]
    v_mfma_f32_16x16x32_bf16 v[176:179], v[132:135], v[168:171], v[176:179]
    v_mfma_f32_16x16x32_bf16 v[20:23], v[12:15], v[168:171], v[20:23]
    s_branch m_p5_bp2_done
m_p5_bp2_1:
    v_exp_f32 v200, v200
    v_exp_f32 v201, v201
    v_exp_f32 v202, v202
    v_exp_f32 v203, v203
    v_exp_f32 v204, v204
    v_exp_f32 v205, v205
    v_exp_f32 v206, v206
    v_exp_f32 v207, v207
    v_exp_f32 v208, v208
    v_exp_f32 v209, v209
    v_exp_f32 v210, v210
    v_exp_f32 v211, v211
    v_exp_f32 v212, v212
    v_exp_f32 v213, v213
    v_exp_f32 v214, v214
    v_exp_f32 v215, v215
    v_cvt_pk_bf16_f32 v164, v200, v201
    v_cvt_pk_bf16_f32 v165, v202, v203
    v_cvt_pk_bf16_f32 v166, v204, v205
    v_cvt_pk_bf16_f32 v167, v206, v207
    v_cvt_pk_bf16_f32 v168, v208, v209
    v_cvt_pk_bf16_f32 v169, v210, v211
    v_cvt_pk_bf16_f32 v170, v212, v213
    v_cvt_pk_bf16_f32 v171, v214, v215
    s_nop 1
    v_mfma_f32_16x16x32_bf16 v[172:175], v[128:131], v[164:167], v[172:175]
    v_mfma_f32_16x16x32_bf16 v[16:19], v[12:15], v[164:167], v[16:19]
    v_mfma_f32_16x16x32_bf16 v[176:179], v[128:131], v[168:171], v[176:179]
    v_mfma_f32_16x16x32_bf16 v[20:23], v[12:15], v[168:171], v[20:23]
m_p5_bp2_done:
    s_lshl_b32 s52, s15, 15
    s_lshr_b32 s53, s65, 1
    s_lshl_b32 s53, s53, 10
    s_add_u32 s52, s52, s53
    s_and_b32 s53, s65, 1
    s_lshl_b32 s53, s53, 3
    s_add_u32 s52, s52, s53
    s_add_u32 s52, s52, 50331648
    s_add_u32 s53, s52, 16384
    v_add_f32 v7, v16, v20
    v_fma_f32 v7, v172, 0, v7
    v_fma_f32 v7, v173, 0, v7
    v_fma_f32 v7, v174, 0, v7
    v_fma_f32 v7, v175, 0, v7
    v_fma_f32 v7, v176, 0, v7
    v_fma_f32 v7, v177, 0, v7
    v_fma_f32 v7, v178, 0, v7
    v_fma_f32 v7, v179, 0, v7
    s_mov_b32 s17, 0x71800000
    v_cmp_ngt_f32 vcc, s17, v7
    s_cmp_eq_u32 s18, 0
    s_cbranch_scc1 m_p5_bok
    s_cbranch_vccz m_p5_bok
    v_cmp_gt_i32 vcc, 0, v5
    v_mov_b32 v224, v6
    v_mov_b32 v236, v6
    v_mov_b64 v[220:221], 0
    v_mov_b64 v[222:223], 0
    v_mov_b64 v[240:241], 0
    v_mov_b64 v[242:243], 0
    v_cndmask_b32 v216, 0, v6, vcc
    v_cndmask_b32 v228, 0, v6, vcc
    v_cndmask_b32 v232, v6, v220, vcc
    v_cndmask_b32 v244, v6, v220, vcc
    v_cmp_gt_i32 vcc, 1, v5
    v_mov_b32 v225, v6
    v_mov_b32 v237, v6
    v_cndmask_b32 v217, 0, v6, vcc
    v_cndmask_b32 v229, 0, v6, vcc
    v_cndmask_b32 v233, v6, v220, vcc
    v_cndmask_b32 v245, v6, v220, vcc
    v_cmp_gt_i32 vcc, 2, v5
    v_mov_b32 v226, v6
    v_mov_b32 v238, v6
    v_cndmask_b32 v218, 0, v6, vcc
    v_cndmask_b32 v230, 0, v6, vcc
    v_cndmask_b32 v234, v6, v220, vcc
    v_cndmask_b32 v246, v6, v220, vcc
    v_cmp_gt_i32 vcc, 3, v5
    v_mov_b32 v227, v6
    v_mov_b32 v239, v6
    v_cndmask_b32 v219, 0, v6, vcc
    v_cndmask_b32 v231, 0, v6, vcc
    v_cndmask_b32 v235, v6, v220, vcc
    v_cndmask_b32 v247, v6, v220, vcc
    v_mov_b64 v[172:173], 0
    v_mov_b64 v[174:175], 0
    v_mov_b64 v[176:177], 0
    v_mov_b64 v[178:179], 0
    v_mov_b64 v[16:17], 0
    v_mov_b64 v[18:19], 0
    v_mov_b64 v[20:21], 0
    v_mov_b64 v[22:23], 0
    v_mov_b32 v180, v6
    v_mov_b32 v182, v6
    s_mov_b32 s18, 0
    s_branch m_p5_bagain
m_p5_bok:
    v_rcp_f32 v7, v16
    v_rcp_f32 v8, v20
    s_nop 0
    v_mul_f32 v172, v7, v172
    v_mul_f32 v173, v7, v173
    v_mul_f32 v174, v7, v174
    v_mul_f32 v175, v7, v175
    v_cvt_pk_bf16_f32 v164, v172, v173
    v_cvt_pk_bf16_f32 v165, v174, v175
    buffer_store_dwordx2 v[164:165], v1, s[44:47], s52 offen sc1
    v_mul_f32 v176, v8, v176
    v_mul_f32 v177, v8, v177
    v_mul_f32 v178, v8, v178
    v_mul_f32 v179, v8, v179
    v_cvt_pk_bf16_f32 v166, v176, v177
    v_cvt_pk_bf16_f32 v167, v178, v179
    buffer_store_dwordx2 v[166:167], v1, s[44:47], s53 offen sc1
    s_lshl_b32 s52, s50, 2
    s_lshr_b32 s63, s49, 1
    s_lshl_b32 s63, s63, 1
    s_add_u32 s52, s52, s63
    s_lshl_b32 s52, s52, 16
    s_lshl_b32 s63, s55, 8
    s_add_u32 s52, s52, s63
    s_and_b32 s63, s49, 1
    s_lshl_b32 s63, s63, 7
    s_add_u32 s62, s52, s63
    s_waitcnt vmcnt(18)
    s_barrier
    s_cmp_lt_u32 s48, 4
    s_cbranch_scc1 m_p5_pr5
    s_setprio 1
m_p5_pr5:
    ds_read_b64_tr_b16 v[152:153], v32 offset:0
    ds_read_b64_tr_b16 v[154:155], v32 offset:4096
    ds_read_b64_tr_b16 v[176:177], v32 offset:8192
    ds_read_b64_tr_b16 v[178:179], v32 offset:12288
    ds_read_b64_tr_b16 v[156:157], v35 offset:0
    ds_read_b64_tr_b16 v[158:159], v35 offset:4096
    ds_read_b64_tr_b16 v[180:181], v35 offset:8192
    ds_read_b64_tr_b16 v[182:183], v35 offset:12288
    ds_read_b128 v[136:139], v26 offset:0
    ds_read_b128 v[160:163], v26 offset:1024
    ds_read_b128 v[140:143], v26 offset:2048
    ds_read_b128 v[164:167], v26 offset:3072
    ds_read_b128 v[144:147], v26 offset:4096
    ds_read_b128 v[168:171], v26 offset:5120
    ds_read_b128 v[148:151], v26 offset:6144
    ds_read_b128 v[172:175], v26 offset:7168
    s_waitcnt lgkmcnt(6)
    v_mfma_f32_16x16x32_bf16 v[96:99], v[152:155], v[136:139], 0
    v_mfma_f32_16x16x32_bf16 v[96:99], v[176:179], v[160:163], v[96:99]
    v_mfma_f32_16x16x32_bf16 v[100:103], v[156:159], v[136:139], 0
    v_mfma_f32_16x16x32_bf16 v[100:103], v[180:183], v[160:163], v[100:103]
    s_waitcnt lgkmcnt(0)
    s_waitcnt vmcnt(14)
    s_barrier
    ds_read_b64_tr_b16 v[200:201], v32 offset:32768
    v_mfma_f32_16x16x32_bf16 v[104:107], v[152:155], v[140:143], 0
    ds_read_b64_tr_b16 v[202:203], v32 offset:36864
    s_add_u32 m0, s56, 0
    s_add_u32 s53, s58, 10240
    buffer_load_dwordx4 v1, s[44:47], s53 offen sc1 lds
    v_mfma_f32_16x16x32_bf16 v[104:107], v[176:179], v[164:167], v[104:107]
    ds_read_b64_tr_b16 v[224:225], v32 offset:40960
    v_mfma_f32_16x16x32_bf16 v[108:111], v[156:159], v[140:143], 0
    ds_read_b64_tr_b16 v[226:227], v32 offset:45056
    ds_read_b64_tr_b16 v[204:205], v35 offset:32768
    v_mfma_f32_16x16x32_bf16 v[108:111], v[180:183], v[164:167], v[108:111]
    ds_read_b64_tr_b16 v[206:207], v35 offset:36864
    buffer_load_dwordx4 v1, s[44:47], s53 offen offset:1024 sc1 lds
    v_mfma_f32_16x16x32_bf16 v[112:115], v[152:155], v[144:147], 0
    ds_read_b64_tr_b16 v[228:229], v35 offset:40960
    v_mfma_f32_16x16x32_bf16 v[112:115], v[176:179], v[168:171], v[112:115]
    ds_read_b64_tr_b16 v[230:231], v35 offset:45056
    ds_read_b128 v[184:187], v26 offset:32768
    v_mfma_f32_16x16x32_bf16 v[116:119], v[156:159], v[144:147], 0
    ds_read_b128 v[208:211], v26 offset:33792
    s_add_u32 m0, s51, 16384
    s_add_u32 s53, s60, 327680
    buffer_load_dwordx4 v2, s[28:31], s53 offen lds
    v_mfma_f32_16x16x32_bf16 v[116:119], v[180:183], v[168:171], v[116:119]
    ds_read_b128 v[188:191], v26 offset:34816
    v_mfma_f32_16x16x32_bf16 v[120:123], v[152:155], v[148:151], 0
    ds_read_b128 v[212:215], v26 offset:35840
    ds_read_b128 v[192:195], v26 offset:36864
    v_mfma_f32_16x16x32_bf16 v[120:123], v[176:179], v[172:175], v[120:123]
    ds_read_b128 v[216:219], v26 offset:37888
    s_add_u32 m0, s51, 24576
    s_add_u32 s53, s60, 360448
    buffer_load_dwordx4 v2, s[28:31], s53 offen lds
    v_mfma_f32_16x16x32_bf16 v[124:127], v[156:159], v[148:151], 0
    ds_read_b128 v[196:199], v26 offset:38912
    v_mfma_f32_16x16x32_bf16 v[124:127], v[180:183], v[172:175], v[124:127]
    ds_read_b128 v[220:223], v26 offset:39936
    s_waitcnt lgkmcnt(6)
    v_mfma_f32_16x16x32_bf16 v[96:99], v[200:203], v[184:187], v[96:99]
    v_mfma_f32_16x16x32_bf16 v[96:99], v[224:227], v[208:211], v[96:99]
    v_mfma_f32_16x16x32_bf16 v[100:103], v[204:207], v[184:187], v[100:103]
    v_mfma_f32_16x16x32_bf16 v[100:103], v[228:231], v[208:211], v[100:103]
    s_waitcnt lgkmcnt(0)
    s_waitcnt vmcnt(14)
    s_barrier
    ds_read_b64_tr_b16 v[152:153], v33 offset:0
    v_mfma_f32_16x16x32_bf16 v[104:107], v[200:203], v[188:191], v[104:107]
    ds_read_b64_tr_b16 v[154:155], v33 offset:4096
    s_add_u32 m0, s56, 32768
    s_add_u32 s53, s58, 12288
    buffer_load_dwordx4 v1, s[44:47], s53 offen sc1 lds
    v_mfma_f32_16x16x32_bf16 v[104:107], v[224:227], v[212:215], v[104:107]
    ds_read_b64_tr_b16 v[176:177], v33 offset:8192
    v_mfma_f32_16x16x32_bf16 v[108:111], v[204:207], v[188:191], v[108:111]
    ds_read_b64_tr_b16 v[178:179], v33 offset:12288
    ds_read_b64_tr_b16 v[156:157], v36 offset:0
    v_mfma_f32_16x16x32_bf16 v[108:111], v[228:231], v[212:215], v[108:111]
    ds_read_b64_tr_b16 v[158:159], v36 offset:4096
    buffer_load_dwordx4 v1, s[44:47], s53 offen offset:1024 sc1 lds
    v_mfma_f32_16x16x32_bf16 v[112:115], v[200:203], v[192:195], v[112:115]
    ds_read_b64_tr_b16 v[180:181], v36 offset:8192
    v_mfma_f32_16x16x32_bf16 v[112:115], v[224:227], v[216:219], v[112:115]
    ds_read_b64_tr_b16 v[182:183], v36 offset:12288
    ds_read_b128 v[136:139], v27 offset:0
    v_mfma_f32_16x16x32_bf16 v[116:119], v[204:207], v[192:195], v[116:119]
    ds_read_b128 v[160:163], v27 offset:1024
    s_add_u32 m0, s51, 49152
    s_add_u32 s53, s60, 393216
    buffer_load_dwordx4 v2, s[28:31], s53 offen lds
    v_mfma_f32_16x16x32_bf16 v[116:119], v[228:231], v[216:219], v[116:119]
    ds_read_b128 v[140:143], v27 offset:2048
    v_mfma_f32_16x16x32_bf16 v[120:123], v[200:203], v[196:199], v[120:123]
    ds_read_b128 v[164:167], v27 offset:3072
    ds_read_b128 v[144:147], v27 offset:4096
    v_mfma_f32_16x16x32_bf16 v[120:123], v[224:227], v[220:223], v[120:123]
    ds_read_b128 v[168:171], v27 offset:5120
    s_add_u32 m0, s51, 57344
    s_add_u32 s53, s60, 425984
    buffer_load_dwordx4 v2, s[28:31], s53 offen lds
    v_mfma_f32_16x16x32_bf16 v[124:127], v[204:207], v[196:199], v[124:127]
    ds_read_b128 v[148:151], v27 offset:6144
    v_mfma_f32_16x16x32_bf16 v[124:127], v[228:231], v[220:223], v[124:127]
    ds_read_b128 v[172:175], v27 offset:7168
    s_waitcnt lgkmcnt(6)
    v_mfma_f32_16x16x32_bf16 v[96:99], v[152:155], v[136:139], v[96:99]
    v_mfma_f32_16x16x32_bf16 v[96:99], v[176:179], v[160:163], v[96:99]
    v_mfma_f32_16x16x32_bf16 v[100:103], v[156:159], v[136:139], v[100:103]
    v_mfma_f32_16x16x32_bf16 v[100:103], v[180:183], v[160:163], v[100:103]
    s_waitcnt lgkmcnt(0)
    s_waitcnt vmcnt(14)
    s_barrier
    ds_read_b64_tr_b16 v[200:201], v33 offset:32768
    v_mfma_f32_16x16x32_bf16 v[104:107], v[152:155], v[140:143], v[104:107]
    ds_read_b64_tr_b16 v[202:203], v33 offset:36864
    s_add_u32 m0, s56, 65536
    s_add_u32 s53, s58, 14336
    buffer_load_dwordx4 v1, s[44:47], s53 offen sc1 lds
    v_mfma_f32_16x16x32_bf16 v[104:107], v[176:179], v[164:167], v[104:107]
    ds_read_b64_tr_b16 v[224:225], v33 offset:40960
    v_mfma_f32_16x16x32_bf16 v[108:111], v[156:159], v[140:143], v[108:111]
    ds_read_b64_tr_b16 v[226:227], v33 offset:45056
    ds_read_b64_tr_b16 v[204:205], v36 offset:32768
    v_mfma_f32_16x16x32_bf16 v[108:111], v[180:183], v[164:167], v[108:111]
    ds_read_b64_tr_b16 v[206:207], v36 offset:36864
    buffer_load_dwordx4 v1, s[44:47], s53 offen offset:1024 sc1 lds
    v_mfma_f32_16x16x32_bf16 v[112:115], v[152:155], v[144:147], v[112:115]
    ds_read_b64_tr_b16 v[228:229], v36 offset:40960
    v_mfma_f32_16x16x32_bf16 v[112:115], v[176:179], v[168:171], v[112:115]
    ds_read_b64_tr_b16 v[230:231], v36 offset:45056
    ds_read_b128 v[184:187], v27 offset:32768
    v_mfma_f32_16x16x32_bf16 v[116:119], v[156:159], v[144:147], v[116:119]
    ds_read_b128 v[208:211], v27 offset:33792
    s_add_u32 m0, s51, 81920
    s_add_u32 s53, s60, 458752
    buffer_load_dwordx4 v2, s[28:31], s53 offen lds
    v_mfma_f32_16x16x32_bf16 v[116:119], v[180:183], v[168:171], v[116:119]
    ds_read_b128 v[188:191], v27 offset:34816
    v_mfma_f32_16x16x32_bf16 v[120:123], v[152:155], v[148:151], v[120:123]
    ds_read_b128 v[212:215], v27 offset:35840
    ds_read_b128 v[192:195], v27 offset:36864
    v_mfma_f32_16x16x32_bf16 v[120:123], v[176:179], v[172:175], v[120:123]
    ds_read_b128 v[216:219], v27 offset:37888
    s_add_u32 m0, s51, 90112
    s_add_u32 s53, s60, 491520
    buffer_load_dwordx4 v2, s[28:31], s53 offen lds
    v_mfma_f32_16x16x32_bf16 v[124:127], v[156:159], v[148:151], v[124:127]
    ds_read_b128 v[196:199], v27 offset:38912
    v_mfma_f32_16x16x32_bf16 v[124:127], v[180:183], v[172:175], v[124:127]
    ds_read_b128 v[220:223], v27 offset:39936
    s_waitcnt lgkmcnt(6)
    v_mfma_f32_16x16x32_bf16 v[96:99], v[200:203], v[184:187], v[96:99]
    v_mfma_f32_16x16x32_bf16 v[96:99], v[224:227], v[208:211], v[96:99]
    v_mfma_f32_16x16x32_bf16 v[100:103], v[204:207], v[184:187], v[100:103]
    v_mfma_f32_16x16x32_bf16 v[100:103], v[228:231], v[208:211], v[100:103]
    s_waitcnt lgkmcnt(0)
    s_waitcnt vmcnt(12)
    s_barrier
    ds_read_b64_tr_b16 v[152:153], v34 offset:0
    v_mfma_f32_16x16x32_bf16 v[104:107], v[200:203], v[188:191], v[104:107]
    ds_read_b64_tr_b16 v[154:155], v34 offset:4096
    s_cmp_lg_u32 s48, 0
    s_cbranch_scc1 m_p5_sigb
    s_lshl_b32 s52, s2, 3
    s_add_u32 s52, s52, 63983616
    s_mov_b64 exec, 1
    buffer_store_dwordx2 v[42:43], off, s[44:47], s52 sc1
    s_mov_b64 exec, -1
m_p5_sigb:
    v_mfma_f32_16x16x32_bf16 v[104:107], v[224:227], v[212:215], v[104:107]
    ds_read_b64_tr_b16 v[176:177], v34 offset:8192
    v_mfma_f32_16x16x32_bf16 v[108:111], v[204:207], v[188:191], v[108:111]
    ds_read_b64_tr_b16 v[178:179], v34 offset:12288
    ds_read_b64_tr_b16 v[156:157], v37 offset:0
    s_add_u32 m0, s56, 98304
    s_add_u32 s53, s58, 16384
    buffer_load_dwordx4 v1, s[44:47], s53 offen sc1 lds
    v_mfma_f32_16x16x32_bf16 v[108:111], v[228:231], v[212:215], v[108:111]
    ds_read_b64_tr_b16 v[158:159], v37 offset:4096
    v_mfma_f32_16x16x32_bf16 v[112:115], v[200:203], v[192:195], v[112:115]
    ds_read_b64_tr_b16 v[180:181], v37 offset:8192
    buffer_load_dwordx4 v1, s[44:47], s53 offen offset:1024 sc1 lds
    v_mfma_f32_16x16x32_bf16 v[112:115], v[224:227], v[216:219], v[112:115]
    ds_read_b64_tr_b16 v[182:183], v37 offset:12288
    ds_read_b128 v[136:139], v28 offset:0
    v_mfma_f32_16x16x32_bf16 v[116:119], v[204:207], v[192:195], v[116:119]
    ds_read_b128 v[160:163], v28 offset:1024
    v_mfma_f32_16x16x32_bf16 v[116:119], v[228:231], v[216:219], v[116:119]
    ds_read_b128 v[140:143], v28 offset:2048
    s_add_u32 m0, s51, 114688
    s_add_u32 s53, s60, 524288
    buffer_load_dwordx4 v2, s[28:31], s53 offen lds
    v_mfma_f32_16x16x32_bf16 v[120:123], v[200:203], v[196:199], v[120:123]
    ds_read_b128 v[164:167], v28 offset:3072
    ds_read_b128 v[144:147], v28 offset:4096
    v_mfma_f32_16x16x32_bf16 v[120:123], v[224:227], v[220:223], v[120:123]
    ds_read_b128 v[168:171], v28 offset:5120
    s_add_u32 m0, s51, 122880
    s_add_u32 s53, s60, 557056
    buffer_load_dwordx4 v2, s[28:31], s53 offen lds
    v_mfma_f32_16x16x32_bf16 v[124:127], v[204:207], v[196:199], v[124:127]
    ds_read_b128 v[148:151], v28 offset:6144
    v_mfma_f32_16x16x32_bf16 v[124:127], v[228:231], v[220:223], v[124:127]
    ds_read_b128 v[172:175], v28 offset:7168
    s_waitcnt lgkmcnt(6)
    v_mfma_f32_16x16x32_bf16 v[96:99], v[152:155], v[136:139], v[96:99]
    v_mfma_f32_16x16x32_bf16 v[96:99], v[176:179], v[160:163], v[96:99]
    v_mfma_f32_16x16x32_bf16 v[100:103], v[156:159], v[136:139], v[100:103]
    v_mfma_f32_16x16x32_bf16 v[100:103], v[180:183], v[160:163], v[100:103]
    s_waitcnt lgkmcnt(0)
    s_waitcnt vmcnt(12)
    s_barrier
    ds_read_b64_tr_b16 v[200:201], v32 offset:0
    v_mfma_f32_16x16x32_bf16 v[104:107], v[152:155], v[140:143], v[104:107]
    ds_read_b64_tr_b16 v[202:203], v32 offset:4096
    s_add_u32 m0, s56, 131072
    s_add_u32 s53, s58, 18432
    buffer_load_dwordx4 v1, s[44:47], s53 offen sc1 lds
    v_mfma_f32_16x16x32_bf16 v[104:107], v[176:179], v[164:167], v[104:107]
    ds_read_b64_tr_b16 v[224:225], v32 offset:8192
    v_mfma_f32_16x16x32_bf16 v[108:111], v[156:159], v[140:143], v[108:111]
    ds_read_b64_tr_b16 v[226:227], v32 offset:12288
    ds_read_b64_tr_b16 v[204:205], v35 offset:0
    v_mfma_f32_16x16x32_bf16 v[108:111], v[180:183], v[164:167], v[108:111]
    ds_read_b64_tr_b16 v[206:207], v35 offset:4096
    buffer_load_dwordx4 v1, s[44:47], s53 offen offset:1024 sc1 lds
    v_mfma_f32_16x16x32_bf16 v[112:115], v[152:155], v[144:147], v[112:115]
    ds_read_b64_tr_b16 v[228:229], v35 offset:8192
    v_mfma_f32_16x16x32_bf16 v[112:115], v[176:179], v[168:171], v[112:115]
    ds_read_b64_tr_b16 v[230:231], v35 offset:12288
    ds_read_b128 v[184:187], v26 offset:0
    v_mfma_f32_16x16x32_bf16 v[116:119], v[156:159], v[144:147], v[116:119]
    ds_read_b128 v[208:211], v26 offset:1024
    s_add_u32 m0, s51, 147456
    s_add_u32 s53, s60, 589824
    buffer_load_dwordx4 v2, s[28:31], s53 offen lds
    v_mfma_f32_16x16x32_bf16 v[116:119], v[180:183], v[168:171], v[116:119]
    ds_read_b128 v[188:191], v26 offset:2048
    v_mfma_f32_16x16x32_bf16 v[120:123], v[152:155], v[148:151], v[120:123]
    ds_read_b128 v[212:215], v26 offset:3072
    ds_read_b128 v[192:195], v26 offset:4096
    v_mfma_f32_16x16x32_bf16 v[120:123], v[176:179], v[172:175], v[120:123]
    ds_read_b128 v[216:219], v26 offset:5120
    s_add_u32 m0, s51, 155648
    s_add_u32 s53, s60, 622592
    buffer_load_dwordx4 v2, s[28:31], s53 offen lds
    v_mfma_f32_16x16x32_bf16 v[124:127], v[156:159], v[148:151], v[124:127]
    ds_read_b128 v[196:199], v26 offset:6144
    v_mfma_f32_16x16x32_bf16 v[124:127], v[180:183], v[172:175], v[124:127]
    ds_read_b128 v[220:223], v26 offset:7168
    s_waitcnt lgkmcnt(6)
    v_mfma_f32_16x16x32_bf16 v[96:99], v[200:203], v[184:187], v[96:99]
    v_mfma_f32_16x16x32_bf16 v[96:99], v[224:227], v[208:211], v[96:99]
    v_mfma_f32_16x16x32_bf16 v[100:103], v[204:207], v[184:187], v[100:103]
    v_mfma_f32_16x16x32_bf16 v[100:103], v[228:231], v[208:211], v[100:103]
    s_waitcnt lgkmcnt(0)
    s_waitcnt vmcnt(12)
    s_barrier
    ds_read_b64_tr_b16 v[152:153], v32 offset:32768
    v_mfma_f32_16x16x32_bf16 v[104:107], v[200:203], v[188:191], v[104:107]
    ds_read_b64_tr_b16 v[154:155], v32 offset:36864
    s_add_u32 m0, s56, 0
    s_add_u32 s53, s58, 20480
    buffer_load_dwordx4 v1, s[44:47], s53 offen sc1 lds
    v_mfma_f32_16x16x32_bf16 v[104:107], v[224:227], v[212:215], v[104:107]
    ds_read_b64_tr_b16 v[176:177], v32 offset:40960
    v_mfma_f32_16x16x32_bf16 v[108:111], v[204:207], v[188:191], v[108:111]
    ds_read_b64_tr_b16 v[178:179], v32 offset:45056
    ds_read_b64_tr_b16 v[156:157], v35 offset:32768
    v_mfma_f32_16x16x32_bf16 v[108:111], v[228:231], v[212:215], v[108:111]
    ds_read_b64_tr_b16 v[158:159], v35 offset:36864
    buffer_load_dwordx4 v1, s[44:47], s53 offen offset:1024 sc1 lds
    v_mfma_f32_16x16x32_bf16 v[112:115], v[200:203], v[192:195], v[112:115]
    ds_read_b64_tr_b16 v[180:181], v35 offset:40960
    v_mfma_f32_16x16x32_bf16 v[112:115], v[224:227], v[216:219], v[112:115]
    ds_read_b64_tr_b16 v[182:183], v35 offset:45056
    ds_read_b128 v[136:139], v26 offset:32768
    v_mfma_f32_16x16x32_bf16 v[116:119], v[204:207], v[192:195], v[116:119]
    ds_read_b128 v[160:163], v26 offset:33792
    s_add_u32 m0, s51, 16384
    s_add_u32 s53, s60, 655360
    buffer_load_dwordx4 v2, s[28:31], s53 offen lds
    v_mfma_f32_16x16x32_bf16 v[116:119], v[228:231], v[216:219], v[116:119]
    ds_read_b128 v[140:143], v26 offset:34816
    v_mfma_f32_16x16x32_bf16 v[120:123], v[200:203], v[196:199], v[120:123]
    ds_read_b128 v[164:167], v26 offset:35840
    ds_read_b128 v[144:147], v26 offset:36864
    v_mfma_f32_16x16x32_bf16 v[120:123], v[224:227], v[220:223], v[120:123]
    ds_read_b128 v[168:171], v26 offset:37888
    s_add_u32 m0, s51, 24576
    s_add_u32 s53, s60, 688128
    buffer_load_dwordx4 v2, s[28:31], s53 offen lds
    v_mfma_f32_16x16x32_bf16 v[124:127], v[204:207], v[196:199], v[124:127]
    ds_read_b128 v[148:151], v26 offset:38912
    v_mfma_f32_16x16x32_bf16 v[124:127], v[228:231], v[220:223], v[124:127]
    ds_read_b128 v[172:175], v26 offset:39936
    s_waitcnt lgkmcnt(6)
    v_mfma_f32_16x16x32_bf16 v[96:99], v[152:155], v[136:139], v[96:99]
    v_mfma_f32_16x16x32_bf16 v[96:99], v[176:179], v[160:163], v[96:99]
    v_mfma_f32_16x16x32_bf16 v[100:103], v[156:159], v[136:139], v[100:103]
    v_mfma_f32_16x16x32_bf16 v[100:103], v[180:183], v[160:163], v[100:103]
    s_waitcnt lgkmcnt(0)
    s_waitcnt vmcnt(12)
    s_barrier
    ds_read_b64_tr_b16 v[200:201], v33 offset:0
    v_mfma_f32_16x16x32_bf16 v[104:107], v[152:155], v[140:143], v[104:107]
    ds_read_b64_tr_b16 v[202:203], v33 offset:4096
    s_add_u32 m0, s56, 32768
    s_add_u32 s53, s58, 22528
    buffer_load_dwordx4 v1, s[44:47], s53 offen sc1 lds
    v_mfma_f32_16x16x32_bf16 v[104:107], v[176:179], v[164:167], v[104:107]
    ds_read_b64_tr_b16 v[224:225], v33 offset:8192
    v_mfma_f32_16x16x32_bf16 v[108:111], v[156:159], v[140:143], v[108:111]
    ds_read_b64_tr_b16 v[226:227], v33 offset:12288
    ds_read_b64_tr_b16 v[204:205], v36 offset:0
    v_mfma_f32_16x16x32_bf16 v[108:111], v[180:183], v[164:167], v[108:111]
    ds_read_b64_tr_b16 v[206:207], v36 offset:4096
    buffer_load_dwordx4 v1, s[44:47], s53 offen offset:1024 sc1 lds
    v_mfma_f32_16x16x32_bf16 v[112:115], v[152:155], v[144:147], v[112:115]
    ds_read_b64_tr_b16 v[228:229], v36 offset:8192
    v_mfma_f32_16x16x32_bf16 v[112:115], v[176:179], v[168:171], v[112:115]
    ds_read_b64_tr_b16 v[230:231], v36 offset:12288
    ds_read_b128 v[184:187], v27 offset:0
    v_mfma_f32_16x16x32_bf16 v[116:119], v[156:159], v[144:147], v[116:119]
    ds_read_b128 v[208:211], v27 offset:1024
    s_add_u32 m0, s51, 49152
    s_add_u32 s53, s60, 720896
    buffer_load_dwordx4 v2, s[28:31], s53 offen lds
    v_mfma_f32_16x16x32_bf16 v[116:119], v[180:183], v[168:171], v[116:119]
    ds_read_b128 v[188:191], v27 offset:2048
    v_mfma_f32_16x16x32_bf16 v[120:123], v[152:155], v[148:151], v[120:123]
    ds_read_b128 v[212:215], v27 offset:3072
    ds_read_b128 v[192:195], v27 offset:4096
    v_mfma_f32_16x16x32_bf16 v[120:123], v[176:179], v[172:175], v[120:123]
    ds_read_b128 v[216:219], v27 offset:5120
    s_add_u32 m0, s51, 57344
    s_add_u32 s53, s60, 753664
    buffer_load_dwordx4 v2, s[28:31], s53 offen lds
    v_mfma_f32_16x16x32_bf16 v[124:127], v[156:159], v[148:151], v[124:127]
    ds_read_b128 v[196:199], v27 offset:6144
    v_mfma_f32_16x16x32_bf16 v[124:127], v[180:183], v[172:175], v[124:127]
    ds_read_b128 v[220:223], v27 offset:7168
    s_waitcnt lgkmcnt(6)
    v_mfma_f32_16x16x32_bf16 v[96:99], v[200:203], v[184:187], v[96:99]
    v_mfma_f32_16x16x32_bf16 v[96:99], v[224:227], v[208:211], v[96:99]
    v_mfma_f32_16x16x32_bf16 v[100:103], v[204:207], v[184:187], v[100:103]
    v_mfma_f32_16x16x32_bf16 v[100:103], v[228:231], v[208:211], v[100:103]
    s_waitcnt lgkmcnt(0)
    s_waitcnt vmcnt(12)
    s_barrier
    ds_read_b64_tr_b16 v[152:153], v33 offset:32768
    v_mfma_f32_16x16x32_bf16 v[104:107], v[200:203], v[188:191], v[104:107]
    ds_read_b64_tr_b16 v[154:155], v33 offset:36864
    s_add_u32 m0, s56, 65536
    s_add_u32 s53, s58, 24576
    buffer_load_dwordx4 v1, s[44:47], s53 offen sc1 lds
    v_mfma_f32_16x16x32_bf16 v[104:107], v[224:227], v[212:215], v[104:107]
    ds_read_b64_tr_b16 v[176:177], v33 offset:40960
    v_mfma_f32_16x16x32_bf16 v[108:111], v[204:207], v[188:191], v[108:111]
    ds_read_b64_tr_b16 v[178:179], v33 offset:45056
    ds_read_b64_tr_b16 v[156:157], v36 offset:32768
    v_mfma_f32_16x16x32_bf16 v[108:111], v[228:231], v[212:215], v[108:111]
    ds_read_b64_tr_b16 v[158:159], v36 offset:36864
    buffer_load_dwordx4 v1, s[44:47], s53 offen offset:1024 sc1 lds
    v_mfma_f32_16x16x32_bf16 v[112:115], v[200:203], v[192:195], v[112:115]
    ds_read_b64_tr_b16 v[180:181], v36 offset:40960
    v_mfma_f32_16x16x32_bf16 v[112:115], v[224:227], v[216:219], v[112:115]
    ds_read_b64_tr_b16 v[182:183], v36 offset:45056
    ds_read_b128 v[136:139], v27 offset:32768
    v_mfma_f32_16x16x32_bf16 v[116:119], v[204:207], v[192:195], v[116:119]
    ds_read_b128 v[160:163], v27 offset:33792
    s_add_u32 m0, s51, 81920
    s_add_u32 s53, s60, 786432
    buffer_load_dwordx4 v2, s[28:31], s53 offen lds
    v_mfma_f32_16x16x32_bf16 v[116:119], v[228:231], v[216:219], v[116:119]
    ds_read_b128 v[140:143], v27 offset:34816
    v_mfma_f32_16x16x32_bf16 v[120:123], v[200:203], v[196:199], v[120:123]
    ds_read_b128 v[164:167], v27 offset:35840
    ds_read_b128 v[144:147], v27 offset:36864
    v_mfma_f32_16x16x32_bf16 v[120:123], v[224:227], v[220:223], v[120:123]
    ds_read_b128 v[168:171], v27 offset:37888
    s_add_u32 m0, s51, 90112
    s_add_u32 s53, s60, 819200
    buffer_load_dwordx4 v2, s[28:31], s53 offen lds
    v_mfma_f32_16x16x32_bf16 v[124:127], v[204:207], v[196:199], v[124:127]
    ds_read_b128 v[148:151], v27 offset:38912
    v_mfma_f32_16x16x32_bf16 v[124:127], v[228:231], v[220:223], v[124:127]
    ds_read_b128 v[172:175], v27 offset:39936
    s_waitcnt lgkmcnt(6)
    v_mfma_f32_16x16x32_bf16 v[96:99], v[152:155], v[136:139], v[96:99]
    v_mfma_f32_16x16x32_bf16 v[96:99], v[176:179], v[160:163], v[96:99]
    v_mfma_f32_16x16x32_bf16 v[100:103], v[156:159], v[136:139], v[100:103]
    v_mfma_f32_16x16x32_bf16 v[100:103], v[180:183], v[160:163], v[100:103]
    s_waitcnt lgkmcnt(0)
    s_waitcnt vmcnt(12)
    s_barrier
    ds_read_b64_tr_b16 v[200:201], v34 offset:0
    v_mfma_f32_16x16x32_bf16 v[104:107], v[152:155], v[140:143], v[104:107]
    ds_read_b64_tr_b16 v[202:203], v34 offset:4096
    s_cmp_lg_u32 s48, 0
    s_cbranch_scc1 m_p5_pb
    buffer_load_dwordx2 v[252:253], v4, s[44:47], s14 offen sc1
m_p5_pb:
    v_mfma_f32_16x16x32_bf16 v[104:107], v[176:179], v[164:167], v[104:107]
    ds_read_b64_tr_b16 v[224:225], v34 offset:8192
    v_mfma_f32_16x16x32_bf16 v[108:111], v[156:159], v[140:143], v[108:111]
    ds_read_b64_tr_b16 v[226:227], v34 offset:12288
    ds_read_b64_tr_b16 v[204:205], v37 offset:0
    s_add_u32 m0, s56, 98304
    s_add_u32 s53, s58, 26624
    buffer_load_dwordx4 v1, s[44:47], s53 offen sc1 lds
    v_mfma_f32_16x16x32_bf16 v[108:111], v[180:183], v[164:167], v[108:111]
    ds_read_b64_tr_b16 v[206:207], v37 offset:4096
    v_mfma_f32_16x16x32_bf16 v[112:115], v[152:155], v[144:147], v[112:115]
    ds_read_b64_tr_b16 v[228:229], v37 offset:8192
    buffer_load_dwordx4 v1, s[44:47], s53 offen offset:1024 sc1 lds
    v_mfma_f32_16x16x32_bf16 v[112:115], v[176:179], v[168:171], v[112:115]
    ds_read_b64_tr_b16 v[230:231], v37 offset:12288
    ds_read_b128 v[184:187], v28 offset:0
    v_mfma_f32_16x16x32_bf16 v[116:119], v[156:159], v[144:147], v[116:119]
    ds_read_b128 v[208:211], v28 offset:1024
    v_mfma_f32_16x16x32_bf16 v[116:119], v[180:183], v[168:171], v[116:119]
    ds_read_b128 v[188:191], v28 offset:2048
    s_add_u32 m0, s51, 114688
    s_add_u32 s53, s60, 851968
    buffer_load_dwordx4 v2, s[28:31], s53 offen lds
    v_mfma_f32_16x16x32_bf16 v[120:123], v[152:155], v[148:151], v[120:123]
    ds_read_b128 v[212:215], v28 offset:3072
    ds_read_b128 v[192:195], v28 offset:4096
    v_mfma_f32_16x16x32_bf16 v[120:123], v[176:179], v[172:175], v[120:123]
    ds_read_b128 v[216:219], v28 offset:5120
    s_add_u32 m0, s51, 122880
    s_add_u32 s53, s60, 884736
    buffer_load_dwordx4 v2, s[28:31], s53 offen lds
    v_mfma_f32_16x16x32_bf16 v[124:127], v[156:159], v[148:151], v[124:127]
    ds_read_b128 v[196:199], v28 offset:6144
    v_mfma_f32_16x16x32_bf16 v[124:127], v[180:183], v[172:175], v[124:127]
    ds_read_b128 v[220:223], v28 offset:7168
    s_waitcnt lgkmcnt(6)
    v_mfma_f32_16x16x32_bf16 v[96:99], v[200:203], v[184:187], v[96:99]
    v_mfma_f32_16x16x32_bf16 v[96:99], v[224:227], v[208:211], v[96:99]
    v_mfma_f32_16x16x32_bf16 v[100:103], v[204:207], v[184:187], v[100:103]
    v_mfma_f32_16x16x32_bf16 v[100:103], v[228:231], v[208:211], v[100:103]
    s_waitcnt lgkmcnt(0)
    s_waitcnt vmcnt(12)
    s_barrier
    ds_read_b64_tr_b16 v[152:153], v32 offset:0
    v_mfma_f32_16x16x32_bf16 v[104:107], v[200:203], v[188:191], v[104:107]
    ds_read_b64_tr_b16 v[154:155], v32 offset:4096
    s_add_u32 m0, s56, 131072
    s_add_u32 s53, s58, 28672
    buffer_load_dwordx4 v1, s[44:47], s53 offen sc1 lds
    v_mfma_f32_16x16x32_bf16 v[104:107], v[224:227], v[212:215], v[104:107]
    ds_read_b64_tr_b16 v[176:177], v32 offset:8192
    v_mfma_f32_16x16x32_bf16 v[108:111], v[204:207], v[188:191], v[108:111]
    ds_read_b64_tr_b16 v[178:179], v32 offset:12288
    ds_read_b64_tr_b16 v[156:157], v35 offset:0
    v_mfma_f32_16x16x32_bf16 v[108:111], v[228:231], v[212:215], v[108:111]
    ds_read_b64_tr_b16 v[158:159], v35 offset:4096
    buffer_load_dwordx4 v1, s[44:47], s53 offen offset:1024 sc1 lds
    v_mfma_f32_16x16x32_bf16 v[112:115], v[200:203], v[192:195], v[112:115]
    ds_read_b64_tr_b16 v[180:181], v35 offset:8192
    v_mfma_f32_16x16x32_bf16 v[112:115], v[224:227], v[216:219], v[112:115]
    ds_read_b64_tr_b16 v[182:183], v35 offset:12288
    ds_read_b128 v[136:139], v26 offset:0
    v_mfma_f32_16x16x32_bf16 v[116:119], v[204:207], v[192:195], v[116:119]
    ds_read_b128 v[160:163], v26 offset:1024
    s_add_u32 m0, s51, 147456
    s_add_u32 s53, s60, 917504
    buffer_load_dwordx4 v2, s[28:31], s53 offen lds
    v_mfma_f32_16x16x32_bf16 v[116:119], v[228:231], v[216:219], v[116:119]
    ds_read_b128 v[140:143], v26 offset:2048
    v_mfma_f32_16x16x32_bf16 v[120:123], v[200:203], v[196:199], v[120:123]
    ds_read_b128 v[164:167], v26 offset:3072
    ds_read_b128 v[144:147], v26 offset:4096
    v_mfma_f32_16x16x32_bf16 v[120:123], v[224:227], v[220:223], v[120:123]
    ds_read_b128 v[168:171], v26 offset:5120
    s_add_u32 m0, s51, 155648
    s_add_u32 s53, s60, 950272
    buffer_load_dwordx4 v2, s[28:31], s53 offen lds
    v_mfma_f32_16x16x32_bf16 v[124:127], v[204:207], v[196:199], v[124:127]
    ds_read_b128 v[148:151], v26 offset:6144
    v_mfma_f32_16x16x32_bf16 v[124:127], v[228:231], v[220:223], v[124:127]
    ds_read_b128 v[172:175], v26 offset:7168
    s_waitcnt lgkmcnt(6)
    v_mfma_f32_16x16x32_bf16 v[96:99], v[152:155], v[136:139], v[96:99]
    v_mfma_f32_16x16x32_bf16 v[96:99], v[176:179], v[160:163], v[96:99]
    v_mfma_f32_16x16x32_bf16 v[100:103], v[156:159], v[136:139], v[100:103]
    v_mfma_f32_16x16x32_bf16 v[100:103], v[180:183], v[160:163], v[100:103]
    s_waitcnt lgkmcnt(0)
    s_waitcnt vmcnt(12)
    s_cmp_lg_u32 s48, 0
    s_cbranch_scc1 m_p5_cbw
    s_waitcnt vmcnt(8)
    v_cmp_ne_u64 vcc, s[68:69], v[252:253]
    s_mov_b32 s54, 0
    s_nop 0
    s_cbranch_vccz m_p5_cb_ok
m_p5_cb_spin:
    buffer_load_dwordx2 v[252:253], v4, s[44:47], s14 offen sc1
    s_waitcnt vmcnt(0)
    v_cmp_ne_u64 vcc, s[68:69], v[252:253]
    s_add_u32 s54, s54, 1
    s_cmp_ge_u32 s54, 0x200000
    s_cbranch_scc1 m_p5_cb_ok
    s_cbranch_vccnz m_p5_cb_spin
m_p5_cb_ok:
m_p5_cbw:
    s_barrier
    ds_read_b64_tr_b16 v[200:201], v32 offset:32768
    v_mfma_f32_16x16x32_bf16 v[104:107], v[152:155], v[140:143], v[104:107]
    ds_read_b64_tr_b16 v[202:203], v32 offset:36864
    s_add_u32 m0, s56, 0
    s_add_u32 s53, s58, 30720
    buffer_load_dwordx4 v1, s[44:47], s53 offen sc1 lds
    v_mfma_f32_16x16x32_bf16 v[104:107], v[176:179], v[164:167], v[104:107]
    ds_read_b64_tr_b16 v[224:225], v32 offset:40960
    v_mfma_f32_16x16x32_bf16 v[108:111], v[156:159], v[140:143], v[108:111]
    ds_read_b64_tr_b16 v[226:227], v32 offset:45056
    ds_read_b64_tr_b16 v[204:205], v35 offset:32768
    v_mfma_f32_16x16x32_bf16 v[108:111], v[180:183], v[164:167], v[108:111]
    ds_read_b64_tr_b16 v[206:207], v35 offset:36864
    buffer_load_dwordx4 v1, s[44:47], s53 offen offset:1024 sc1 lds
    v_mfma_f32_16x16x32_bf16 v[112:115], v[152:155], v[144:147], v[112:115]
    ds_read_b64_tr_b16 v[228:229], v35 offset:40960
    v_mfma_f32_16x16x32_bf16 v[112:115], v[176:179], v[168:171], v[112:115]
    ds_read_b64_tr_b16 v[230:231], v35 offset:45056
    ds_read_b128 v[184:187], v26 offset:32768
    v_mfma_f32_16x16x32_bf16 v[116:119], v[156:159], v[144:147], v[116:119]
    ds_read_b128 v[208:211], v26 offset:33792
    s_add_u32 m0, s51, 16384
    s_add_u32 s53, s60, 983040
    buffer_load_dwordx4 v2, s[28:31], s53 offen lds
    v_mfma_f32_16x16x32_bf16 v[116:119], v[180:183], v[168:171], v[116:119]
    ds_read_b128 v[188:191], v26 offset:34816
    v_mfma_f32_16x16x32_bf16 v[120:123], v[152:155], v[148:151], v[120:123]
    ds_read_b128 v[212:215], v26 offset:35840
    ds_read_b128 v[192:195], v26 offset:36864
    v_mfma_f32_16x16x32_bf16 v[120:123], v[176:179], v[172:175], v[120:123]
    ds_read_b128 v[216:219], v26 offset:37888
    s_add_u32 m0, s51, 24576
    s_add_u32 s53, s60, 1015808
    buffer_load_dwordx4 v2, s[28:31], s53 offen lds
    v_mfma_f32_16x16x32_bf16 v[124:127], v[156:159], v[148:151], v[124:127]
    ds_read_b128 v[196:199], v26 offset:38912
    v_mfma_f32_16x16x32_bf16 v[124:127], v[180:183], v[172:175], v[124:127]
    ds_read_b128 v[220:223], v26 offset:39936
    s_waitcnt lgkmcnt(6)
    v_mfma_f32_16x16x32_bf16 v[96:99], v[200:203], v[184:187], v[96:99]
    v_mfma_f32_16x16x32_bf16 v[96:99], v[224:227], v[208:211], v[96:99]
    v_mfma_f32_16x16x32_bf16 v[100:103], v[204:207], v[184:187], v[100:103]
    v_mfma_f32_16x16x32_bf16 v[100:103], v[228:231], v[208:211], v[100:103]
    s_waitcnt lgkmcnt(0)
    s_waitcnt vmcnt(12)
    s_barrier
    ds_read_b64_tr_b16 v[152:153], v33 offset:0
    v_mfma_f32_16x16x32_bf16 v[104:107], v[200:203], v[188:191], v[104:107]
    ds_read_b64_tr_b16 v[154:155], v33 offset:4096
    s_add_u32 m0, s56, 32768
    s_add_u32 s53, s59, 0
    buffer_load_dwordx4 v1, s[44:47], s53 offen sc1 lds
    v_mfma_f32_16x16x32_bf16 v[104:107], v[224:227], v[212:215], v[104:107]
    ds_read_b64_tr_b16 v[176:177], v33 offset:8192
    v_mfma_f32_16x16x32_bf16 v[108:111], v[204:207], v[188:191], v[108:111]
    ds_read_b64_tr_b16 v[178:179], v33 offset:12288
    ds_read_b64_tr_b16 v[156:157], v36 offset:0
    v_mfma_f32_16x16x32_bf16 v[108:111], v[228:231], v[212:215], v[108:111]
    ds_read_b64_tr_b16 v[158:159], v36 offset:4096
    buffer_load_dwordx4 v1, s[44:47], s53 offen offset:1024 sc1 lds
    v_mfma_f32_16x16x32_bf16 v[112:115], v[200:203], v[192:195], v[112:115]
    ds_read_b64_tr_b16 v[180:181], v36 offset:8192
    v_mfma_f32_16x16x32_bf16 v[112:115], v[224:227], v[216:219], v[112:115]
    ds_read_b64_tr_b16 v[182:183], v36 offset:12288
    ds_read_b128 v[136:139], v27 offset:0
    v_mfma_f32_16x16x32_bf16 v[116:119], v[204:207], v[192:195], v[116:119]
    ds_read_b128 v[160:163], v27 offset:1024
    s_add_u32 m0, s56, 49152
    s_add_u32 s53, s61, 0
    buffer_load_dwordx4 v3, s[32:35], s53 offen lds
    v_mfma_f32_16x16x32_bf16 v[116:119], v[228:231], v[216:219], v[116:119]
    ds_read_b128 v[140:143], v27 offset:2048
    v_mfma_f32_16x16x32_bf16 v[120:123], v[200:203], v[196:199], v[120:123]
    ds_read_b128 v[164:167], v27 offset:3072
    ds_read_b128 v[144:147], v27 offset:4096
    v_mfma_f32_16x16x32_bf16 v[120:123], v[224:227], v[220:223], v[120:123]
    ds_read_b128 v[168:171], v27 offset:5120
    buffer_load_dwordx4 v54, s[32:35], s53 offen offset:1024 lds
    v_mfma_f32_16x16x32_bf16 v[124:127], v[204:207], v[196:199], v[124:127]
    ds_read_b128 v[148:151], v27 offset:6144
    v_mfma_f32_16x16x32_bf16 v[124:127], v[228:231], v[220:223], v[124:127]
    ds_read_b128 v[172:175], v27 offset:7168
    s_waitcnt lgkmcnt(6)
    v_mfma_f32_16x16x32_bf16 v[96:99], v[152:155], v[136:139], v[96:99]
    v_mfma_f32_16x16x32_bf16 v[96:99], v[176:179], v[160:163], v[96:99]
    v_mfma_f32_16x16x32_bf16 v[100:103], v[156:159], v[136:139], v[100:103]
    v_mfma_f32_16x16x32_bf16 v[100:103], v[180:183], v[160:163], v[100:103]
    s_waitcnt lgkmcnt(0)
    s_waitcnt vmcnt(12)
    s_barrier
    ds_read_b64_tr_b16 v[200:201], v33 offset:32768
    v_mfma_f32_16x16x32_bf16 v[104:107], v[152:155], v[140:143], v[104:107]
    ds_read_b64_tr_b16 v[202:203], v33 offset:36864
    s_add_u32 m0, s56, 65536
    s_add_u32 s53, s59, 4096
    buffer_load_dwordx4 v1, s[44:47], s53 offen sc1 lds
    v_mfma_f32_16x16x32_bf16 v[104:107], v[176:179], v[164:167], v[104:107]
    ds_read_b64_tr_b16 v[224:225], v33 offset:40960
    v_mfma_f32_16x16x32_bf16 v[108:111], v[156:159], v[140:143], v[108:111]
    ds_read_b64_tr_b16 v[226:227], v33 offset:45056
    ds_read_b64_tr_b16 v[204:205], v36 offset:32768
    v_mfma_f32_16x16x32_bf16 v[108:111], v[180:183], v[164:167], v[108:111]
    ds_read_b64_tr_b16 v[206:207], v36 offset:36864
    buffer_load_dwordx4 v1, s[44:47], s53 offen offset:1024 sc1 lds
    v_mfma_f32_16x16x32_bf16 v[112:115], v[152:155], v[144:147], v[112:115]
    ds_read_b64_tr_b16 v[228:229], v36 offset:40960
    v_mfma_f32_16x16x32_bf16 v[112:115], v[176:179], v[168:171], v[112:115]
    ds_read_b64_tr_b16 v[230:231], v36 offset:45056
    ds_read_b128 v[184:187], v27 offset:32768
    v_mfma_f32_16x16x32_bf16 v[116:119], v[156:159], v[144:147], v[116:119]
    ds_read_b128 v[208:211], v27 offset:33792
    s_add_u32 m0, s56, 81920
    s_add_u32 s53, s61, 131072
    buffer_load_dwordx4 v3, s[32:35], s53 offen lds
    v_mfma_f32_16x16x32_bf16 v[116:119], v[180:183], v[168:171], v[116:119]
    ds_read_b128 v[188:191], v27 offset:34816
    v_mfma_f32_16x16x32_bf16 v[120:123], v[152:155], v[148:151], v[120:123]
    ds_read_b128 v[212:215], v27 offset:35840
    ds_read_b128 v[192:195], v27 offset:36864
    v_mfma_f32_16x16x32_bf16 v[120:123], v[176:179], v[172:175], v[120:123]
    ds_read_b128 v[216:219], v27 offset:37888
    buffer_load_dwordx4 v54, s[32:35], s53 offen offset:1024 lds
    v_mfma_f32_16x16x32_bf16 v[124:127], v[156:159], v[148:151], v[124:127]
    ds_read_b128 v[196:199], v27 offset:38912
    v_mfma_f32_16x16x32_bf16 v[124:127], v[180:183], v[172:175], v[124:127]
    ds_read_b128 v[220:223], v27 offset:39936
    s_waitcnt lgkmcnt(6)
    v_mfma_f32_16x16x32_bf16 v[96:99], v[200:203], v[184:187], v[96:99]
    v_mfma_f32_16x16x32_bf16 v[96:99], v[224:227], v[208:211], v[96:99]
    v_mfma_f32_16x16x32_bf16 v[100:103], v[204:207], v[184:187], v[100:103]
    v_mfma_f32_16x16x32_bf16 v[100:103], v[228:231], v[208:211], v[100:103]
    s_waitcnt lgkmcnt(0)
    s_waitcnt vmcnt(12)
    s_barrier
    ds_read_b64_tr_b16 v[152:153], v34 offset:0
    v_mfma_f32_16x16x32_bf16 v[104:107], v[200:203], v[188:191], v[104:107]
    ds_read_b64_tr_b16 v[154:155], v34 offset:4096
    s_add_u32 m0, s56, 98304
    s_add_u32 s53, s59, 8192
    buffer_load_dwordx4 v1, s[44:47], s53 offen sc1 lds
    v_mfma_f32_16x16x32_bf16 v[104:107], v[224:227], v[212:215], v[104:107]
    ds_read_b64_tr_b16 v[176:177], v34 offset:8192
    v_mfma_f32_16x16x32_bf16 v[108:111], v[204:207], v[188:191], v[108:111]
    ds_read_b64_tr_b16 v[178:179], v34 offset:12288
    ds_read_b64_tr_b16 v[156:157], v37 offset:0
    v_mfma_f32_16x16x32_bf16 v[108:111], v[228:231], v[212:215], v[108:111]
    ds_read_b64_tr_b16 v[158:159], v37 offset:4096
    buffer_load_dwordx4 v1, s[44:47], s53 offen offset:1024 sc1 lds
    v_mfma_f32_16x16x32_bf16 v[112:115], v[200:203], v[192:195], v[112:115]
    ds_read_b64_tr_b16 v[180:181], v37 offset:8192
    v_mfma_f32_16x16x32_bf16 v[112:115], v[224:227], v[216:219], v[112:115]
    ds_read_b64_tr_b16 v[182:183], v37 offset:12288
    ds_read_b128 v[136:139], v28 offset:0
    v_mfma_f32_16x16x32_bf16 v[116:119], v[204:207], v[192:195], v[116:119]
    ds_read_b128 v[160:163], v28 offset:1024
    s_add_u32 m0, s56, 114688
    s_add_u32 s53, s61, 262144
    buffer_load_dwordx4 v3, s[32:35], s53 offen lds
    v_mfma_f32_16x16x32_bf16 v[116:119], v[228:231], v[216:219], v[116:119]
    ds_read_b128 v[140:143], v28 offset:2048
    v_mfma_f32_16x16x32_bf16 v[120:123], v[200:203], v[196:199], v[120:123]
    ds_read_b128 v[164:167], v28 offset:3072
    ds_read_b128 v[144:147], v28 offset:4096
    v_mfma_f32_16x16x32_bf16 v[120:123], v[224:227], v[220:223], v[120:123]
    ds_read_b128 v[168:171], v28 offset:5120
    buffer_load_dwordx4 v54, s[32:35], s53 offen offset:1024 lds
    v_mfma_f32_16x16x32_bf16 v[124:127], v[204:207], v[196:199], v[124:127]
    ds_read_b128 v[148:151], v28 offset:6144
    v_mfma_f32_16x16x32_bf16 v[124:127], v[228:231], v[220:223], v[124:127]
    ds_read_b128 v[172:175], v28 offset:7168
    s_waitcnt lgkmcnt(6)
    v_mfma_f32_16x16x32_bf16 v[96:99], v[152:155], v[136:139], v[96:99]
    v_mfma_f32_16x16x32_bf16 v[96:99], v[176:179], v[160:163], v[96:99]
    v_mfma_f32_16x16x32_bf16 v[100:103], v[156:159], v[136:139], v[100:103]
    v_mfma_f32_16x16x32_bf16 v[100:103], v[180:183], v[160:163], v[100:103]
    s_waitcnt lgkmcnt(0)
    s_waitcnt vmcnt(12)
    s_barrier
    ds_read_b64_tr_b16 v[200:201], v32 offset:0
    v_mfma_f32_16x16x32_bf16 v[104:107], v[152:155], v[140:143], v[104:107]
    ds_read_b64_tr_b16 v[202:203], v32 offset:4096
    s_add_u32 m0, s56, 131072
    s_add_u32 s53, s59, 12288
    buffer_load_dwordx4 v1, s[44:47], s53 offen sc1 lds
    v_mfma_f32_16x16x32_bf16 v[104:107], v[176:179], v[164:167], v[104:107]
    ds_read_b64_tr_b16 v[224:225], v32 offset:8192
    v_mfma_f32_16x16x32_bf16 v[108:111], v[156:159], v[140:143], v[108:111]
    ds_read_b64_tr_b16 v[226:227], v32 offset:12288
    ds_read_b64_tr_b16 v[204:205], v35 offset:0
    v_mfma_f32_16x16x32_bf16 v[108:111], v[180:183], v[164:167], v[108:111]
    ds_read_b64_tr_b16 v[206:207], v35 offset:4096
    buffer_load_dwordx4 v1, s[44:47], s53 offen offset:1024 sc1 lds
    v_mfma_f32_16x16x32_bf16 v[112:115], v[152:155], v[144:147], v[112:115]
    ds_read_b64_tr_b16 v[228:229], v35 offset:8192
    v_mfma_f32_16x16x32_bf16 v[112:115], v[176:179], v[168:171], v[112:115]
    ds_read_b64_tr_b16 v[230:231], v35 offset:12288
    ds_read_b128 v[184:187], v26 offset:0
    v_mfma_f32_16x16x32_bf16 v[116:119], v[156:159], v[144:147], v[116:119]
    ds_read_b128 v[208:211], v26 offset:1024
    s_add_u32 m0, s56, 147456
    s_add_u32 s53, s61, 393216
    buffer_load_dwordx4 v3, s[32:35], s53 offen lds
    v_mfma_f32_16x16x32_bf16 v[116:119], v[180:183], v[168:171], v[116:119]
    ds_read_b128 v[188:191], v26 offset:2048
    v_mfma_f32_16x16x32_bf16 v[120:123], v[152:155], v[148:151], v[120:123]
    ds_read_b128 v[212:215], v26 offset:3072
    ds_read_b128 v[192:195], v26 offset:4096
    v_mfma_f32_16x16x32_bf16 v[120:123], v[176:179], v[172:175], v[120:123]
    ds_read_b128 v[216:219], v26 offset:5120
    buffer_load_dwordx4 v54, s[32:35], s53 offen offset:1024 lds
    v_mfma_f32_16x16x32_bf16 v[124:127], v[156:159], v[148:151], v[124:127]
    ds_read_b128 v[196:199], v26 offset:6144
    v_mfma_f32_16x16x32_bf16 v[124:127], v[180:183], v[172:175], v[124:127]
    ds_read_b128 v[220:223], v26 offset:7168
    s_waitcnt lgkmcnt(6)
    v_mfma_f32_16x16x32_bf16 v[96:99], v[200:203], v[184:187], v[96:99]
    v_mfma_f32_16x16x32_bf16 v[96:99], v[224:227], v[208:211], v[96:99]
    v_mfma_f32_16x16x32_bf16 v[100:103], v[204:207], v[184:187], v[100:103]
    v_mfma_f32_16x16x32_bf16 v[100:103], v[228:231], v[208:211], v[100:103]
    s_waitcnt lgkmcnt(0)
    s_waitcnt vmcnt(12)
    s_barrier
    ds_read_b128 v[136:139], v26 offset:32768
    v_mfma_f32_16x16x32_bf16 v[104:107], v[200:203], v[188:191], v[104:107]
    ds_read_b128 v[140:143], v26 offset:36864
    v_mfma_f32_16x16x32_bf16 v[104:107], v[224:227], v[212:215], v[104:107]
    ds_read_b64_tr_b16 v[144:145], v38 offset:32768
    v_mfma_f32_16x16x32_bf16 v[108:111], v[204:207], v[188:191], v[108:111]
    ds_read_b64_tr_b16 v[146:147], v38 offset:34816
    ds_read_b128 v[148:151], v26 offset:33792
    v_mfma_f32_16x16x32_bf16 v[108:111], v[228:231], v[212:215], v[108:111]
    ds_read_b128 v[152:155], v26 offset:37888
    v_mfma_f32_16x16x32_bf16 v[112:115], v[200:203], v[192:195], v[112:115]
    ds_read_b64_tr_b16 v[156:157], v38 offset:36864
    v_mfma_f32_16x16x32_bf16 v[112:115], v[224:227], v[216:219], v[112:115]
    ds_read_b64_tr_b16 v[158:159], v38 offset:38912
    ds_read_b128 v[160:163], v26 offset:34816
    v_mfma_f32_16x16x32_bf16 v[116:119], v[204:207], v[192:195], v[116:119]
    ds_read_b128 v[164:167], v26 offset:38912
    v_mfma_f32_16x16x32_bf16 v[116:119], v[228:231], v[216:219], v[116:119]
    ds_read_b64_tr_b16 v[168:169], v38 offset:40960
    v_mfma_f32_16x16x32_bf16 v[120:123], v[200:203], v[196:199], v[120:123]
    ds_read_b64_tr_b16 v[170:171], v38 offset:43008
    ds_read_b128 v[172:175], v26 offset:35840
    v_mfma_f32_16x16x32_bf16 v[120:123], v[224:227], v[220:223], v[120:123]
    ds_read_b128 v[176:179], v26 offset:39936
    v_mfma_f32_16x16x32_bf16 v[124:127], v[204:207], v[196:199], v[124:127]
    ds_read_b64_tr_b16 v[180:181], v38 offset:45056
    v_mfma_f32_16x16x32_bf16 v[124:127], v[228:231], v[220:223], v[124:127]
    ds_read_b64_tr_b16 v[182:183], v38 offset:47104
    s_lshl_b32 s58, s49, 15
    s_add_u32 s58, s58, s66
    s_lshl_b32 s63, s48, 12
    s_add_u32 s58, s58, s63
    s_lshr_b32 s63, s48, 1
    s_cmp_eq_u32 s63, s49
    s_cselect_b32 s58, 0x7ff00000, s58
    s_cbranch_scc0 m_p5_nokeep
    s_and_b32 s63, s48, 1
    s_lshl_b32 s63, s63, 13
    s_add_u32 s63, s63, 0
    v_add_u32 v7, s63, v1
    s_nop 0
    ds_write_b128 v7, v[96:99] offset:0
    ds_write_b128 v7, v[100:103] offset:1024
    ds_write_b128 v7, v[104:107] offset:2048
    ds_write_b128 v7, v[108:111] offset:3072
    ds_write_b128 v7, v[112:115] offset:4096
    ds_write_b128 v7, v[116:119] offset:5120
    ds_write_b128 v7, v[120:123] offset:6144
    ds_write_b128 v7, v[124:127] offset:7168
m_p5_nokeep:
    s_waitcnt lgkmcnt(0)
    v_mfma_f32_16x16x32_bf16 v[128:131], v[144:147], v[136:139], 0
    v_mfma_f32_16x16x32_bf16 v[128:131], v[156:159], v[148:151], v[128:131]
    s_waitcnt lgkmcnt(0)
    s_waitcnt vmcnt(8)
    s_barrier
    ds_read_b128 v[184:187], v27 offset:0
    ds_read_b128 v[188:191], v27 offset:4096
    v_mfma_f32_16x16x32_bf16 v[128:131], v[168:171], v[160:163], v[128:131]
    ds_read_b64_tr_b16 v[192:193], v39 offset:0
    ds_read_b64_tr_b16 v[194:195], v39 offset:2048
    v_cvt_pk_bf16_f32 v56, v96, v97
    v_cvt_pk_bf16_f32 v57, v98, v99
    v_cvt_pk_bf16_f32 v58, v104, v105
    v_cvt_pk_bf16_f32 v59, v106, v107
    buffer_store_dwordx4 v[56:59], v1, s[44:47], s58 offen offset:0 sc1
    v_mfma_f32_16x16x32_bf16 v[128:131], v[180:183], v[172:175], v[128:131]
    ds_read_b128 v[196:199], v27 offset:1024
    ds_read_b128 v[200:203], v27 offset:5120
    v_cvt_pk_bf16_f32 v60, v100, v101
    v_cvt_pk_bf16_f32 v61, v102, v103
    v_cvt_pk_bf16_f32 v62, v108, v109
    v_cvt_pk_bf16_f32 v63, v110, v111
    buffer_store_dwordx4 v[60:63], v1, s[44:47], s58 offen offset:1024 sc1
    v_mfma_f32_16x16x32_bf16 v[132:135], v[144:147], v[140:143], 0
    ds_read_b64_tr_b16 v[204:205], v39 offset:4096
    ds_read_b64_tr_b16 v[206:207], v39 offset:6144
    v_mfma_f32_16x16x32_bf16 v[132:135], v[156:159], v[152:155], v[132:135]
    ds_read_b128 v[208:211], v27 offset:2048
    ds_read_b128 v[212:215], v27 offset:6144
    v_cvt_pk_bf16_f32 v64, v112, v113
    v_cvt_pk_bf16_f32 v65, v114, v115
    v_cvt_pk_bf16_f32 v66, v120, v121
    v_cvt_pk_bf16_f32 v67, v122, v123
    buffer_store_dwordx4 v[64:67], v1, s[44:47], s58 offen offset:2048 sc1
    v_mfma_f32_16x16x32_bf16 v[132:135], v[168:171], v[164:167], v[132:135]
    ds_read_b64_tr_b16 v[216:217], v39 offset:8192
    ds_read_b64_tr_b16 v[218:219], v39 offset:10240
    v_cvt_pk_bf16_f32 v68, v116, v117
    v_cvt_pk_bf16_f32 v69, v118, v119
    v_cvt_pk_bf16_f32 v70, v124, v125
    v_cvt_pk_bf16_f32 v71, v126, v127
    buffer_store_dwordx4 v[68:71], v1, s[44:47], s58 offen offset:3072 sc1
    v_mfma_f32_16x16x32_bf16 v[132:135], v[180:183], v[176:179], v[132:135]
    ds_read_b128 v[220:223], v27 offset:3072
    ds_read_b128 v[224:227], v27 offset:7168
    ds_read_b64_tr_b16 v[228:229], v39 offset:12288
    ds_read_b64_tr_b16 v[230:231], v39 offset:14336
    s_waitcnt lgkmcnt(0)
    v_mfma_f32_16x16x32_bf16 v[128:131], v[192:195], v[184:187], v[128:131]
    v_mfma_f32_16x16x32_bf16 v[128:131], v[204:207], v[196:199], v[128:131]
    s_waitcnt lgkmcnt(0)
    s_waitcnt vmcnt(8)
    s_barrier
    ds_read_b128 v[136:139], v27 offset:32768
    ds_read_b128 v[140:143], v27 offset:36864
    v_mfma_f32_16x16x32_bf16 v[128:131], v[216:219], v[208:211], v[128:131]
    ds_read_b64_tr_b16 v[144:145], v39 offset:32768
    ds_read_b64_tr_b16 v[146:147], v39 offset:34816
    v_mfma_f32_16x16x32_bf16 v[128:131], v[228:231], v[220:223], v[128:131]
    ds_read_b128 v[148:151], v27 offset:33792
    ds_read_b128 v[152:155], v27 offset:37888
    v_mfma_f32_16x16x32_bf16 v[132:135], v[192:195], v[188:191], v[132:135]
    ds_read_b64_tr_b16 v[156:157], v39 offset:36864
    ds_read_b64_tr_b16 v[158:159], v39 offset:38912
    v_mfma_f32_16x16x32_bf16 v[132:135], v[204:207], v[200:203], v[132:135]
    ds_read_b128 v[160:163], v27 offset:34816
    ds_read_b128 v[164:167], v27 offset:38912
    v_mfma_f32_16x16x32_bf16 v[132:135], v[216:219], v[212:215], v[132:135]
    ds_read_b64_tr_b16 v[168:169], v39 offset:40960
    ds_read_b64_tr_b16 v[170:171], v39 offset:43008
    v_mfma_f32_16x16x32_bf16 v[132:135], v[228:231], v[224:227], v[132:135]
    ds_read_b128 v[172:175], v27 offset:35840
    ds_read_b128 v[176:179], v27 offset:39936
    ds_read_b64_tr_b16 v[180:181], v39 offset:45056
    ds_read_b64_tr_b16 v[182:183], v39 offset:47104
    s_waitcnt lgkmcnt(0)
    v_mfma_f32_16x16x32_bf16 v[128:131], v[144:147], v[136:139], v[128:131]
    v_mfma_f32_16x16x32_bf16 v[128:131], v[156:159], v[148:151], v[128:131]
    s_waitcnt lgkmcnt(0)
    s_waitcnt vmcnt(0)
    s_barrier
    ds_read_b128 v[184:187], v28 offset:0
    ds_read_b128 v[188:191], v28 offset:4096
    v_mfma_f32_16x16x32_bf16 v[128:131], v[168:171], v[160:163], v[128:131]
    ds_read_b64_tr_b16 v[192:193], v40 offset:0
    ds_read_b64_tr_b16 v[194:195], v40 offset:2048
    s_cmp_lg_u32 s48, 0
    s_cbranch_scc1 m_p5_sigp
    s_lshl_b32 s52, s49, 3
    s_add_u32 s52, s52, s67
    s_mov_b64 exec, 1
    buffer_store_dwordx2 v[42:43], off, s[44:47], s52 sc1
    s_mov_b64 exec, -1
m_p5_sigp:
    v_mfma_f32_16x16x32_bf16 v[128:131], v[180:183], v[172:175], v[128:131]
    ds_read_b128 v[196:199], v28 offset:1024
    ds_read_b128 v[200:203], v28 offset:5120
    v_mfma_f32_16x16x32_bf16 v[132:135], v[144:147], v[140:143], v[132:135]
    ds_read_b64_tr_b16 v[204:205], v40 offset:4096
    ds_read_b64_tr_b16 v[206:207], v40 offset:6144
    v_mfma_f32_16x16x32_bf16 v[132:135], v[156:159], v[152:155], v[132:135]
    ds_read_b128 v[208:211], v28 offset:2048
    ds_read_b128 v[212:215], v28 offset:6144
    v_mfma_f32_16x16x32_bf16 v[132:135], v[168:171], v[164:167], v[132:135]
    ds_read_b64_tr_b16 v[216:217], v40 offset:8192
    ds_read_b64_tr_b16 v[218:219], v40 offset:10240
    v_mfma_f32_16x16x32_bf16 v[132:135], v[180:183], v[176:179], v[132:135]
    ds_read_b128 v[220:223], v28 offset:3072
    ds_read_b128 v[224:227], v28 offset:7168
    ds_read_b64_tr_b16 v[228:229], v40 offset:12288
    ds_read_b64_tr_b16 v[230:231], v40 offset:14336
    s_waitcnt lgkmcnt(0)
    v_mfma_f32_16x16x32_bf16 v[128:131], v[192:195], v[184:187], v[128:131]
    v_mfma_f32_16x16x32_bf16 v[128:131], v[204:207], v[196:199], v[128:131]
    s_waitcnt lgkmcnt(0)
    v_mfma_f32_16x16x32_bf16 v[128:131], v[216:219], v[208:211], v[128:131]
    buffer_load_dwordx2 v[52:53], v9, s[44:47], s67 offen sc1
    v_mfma_f32_16x16x32_bf16 v[128:131], v[228:231], v[220:223], v[128:131]
    v_mfma_f32_16x16x32_bf16 v[132:135], v[192:195], v[188:191], v[132:135]
    v_mfma_f32_16x16x32_bf16 v[132:135], v[204:207], v[200:203], v[132:135]
    v_mfma_f32_16x16x32_bf16 v[132:135], v[216:219], v[212:215], v[132:135]
    v_mfma_f32_16x16x32_bf16 v[132:135], v[228:231], v[224:227], v[132:135]
    s_nop 7
    s_lshr_b32 s63, s48, 2
    s_lshl_b32 s63, s63, 16
    s_add_u32 s52, s62, s63
    s_and_b32 s63, s48, 3
    s_lshl_b32 s63, s63, 5
    s_add_u32 s52, s52, s63
    v_cvt_pk_bf16_f32 v44, v128, v129
    v_cvt_pk_bf16_f32 v45, v130, v131
    v_cvt_pk_bf16_f32 v46, v132, v133
    v_cvt_pk_bf16_f32 v47, v134, v135
    s_nop 1
    v_permlane16_swap_b32 v44, v46
    v_permlane16_swap_b32 v45, v47
    buffer_store_dwordx4 v[44:47], v41, s[36:39], s52 offen offset:1024
    s_lshl_b32 s52, s49, 13
    s_add_u32 s66, s66, s52
    s_add_u32 s66, s66, s51
    s_lshr_b32 s52, s48, 2
    s_lshl_b32 s63, s52, 13
    s_lshl_b32 s52, s52, 6
    s_add_u32 s62, s62, s52
    s_bfe_u32 s53, s48, 0x10001
    s_lshl_b32 s52, s53, 12
    s_add_u32 s63, s63, s52
    s_lshl_b32 s53, s53, 16
    s_add_u32 s62, s62, s53
    s_and_b32 s53, s48, 1
    s_lshl_b32 s52, s53, 10
    s_add_u32 s63, s63, s52
    s_lshl_b32 s53, s53, 5
    s_add_u32 s62, s62, s53
    s_add_u32 s63, s63, 0
    v_add_u32 v7, s63, v1
    ds_read_b128 v[72:75], v7 offset:0
    ds_read_b128 v[76:79], v7 offset:2048
    s_waitcnt vmcnt(1)
    v_cmp_ne_u64 vcc, s[68:69], v[52:53]
    s_mov_b32 s54, 0
    s_nop 0
    s_cbranch_vccz m_p5_pp2_ok
m_p5_pp2_spin:
    buffer_load_dwordx2 v[52:53], v9, s[44:47], s67 offen sc1
    s_waitcnt vmcnt(0)
    v_cmp_ne_u64 vcc, s[68:69], v[52:53]
    s_add_u32 s54, s54, 1
    s_cmp_ge_u32 s54, 0x200000
    s_cbranch_scc1 m_p5_pp2_ok
    s_cbranch_vccnz m_p5_pp2_spin
m_p5_pp2_ok:
    s_add_u32 s52, s49, 1
    s_and_b32 s52, s52, 3
    s_lshl_b32 s52, s52, 15
    s_add_u32 s52, s52, s66
    buffer_load_dwordx4 v[84:87], v1, s[44:47], s52 offen sc1
    s_add_u32 s52, s49, 2
    s_and_b32 s52, s52, 3
    s_lshl_b32 s52, s52, 15
    s_add_u32 s52, s52, s66
    buffer_load_dwordx4 v[88:91], v1, s[44:47], s52 offen sc1
    s_add_u32 s52, s49, 3
    s_and_b32 s52, s52, 3
    s_lshl_b32 s52, s52, 15
    s_add_u32 s52, s52, s66
    buffer_load_dwordx4 v[92:95], v1, s[44:47], s52 offen sc1
    s_waitcnt lgkmcnt(0)
    s_waitcnt vmcnt(2)
    v_lshlrev_b32 v80, 16, v84
    v_and_b32 v81, 0xffff0000, v84
    v_add_f32 v72, v72, v80
    v_add_f32 v73, v73, v81
    v_lshlrev_b32 v80, 16, v85
    v_and_b32 v81, 0xffff0000, v85
    v_add_f32 v74, v74, v80
    v_add_f32 v75, v75, v81
    v_lshlrev_b32 v80, 16, v86
    v_and_b32 v81, 0xffff0000, v86
    v_add_f32 v76, v76, v80
    v_add_f32 v77, v77, v81
    v_lshlrev_b32 v80, 16, v87
    v_and_b32 v81, 0xffff0000, v87
    v_add_f32 v78, v78, v80
    v_add_f32 v79, v79, v81
    s_waitcnt vmcnt(1)
    v_lshlrev_b32 v80, 16, v88
    v_and_b32 v81, 0xffff0000, v88
    v_add_f32 v72, v72, v80
    v_add_f32 v73, v73, v81
    v_lshlrev_b32 v80, 16, v89
    v_and_b32 v81, 0xffff0000, v89
    v_add_f32 v74, v74, v80
    v_add_f32 v75, v75, v81
    v_lshlrev_b32 v80, 16, v90
    v_and_b32 v81, 0xffff0000, v90
    v_add_f32 v76, v76, v80
    v_add_f32 v77, v77, v81
    v_lshlrev_b32 v80, 16, v91
    v_and_b32 v81, 0xffff0000, v91
    v_add_f32 v78, v78, v80
    v_add_f32 v79, v79, v81
    s_waitcnt vmcnt(0)
    v_lshlrev_b32 v80, 16, v92
    v_and_b32 v81, 0xffff0000, v92
    v_add_f32 v72, v72, v80
    v_add_f32 v73, v73, v81
    v_lshlrev_b32 v80, 16, v93
    v_and_b32 v81, 0xffff0000, v93
    v_add_f32 v74, v74, v80
    v_add_f32 v75, v75, v81
    v_lshlrev_b32 v80, 16, v94
    v_and_b32 v81, 0xffff0000, v94
    v_add_f32 v76, v76, v80
    v_add_f32 v77, v77, v81
    v_lshlrev_b32 v80, 16, v95
    v_and_b32 v81, 0xffff0000, v95
    v_add_f32 v78, v78, v80
    v_add_f32 v79, v79, v81
    v_cvt_pk_bf16_f32 v48, v72, v73
    v_cvt_pk_bf16_f32 v49, v74, v75
    v_cvt_pk_bf16_f32 v50, v76, v77
    v_cvt_pk_bf16_f32 v51, v78, v79
    s_nop 1
    v_permlane16_swap_b32 v48, v50
    v_permlane16_swap_b32 v49, v51
    buffer_store_dwordx4 v[48:51], v41, s[36:39], s62 offen offset:0
m_end:
    s_endpgm
m_slow:
    s_waitcnt vmcnt(0) lgkmcnt(0)
    v_mov_b32 v184, 0
    v_mov_b32 v185, 0
    v_mov_b32 v186, 0
    v_mov_b32 v187, 0
    v_mov_b32 v188, 0
    v_mov_b32 v189, 0
    v_mov_b32 v190, 0
    v_mov_b32 v191, 0
    v_mov_b32 v192, 0
    v_mov_b32 v193, 0
    v_mov_b32 v194, 0
    v_mov_b32 v195, 0
    v_mov_b32 v196, 0
    v_mov_b32 v197, 0
    v_mov_b32 v198, 0
    v_mov_b32 v199, 0
    v_mov_b32 v200, 0
    v_mov_b32 v201, 0
    v_mov_b32 v202, 0
    v_mov_b32 v203, 0
    v_mov_b32 v204, 0
    v_mov_b32 v205, 0
    v_mov_b32 v206, 0
    v_mov_b32 v207, 0
    v_mov_b32 v208, 0
    v_mov_b32 v209, 0
    v_mov_b32 v210, 0
    v_mov_b32 v211, 0
    v_mov_b32 v212, 0
    v_mov_b32 v213, 0
    v_mov_b32 v214, 0
    v_mov_b32 v215, 0
    v_mov_b32 v216, 0
    v_mov_b32 v217, 0
    v_mov_b32 v218, 0
    v_mov_b32 v219, 0
    v_mov_b32 v220, 0
    v_mov_b32 v221, 0
    v_mov_b32 v222, 0
    v_mov_b32 v223, 0
    v_mov_b32 v224, 0
    v_mov_b32 v225, 0
    v_mov_b32 v226, 0
    v_mov_b32 v227, 0
    v_mov_b32 v228, 0
    v_mov_b32 v229, 0
    v_mov_b32 v230, 0
    v_mov_b32 v231, 0
    v_mov_b32 v232, 0
    v_mov_b32 v233, 0
    v_mov_b32 v234, 0
    v_mov_b32 v235, 0
    v_mov_b32 v236, 0
    v_mov_b32 v237, 0
    v_mov_b32 v238, 0
    v_mov_b32 v239, 0
    v_mov_b32 v240, 0
    v_mov_b32 v241, 0
    v_mov_b32 v242, 0
    v_mov_b32 v243, 0
    v_mov_b32 v244, 0
    v_mov_b32 v245, 0
    v_mov_b32 v246, 0
    v_mov_b32 v247, 0
    v_mov_b32 v16, 0
    v_mov_b32 v17, 0
    v_mov_b32 v18, 0
    v_mov_b32 v19, 0
    v_mov_b32 v20, 0
    v_mov_b32 v21, 0
    v_mov_b32 v22, 0
    v_mov_b32 v23, 0
    v_mov_b32 v24, 0
    v_mov_b32 v25, 0
    v_mov_b32 v26, 0
    v_mov_b32 v27, 0
    v_mov_b32 v28, 0
    v_mov_b32 v29, 0
    v_mov_b32 v30, 0
    v_mov_b32 v31, 0
    v_mov_b32 v32, 0
    v_mov_b32 v33, 0
    v_mov_b32 v34, 0
    v_mov_b32 v35, 0
    v_mov_b32 v36, 0
    v_mov_b32 v37, 0
    v_mov_b32 v38, 0
    v_mov_b32 v39, 0
    v_mov_b32 v248, v6
    v_mov_b32 v249, v6
    s_mov_b32 s100, 0
m_slow_loop:
    s_lshl_b32 s52, s100, 13
    s_add_u32 s53, s52, 4096
    buffer_load_dwordx4 v[88:91], v1, s[28:31], s52 offen offset:0 sc1
    buffer_load_dwordx4 v[92:95], v1, s[28:31], s52 offen offset:1024 sc1
    buffer_load_dwordx4 v[96:99], v1, s[28:31], s52 offen offset:2048 sc1
    buffer_load_dwordx4 v[100:103], v1, s[28:31], s52 offen offset:3072 sc1
    buffer_load_dwordx4 v[104:107], v1, s[28:31], s53 offen offset:0 sc1
    buffer_load_dwordx4 v[108:111], v1, s[28:31], s53 offen offset:1024 sc1
    buffer_load_dwordx4 v[112:115], v1, s[28:31], s53 offen offset:2048 sc1
    buffer_load_dwordx4 v[116:119], v1, s[28:31], s53 offen offset:3072 sc1
    buffer_load_dwordx4 v[120:123], v1, s[8:11], s52 offen offset:0 sc1
    buffer_load_dwordx4 v[124:127], v1, s[8:11], s52 offen offset:1024 sc1
    buffer_load_dwordx4 v[128:131], v1, s[8:11], s52 offen offset:2048 sc1
    buffer_load_dwordx4 v[132:135], v1, s[8:11], s52 offen offset:3072 sc1
    buffer_load_dwordx4 v[136:139], v1, s[8:11], s53 offen offset:0 sc1
    buffer_load_dwordx4 v[140:143], v1, s[8:11], s53 offen offset:1024 sc1
    buffer_load_dwordx4 v[144:147], v1, s[8:11], s53 offen offset:2048 sc1
    buffer_load_dwordx4 v[148:151], v1, s[8:11], s53 offen offset:3072 sc1
    s_cmp_lg_u32 s100, s59
    s_cbranch_scc1 m_slow_nm
    v_cmp_gt_i32 vcc, 0, v5
    v_mov_b32 v32, v6
    s_nop 0
    v_cndmask_b32 v24, v24, v6, vcc
    v_cndmask_b32 v36, v36, v6, vcc
    v_cmp_gt_i32 vcc, 1, v5
    v_mov_b32 v33, v6
    s_nop 0
    v_cndmask_b32 v25, v25, v6, vcc
    v_cndmask_b32 v37, v37, v6, vcc
    v_cmp_gt_i32 vcc, 2, v5
    v_mov_b32 v34, v6
    s_nop 0
    v_cndmask_b32 v26, v26, v6, vcc
    v_cndmask_b32 v38, v38, v6, vcc
    v_cmp_gt_i32 vcc, 3, v5
    v_mov_b32 v35, v6
    s_nop 0
    v_cndmask_b32 v27, v27, v6, vcc
    v_cndmask_b32 v39, v39, v6, vcc
    s_nop 1
m_slow_nm:
    s_waitcnt vmcnt(0)
    v_mfma_f32_16x16x32_bf16 v[56:59], v[88:91], v[152:155], v[24:27]
    v_mfma_f32_16x16x32_bf16 v[56:59], v[92:95], v[156:159], v[56:59]
    v_mfma_f32_16x16x32_bf16 v[56:59], v[96:99], v[160:163], v[56:59]
    v_mfma_f32_16x16x32_bf16 v[56:59], v[100:103], v[164:167], v[56:59]
    v_mfma_f32_16x16x32_bf16 v[64:67], v[88:91], v[168:171], v[28:31]
    v_mfma_f32_16x16x32_bf16 v[64:67], v[92:95], v[172:175], v[64:67]
    v_mfma_f32_16x16x32_bf16 v[64:67], v[96:99], v[176:179], v[64:67]
    v_mfma_f32_16x16x32_bf16 v[64:67], v[100:103], v[180:183], v[64:67]
    v_mfma_f32_16x16x32_bf16 v[60:63], v[104:107], v[152:155], v[32:35]
    v_mfma_f32_16x16x32_bf16 v[60:63], v[108:111], v[156:159], v[60:63]
    v_mfma_f32_16x16x32_bf16 v[60:63], v[112:115], v[160:163], v[60:63]
    v_mfma_f32_16x16x32_bf16 v[60:63], v[116:119], v[164:167], v[60:63]
    v_mfma_f32_16x16x32_bf16 v[68:71], v[104:107], v[168:171], v[36:39]
    v_mfma_f32_16x16x32_bf16 v[68:71], v[108:111], v[172:175], v[68:71]
    v_mfma_f32_16x16x32_bf16 v[68:71], v[112:115], v[176:179], v[68:71]
    v_mfma_f32_16x16x32_bf16 v[68:71], v[116:119], v[180:183], v[68:71]
    s_nop 7
    v_max3_f32 v250, v56, v57, v58
    v_max3_f32 v250, v250, v59, v60
    v_max3_f32 v250, v250, v61, v62
    v_max_f32 v250, v250, v63
    v_mov_b32 v9, v250
    s_nop 1
    v_permlane16_swap_b32 v250, v9
    v_max_f32 v250, v250, v9
    v_mov_b32 v9, v250
    s_nop 1
    v_permlane32_swap_b32 v250, v9
    v_max_f32 v250, v250, v9
    v_max_f32 v250, v250, v248
    v_sub_f32 v10, v248, v250
    v_exp_f32 v10, v10
    v_mov_b32 v248, v250
    v_sub_f32 v56, v56, v250
    v_sub_f32 v57, v57, v250
    v_sub_f32 v58, v58, v250
    v_sub_f32 v59, v59, v250
    v_sub_f32 v60, v60, v250
    v_sub_f32 v61, v61, v250
    v_sub_f32 v62, v62, v250
    v_sub_f32 v63, v63, v250
    v_exp_f32 v56, v56
    v_exp_f32 v57, v57
    v_exp_f32 v58, v58
    v_exp_f32 v59, v59
    v_exp_f32 v60, v60
    v_exp_f32 v61, v61
    v_exp_f32 v62, v62
    v_exp_f32 v63, v63
    v_mul_f32 v184, v10, v184
    v_mul_f32 v185, v10, v185
    v_mul_f32 v186, v10, v186
    v_mul_f32 v187, v10, v187
    v_mul_f32 v192, v10, v192
    v_mul_f32 v193, v10, v193
    v_mul_f32 v194, v10, v194
    v_mul_f32 v195, v10, v195
    v_mul_f32 v200, v10, v200
    v_mul_f32 v201, v10, v201
    v_mul_f32 v202, v10, v202
    v_mul_f32 v203, v10, v203
    v_mul_f32 v208, v10, v208
    v_mul_f32 v209, v10, v209
    v_mul_f32 v210, v10, v210
    v_mul_f32 v211, v10, v211
    v_mul_f32 v216, v10, v216
    v_mul_f32 v217, v10, v217
    v_mul_f32 v218, v10, v218
    v_mul_f32 v219, v10, v219
    v_mul_f32 v224, v10, v224
    v_mul_f32 v225, v10, v225
    v_mul_f32 v226, v10, v226
    v_mul_f32 v227, v10, v227
    v_mul_f32 v232, v10, v232
    v_mul_f32 v233, v10, v233
    v_mul_f32 v234, v10, v234
    v_mul_f32 v235, v10, v235
    v_mul_f32 v240, v10, v240
    v_mul_f32 v241, v10, v241
    v_mul_f32 v242, v10, v242
    v_mul_f32 v243, v10, v243
    v_mul_f32 v16, v10, v16
    v_mul_f32 v17, v10, v17
    v_mul_f32 v18, v10, v18
    v_mul_f32 v19, v10, v19
    v_cvt_pk_bf16_f32 v40, v56, v57
    v_cvt_pk_bf16_f32 v41, v58, v59
    v_cvt_pk_bf16_f32 v42, v60, v61
    v_cvt_pk_bf16_f32 v43, v62, v63
    v_max3_f32 v251, v64, v65, v66
    v_max3_f32 v251, v251, v67, v68
    v_max3_f32 v251, v251, v69, v70
    v_max_f32 v251, v251, v71
    v_mov_b32 v9, v251
    s_nop 1
    v_permlane16_swap_b32 v251, v9
    v_max_f32 v251, v251, v9
    v_mov_b32 v9, v251
    s_nop 1
    v_permlane32_swap_b32 v251, v9
    v_max_f32 v251, v251, v9
    v_max_f32 v251, v251, v249
    v_sub_f32 v11, v249, v251
    v_exp_f32 v11, v11
    v_mov_b32 v249, v251
    v_sub_f32 v64, v64, v251
    v_sub_f32 v65, v65, v251
    v_sub_f32 v66, v66, v251
    v_sub_f32 v67, v67, v251
    v_sub_f32 v68, v68, v251
    v_sub_f32 v69, v69, v251
    v_sub_f32 v70, v70, v251
    v_sub_f32 v71, v71, v251
    v_exp_f32 v64, v64
    v_exp_f32 v65, v65
    v_exp_f32 v66, v66
    v_exp_f32 v67, v67
    v_exp_f32 v68, v68
    v_exp_f32 v69, v69
    v_exp_f32 v70, v70
    v_exp_f32 v71, v71
    v_mul_f32 v188, v11, v188
    v_mul_f32 v189, v11, v189
    v_mul_f32 v190, v11, v190
    v_mul_f32 v191, v11, v191
    v_mul_f32 v196, v11, v196
    v_mul_f32 v197, v11, v197
    v_mul_f32 v198, v11, v198
    v_mul_f32 v199, v11, v199
    v_mul_f32 v204, v11, v204
    v_mul_f32 v205, v11, v205
    v_mul_f32 v206, v11, v206
    v_mul_f32 v207, v11, v207
    v_mul_f32 v212, v11, v212
    v_mul_f32 v213, v11, v213
    v_mul_f32 v214, v11, v214
    v_mul_f32 v215, v11, v215
    v_mul_f32 v220, v11, v220
    v_mul_f32 v221, v11, v221
    v_mul_f32 v222, v11, v222
    v_mul_f32 v223, v11, v223
    v_mul_f32 v228, v11, v228
    v_mul_f32 v229, v11, v229
    v_mul_f32 v230, v11, v230
    v_mul_f32 v231, v11, v231
    v_mul_f32 v236, v11, v236
    v_mul_f32 v237, v11, v237
    v_mul_f32 v238, v11, v238
    v_mul_f32 v239, v11, v239
    v_mul_f32 v244, v11, v244
    v_mul_f32 v245, v11, v245
    v_mul_f32 v246, v11, v246
    v_mul_f32 v247, v11, v247
    v_mul_f32 v20, v11, v20
    v_mul_f32 v21, v11, v21
    v_mul_f32 v22, v11, v22
    v_mul_f32 v23, v11, v23
    v_cvt_pk_bf16_f32 v44, v64, v65
    v_cvt_pk_bf16_f32 v45, v66, v67
    v_cvt_pk_bf16_f32 v46, v68, v69
    v_cvt_pk_bf16_f32 v47, v70, v71
    s_nop 1
    v_mfma_f32_16x16x32_bf16 v[184:187], v[120:123], v[40:43], v[184:187]
    v_mfma_f32_16x16x32_bf16 v[188:191], v[120:123], v[44:47], v[188:191]
    v_mfma_f32_16x16x32_bf16 v[192:195], v[124:127], v[40:43], v[192:195]
    v_mfma_f32_16x16x32_bf16 v[196:199], v[124:127], v[44:47], v[196:199]
    v_mfma_f32_16x16x32_bf16 v[200:203], v[128:131], v[40:43], v[200:203]
    v_mfma_f32_16x16x32_bf16 v[204:207], v[128:131], v[44:47], v[204:207]
    v_mfma_f32_16x16x32_bf16 v[208:211], v[132:135], v[40:43], v[208:211]
    v_mfma_f32_16x16x32_bf16 v[212:215], v[132:135], v[44:47], v[212:215]
    v_mfma_f32_16x16x32_bf16 v[216:219], v[136:139], v[40:43], v[216:219]
    v_mfma_f32_16x16x32_bf16 v[220:223], v[136:139], v[44:47], v[220:223]
    v_mfma_f32_16x16x32_bf16 v[224:227], v[140:143], v[40:43], v[224:227]
    v_mfma_f32_16x16x32_bf16 v[228:231], v[140:143], v[44:47], v[228:231]
    v_mfma_f32_16x16x32_bf16 v[232:235], v[144:147], v[40:43], v[232:235]
    v_mfma_f32_16x16x32_bf16 v[236:239], v[144:147], v[44:47], v[236:239]
    v_mfma_f32_16x16x32_bf16 v[240:243], v[148:151], v[40:43], v[240:243]
    v_mfma_f32_16x16x32_bf16 v[244:247], v[148:151], v[44:47], v[244:247]
    v_mfma_f32_16x16x32_bf16 v[16:19], v[12:15], v[40:43], v[16:19]
    v_mfma_f32_16x16x32_bf16 v[20:23], v[12:15], v[44:47], v[20:23]
    s_nop 7
    s_add_u32 s100, s100, 1
    s_cmp_le_u32 s100, s59
    s_cbranch_scc1 m_slow_loop
    s_branch m_store
m_code_end:
.section .rodata,"a"
.p2align 6
.amdhsa_kernel concat_heads__compressed_kv_cla__sliding_block__prompt_kernel
  .amdhsa_next_free_vgpr 256
  .amdhsa_next_free_sgpr 102
  .amdhsa_accum_offset 256
  .amdhsa_group_segment_fixed_size 0
  .amdhsa_kernarg_size 96
  .amdhsa_user_sgpr_count 2
  .amdhsa_user_sgpr_kernarg_segment_ptr 1
  .amdhsa_system_sgpr_workgroup_id_x 1
.end_amdhsa_kernel
```
